```python
import torch

def _softmax(x, axis=-1):
    return torch.softmax(x, dim=axis)
def _gelu(x):
    return torch.nn.functional.gelu(x, approximate="tanh")
def _silu(x):
    return torch.nn.functional.silu(x)
def _sigmoid(x):
    return torch.sigmoid(x)
def _layernorm(x, axis=-1, eps=1e-5):
    m = x.mean(dim=axis, keepdim=True)
    v = x.var(dim=axis, keepdim=True, unbiased=False)
    return (x - m) / torch.sqrt(v + eps)
def _scatter_add(tgt, idx, src, axis=0):
    return tgt.clone().index_add_(axis, idx, src)
def _segment_sum(src, seg, n):
    out = torch.zeros((n,) + src.shape[1:], dtype=src.dtype)
    return out.index_add_(0, seg, src)
def _pad(x, pw):
    flat = tuple(v for pair in reversed(pw) for v in pair)
    return torch.nn.functional.pad(x, flat)

kernel_name = 'standalone__mha_block_cached__near_ridge'

def setup_inputs():

    _w = (lambda a: (lambda t: t.to(torch.bfloat16) if t.is_floating_point() else t)(torch.as_tensor(a)))
    B, Sq, D = 16, 112, 640
    H, Sk, Dh = 32, 512, 192
    return {
        "x": _w((lambda *s: torch.randn(*s, dtype=torch.bfloat16) * 0.8)(B, Sq, D)),
        "k_cache": _w((lambda *s: torch.randn(*s, dtype=torch.bfloat16) * 0.8)(B, H, Sk, Dh)),
        "v_cache": _w((lambda *s: torch.randn(*s, dtype=torch.bfloat16) * 0.05)(B, H, Sk, Dh)),
        "wq": _w((lambda *s: torch.randn(*s, dtype=torch.bfloat16) * 0.8)(D, H * Dh) * (D ** -0.5)),
        "wo": _w((lambda *s: torch.randn(*s, dtype=torch.bfloat16) * 0.05)(H * Dh, D) * ((H * Dh) ** -0.5)),
    }

def reference(x, k_cache, v_cache, wq, wo):
    B, Sq, D = x.shape
    H, Dh = 32, 192
    q = (lambda x, *d: x.permute(*d))((x @ wq).reshape(B, Sq, H, Dh), 0, 2, 1, 3)
    scores = torch.einsum("bhqd,bhkd->bhqk", q, k_cache) * (Dh ** -0.5)
    p = _softmax(scores, axis=-1)
    o = torch.einsum("bhqk,bhkd->bhqd", p, v_cache)
    return (lambda x, *d: x.permute(*d))(o, 0, 2, 1, 3).reshape(B, Sq, H * Dh) @ wo
```

```asm
; @launch grid=(256,1,1) block=(512,1,1) lds=163840
.amdgcn_target "amdgcn-amd-amdhsa--gfx950"
.text
.globl standalone__mha_block_cached__near_ridge_kernel
.p2align 8
.type standalone__mha_block_cached__near_ridge_kernel,@function
standalone__mha_block_cached__near_ridge_kernel:
    s_cmp_ge_u32 s2, 256
    s_cbranch_scc1 L_end
    s_load_dwordx8 s[4:11], s[0:1], 0
    s_load_dwordx2 s[12:13], s[0:1], 32
    s_load_dwordx2 s[14:15], s[0:1], 56
    v_readfirstlane_b32 s40, v0
    v_and_b32 v236, 63, v0
    s_lshr_b32 s40, s40, 6
    s_lshr_b32 s41, s40, 2
    s_and_b32 s42, s40, 3
    s_and_b32 s66, s2, 7
    s_lshr_b32 s67, s2, 3
    s_lshr_b32 s43, s67, 1
    s_and_b32 s67, s67, 1
    s_lshl_b32 s44, s66, 1
    s_add_u32 s44, s44, s67
    s_mul_i32 s65, s67, 5
    s_add_u32 s65, s65, s66
    s_mul_i32 s45, s42, 3072
    s_cmp_lg_u32 s41, 0
    s_cbranch_scc1 L_npf
    s_getpc_b64 s[70:71]
L_pc:
    s_and_b32 s67, s43, 7
    s_lshl_b32 s67, s67, 2
    s_add_u32 s67, s67, s42
    s_mul_i32 s67, s67, CODE_SHARE-0
    v_lshlrev_b32 v241, 7, v236
    v_min_u32 v241, CODE_SHARE-128, v241
    v_add_u32 v241, s67, v241
    v_min_u32 v241, CODE_LAST-0, v241
    global_load_dword v144, v241, s[70:71]
L_npf:
    s_cmp_eq_u32 s42, 3
    s_cselect_b32 s47, 0, 2048
    s_cselect_b32 s48, 0, 20480
    s_lshl_b32 s46, s42, 12
    s_add_u32 s46, s46, 135168
    s_add_u32 s47, s47, s46
    s_mul_i32 s66, s42, 40960
    v_lshrrev_b32 v240, 3, v236
    v_lshrrev_b32 v237, 4, v236
    v_and_b32 v242, 7, v236
    v_xor_b32 v241, v237, v242
    v_mul_u32_u24 v240, 1280, v240
    v_add_u32 v240, s66, v240
    v_lshl_add_u32 v219, v241, 4, v240
    v_xor_b32 v241, 4, v241
    v_lshl_add_u32 v220, v241, 4, v240
    v_add_u32 v220, 9216, v220
    s_lshl_b32 s66, s42, 3
    s_and_b32 s68, s42, 1
    s_lshl_b32 s68, s68, 2
    v_add_u32 v240, 0, v236
    v_mul_u32_u24 v241, 171, v240
    v_lshrrev_b32 v241, 12, v241
    v_mul_u32_u24 v242, 24, v241
    v_sub_u32 v213, v240, v242
    v_add_u32 v210, s66, v241
    v_and_or_b32 v243, v241, 2, s68
    v_xor_b32 v243, v213, v243
    v_mul_u32_u24 v244, 12288, v210
    v_lshl_add_u32 v243, v243, 4, v244
    v_subrev_u32 v216, 0, v243
    v_add_u32 v240, 64, v236
    v_mul_u32_u24 v241, 171, v240
    v_lshrrev_b32 v241, 12, v241
    v_mul_u32_u24 v242, 24, v241
    v_sub_u32 v214, v240, v242
    v_add_u32 v211, s66, v241
    v_and_or_b32 v243, v241, 2, s68
    v_xor_b32 v243, v214, v243
    v_mul_u32_u24 v244, 12288, v211
    v_lshl_add_u32 v243, v243, 4, v244
    v_subrev_u32 v217, 1024, v243
    v_add_u32 v240, 128, v236
    v_mul_u32_u24 v241, 171, v240
    v_lshrrev_b32 v241, 12, v241
    v_mul_u32_u24 v242, 24, v241
    v_sub_u32 v215, v240, v242
    v_add_u32 v212, s66, v241
    v_and_or_b32 v243, v241, 2, s68
    v_xor_b32 v243, v215, v243
    v_mul_u32_u24 v244, 12288, v212
    v_lshl_add_u32 v243, v243, 4, v244
    v_subrev_u32 v218, 2048, v243
    s_mul_i32 s66, s43, 143360
    s_and_b32 s73, s44, 3
    s_lshr_b32 s73, 3, s73
    s_and_b32 s73, s73, 1
    s_lshl_b32 s67, s44, 1
    s_add_u32 s67, s67, s73
    s_mul_i32 s67, s67, 384
    s_mov_b32 s18, 143360
    s_mov_b32 s19, 0x20000
    s_sub_u32 s30, 7864320, s67
    s_mov_b32 s31, 0x20000
    s_mov_b32 s51, s65
    s_mov_b32 s50, s43
    s_add_u32 s51, s51, s50
    s_mul_i32 s50, s51, 205
    s_lshr_b32 s50, s50, 11
    s_mul_i32 s50, s50, 10
    s_sub_u32 s51, s51, s50
    s_mul_i32 s50, s51, 786432
    s_lshl_b32 s51, s51, 7
    s_waitcnt lgkmcnt(0)
    s_add_u32 s16, s4, s66
    s_addc_u32 s17, s5, 0
    s_add_u32 s28, s10, s67
    s_addc_u32 s29, s11, 0
    s_cmp_eq_u32 s41, 0
    s_cbranch_scc1 L_p0
    s_add_u32 m0, s46, 0
    s_add_u32 s67, s51, s48
    buffer_load_dwordx4 v219, s[16:19], s51 offen lds
    buffer_load_dwordx4 v220, s[16:19], s51 offen offset:1024 lds
    s_add_u32 m0, s47, 0
    s_add_u32 s51, s51, 128
    buffer_load_dwordx4 v219, s[16:19], s67 offen lds
    buffer_load_dwordx4 v220, s[16:19], s67 offen offset:1024 lds
    s_cmp_ge_u32 s51, 1280
    s_cselect_b32 s51, 0, s51
    s_add_u32 m0, s45, 86016
    s_nop 0
    buffer_load_dwordx4 v216, s[28:31], s50 offen lds
    buffer_load_dwordx4 v217, s[28:31], s50 offen offset:1024 lds
    buffer_load_dwordx4 v218, s[28:31], s50 offen offset:2048 lds
    s_add_u32 s50, s50, 393216
    s_add_u32 m0, s45, 98304
    s_nop 0
    buffer_load_dwordx4 v216, s[28:31], s50 offen lds
    buffer_load_dwordx4 v217, s[28:31], s50 offen offset:1024 lds
    buffer_load_dwordx4 v218, s[28:31], s50 offen offset:2048 lds
    s_add_u32 s50, s50, 393216
    s_cmp_ge_u32 s50, 7864320
    s_cselect_b32 s50, 0, s50
    s_branch L_p1
L_p0:
L_p1:
    s_lshl_b32 s66, s43, 4
    s_add_u32 s66, s66, s44
    s_mul_i32 s67, s66, 393216
    s_add_u32 s20, s6, s67
    s_addc_u32 s21, s7, 0
    s_mov_b32 s22, 393216
    s_mov_b32 s23, 0x20000
    s_add_u32 s24, s8, s67
    s_addc_u32 s25, s9, 0
    s_mov_b32 s26, 393216
    s_mov_b32 s27, 0x20000
    s_mul_i32 s67, s66, 168192
    s_add_u32 s36, s14, s67
    s_addc_u32 s37, s15, 0
    s_mov_b32 s38, 163840
    s_mov_b32 s39, 0x20000
    s_mov_b32 s32, s12
    s_mov_b32 s33, s13
    s_mov_b32 s34, 7864320
    s_mov_b32 s35, 0x20000
    s_load_dwordx4 s[4:7], s[0:1], 40
    s_lshl_b32 s60, s44, 1
    s_add_u32 s60, s60, s73
    s_xor_b32 s70, s60, 1
    s_mul_i32 s60, s60, 245760
    s_mul_i32 s70, s70, 245760
    s_lshl_b32 s73, s73, 4
    s_xor_b32 s74, s73, 16
    s_mul_i32 s65, s43, 5
    s_lshr_b32 s65, s65, 3
    s_mul_i32 s59, s42, 6144
    s_min_u32 s62, s42, 1
    s_add_u32 s62, s62, s42
    s_cmp_eq_u32 s42, 3
    s_cselect_b32 s62, 6, s62
    s_mul_i32 s62, s62, 12288
    s_lshl_b32 s61, s42, 11
    s_add_u32 s72, s61, 1024
    s_cmp_eq_u32 s42, 3
    s_cselect_b32 s72, 0x40000000, s72
    s_lshl_b32 s67, s42, 1
    v_mul_u32_u24 v244, 384, v210
    v_subrev_u32 v244, 0, v244
    v_bfe_u32 v243, v210, 1, 1
    v_or_b32 v243, s67, v243
    v_and_or_b32 v242, v210, 2, s68
    v_xor_b32 v243, v213, v243
    v_xor_b32 v242, v213, v242
    v_lshl_add_u32 v210, v243, 4, v244
    v_lshl_add_u32 v213, v242, 4, v244
    v_mul_u32_u24 v244, 384, v211
    v_subrev_u32 v244, 1024, v244
    v_bfe_u32 v243, v211, 1, 1
    v_or_b32 v243, s67, v243
    v_and_or_b32 v242, v211, 2, s68
    v_xor_b32 v243, v214, v243
    v_xor_b32 v242, v214, v242
    v_lshl_add_u32 v211, v243, 4, v244
    v_lshl_add_u32 v214, v242, 4, v244
    v_mul_u32_u24 v244, 384, v212
    v_subrev_u32 v244, 2048, v244
    v_bfe_u32 v243, v212, 1, 1
    v_or_b32 v243, s67, v243
    v_and_or_b32 v242, v212, 2, s68
    v_xor_b32 v243, v215, v243
    v_xor_b32 v242, v215, v242
    v_lshl_add_u32 v212, v243, 4, v244
    v_lshl_add_u32 v215, v242, 4, v244
    v_and_b32 v238, 15, v236
    v_lshrrev_b32 v240, 2, v238
    v_and_b32 v243, 3, v238
    v_lshl_add_u32 v241, v240, 3, v243
    v_mul_u32_u24 v241, 384, v241
    v_lshrrev_b32 v242, 1, v238
    v_xor_b32 v242, v242, v237
    v_lshl_add_u32 v204, v242, 4, v241
    v_lshlrev_b32 v241, 7, v238
    v_add_u32 v241, s46, v241
    v_lshl_add_u32 v196, v242, 4, v241
    v_xor_b32 v197, 64, v196
    v_bfe_u32 v239, v236, 3, 2
    v_lshlrev_b32 v239, 5, v239
    v_lshl_add_u32 v239, v243, 3, v239
    v_lshl_add_u32 v241, v237, 3, v240
    v_mul_u32_u24 v241, 384, v241
    v_add_u32 v224, v241, v239
    v_add_u32 v192, 86016, v224
    v_xor_b32 v193, 32, v192
    v_xor_b32 v194, 64, v192
    v_xor_b32 v195, 96, v192
    v_lshl_add_u32 v241, v237, 2, v240
    v_lshl_add_u32 v249, v241, 7, v239
    s_mul_i32 s66, s42, 61440
    v_lshrrev_b32 v240, 3, v236
    v_mul_u32_u24 v240, 1280, v240
    v_and_b32 v241, 7, v236
    v_lshlrev_b32 v242, 1, v237
    v_xor_b32 v241, v241, v242
    v_lshlrev_b32 v241, 4, v241
    v_add3_u32 v248, v240, v241, s66
    v_lshlrev_b32 v251, 4, v236
    s_mov_b32 s56, 0x3dd53b95
    s_mov_b32 s57, 0x41000000
    v_mov_b32 v200, 0x3f803f80
    v_mov_b32 v201, 0x3f803f80
    v_mov_b32 v202, 0x3f803f80
    v_mov_b32 v203, 0x3f803f80
    s_mov_b32 s58, 0
    s_mul_i32 s52, s41, 49152
    s_mov_b32 s53, 61440
    s_mov_b32 s54, 3
    s_mov_b32 s55, 1
    s_add_u32 s63, s43, s44
    v_mov_b32 v0, 0
    v_mov_b32 v1, 0
    v_mov_b32 v2, 0
    v_mov_b32 v3, 0
    v_mov_b32 v4, 0
    v_mov_b32 v5, 0
    v_mov_b32 v6, 0
    v_mov_b32 v7, 0
    v_mov_b32 v8, 0
    v_mov_b32 v9, 0
    v_mov_b32 v10, 0
    v_mov_b32 v11, 0
    v_mov_b32 v12, 0
    v_mov_b32 v13, 0
    v_mov_b32 v14, 0
    v_mov_b32 v15, 0
    v_mov_b32 v16, 0
    v_mov_b32 v17, 0
    v_mov_b32 v18, 0
    v_mov_b32 v19, 0
    v_mov_b32 v20, 0
    v_mov_b32 v21, 0
    v_mov_b32 v22, 0
    v_mov_b32 v23, 0
    v_mov_b32 v24, 0
    v_mov_b32 v25, 0
    v_mov_b32 v26, 0
    v_mov_b32 v27, 0
    v_mov_b32 v28, 0
    v_mov_b32 v29, 0
    v_mov_b32 v30, 0
    v_mov_b32 v31, 0
    v_mov_b32 v32, 0
    v_mov_b32 v33, 0
    v_mov_b32 v34, 0
    v_mov_b32 v35, 0
    v_mov_b32 v36, 0
    v_mov_b32 v37, 0
    v_mov_b32 v38, 0
    v_mov_b32 v39, 0
    v_mov_b32 v40, 0
    v_mov_b32 v41, 0
    v_mov_b32 v42, 0
    v_mov_b32 v43, 0
    v_mov_b32 v44, 0
    v_mov_b32 v45, 0
    v_mov_b32 v46, 0
    v_mov_b32 v47, 0
    v_mov_b32 v48, 0
    v_mov_b32 v49, 0
    v_mov_b32 v50, 0
    v_mov_b32 v51, 0
    v_mov_b32 v52, 0
    v_mov_b32 v53, 0
    v_mov_b32 v54, 0
    v_mov_b32 v55, 0
    v_mov_b32 v56, 0
    v_mov_b32 v57, 0
    v_mov_b32 v58, 0
    v_mov_b32 v59, 0
    v_mov_b32 v60, 0
    v_mov_b32 v61, 0
    v_mov_b32 v62, 0
    v_mov_b32 v63, 0
    v_mov_b32 v64, 0
    v_mov_b32 v65, 0
    v_mov_b32 v66, 0
    v_mov_b32 v67, 0
    v_mov_b32 v68, 0
    v_mov_b32 v69, 0
    v_mov_b32 v70, 0
    v_mov_b32 v71, 0
    v_mov_b32 v72, 0
    v_mov_b32 v73, 0
    v_mov_b32 v74, 0
    v_mov_b32 v75, 0
    v_mov_b32 v76, 0
    v_mov_b32 v77, 0
    v_mov_b32 v78, 0
    v_mov_b32 v79, 0
    v_mov_b32 v80, 0
    v_mov_b32 v81, 0
    v_mov_b32 v82, 0
    v_mov_b32 v83, 0
    v_mov_b32 v84, 0
    v_mov_b32 v85, 0
    v_mov_b32 v86, 0
    v_mov_b32 v87, 0
    v_mov_b32 v88, 0
    v_mov_b32 v89, 0
    v_mov_b32 v90, 0
    v_mov_b32 v91, 0
    v_mov_b32 v92, 0
    v_mov_b32 v93, 0
    v_mov_b32 v94, 0
    v_mov_b32 v95, 0
    v_mov_b32 v120, 0
    v_mov_b32 v121, 0
    v_mov_b32 v122, 0
    v_mov_b32 v123, 0
    v_mov_b32 v124, 0
    v_mov_b32 v125, 0
    v_mov_b32 v126, 0
    v_mov_b32 v127, 0
    v_mov_b32 v180, 0
    v_mov_b32 v181, 0
    v_mov_b32 v182, 0
    v_mov_b32 v183, 0
    v_mov_b32 v184, 0
    v_mov_b32 v185, 0
    v_mov_b32 v186, 0
    v_mov_b32 v187, 0
    v_mov_b32 v188, 0
    v_mov_b32 v189, 0
    v_mov_b32 v190, 0
    v_mov_b32 v191, 0
    s_mov_b32 s49, 0
    s_waitcnt lgkmcnt(0)
    v_mov_b32 v162, 0
    s_mov_b32 s38, 168192
    s_cmp_eq_u32 s42, 3
    s_cbranch_scc1 L_light
    s_cmp_eq_u32 s41, 0
    s_cbranch_scc0 L_g2a
    s_barrier
    ds_read_b128 v[96:99], v196
    ds_read_b128 v[100:103], v196 offset:2048
    ds_read_b128 v[104:107], v197
    ds_read_b128 v[108:111], v197 offset:2048
L_qloop:
    s_waitcnt lgkmcnt(0)
    s_barrier
    ds_read_b64_tr_b16 v[168:169], v192
    ds_read_b64_tr_b16 v[170:171], v192 offset:1536
    ds_read_b64_tr_b16 v[172:173], v193
    ds_read_b64_tr_b16 v[174:175], v193 offset:1536
    v_mfma_f32_16x16x32_bf16 v[36:39], v[180:183], v[120:123], v[36:39]
    ds_read_b64_tr_b16 v[176:177], v194
    v_mfma_f32_16x16x32_bf16 v[84:87], v[180:183], v[124:127], v[84:87]
    ds_read_b64_tr_b16 v[178:179], v194 offset:1536
    v_mfma_f32_16x16x32_bf16 v[40:43], v[184:187], v[120:123], v[40:43]
    ds_read_b64_tr_b16 v[180:181], v195
    v_mfma_f32_16x16x32_bf16 v[88:91], v[184:187], v[124:127], v[88:91]
    ds_read_b64_tr_b16 v[182:183], v195 offset:1536
    v_mfma_f32_16x16x32_bf16 v[44:47], v[188:191], v[120:123], v[44:47]
    ds_read_b64_tr_b16 v[184:185], v192 offset:128
    v_mfma_f32_16x16x32_bf16 v[92:95], v[188:191], v[124:127], v[92:95]
    ds_read_b64_tr_b16 v[186:187], v192 offset:1664
    s_waitcnt lgkmcnt(6)
    v_mfma_f32_16x16x32_bf16 v[0:3], v[168:171], v[96:99], v[0:3]
    ds_read_b64_tr_b16 v[188:189], v193 offset:128
    v_mfma_f32_16x16x32_bf16 v[48:51], v[168:171], v[100:103], v[48:51]
    ds_read_b64_tr_b16 v[190:191], v193 offset:1664
    v_mfma_f32_16x16x32_bf16 v[4:7], v[172:175], v[96:99], v[4:7]
    ds_read_b64_tr_b16 v[168:169], v194 offset:128
    v_mfma_f32_16x16x32_bf16 v[52:55], v[172:175], v[100:103], v[52:55]
    ds_read_b64_tr_b16 v[170:171], v194 offset:1664
    s_waitcnt lgkmcnt(6)
    v_mfma_f32_16x16x32_bf16 v[8:11], v[176:179], v[96:99], v[8:11]
    ds_read_b64_tr_b16 v[172:173], v195 offset:128
    v_mfma_f32_16x16x32_bf16 v[56:59], v[176:179], v[100:103], v[56:59]
    ds_read_b64_tr_b16 v[174:175], v195 offset:1664
    v_mfma_f32_16x16x32_bf16 v[12:15], v[180:183], v[96:99], v[12:15]
    ds_read_b64_tr_b16 v[176:177], v192 offset:256
    v_mfma_f32_16x16x32_bf16 v[60:63], v[180:183], v[100:103], v[60:63]
    ds_read_b64_tr_b16 v[178:179], v192 offset:1792
    s_waitcnt lgkmcnt(6)
    v_mfma_f32_16x16x32_bf16 v[16:19], v[184:187], v[96:99], v[16:19]
    ds_read_b64_tr_b16 v[180:181], v193 offset:256
    v_mfma_f32_16x16x32_bf16 v[64:67], v[184:187], v[100:103], v[64:67]
    ds_read_b64_tr_b16 v[182:183], v193 offset:1792
    v_mfma_f32_16x16x32_bf16 v[20:23], v[188:191], v[96:99], v[20:23]
    ds_read_b64_tr_b16 v[184:185], v194 offset:256
    v_mfma_f32_16x16x32_bf16 v[68:71], v[188:191], v[100:103], v[68:71]
    ds_read_b64_tr_b16 v[186:187], v194 offset:1792
    s_waitcnt lgkmcnt(6)
    v_mfma_f32_16x16x32_bf16 v[24:27], v[168:171], v[96:99], v[24:27]
    ds_read_b64_tr_b16 v[188:189], v195 offset:256
    v_mfma_f32_16x16x32_bf16 v[72:75], v[168:171], v[100:103], v[72:75]
    ds_read_b64_tr_b16 v[190:191], v195 offset:1792
    v_mfma_f32_16x16x32_bf16 v[28:31], v[172:175], v[96:99], v[28:31]
    v_mfma_f32_16x16x32_bf16 v[76:79], v[172:175], v[100:103], v[76:79]
    s_waitcnt lgkmcnt(6)
    v_mfma_f32_16x16x32_bf16 v[32:35], v[176:179], v[96:99], v[32:35]
    v_mfma_f32_16x16x32_bf16 v[80:83], v[176:179], v[100:103], v[80:83]
    s_waitcnt lgkmcnt(0)
    s_barrier
    ds_read_b64_tr_b16 v[168:169], v192 offset:12288
    ds_read_b64_tr_b16 v[170:171], v192 offset:13824
    ds_read_b64_tr_b16 v[172:173], v193 offset:12288
    ds_read_b64_tr_b16 v[174:175], v193 offset:13824
    v_mfma_f32_16x16x32_bf16 v[36:39], v[180:183], v[96:99], v[36:39]
    ds_read_b64_tr_b16 v[176:177], v194 offset:12288
    v_mfma_f32_16x16x32_bf16 v[84:87], v[180:183], v[100:103], v[84:87]
    ds_read_b64_tr_b16 v[178:179], v194 offset:13824
    v_mfma_f32_16x16x32_bf16 v[40:43], v[184:187], v[96:99], v[40:43]
    ds_read_b64_tr_b16 v[180:181], v195 offset:12288
    v_mfma_f32_16x16x32_bf16 v[88:91], v[184:187], v[100:103], v[88:91]
    ds_read_b64_tr_b16 v[182:183], v195 offset:13824
    v_mfma_f32_16x16x32_bf16 v[44:47], v[188:191], v[96:99], v[44:47]
    ds_read_b64_tr_b16 v[184:185], v192 offset:12416
    v_mfma_f32_16x16x32_bf16 v[92:95], v[188:191], v[100:103], v[92:95]
    ds_read_b64_tr_b16 v[186:187], v192 offset:13952
    s_waitcnt lgkmcnt(6)
    v_mfma_f32_16x16x32_bf16 v[0:3], v[168:171], v[104:107], v[0:3]
    ds_read_b64_tr_b16 v[188:189], v193 offset:12416
    v_mfma_f32_16x16x32_bf16 v[48:51], v[168:171], v[108:111], v[48:51]
    ds_read_b64_tr_b16 v[190:191], v193 offset:13952
    v_mfma_f32_16x16x32_bf16 v[4:7], v[172:175], v[104:107], v[4:7]
    ds_read_b64_tr_b16 v[168:169], v194 offset:12416
    v_mfma_f32_16x16x32_bf16 v[52:55], v[172:175], v[108:111], v[52:55]
    ds_read_b64_tr_b16 v[170:171], v194 offset:13952
    s_waitcnt lgkmcnt(6)
    v_mfma_f32_16x16x32_bf16 v[8:11], v[176:179], v[104:107], v[8:11]
    ds_read_b64_tr_b16 v[172:173], v195 offset:12416
    v_mfma_f32_16x16x32_bf16 v[56:59], v[176:179], v[108:111], v[56:59]
    ds_read_b64_tr_b16 v[174:175], v195 offset:13952
    ds_read_b128 v[112:115], v196 offset:14336
    v_mfma_f32_16x16x32_bf16 v[12:15], v[180:183], v[104:107], v[12:15]
    ds_read_b64_tr_b16 v[176:177], v192 offset:12544
    v_mfma_f32_16x16x32_bf16 v[60:63], v[180:183], v[108:111], v[60:63]
    ds_read_b64_tr_b16 v[178:179], v192 offset:14080
    ds_read_b128 v[116:119], v196 offset:16384
    s_waitcnt lgkmcnt(8)
    v_mfma_f32_16x16x32_bf16 v[16:19], v[184:187], v[104:107], v[16:19]
    ds_read_b64_tr_b16 v[180:181], v193 offset:12544
    v_mfma_f32_16x16x32_bf16 v[64:67], v[184:187], v[108:111], v[64:67]
    ds_read_b64_tr_b16 v[182:183], v193 offset:14080
    ds_read_b128 v[120:123], v197 offset:14336
    v_mfma_f32_16x16x32_bf16 v[20:23], v[188:191], v[104:107], v[20:23]
    ds_read_b64_tr_b16 v[184:185], v194 offset:12544
    v_mfma_f32_16x16x32_bf16 v[68:71], v[188:191], v[108:111], v[68:71]
    ds_read_b64_tr_b16 v[186:187], v194 offset:14080
    ds_read_b128 v[124:127], v197 offset:16384
    s_waitcnt lgkmcnt(10)
    v_mfma_f32_16x16x32_bf16 v[24:27], v[168:171], v[104:107], v[24:27]
    ds_read_b64_tr_b16 v[188:189], v195 offset:12544
    v_mfma_f32_16x16x32_bf16 v[72:75], v[168:171], v[108:111], v[72:75]
    ds_read_b64_tr_b16 v[190:191], v195 offset:14080
    v_mfma_f32_16x16x32_bf16 v[28:31], v[172:175], v[104:107], v[28:31]
    v_mfma_f32_16x16x32_bf16 v[76:79], v[172:175], v[108:111], v[76:79]
    s_waitcnt lgkmcnt(9)
    v_mfma_f32_16x16x32_bf16 v[32:35], v[176:179], v[104:107], v[32:35]
    v_mfma_f32_16x16x32_bf16 v[80:83], v[176:179], v[108:111], v[80:83]
    s_waitcnt lgkmcnt(0)
    s_barrier
    ds_read_b64_tr_b16 v[168:169], v192 offset:24576
    ds_read_b64_tr_b16 v[170:171], v192 offset:26112
    ds_read_b64_tr_b16 v[172:173], v193 offset:24576
    ds_read_b64_tr_b16 v[174:175], v193 offset:26112
    v_mfma_f32_16x16x32_bf16 v[36:39], v[180:183], v[104:107], v[36:39]
    ds_read_b64_tr_b16 v[176:177], v194 offset:24576
    v_mfma_f32_16x16x32_bf16 v[84:87], v[180:183], v[108:111], v[84:87]
    ds_read_b64_tr_b16 v[178:179], v194 offset:26112
    v_mfma_f32_16x16x32_bf16 v[40:43], v[184:187], v[104:107], v[40:43]
    ds_read_b64_tr_b16 v[180:181], v195 offset:24576
    v_mfma_f32_16x16x32_bf16 v[88:91], v[184:187], v[108:111], v[88:91]
    ds_read_b64_tr_b16 v[182:183], v195 offset:26112
    v_mfma_f32_16x16x32_bf16 v[44:47], v[188:191], v[104:107], v[44:47]
    ds_read_b64_tr_b16 v[184:185], v192 offset:24704
    v_mfma_f32_16x16x32_bf16 v[92:95], v[188:191], v[108:111], v[92:95]
    ds_read_b64_tr_b16 v[186:187], v192 offset:26240
    s_waitcnt lgkmcnt(6)
    v_mfma_f32_16x16x32_bf16 v[0:3], v[168:171], v[112:115], v[0:3]
    ds_read_b64_tr_b16 v[188:189], v193 offset:24704
    v_mfma_f32_16x16x32_bf16 v[48:51], v[168:171], v[116:119], v[48:51]
    ds_read_b64_tr_b16 v[190:191], v193 offset:26240
    v_mfma_f32_16x16x32_bf16 v[4:7], v[172:175], v[112:115], v[4:7]
    ds_read_b64_tr_b16 v[168:169], v194 offset:24704
    v_mfma_f32_16x16x32_bf16 v[52:55], v[172:175], v[116:119], v[52:55]
    ds_read_b64_tr_b16 v[170:171], v194 offset:26240
    s_waitcnt lgkmcnt(6)
    v_mfma_f32_16x16x32_bf16 v[8:11], v[176:179], v[112:115], v[8:11]
    ds_read_b64_tr_b16 v[172:173], v195 offset:24704
    v_mfma_f32_16x16x32_bf16 v[56:59], v[176:179], v[116:119], v[56:59]
    ds_read_b64_tr_b16 v[174:175], v195 offset:26240
    v_mfma_f32_16x16x32_bf16 v[12:15], v[180:183], v[112:115], v[12:15]
    ds_read_b64_tr_b16 v[176:177], v192 offset:24832
    v_mfma_f32_16x16x32_bf16 v[60:63], v[180:183], v[116:119], v[60:63]
    ds_read_b64_tr_b16 v[178:179], v192 offset:26368
    s_waitcnt lgkmcnt(6)
    v_mfma_f32_16x16x32_bf16 v[16:19], v[184:187], v[112:115], v[16:19]
    ds_read_b64_tr_b16 v[180:181], v193 offset:24832
    v_mfma_f32_16x16x32_bf16 v[64:67], v[184:187], v[116:119], v[64:67]
    ds_read_b64_tr_b16 v[182:183], v193 offset:26368
    v_mfma_f32_16x16x32_bf16 v[20:23], v[188:191], v[112:115], v[20:23]
    ds_read_b64_tr_b16 v[184:185], v194 offset:24832
    v_mfma_f32_16x16x32_bf16 v[68:71], v[188:191], v[116:119], v[68:71]
    ds_read_b64_tr_b16 v[186:187], v194 offset:26368
    s_waitcnt lgkmcnt(6)
    v_mfma_f32_16x16x32_bf16 v[24:27], v[168:171], v[112:115], v[24:27]
    ds_read_b64_tr_b16 v[188:189], v195 offset:24832
    v_mfma_f32_16x16x32_bf16 v[72:75], v[168:171], v[116:119], v[72:75]
    ds_read_b64_tr_b16 v[190:191], v195 offset:26368
    v_mfma_f32_16x16x32_bf16 v[28:31], v[172:175], v[112:115], v[28:31]
    v_mfma_f32_16x16x32_bf16 v[76:79], v[172:175], v[116:119], v[76:79]
    s_cmp_lg_u32 s49, 1
    s_cbranch_scc1 L_nbl
    s_mov_b32 s66, 163840
    buffer_load_dword v161, v162, s[36:39], s66 offen sc1
    s_cmp_lg_u32 s40, 1
    s_cbranch_scc1 L_nb1
    s_mov_b32 s16, s6
    s_mov_b32 s17, s7
    s_mov_b32 s18, 256
    s_lshl_b32 s66, s43, 4
    s_mov_b64 exec, 1
    buffer_atomic_add v162, v251, s[16:19], s66 offen
    s_mov_b64 exec, -1
L_nb1:
L_nbl:
    s_waitcnt lgkmcnt(6)
    v_mfma_f32_16x16x32_bf16 v[32:35], v[176:179], v[112:115], v[32:35]
    v_mfma_f32_16x16x32_bf16 v[80:83], v[176:179], v[116:119], v[80:83]
    s_waitcnt lgkmcnt(0)
    s_barrier
    ds_read_b64_tr_b16 v[168:169], v192 offset:36864
    ds_read_b64_tr_b16 v[170:171], v192 offset:38400
    ds_read_b64_tr_b16 v[172:173], v193 offset:36864
    ds_read_b64_tr_b16 v[174:175], v193 offset:38400
    v_mfma_f32_16x16x32_bf16 v[36:39], v[180:183], v[112:115], v[36:39]
    ds_read_b64_tr_b16 v[176:177], v194 offset:36864
    v_mfma_f32_16x16x32_bf16 v[84:87], v[180:183], v[116:119], v[84:87]
    ds_read_b64_tr_b16 v[178:179], v194 offset:38400
    v_mfma_f32_16x16x32_bf16 v[40:43], v[184:187], v[112:115], v[40:43]
    ds_read_b64_tr_b16 v[180:181], v195 offset:36864
    v_mfma_f32_16x16x32_bf16 v[88:91], v[184:187], v[116:119], v[88:91]
    ds_read_b64_tr_b16 v[182:183], v195 offset:38400
    v_mfma_f32_16x16x32_bf16 v[44:47], v[188:191], v[112:115], v[44:47]
    ds_read_b64_tr_b16 v[184:185], v192 offset:36992
    v_mfma_f32_16x16x32_bf16 v[92:95], v[188:191], v[116:119], v[92:95]
    ds_read_b64_tr_b16 v[186:187], v192 offset:38528
    s_waitcnt lgkmcnt(6)
    v_mfma_f32_16x16x32_bf16 v[0:3], v[168:171], v[120:123], v[0:3]
    ds_read_b64_tr_b16 v[188:189], v193 offset:36992
    v_mfma_f32_16x16x32_bf16 v[48:51], v[168:171], v[124:127], v[48:51]
    ds_read_b64_tr_b16 v[190:191], v193 offset:38528
    v_mfma_f32_16x16x32_bf16 v[4:7], v[172:175], v[120:123], v[4:7]
    ds_read_b64_tr_b16 v[168:169], v194 offset:36992
    v_mfma_f32_16x16x32_bf16 v[52:55], v[172:175], v[124:127], v[52:55]
    ds_read_b64_tr_b16 v[170:171], v194 offset:38528
    s_waitcnt lgkmcnt(6)
    v_mfma_f32_16x16x32_bf16 v[8:11], v[176:179], v[120:123], v[8:11]
    ds_read_b64_tr_b16 v[172:173], v195 offset:36992
    v_mfma_f32_16x16x32_bf16 v[56:59], v[176:179], v[124:127], v[56:59]
    ds_read_b64_tr_b16 v[174:175], v195 offset:38528
    ds_read_b128 v[96:99], v196
    v_mfma_f32_16x16x32_bf16 v[12:15], v[180:183], v[120:123], v[12:15]
    ds_read_b64_tr_b16 v[176:177], v192 offset:37120
    v_mfma_f32_16x16x32_bf16 v[60:63], v[180:183], v[124:127], v[60:63]
    ds_read_b64_tr_b16 v[178:179], v192 offset:38656
    ds_read_b128 v[100:103], v196 offset:2048
    s_waitcnt lgkmcnt(8)
    v_mfma_f32_16x16x32_bf16 v[16:19], v[184:187], v[120:123], v[16:19]
    ds_read_b64_tr_b16 v[180:181], v193 offset:37120
    v_mfma_f32_16x16x32_bf16 v[64:67], v[184:187], v[124:127], v[64:67]
    ds_read_b64_tr_b16 v[182:183], v193 offset:38656
    ds_read_b128 v[104:107], v197
    v_mfma_f32_16x16x32_bf16 v[20:23], v[188:191], v[120:123], v[20:23]
    ds_read_b64_tr_b16 v[184:185], v194 offset:37120
    v_mfma_f32_16x16x32_bf16 v[68:71], v[188:191], v[124:127], v[68:71]
    ds_read_b64_tr_b16 v[186:187], v194 offset:38656
    ds_read_b128 v[108:111], v197 offset:2048
    s_waitcnt lgkmcnt(10)
    v_mfma_f32_16x16x32_bf16 v[24:27], v[168:171], v[120:123], v[24:27]
    ds_read_b64_tr_b16 v[188:189], v195 offset:37120
    v_mfma_f32_16x16x32_bf16 v[72:75], v[168:171], v[124:127], v[72:75]
    ds_read_b64_tr_b16 v[190:191], v195 offset:38656
    v_mfma_f32_16x16x32_bf16 v[28:31], v[172:175], v[120:123], v[28:31]
    v_mfma_f32_16x16x32_bf16 v[76:79], v[172:175], v[124:127], v[76:79]
    s_waitcnt lgkmcnt(9)
    v_mfma_f32_16x16x32_bf16 v[32:35], v[176:179], v[120:123], v[32:35]
    v_mfma_f32_16x16x32_bf16 v[80:83], v[176:179], v[124:127], v[80:83]
    s_add_u32 s49, s49, 1
    s_cmp_lt_u32 s49, 5
    s_cbranch_scc1 L_qloop
    s_waitcnt vmcnt(0) lgkmcnt(0)
    v_readfirstlane_b32 s71, v161
    s_branch L_qend
L_g2a:
    s_waitcnt vmcnt(6)
    s_barrier
    s_add_u32 m0, s46, 14336
    s_add_u32 s67, s51, s48
    buffer_load_dwordx4 v219, s[16:19], s51 offen lds
    buffer_load_dwordx4 v220, s[16:19], s51 offen offset:1024 lds
    s_add_u32 m0, s47, 14336
    s_add_u32 s51, s51, 128
    buffer_load_dwordx4 v219, s[16:19], s67 offen lds
    buffer_load_dwordx4 v220, s[16:19], s67 offen offset:1024 lds
    s_cmp_ge_u32 s51, 1280
    s_cselect_b32 s51, 0, s51
    s_waitcnt vmcnt(7)
    s_barrier
    s_add_u32 m0, s45, 110592
    s_nop 0
    buffer_load_dwordx4 v216, s[28:31], s50 offen lds
    buffer_load_dwordx4 v217, s[28:31], s50 offen offset:1024 lds
    buffer_load_dwordx4 v218, s[28:31], s50 offen offset:2048 lds
    s_add_u32 s50, s50, 393216
    s_add_u32 m0, s46, 0
    s_add_u32 s67, s51, s48
    buffer_load_dwordx4 v219, s[16:19], s51 offen lds
    buffer_load_dwordx4 v220, s[16:19], s51 offen offset:1024 lds
    s_add_u32 m0, s47, 0
    s_add_u32 s51, s51, 128
    buffer_load_dwordx4 v219, s[16:19], s67 offen lds
    buffer_load_dwordx4 v220, s[16:19], s67 offen offset:1024 lds
    s_cmp_ge_u32 s51, 1280
    s_cselect_b32 s51, 0, s51
    s_add_u32 m0, s45, 122880
    s_nop 0
    buffer_load_dwordx4 v216, s[28:31], s50 offen lds
    buffer_load_dwordx4 v217, s[28:31], s50 offen offset:1024 lds
    buffer_load_dwordx4 v218, s[28:31], s50 offen offset:2048 lds
    s_add_u32 s50, s50, 393216
    s_cmp_ge_u32 s50, 7864320
    s_cselect_b32 s50, 0, s50
    s_waitcnt vmcnt(10)
    s_barrier
    s_add_u32 m0, s45, 86016
    s_nop 0
    buffer_load_dwordx4 v216, s[28:31], s50 offen lds
    buffer_load_dwordx4 v217, s[28:31], s50 offen offset:1024 lds
    buffer_load_dwordx4 v218, s[28:31], s50 offen offset:2048 lds
    s_add_u32 s50, s50, 393216
    s_waitcnt vmcnt(10)
    s_barrier
    s_add_u32 m0, s46, 14336
    s_add_u32 s67, s51, s48
    buffer_load_dwordx4 v219, s[16:19], s51 offen lds
    buffer_load_dwordx4 v220, s[16:19], s51 offen offset:1024 lds
    s_add_u32 m0, s47, 14336
    s_add_u32 s51, s51, 128
    buffer_load_dwordx4 v219, s[16:19], s67 offen lds
    buffer_load_dwordx4 v220, s[16:19], s67 offen offset:1024 lds
    s_cmp_ge_u32 s51, 1280
    s_cselect_b32 s51, 0, s51
    s_add_u32 m0, s45, 98304
    s_nop 0
    buffer_load_dwordx4 v216, s[28:31], s50 offen lds
    buffer_load_dwordx4 v217, s[28:31], s50 offen offset:1024 lds
    buffer_load_dwordx4 v218, s[28:31], s50 offen offset:2048 lds
    s_add_u32 s50, s50, 393216
    s_cmp_ge_u32 s50, 7864320
    s_cselect_b32 s50, 0, s50
    s_waitcnt vmcnt(10)
    s_barrier
    s_add_u32 m0, s45, 110592
    s_nop 0
    buffer_load_dwordx4 v216, s[28:31], s50 offen lds
    buffer_load_dwordx4 v217, s[28:31], s50 offen offset:1024 lds
    buffer_load_dwordx4 v218, s[28:31], s50 offen offset:2048 lds
    s_add_u32 s50, s50, 393216
    s_waitcnt vmcnt(10)
    s_barrier
    s_add_u32 m0, s46, 0
    s_add_u32 s67, s51, s48
    buffer_load_dwordx4 v219, s[16:19], s51 offen lds
    buffer_load_dwordx4 v220, s[16:19], s51 offen offset:1024 lds
    s_add_u32 m0, s47, 0
    s_add_u32 s51, s51, 128
    buffer_load_dwordx4 v219, s[16:19], s67 offen lds
    buffer_load_dwordx4 v220, s[16:19], s67 offen offset:1024 lds
    s_cmp_ge_u32 s51, 1280
    s_cselect_b32 s51, 0, s51
    s_add_u32 m0, s45, 122880
    s_nop 0
    buffer_load_dwordx4 v216, s[28:31], s50 offen lds
    buffer_load_dwordx4 v217, s[28:31], s50 offen offset:1024 lds
    buffer_load_dwordx4 v218, s[28:31], s50 offen offset:2048 lds
    s_add_u32 s50, s50, 393216
    s_cmp_ge_u32 s50, 7864320
    s_cselect_b32 s50, 0, s50
    s_waitcnt vmcnt(10)
    s_barrier
    s_add_u32 m0, s45, 86016
    s_nop 0
    buffer_load_dwordx4 v216, s[28:31], s50 offen lds
    buffer_load_dwordx4 v217, s[28:31], s50 offen offset:1024 lds
    buffer_load_dwordx4 v218, s[28:31], s50 offen offset:2048 lds
    s_add_u32 s50, s50, 393216
    s_waitcnt vmcnt(10)
    s_barrier
    s_mov_b32 s66, 163968
    buffer_load_dword v161, v162, s[36:39], s66 offen sc1
    s_add_u32 m0, s46, 14336
    s_add_u32 s67, s51, s48
    buffer_load_dwordx4 v219, s[16:19], s51 offen lds
    buffer_load_dwordx4 v220, s[16:19], s51 offen offset:1024 lds
    s_add_u32 m0, s47, 14336
    s_add_u32 s51, s51, 128
    buffer_load_dwordx4 v219, s[16:19], s67 offen lds
    buffer_load_dwordx4 v220, s[16:19], s67 offen offset:1024 lds
    s_cmp_ge_u32 s51, 1280
    s_cselect_b32 s51, 0, s51
    s_add_u32 m0, s45, 98304
    s_nop 0
    buffer_load_dwordx4 v216, s[28:31], s50 offen lds
    buffer_load_dwordx4 v217, s[28:31], s50 offen offset:1024 lds
    buffer_load_dwordx4 v218, s[28:31], s50 offen offset:2048 lds
    s_add_u32 s50, s50, 393216
    s_cmp_ge_u32 s50, 7864320
    s_cselect_b32 s50, 0, s50
    s_waitcnt vmcnt(11)
    s_barrier
    s_add_u32 m0, s45, 110592
    s_nop 0
    buffer_load_dwordx4 v216, s[28:31], s50 offen lds
    buffer_load_dwordx4 v217, s[28:31], s50 offen offset:1024 lds
    buffer_load_dwordx4 v218, s[28:31], s50 offen offset:2048 lds
    s_add_u32 s50, s50, 393216
    s_waitcnt vmcnt(11)
    s_barrier
    s_add_u32 m0, s46, 0
    s_add_u32 s67, s51, s48
    buffer_load_dwordx4 v219, s[16:19], s51 offen lds
    buffer_load_dwordx4 v220, s[16:19], s51 offen offset:1024 lds
    s_add_u32 m0, s47, 0
    s_add_u32 s51, s51, 128
    buffer_load_dwordx4 v219, s[16:19], s67 offen lds
    buffer_load_dwordx4 v220, s[16:19], s67 offen offset:1024 lds
    s_cmp_ge_u32 s51, 1280
    s_cselect_b32 s51, 0, s51
    s_add_u32 m0, s45, 122880
    s_nop 0
    buffer_load_dwordx4 v216, s[28:31], s50 offen lds
    buffer_load_dwordx4 v217, s[28:31], s50 offen offset:1024 lds
    buffer_load_dwordx4 v218, s[28:31], s50 offen offset:2048 lds
    s_add_u32 s50, s50, 393216
    s_cmp_ge_u32 s50, 7864320
    s_cselect_b32 s50, 0, s50
    s_waitcnt vmcnt(10)
    s_barrier
    s_add_u32 m0, s45, 86016
    s_nop 0
    buffer_load_dwordx4 v216, s[28:31], s50 offen lds
    buffer_load_dwordx4 v217, s[28:31], s50 offen offset:1024 lds
    buffer_load_dwordx4 v218, s[28:31], s50 offen offset:2048 lds
    s_add_u32 s50, s50, 393216
    s_add_u32 s69, s63, 0
    s_and_b32 s69, s69, 15
    s_or_b32 s69, s69, s73
    s_add_u32 m0, s45, 0
    s_mul_i32 s69, s69, 12288
    buffer_load_dwordx4 v210, s[20:23], s69 offen nt lds
    buffer_load_dwordx4 v211, s[20:23], s69 offen offset:1024 nt lds
    buffer_load_dwordx4 v212, s[20:23], s69 offen offset:2048 nt lds
    s_waitcnt vmcnt(13)
    s_barrier
    s_add_u32 m0, s46, 14336
    s_add_u32 s67, s51, s48
    buffer_load_dwordx4 v219, s[16:19], s51 offen lds
    buffer_load_dwordx4 v220, s[16:19], s51 offen offset:1024 lds
    s_add_u32 m0, s47, 14336
    s_add_u32 s51, s51, 128
    buffer_load_dwordx4 v219, s[16:19], s67 offen lds
    buffer_load_dwordx4 v220, s[16:19], s67 offen offset:1024 lds
    s_cmp_ge_u32 s51, 1280
    s_cselect_b32 s51, 0, s51
    s_add_u32 m0, s45, 98304
    s_nop 0
    buffer_load_dwordx4 v216, s[28:31], s50 offen lds
    buffer_load_dwordx4 v217, s[28:31], s50 offen offset:1024 lds
    buffer_load_dwordx4 v218, s[28:31], s50 offen offset:2048 lds
    s_add_u32 s50, s50, 393216
    s_cmp_ge_u32 s50, 7864320
    s_cselect_b32 s50, 0, s50
    s_waitcnt vmcnt(13)
    s_barrier
    v_readfirstlane_b32 s71, v161
    s_add_u32 m0, s45, 110592
    s_nop 0
    buffer_load_dwordx4 v216, s[28:31], s50 offen lds
    buffer_load_dwordx4 v217, s[28:31], s50 offen offset:1024 lds
    buffer_load_dwordx4 v218, s[28:31], s50 offen offset:2048 lds
    s_add_u32 s50, s50, 393216
    s_waitcnt vmcnt(13)
    s_barrier
    s_add_u32 m0, s46, 0
    s_add_u32 s67, s51, s48
    buffer_load_dwordx4 v219, s[16:19], s51 offen lds
    buffer_load_dwordx4 v220, s[16:19], s51 offen offset:1024 lds
    s_add_u32 m0, s47, 0
    s_add_u32 s51, s51, 128
    buffer_load_dwordx4 v219, s[16:19], s67 offen lds
    buffer_load_dwordx4 v220, s[16:19], s67 offen offset:1024 lds
    s_cmp_ge_u32 s51, 1280
    s_cselect_b32 s51, 0, s51
    s_add_u32 m0, s45, 122880
    s_nop 0
    buffer_load_dwordx4 v216, s[28:31], s50 offen lds
    buffer_load_dwordx4 v217, s[28:31], s50 offen offset:1024 lds
    buffer_load_dwordx4 v218, s[28:31], s50 offen offset:2048 lds
    s_add_u32 s50, s50, 393216
    s_cmp_ge_u32 s50, 7864320
    s_cselect_b32 s50, 0, s50
    s_waitcnt vmcnt(10)
    s_barrier
    s_add_u32 m0, s45, 86016
    s_nop 0
    buffer_load_dwordx4 v216, s[28:31], s50 offen lds
    buffer_load_dwordx4 v217, s[28:31], s50 offen offset:1024 lds
    buffer_load_dwordx4 v218, s[28:31], s50 offen offset:2048 lds
    s_add_u32 s50, s50, 393216
    s_waitcnt vmcnt(10)
    s_barrier
    s_add_u32 m0, s46, 14336
    s_add_u32 s67, s51, s48
    buffer_load_dwordx4 v219, s[16:19], s51 offen lds
    buffer_load_dwordx4 v220, s[16:19], s51 offen offset:1024 lds
    s_add_u32 m0, s47, 14336
    s_add_u32 s51, s51, 128
    buffer_load_dwordx4 v219, s[16:19], s67 offen lds
    buffer_load_dwordx4 v220, s[16:19], s67 offen offset:1024 lds
    s_cmp_ge_u32 s51, 1280
    s_cselect_b32 s51, 0, s51
    s_add_u32 m0, s45, 98304
    s_nop 0
    buffer_load_dwordx4 v216, s[28:31], s50 offen lds
    buffer_load_dwordx4 v217, s[28:31], s50 offen offset:1024 lds
    buffer_load_dwordx4 v218, s[28:31], s50 offen offset:2048 lds
    s_add_u32 s50, s50, 393216
    s_cmp_ge_u32 s50, 7864320
    s_cselect_b32 s50, 0, s50
    s_waitcnt vmcnt(10)
    s_barrier
    s_add_u32 m0, s45, 110592
    s_nop 0
    buffer_load_dwordx4 v216, s[28:31], s50 offen lds
    buffer_load_dwordx4 v217, s[28:31], s50 offen offset:1024 lds
    buffer_load_dwordx4 v218, s[28:31], s50 offen offset:2048 lds
    s_add_u32 s50, s50, 393216
    s_add_u32 s69, s63, 1
    s_and_b32 s69, s69, 15
    s_or_b32 s69, s69, s73
    s_add_u32 m0, s45, 24576
    s_mul_i32 s69, s69, 12288
    buffer_load_dwordx4 v210, s[20:23], s69 offen nt lds
    buffer_load_dwordx4 v211, s[20:23], s69 offen offset:1024 nt lds
    buffer_load_dwordx4 v212, s[20:23], s69 offen offset:2048 nt lds
    s_waitcnt vmcnt(13)
    s_barrier
    s_mov_b32 s51, 0
    s_add_u32 m0, s46, 0
    s_add_u32 s67, s51, s48
    buffer_load_dwordx4 v219, s[16:19], s51 offen lds
    buffer_load_dwordx4 v220, s[16:19], s51 offen offset:1024 lds
    s_add_u32 m0, s47, 0
    s_add_u32 s51, s51, 128
    buffer_load_dwordx4 v219, s[16:19], s67 offen lds
    buffer_load_dwordx4 v220, s[16:19], s67 offen offset:1024 lds
    s_cmp_ge_u32 s51, 1280
    s_cselect_b32 s51, 0, s51
    s_add_u32 m0, s45, 122880
    s_nop 0
    buffer_load_dwordx4 v216, s[28:31], s50 offen lds
    buffer_load_dwordx4 v217, s[28:31], s50 offen offset:1024 lds
    buffer_load_dwordx4 v218, s[28:31], s50 offen offset:2048 lds
    s_add_u32 s50, s50, 393216
    s_cmp_ge_u32 s50, 7864320
    s_cselect_b32 s50, 0, s50
    s_waitcnt vmcnt(13)
    s_barrier
    s_lshr_b32 s67, s74, 4
    s_lshl_b32 s66, s44, 1
    s_add_u32 s67, s67, s66
    s_mul_i32 s67, s67, 384
    s_add_u32 s28, s10, s67
    s_addc_u32 s29, s11, 0
    s_sub_u32 s30, 7864320, s67
    s_mov_b32 s50, 0
    s_add_u32 m0, s45, 86016
    s_nop 0
    buffer_load_dwordx4 v216, s[28:31], s50 offen lds
    buffer_load_dwordx4 v217, s[28:31], s50 offen offset:1024 lds
    buffer_load_dwordx4 v218, s[28:31], s50 offen offset:2048 lds
    s_add_u32 s50, s50, 393216
    s_waitcnt vmcnt(13)
    s_barrier
    s_add_u32 m0, s46, 14336
    s_add_u32 s67, s51, s48
    buffer_load_dwordx4 v219, s[16:19], s51 offen lds
    buffer_load_dwordx4 v220, s[16:19], s51 offen offset:1024 lds
    s_add_u32 m0, s47, 14336
    s_add_u32 s51, s51, 128
    buffer_load_dwordx4 v219, s[16:19], s67 offen lds
    buffer_load_dwordx4 v220, s[16:19], s67 offen offset:1024 lds
    s_cmp_ge_u32 s51, 1280
    s_cselect_b32 s51, 0, s51
    s_add_u32 m0, s45, 98304
    s_nop 0
    buffer_load_dwordx4 v216, s[28:31], s50 offen lds
    buffer_load_dwordx4 v217, s[28:31], s50 offen offset:1024 lds
    buffer_load_dwordx4 v218, s[28:31], s50 offen offset:2048 lds
    s_add_u32 s50, s50, 393216
    s_cmp_ge_u32 s50, 7864320
    s_cselect_b32 s50, 0, s50
    s_waitcnt vmcnt(10)
    s_barrier
    s_add_u32 m0, s45, 110592
    s_nop 0
    buffer_load_dwordx4 v216, s[28:31], s50 offen lds
    buffer_load_dwordx4 v217, s[28:31], s50 offen offset:1024 lds
    buffer_load_dwordx4 v218, s[28:31], s50 offen offset:2048 lds
    s_add_u32 s50, s50, 393216
    s_add_u32 s69, s63, 0
    s_and_b32 s69, s69, 15
    s_or_b32 s69, s69, s73
    s_add_u32 m0, s45, 36864
    s_mul_i32 s69, s69, 12288
    buffer_load_dwordx4 v213, s[24:27], s69 offen nt lds
    buffer_load_dwordx4 v214, s[24:27], s69 offen offset:1024 nt lds
    buffer_load_dwordx4 v215, s[24:27], s69 offen offset:2048 nt lds
    s_barrier
    s_add_u32 s69, s63, 2
    s_and_b32 s69, s69, 15
    s_or_b32 s69, s69, s73
    s_add_u32 m0, s45, 49152
    s_mul_i32 s69, s69, 12288
    buffer_load_dwordx4 v210, s[20:23], s69 offen nt lds
    buffer_load_dwordx4 v211, s[20:23], s69 offen offset:1024 nt lds
    buffer_load_dwordx4 v212, s[20:23], s69 offen offset:2048 nt lds
    ds_read_b128 v[96:99], v196
    ds_read_b128 v[100:103], v196 offset:2048
    ds_read_b128 v[104:107], v197
    ds_read_b128 v[108:111], v197 offset:2048
    s_branch L_q2loop
L_light:
    s_cmp_eq_u32 s41, 0
    s_cbranch_scc0 L_g2a_L
    s_barrier
    ds_read_b128 v[96:99], v196
    ds_read_b128 v[104:107], v197
L_qloop_L:
    s_waitcnt lgkmcnt(0)
    s_barrier
    ds_read_b64_tr_b16 v[168:169], v192
    ds_read_b64_tr_b16 v[170:171], v192 offset:1536
    ds_read_b64_tr_b16 v[172:173], v193
    ds_read_b64_tr_b16 v[174:175], v193 offset:1536
    v_mfma_f32_16x16x32_bf16 v[36:39], v[180:183], v[120:123], v[36:39]
    ds_read_b64_tr_b16 v[176:177], v194
    ds_read_b64_tr_b16 v[178:179], v194 offset:1536
    v_mfma_f32_16x16x32_bf16 v[40:43], v[184:187], v[120:123], v[40:43]
    ds_read_b64_tr_b16 v[180:181], v195
    ds_read_b64_tr_b16 v[182:183], v195 offset:1536
    v_mfma_f32_16x16x32_bf16 v[44:47], v[188:191], v[120:123], v[44:47]
    ds_read_b64_tr_b16 v[184:185], v192 offset:128
    ds_read_b64_tr_b16 v[186:187], v192 offset:1664
    s_waitcnt lgkmcnt(6)
    v_mfma_f32_16x16x32_bf16 v[0:3], v[168:171], v[96:99], v[0:3]
    ds_read_b64_tr_b16 v[188:189], v193 offset:128
    ds_read_b64_tr_b16 v[190:191], v193 offset:1664
    v_mfma_f32_16x16x32_bf16 v[4:7], v[172:175], v[96:99], v[4:7]
    ds_read_b64_tr_b16 v[168:169], v194 offset:128
    ds_read_b64_tr_b16 v[170:171], v194 offset:1664
    s_waitcnt lgkmcnt(6)
    v_mfma_f32_16x16x32_bf16 v[8:11], v[176:179], v[96:99], v[8:11]
    ds_read_b64_tr_b16 v[172:173], v195 offset:128
    ds_read_b64_tr_b16 v[174:175], v195 offset:1664
    v_mfma_f32_16x16x32_bf16 v[12:15], v[180:183], v[96:99], v[12:15]
    ds_read_b64_tr_b16 v[176:177], v192 offset:256
    ds_read_b64_tr_b16 v[178:179], v192 offset:1792
    s_waitcnt lgkmcnt(6)
    v_mfma_f32_16x16x32_bf16 v[16:19], v[184:187], v[96:99], v[16:19]
    ds_read_b64_tr_b16 v[180:181], v193 offset:256
    ds_read_b64_tr_b16 v[182:183], v193 offset:1792
    v_mfma_f32_16x16x32_bf16 v[20:23], v[188:191], v[96:99], v[20:23]
    ds_read_b64_tr_b16 v[184:185], v194 offset:256
    ds_read_b64_tr_b16 v[186:187], v194 offset:1792
    s_waitcnt lgkmcnt(6)
    v_mfma_f32_16x16x32_bf16 v[24:27], v[168:171], v[96:99], v[24:27]
    ds_read_b64_tr_b16 v[188:189], v195 offset:256
    ds_read_b64_tr_b16 v[190:191], v195 offset:1792
    v_mfma_f32_16x16x32_bf16 v[28:31], v[172:175], v[96:99], v[28:31]
    s_waitcnt lgkmcnt(6)
    v_mfma_f32_16x16x32_bf16 v[32:35], v[176:179], v[96:99], v[32:35]
    s_waitcnt lgkmcnt(0)
    s_barrier
    ds_read_b64_tr_b16 v[168:169], v192 offset:12288
    ds_read_b64_tr_b16 v[170:171], v192 offset:13824
    ds_read_b64_tr_b16 v[172:173], v193 offset:12288
    ds_read_b64_tr_b16 v[174:175], v193 offset:13824
    v_mfma_f32_16x16x32_bf16 v[36:39], v[180:183], v[96:99], v[36:39]
    ds_read_b64_tr_b16 v[176:177], v194 offset:12288
    ds_read_b64_tr_b16 v[178:179], v194 offset:13824
    v_mfma_f32_16x16x32_bf16 v[40:43], v[184:187], v[96:99], v[40:43]
    ds_read_b64_tr_b16 v[180:181], v195 offset:12288
    ds_read_b64_tr_b16 v[182:183], v195 offset:13824
    v_mfma_f32_16x16x32_bf16 v[44:47], v[188:191], v[96:99], v[44:47]
    ds_read_b64_tr_b16 v[184:185], v192 offset:12416
    ds_read_b64_tr_b16 v[186:187], v192 offset:13952
    s_waitcnt lgkmcnt(6)
    v_mfma_f32_16x16x32_bf16 v[0:3], v[168:171], v[104:107], v[0:3]
    ds_read_b64_tr_b16 v[188:189], v193 offset:12416
    ds_read_b64_tr_b16 v[190:191], v193 offset:13952
    v_mfma_f32_16x16x32_bf16 v[4:7], v[172:175], v[104:107], v[4:7]
    ds_read_b64_tr_b16 v[168:169], v194 offset:12416
    ds_read_b64_tr_b16 v[170:171], v194 offset:13952
    s_waitcnt lgkmcnt(6)
    v_mfma_f32_16x16x32_bf16 v[8:11], v[176:179], v[104:107], v[8:11]
    ds_read_b64_tr_b16 v[172:173], v195 offset:12416
    ds_read_b64_tr_b16 v[174:175], v195 offset:13952
    ds_read_b128 v[112:115], v196 offset:14336
    v_mfma_f32_16x16x32_bf16 v[12:15], v[180:183], v[104:107], v[12:15]
    ds_read_b64_tr_b16 v[176:177], v192 offset:12544
    ds_read_b64_tr_b16 v[178:179], v192 offset:14080
    ds_read_b128 v[120:123], v197 offset:14336
    s_waitcnt lgkmcnt(8)
    v_mfma_f32_16x16x32_bf16 v[16:19], v[184:187], v[104:107], v[16:19]
    ds_read_b64_tr_b16 v[180:181], v193 offset:12544
    ds_read_b64_tr_b16 v[182:183], v193 offset:14080
    v_mfma_f32_16x16x32_bf16 v[20:23], v[188:191], v[104:107], v[20:23]
    ds_read_b64_tr_b16 v[184:185], v194 offset:12544
    ds_read_b64_tr_b16 v[186:187], v194 offset:14080
    s_waitcnt lgkmcnt(8)
    v_mfma_f32_16x16x32_bf16 v[24:27], v[168:171], v[104:107], v[24:27]
    ds_read_b64_tr_b16 v[188:189], v195 offset:12544
    ds_read_b64_tr_b16 v[190:191], v195 offset:14080
    v_mfma_f32_16x16x32_bf16 v[28:31], v[172:175], v[104:107], v[28:31]
    s_waitcnt lgkmcnt(7)
    v_mfma_f32_16x16x32_bf16 v[32:35], v[176:179], v[104:107], v[32:35]
    s_waitcnt lgkmcnt(0)
    s_barrier
    ds_read_b64_tr_b16 v[168:169], v192 offset:24576
    ds_read_b64_tr_b16 v[170:171], v192 offset:26112
    ds_read_b64_tr_b16 v[172:173], v193 offset:24576
    ds_read_b64_tr_b16 v[174:175], v193 offset:26112
    v_mfma_f32_16x16x32_bf16 v[36:39], v[180:183], v[104:107], v[36:39]
    ds_read_b64_tr_b16 v[176:177], v194 offset:24576
    ds_read_b64_tr_b16 v[178:179], v194 offset:26112
    v_mfma_f32_16x16x32_bf16 v[40:43], v[184:187], v[104:107], v[40:43]
    ds_read_b64_tr_b16 v[180:181], v195 offset:24576
    ds_read_b64_tr_b16 v[182:183], v195 offset:26112
    v_mfma_f32_16x16x32_bf16 v[44:47], v[188:191], v[104:107], v[44:47]
    ds_read_b64_tr_b16 v[184:185], v192 offset:24704
    ds_read_b64_tr_b16 v[186:187], v192 offset:26240
    s_waitcnt lgkmcnt(6)
    v_mfma_f32_16x16x32_bf16 v[0:3], v[168:171], v[112:115], v[0:3]
    ds_read_b64_tr_b16 v[188:189], v193 offset:24704
    ds_read_b64_tr_b16 v[190:191], v193 offset:26240
    v_mfma_f32_16x16x32_bf16 v[4:7], v[172:175], v[112:115], v[4:7]
    ds_read_b64_tr_b16 v[168:169], v194 offset:24704
    ds_read_b64_tr_b16 v[170:171], v194 offset:26240
    s_waitcnt lgkmcnt(6)
    v_mfma_f32_16x16x32_bf16 v[8:11], v[176:179], v[112:115], v[8:11]
    ds_read_b64_tr_b16 v[172:173], v195 offset:24704
    ds_read_b64_tr_b16 v[174:175], v195 offset:26240
    v_mfma_f32_16x16x32_bf16 v[12:15], v[180:183], v[112:115], v[12:15]
    ds_read_b64_tr_b16 v[176:177], v192 offset:24832
    ds_read_b64_tr_b16 v[178:179], v192 offset:26368
    s_waitcnt lgkmcnt(6)
    v_mfma_f32_16x16x32_bf16 v[16:19], v[184:187], v[112:115], v[16:19]
    ds_read_b64_tr_b16 v[180:181], v193 offset:24832
    ds_read_b64_tr_b16 v[182:183], v193 offset:26368
    v_mfma_f32_16x16x32_bf16 v[20:23], v[188:191], v[112:115], v[20:23]
    ds_read_b64_tr_b16 v[184:185], v194 offset:24832
    ds_read_b64_tr_b16 v[186:187], v194 offset:26368
    s_waitcnt lgkmcnt(6)
    v_mfma_f32_16x16x32_bf16 v[24:27], v[168:171], v[112:115], v[24:27]
    ds_read_b64_tr_b16 v[188:189], v195 offset:24832
    ds_read_b64_tr_b16 v[190:191], v195 offset:26368
    v_mfma_f32_16x16x32_bf16 v[28:31], v[172:175], v[112:115], v[28:31]
    s_cmp_lg_u32 s49, 1
    s_cbranch_scc1 L_nbl_L
    s_mov_b32 s66, 163840
    buffer_load_dword v161, v162, s[36:39], s66 offen sc1
L_nbl_L:
    s_waitcnt lgkmcnt(6)
    v_mfma_f32_16x16x32_bf16 v[32:35], v[176:179], v[112:115], v[32:35]
    s_waitcnt lgkmcnt(0)
    s_barrier
    ds_read_b64_tr_b16 v[168:169], v192 offset:36864
    ds_read_b64_tr_b16 v[170:171], v192 offset:38400
    ds_read_b64_tr_b16 v[172:173], v193 offset:36864
    ds_read_b64_tr_b16 v[174:175], v193 offset:38400
    v_mfma_f32_16x16x32_bf16 v[36:39], v[180:183], v[112:115], v[36:39]
    ds_read_b64_tr_b16 v[176:177], v194 offset:36864
    ds_read_b64_tr_b16 v[178:179], v194 offset:38400
    v_mfma_f32_16x16x32_bf16 v[40:43], v[184:187], v[112:115], v[40:43]
    ds_read_b64_tr_b16 v[180:181], v195 offset:36864
    ds_read_b64_tr_b16 v[182:183], v195 offset:38400
    v_mfma_f32_16x16x32_bf16 v[44:47], v[188:191], v[112:115], v[44:47]
    ds_read_b64_tr_b16 v[184:185], v192 offset:36992
    ds_read_b64_tr_b16 v[186:187], v192 offset:38528
    s_waitcnt lgkmcnt(6)
    v_mfma_f32_16x16x32_bf16 v[0:3], v[168:171], v[120:123], v[0:3]
    ds_read_b64_tr_b16 v[188:189], v193 offset:36992
    ds_read_b64_tr_b16 v[190:191], v193 offset:38528
    v_mfma_f32_16x16x32_bf16 v[4:7], v[172:175], v[120:123], v[4:7]
    ds_read_b64_tr_b16 v[168:169], v194 offset:36992
    ds_read_b64_tr_b16 v[170:171], v194 offset:38528
    s_waitcnt lgkmcnt(6)
    v_mfma_f32_16x16x32_bf16 v[8:11], v[176:179], v[120:123], v[8:11]
    ds_read_b64_tr_b16 v[172:173], v195 offset:36992
    ds_read_b64_tr_b16 v[174:175], v195 offset:38528
    ds_read_b128 v[96:99], v196
    v_mfma_f32_16x16x32_bf16 v[12:15], v[180:183], v[120:123], v[12:15]
    ds_read_b64_tr_b16 v[176:177], v192 offset:37120
    ds_read_b64_tr_b16 v[178:179], v192 offset:38656
    ds_read_b128 v[104:107], v197
    s_waitcnt lgkmcnt(8)
    v_mfma_f32_16x16x32_bf16 v[16:19], v[184:187], v[120:123], v[16:19]
    ds_read_b64_tr_b16 v[180:181], v193 offset:37120
    ds_read_b64_tr_b16 v[182:183], v193 offset:38656
    v_mfma_f32_16x16x32_bf16 v[20:23], v[188:191], v[120:123], v[20:23]
    ds_read_b64_tr_b16 v[184:185], v194 offset:37120
    ds_read_b64_tr_b16 v[186:187], v194 offset:38656
    s_waitcnt lgkmcnt(8)
    v_mfma_f32_16x16x32_bf16 v[24:27], v[168:171], v[120:123], v[24:27]
    ds_read_b64_tr_b16 v[188:189], v195 offset:37120
    ds_read_b64_tr_b16 v[190:191], v195 offset:38656
    v_mfma_f32_16x16x32_bf16 v[28:31], v[172:175], v[120:123], v[28:31]
    s_waitcnt lgkmcnt(7)
    v_mfma_f32_16x16x32_bf16 v[32:35], v[176:179], v[120:123], v[32:35]
    s_add_u32 s49, s49, 1
    s_cmp_lt_u32 s49, 5
    s_cbranch_scc1 L_qloop_L
    s_waitcnt vmcnt(0) lgkmcnt(0)
    v_readfirstlane_b32 s71, v161
    s_branch L_qend_L
L_g2a_L:
    s_waitcnt vmcnt(6)
    s_barrier
    s_add_u32 m0, s46, 14336
    s_add_u32 s67, s51, s48
    buffer_load_dwordx4 v219, s[16:19], s51 offen lds
    buffer_load_dwordx4 v220, s[16:19], s51 offen offset:1024 lds
    s_add_u32 s51, s51, 128
    s_cmp_ge_u32 s51, 1280
    s_cselect_b32 s51, 0, s51
    s_waitcnt vmcnt(5)
    s_barrier
    s_add_u32 m0, s45, 110592
    s_nop 0
    buffer_load_dwordx4 v216, s[28:31], s50 offen lds
    buffer_load_dwordx4 v217, s[28:31], s50 offen offset:1024 lds
    buffer_load_dwordx4 v218, s[28:31], s50 offen offset:2048 lds
    s_add_u32 s50, s50, 393216
    s_add_u32 m0, s46, 0
    s_add_u32 s67, s51, s48
    buffer_load_dwordx4 v219, s[16:19], s51 offen lds
    buffer_load_dwordx4 v220, s[16:19], s51 offen offset:1024 lds
    s_add_u32 s51, s51, 128
    s_cmp_ge_u32 s51, 1280
    s_cselect_b32 s51, 0, s51
    s_add_u32 m0, s45, 122880
    s_nop 0
    buffer_load_dwordx4 v216, s[28:31], s50 offen lds
    buffer_load_dwordx4 v217, s[28:31], s50 offen offset:1024 lds
    buffer_load_dwordx4 v218, s[28:31], s50 offen offset:2048 lds
    s_add_u32 s50, s50, 393216
    s_cmp_ge_u32 s50, 7864320
    s_cselect_b32 s50, 0, s50
    s_waitcnt vmcnt(8)
    s_barrier
    s_add_u32 m0, s45, 86016
    s_nop 0
    buffer_load_dwordx4 v216, s[28:31], s50 offen lds
    buffer_load_dwordx4 v217, s[28:31], s50 offen offset:1024 lds
    buffer_load_dwordx4 v218, s[28:31], s50 offen offset:2048 lds
    s_add_u32 s50, s50, 393216
    s_waitcnt vmcnt(8)
    s_barrier
    s_add_u32 m0, s46, 14336
    s_add_u32 s67, s51, s48
    buffer_load_dwordx4 v219, s[16:19], s51 offen lds
    buffer_load_dwordx4 v220, s[16:19], s51 offen offset:1024 lds
    s_add_u32 s51, s51, 128
    s_cmp_ge_u32 s51, 1280
    s_cselect_b32 s51, 0, s51
    s_add_u32 m0, s45, 98304
    s_nop 0
    buffer_load_dwordx4 v216, s[28:31], s50 offen lds
    buffer_load_dwordx4 v217, s[28:31], s50 offen offset:1024 lds
    buffer_load_dwordx4 v218, s[28:31], s50 offen offset:2048 lds
    s_add_u32 s50, s50, 393216
    s_cmp_ge_u32 s50, 7864320
    s_cselect_b32 s50, 0, s50
    s_waitcnt vmcnt(8)
    s_barrier
    s_add_u32 m0, s45, 110592
    s_nop 0
    buffer_load_dwordx4 v216, s[28:31], s50 offen lds
    buffer_load_dwordx4 v217, s[28:31], s50 offen offset:1024 lds
    buffer_load_dwordx4 v218, s[28:31], s50 offen offset:2048 lds
    s_add_u32 s50, s50, 393216
    s_waitcnt vmcnt(8)
    s_barrier
    s_add_u32 m0, s46, 0
    s_add_u32 s67, s51, s48
    buffer_load_dwordx4 v219, s[16:19], s51 offen lds
    buffer_load_dwordx4 v220, s[16:19], s51 offen offset:1024 lds
    s_add_u32 s51, s51, 128
    s_cmp_ge_u32 s51, 1280
    s_cselect_b32 s51, 0, s51
    s_add_u32 m0, s45, 122880
    s_nop 0
    buffer_load_dwordx4 v216, s[28:31], s50 offen lds
    buffer_load_dwordx4 v217, s[28:31], s50 offen offset:1024 lds
    buffer_load_dwordx4 v218, s[28:31], s50 offen offset:2048 lds
    s_add_u32 s50, s50, 393216
    s_cmp_ge_u32 s50, 7864320
    s_cselect_b32 s50, 0, s50
    s_waitcnt vmcnt(8)
    s_barrier
    s_add_u32 m0, s45, 86016
    s_nop 0
    buffer_load_dwordx4 v216, s[28:31], s50 offen lds
    buffer_load_dwordx4 v217, s[28:31], s50 offen offset:1024 lds
    buffer_load_dwordx4 v218, s[28:31], s50 offen offset:2048 lds
    s_add_u32 s50, s50, 393216
    s_waitcnt vmcnt(8)
    s_barrier
    s_mov_b32 s66, 163968
    buffer_load_dword v161, v162, s[36:39], s66 offen sc1
    s_add_u32 m0, s46, 14336
    s_add_u32 s67, s51, s48
    buffer_load_dwordx4 v219, s[16:19], s51 offen lds
    buffer_load_dwordx4 v220, s[16:19], s51 offen offset:1024 lds
    s_add_u32 s51, s51, 128
    s_cmp_ge_u32 s51, 1280
    s_cselect_b32 s51, 0, s51
    s_add_u32 m0, s45, 98304
    s_nop 0
    buffer_load_dwordx4 v216, s[28:31], s50 offen lds
    buffer_load_dwordx4 v217, s[28:31], s50 offen offset:1024 lds
    buffer_load_dwordx4 v218, s[28:31], s50 offen offset:2048 lds
    s_add_u32 s50, s50, 393216
    s_cmp_ge_u32 s50, 7864320
    s_cselect_b32 s50, 0, s50
    s_waitcnt vmcnt(9)
    s_barrier
    s_add_u32 m0, s45, 110592
    s_nop 0
    buffer_load_dwordx4 v216, s[28:31], s50 offen lds
    buffer_load_dwordx4 v217, s[28:31], s50 offen offset:1024 lds
    buffer_load_dwordx4 v218, s[28:31], s50 offen offset:2048 lds
    s_add_u32 s50, s50, 393216
    s_waitcnt vmcnt(9)
    s_barrier
    s_add_u32 m0, s46, 0
    s_add_u32 s67, s51, s48
    buffer_load_dwordx4 v219, s[16:19], s51 offen lds
    buffer_load_dwordx4 v220, s[16:19], s51 offen offset:1024 lds
    s_add_u32 s51, s51, 128
    s_cmp_ge_u32 s51, 1280
    s_cselect_b32 s51, 0, s51
    s_add_u32 m0, s45, 122880
    s_nop 0
    buffer_load_dwordx4 v216, s[28:31], s50 offen lds
    buffer_load_dwordx4 v217, s[28:31], s50 offen offset:1024 lds
    buffer_load_dwordx4 v218, s[28:31], s50 offen offset:2048 lds
    s_add_u32 s50, s50, 393216
    s_cmp_ge_u32 s50, 7864320
    s_cselect_b32 s50, 0, s50
    s_waitcnt vmcnt(8)
    s_barrier
    s_add_u32 m0, s45, 86016
    s_nop 0
    buffer_load_dwordx4 v216, s[28:31], s50 offen lds
    buffer_load_dwordx4 v217, s[28:31], s50 offen offset:1024 lds
    buffer_load_dwordx4 v218, s[28:31], s50 offen offset:2048 lds
    s_add_u32 s50, s50, 393216
    s_add_u32 s69, s63, 0
    s_and_b32 s69, s69, 15
    s_or_b32 s69, s69, s73
    s_add_u32 m0, s45, 0
    s_mul_i32 s69, s69, 12288
    buffer_load_dwordx4 v210, s[20:23], s69 offen nt lds
    buffer_load_dwordx4 v211, s[20:23], s69 offen offset:1024 nt lds
    buffer_load_dwordx4 v212, s[20:23], s69 offen offset:2048 nt lds
    s_waitcnt vmcnt(11)
    s_barrier
    s_add_u32 m0, s46, 14336
    s_add_u32 s67, s51, s48
    buffer_load_dwordx4 v219, s[16:19], s51 offen lds
    buffer_load_dwordx4 v220, s[16:19], s51 offen offset:1024 lds
    s_add_u32 s51, s51, 128
    s_cmp_ge_u32 s51, 1280
    s_cselect_b32 s51, 0, s51
    s_add_u32 m0, s45, 98304
    s_nop 0
    buffer_load_dwordx4 v216, s[28:31], s50 offen lds
    buffer_load_dwordx4 v217, s[28:31], s50 offen offset:1024 lds
    buffer_load_dwordx4 v218, s[28:31], s50 offen offset:2048 lds
    s_add_u32 s50, s50, 393216
    s_cmp_ge_u32 s50, 7864320
    s_cselect_b32 s50, 0, s50
    s_waitcnt vmcnt(11)
    s_barrier
    v_readfirstlane_b32 s71, v161
    s_add_u32 m0, s45, 110592
    s_nop 0
    buffer_load_dwordx4 v216, s[28:31], s50 offen lds
    buffer_load_dwordx4 v217, s[28:31], s50 offen offset:1024 lds
    buffer_load_dwordx4 v218, s[28:31], s50 offen offset:2048 lds
    s_add_u32 s50, s50, 393216
    s_waitcnt vmcnt(11)
    s_barrier
    s_add_u32 m0, s46, 0
    s_add_u32 s67, s51, s48
    buffer_load_dwordx4 v219, s[16:19], s51 offen lds
    buffer_load_dwordx4 v220, s[16:19], s51 offen offset:1024 lds
    s_add_u32 s51, s51, 128
    s_cmp_ge_u32 s51, 1280
    s_cselect_b32 s51, 0, s51
    s_add_u32 m0, s45, 122880
    s_nop 0
    buffer_load_dwordx4 v216, s[28:31], s50 offen lds
    buffer_load_dwordx4 v217, s[28:31], s50 offen offset:1024 lds
    buffer_load_dwordx4 v218, s[28:31], s50 offen offset:2048 lds
    s_add_u32 s50, s50, 393216
    s_cmp_ge_u32 s50, 7864320
    s_cselect_b32 s50, 0, s50
    s_waitcnt vmcnt(8)
    s_barrier
    s_add_u32 m0, s45, 86016
    s_nop 0
    buffer_load_dwordx4 v216, s[28:31], s50 offen lds
    buffer_load_dwordx4 v217, s[28:31], s50 offen offset:1024 lds
    buffer_load_dwordx4 v218, s[28:31], s50 offen offset:2048 lds
    s_add_u32 s50, s50, 393216
    s_waitcnt vmcnt(8)
    s_barrier
    s_add_u32 m0, s46, 14336
    s_add_u32 s67, s51, s48
    buffer_load_dwordx4 v219, s[16:19], s51 offen lds
    buffer_load_dwordx4 v220, s[16:19], s51 offen offset:1024 lds
    s_add_u32 s51, s51, 128
    s_cmp_ge_u32 s51, 1280
    s_cselect_b32 s51, 0, s51
    s_add_u32 m0, s45, 98304
    s_nop 0
    buffer_load_dwordx4 v216, s[28:31], s50 offen lds
    buffer_load_dwordx4 v217, s[28:31], s50 offen offset:1024 lds
    buffer_load_dwordx4 v218, s[28:31], s50 offen offset:2048 lds
    s_add_u32 s50, s50, 393216
    s_cmp_ge_u32 s50, 7864320
    s_cselect_b32 s50, 0, s50
    s_waitcnt vmcnt(8)
    s_barrier
    s_add_u32 m0, s45, 110592
    s_nop 0
    buffer_load_dwordx4 v216, s[28:31], s50 offen lds
    buffer_load_dwordx4 v217, s[28:31], s50 offen offset:1024 lds
    buffer_load_dwordx4 v218, s[28:31], s50 offen offset:2048 lds
    s_add_u32 s50, s50, 393216
    s_add_u32 s69, s63, 1
    s_and_b32 s69, s69, 15
    s_or_b32 s69, s69, s73
    s_add_u32 m0, s45, 24576
    s_mul_i32 s69, s69, 12288
    buffer_load_dwordx4 v210, s[20:23], s69 offen nt lds
    buffer_load_dwordx4 v211, s[20:23], s69 offen offset:1024 nt lds
    buffer_load_dwordx4 v212, s[20:23], s69 offen offset:2048 nt lds
    s_waitcnt vmcnt(11)
    s_barrier
    s_mov_b32 s51, 0
    s_add_u32 m0, s46, 0
    s_add_u32 s67, s51, s48
    buffer_load_dwordx4 v219, s[16:19], s51 offen lds
    buffer_load_dwordx4 v220, s[16:19], s51 offen offset:1024 lds
    s_add_u32 s51, s51, 128
    s_cmp_ge_u32 s51, 1280
    s_cselect_b32 s51, 0, s51
    s_add_u32 m0, s45, 122880
    s_nop 0
    buffer_load_dwordx4 v216, s[28:31], s50 offen lds
    buffer_load_dwordx4 v217, s[28:31], s50 offen offset:1024 lds
    buffer_load_dwordx4 v218, s[28:31], s50 offen offset:2048 lds
    s_add_u32 s50, s50, 393216
    s_cmp_ge_u32 s50, 7864320
    s_cselect_b32 s50, 0, s50
    s_waitcnt vmcnt(11)
    s_barrier
    s_lshr_b32 s67, s74, 4
    s_lshl_b32 s66, s44, 1
    s_add_u32 s67, s67, s66
    s_mul_i32 s67, s67, 384
    s_add_u32 s28, s10, s67
    s_addc_u32 s29, s11, 0
    s_sub_u32 s30, 7864320, s67
    s_mov_b32 s50, 0
    s_add_u32 m0, s45, 86016
    s_nop 0
    buffer_load_dwordx4 v216, s[28:31], s50 offen lds
    buffer_load_dwordx4 v217, s[28:31], s50 offen offset:1024 lds
    buffer_load_dwordx4 v218, s[28:31], s50 offen offset:2048 lds
    s_add_u32 s50, s50, 393216
    s_waitcnt vmcnt(11)
    s_barrier
    s_add_u32 m0, s46, 14336
    s_add_u32 s67, s51, s48
    buffer_load_dwordx4 v219, s[16:19], s51 offen lds
    buffer_load_dwordx4 v220, s[16:19], s51 offen offset:1024 lds
    s_add_u32 s51, s51, 128
    s_cmp_ge_u32 s51, 1280
    s_cselect_b32 s51, 0, s51
    s_add_u32 m0, s45, 98304
    s_nop 0
    buffer_load_dwordx4 v216, s[28:31], s50 offen lds
    buffer_load_dwordx4 v217, s[28:31], s50 offen offset:1024 lds
    buffer_load_dwordx4 v218, s[28:31], s50 offen offset:2048 lds
    s_add_u32 s50, s50, 393216
    s_cmp_ge_u32 s50, 7864320
    s_cselect_b32 s50, 0, s50
    s_waitcnt vmcnt(8)
    s_barrier
    s_add_u32 m0, s45, 110592
    s_nop 0
    buffer_load_dwordx4 v216, s[28:31], s50 offen lds
    buffer_load_dwordx4 v217, s[28:31], s50 offen offset:1024 lds
    buffer_load_dwordx4 v218, s[28:31], s50 offen offset:2048 lds
    s_add_u32 s50, s50, 393216
    s_add_u32 s69, s63, 0
    s_and_b32 s69, s69, 15
    s_or_b32 s69, s69, s73
    s_add_u32 m0, s45, 36864
    s_mul_i32 s69, s69, 12288
    buffer_load_dwordx4 v213, s[24:27], s69 offen nt lds
    buffer_load_dwordx4 v214, s[24:27], s69 offen offset:1024 nt lds
    buffer_load_dwordx4 v215, s[24:27], s69 offen offset:2048 nt lds
    s_barrier
    s_add_u32 s69, s63, 2
    s_and_b32 s69, s69, 15
    s_or_b32 s69, s69, s73
    s_add_u32 m0, s45, 49152
    s_mul_i32 s69, s69, 12288
    buffer_load_dwordx4 v210, s[20:23], s69 offen nt lds
    buffer_load_dwordx4 v211, s[20:23], s69 offen offset:1024 nt lds
    buffer_load_dwordx4 v212, s[20:23], s69 offen offset:2048 nt lds
    ds_read_b128 v[96:99], v196
    ds_read_b128 v[104:107], v197
    s_branch L_q2loop_L
L_q2loop:
    s_cmp_eq_u32 s49, 0
    s_cbranch_scc0 L_fw0
    s_waitcnt vmcnt(6)
L_fw0:
    s_waitcnt vmcnt(11) lgkmcnt(0)
    s_barrier
    ds_read_b64_tr_b16 v[168:169], v192
    ds_read_b64_tr_b16 v[170:171], v192 offset:1536
    ds_read_b64_tr_b16 v[172:173], v193
    ds_read_b64_tr_b16 v[174:175], v193 offset:1536
    v_mfma_f32_16x16x32_bf16 v[36:39], v[180:183], v[120:123], v[36:39]
    ds_read_b64_tr_b16 v[176:177], v194
    v_mfma_f32_16x16x32_bf16 v[84:87], v[180:183], v[124:127], v[84:87]
    ds_read_b64_tr_b16 v[178:179], v194 offset:1536
    s_add_u32 s69, s63, s55
    s_and_b32 s69, s69, 15
    s_and_b32 s68, s55, 16
    s_or_b32 s69, s69, s68
    s_xor_b32 s69, s69, s73
    s_add_u32 m0, s45, s53
    s_mul_i32 s69, s69, 12288
    buffer_load_dwordx4 v213, s[24:27], s69 offen nt lds
    v_mfma_f32_16x16x32_bf16 v[40:43], v[184:187], v[120:123], v[40:43]
    ds_read_b64_tr_b16 v[180:181], v195
    v_mfma_f32_16x16x32_bf16 v[88:91], v[184:187], v[124:127], v[88:91]
    ds_read_b64_tr_b16 v[182:183], v195 offset:1536
    s_add_u32 s53, s53, 12288
    s_cmp_ge_u32 s53, 86016
    s_cselect_b32 s53, 0, s53
    buffer_load_dwordx4 v214, s[24:27], s69 offen offset:1024 nt lds
    v_mfma_f32_16x16x32_bf16 v[44:47], v[188:191], v[120:123], v[44:47]
    ds_read_b64_tr_b16 v[184:185], v192 offset:128
    v_mfma_f32_16x16x32_bf16 v[92:95], v[188:191], v[124:127], v[92:95]
    ds_read_b64_tr_b16 v[186:187], v192 offset:1664
    buffer_load_dwordx4 v215, s[24:27], s69 offen offset:2048 nt lds
    s_add_u32 s55, s55, 1
    s_waitcnt lgkmcnt(6)
    v_mfma_f32_16x16x32_bf16 v[0:3], v[168:171], v[96:99], v[0:3]
    ds_read_b64_tr_b16 v[188:189], v193 offset:128
    v_mfma_f32_16x16x32_bf16 v[48:51], v[168:171], v[100:103], v[48:51]
    ds_read_b64_tr_b16 v[190:191], v193 offset:1664
    s_add_u32 m0, s45, 122880
    s_nop 0
    buffer_load_dwordx4 v216, s[28:31], s50 offen lds
    v_mfma_f32_16x16x32_bf16 v[4:7], v[172:175], v[96:99], v[4:7]
    ds_read_b64_tr_b16 v[168:169], v194 offset:128
    v_mfma_f32_16x16x32_bf16 v[52:55], v[172:175], v[100:103], v[52:55]
    ds_read_b64_tr_b16 v[170:171], v194 offset:1664
    buffer_load_dwordx4 v217, s[28:31], s50 offen offset:1024 lds
    s_waitcnt lgkmcnt(6)
    v_mfma_f32_16x16x32_bf16 v[8:11], v[176:179], v[96:99], v[8:11]
    ds_read_b64_tr_b16 v[172:173], v195 offset:128
    v_mfma_f32_16x16x32_bf16 v[56:59], v[176:179], v[100:103], v[56:59]
    ds_read_b64_tr_b16 v[174:175], v195 offset:1664
    buffer_load_dwordx4 v218, s[28:31], s50 offen offset:2048 lds
    s_add_u32 s50, s50, 393216
    v_mfma_f32_16x16x32_bf16 v[12:15], v[180:183], v[96:99], v[12:15]
    v_mfma_f32_16x16x32_bf16 v[60:63], v[180:183], v[100:103], v[60:63]
    s_waitcnt lgkmcnt(6)
    v_mfma_f32_16x16x32_bf16 v[16:19], v[184:187], v[96:99], v[16:19]
    v_mfma_f32_16x16x32_bf16 v[64:67], v[184:187], v[100:103], v[64:67]
    s_waitcnt vmcnt(11) lgkmcnt(0)
    s_barrier
    ds_read_b64_tr_b16 v[176:177], v192 offset:256
    ds_read_b64_tr_b16 v[178:179], v192 offset:1792
    ds_read_b64_tr_b16 v[180:181], v193 offset:256
    ds_read_b64_tr_b16 v[182:183], v193 offset:1792
    v_mfma_f32_16x16x32_bf16 v[20:23], v[188:191], v[96:99], v[20:23]
    ds_read_b64_tr_b16 v[184:185], v194 offset:256
    v_mfma_f32_16x16x32_bf16 v[68:71], v[188:191], v[100:103], v[68:71]
    ds_read_b64_tr_b16 v[186:187], v194 offset:1792
    s_add_u32 s69, s63, s54
    s_and_b32 s69, s69, 15
    s_and_b32 s68, s54, 16
    s_or_b32 s69, s69, s68
    s_xor_b32 s69, s69, s73
    s_add_u32 m0, s45, s53
    s_mul_i32 s69, s69, 12288
    buffer_load_dwordx4 v210, s[20:23], s69 offen nt lds
    v_mfma_f32_16x16x32_bf16 v[24:27], v[168:171], v[96:99], v[24:27]
    ds_read_b64_tr_b16 v[188:189], v195 offset:256
    v_mfma_f32_16x16x32_bf16 v[72:75], v[168:171], v[100:103], v[72:75]
    ds_read_b64_tr_b16 v[190:191], v195 offset:1792
    s_add_u32 s53, s53, 12288
    s_cmp_ge_u32 s53, 86016
    s_cselect_b32 s53, 0, s53
    buffer_load_dwordx4 v211, s[20:23], s69 offen offset:1024 nt lds
    v_mfma_f32_16x16x32_bf16 v[28:31], v[172:175], v[96:99], v[28:31]
    ds_read_b64_tr_b16 v[168:169], v192 offset:12288
    v_mfma_f32_16x16x32_bf16 v[76:79], v[172:175], v[100:103], v[76:79]
    ds_read_b64_tr_b16 v[170:171], v192 offset:13824
    buffer_load_dwordx4 v212, s[20:23], s69 offen offset:2048 nt lds
    s_add_u32 s54, s54, 1
    s_waitcnt lgkmcnt(6)
    v_mfma_f32_16x16x32_bf16 v[32:35], v[176:179], v[96:99], v[32:35]
    ds_read_b64_tr_b16 v[172:173], v193 offset:12288
    v_mfma_f32_16x16x32_bf16 v[80:83], v[176:179], v[100:103], v[80:83]
    ds_read_b64_tr_b16 v[174:175], v193 offset:13824
    s_add_u32 m0, s46, 0
    s_add_u32 s67, s51, s48
    buffer_load_dwordx4 v219, s[16:19], s51 offen lds
    v_mfma_f32_16x16x32_bf16 v[36:39], v[180:183], v[96:99], v[36:39]
    ds_read_b64_tr_b16 v[176:177], v194 offset:12288
    v_mfma_f32_16x16x32_bf16 v[84:87], v[180:183], v[100:103], v[84:87]
    ds_read_b64_tr_b16 v[178:179], v194 offset:13824
    buffer_load_dwordx4 v220, s[16:19], s51 offen offset:1024 lds
    s_waitcnt lgkmcnt(6)
    v_mfma_f32_16x16x32_bf16 v[40:43], v[184:187], v[96:99], v[40:43]
    ds_read_b64_tr_b16 v[180:181], v195 offset:12288
    v_mfma_f32_16x16x32_bf16 v[88:91], v[184:187], v[100:103], v[88:91]
    ds_read_b64_tr_b16 v[182:183], v195 offset:13824
    s_add_u32 m0, s47, 0
    s_add_u32 s51, s51, 128
    buffer_load_dwordx4 v219, s[16:19], s67 offen lds
    v_mfma_f32_16x16x32_bf16 v[44:47], v[188:191], v[96:99], v[44:47]
    v_mfma_f32_16x16x32_bf16 v[92:95], v[188:191], v[100:103], v[92:95]
    buffer_load_dwordx4 v220, s[16:19], s67 offen offset:1024 lds
    s_cmp_ge_u32 s51, 1280
    s_cselect_b32 s51, 0x40000000, s51
    s_waitcnt lgkmcnt(6)
    v_mfma_f32_16x16x32_bf16 v[0:3], v[168:171], v[104:107], v[0:3]
    v_mfma_f32_16x16x32_bf16 v[48:51], v[168:171], v[108:111], v[48:51]
    s_waitcnt vmcnt(11) lgkmcnt(0)
    s_barrier
    ds_read_b64_tr_b16 v[184:185], v192 offset:12416
    ds_read_b64_tr_b16 v[186:187], v192 offset:13952
    ds_read_b64_tr_b16 v[188:189], v193 offset:12416
    ds_read_b64_tr_b16 v[190:191], v193 offset:13952
    v_mfma_f32_16x16x32_bf16 v[4:7], v[172:175], v[104:107], v[4:7]
    ds_read_b64_tr_b16 v[168:169], v194 offset:12416
    v_mfma_f32_16x16x32_bf16 v[52:55], v[172:175], v[108:111], v[52:55]
    ds_read_b64_tr_b16 v[170:171], v194 offset:13952
    s_add_u32 s69, s63, s55
    s_and_b32 s69, s69, 15
    s_and_b32 s68, s55, 16
    s_or_b32 s69, s69, s68
    s_xor_b32 s69, s69, s73
    s_add_u32 m0, s45, s53
    s_mul_i32 s69, s69, 12288
    buffer_load_dwordx4 v213, s[24:27], s69 offen nt lds
    v_mfma_f32_16x16x32_bf16 v[8:11], v[176:179], v[104:107], v[8:11]
    ds_read_b64_tr_b16 v[172:173], v195 offset:12416
    v_mfma_f32_16x16x32_bf16 v[56:59], v[176:179], v[108:111], v[56:59]
    ds_read_b64_tr_b16 v[174:175], v195 offset:13952
    s_add_u32 s53, s53, 12288
    s_cmp_ge_u32 s53, 86016
    s_cselect_b32 s53, 0, s53
    buffer_load_dwordx4 v214, s[24:27], s69 offen offset:1024 nt lds
    v_mfma_f32_16x16x32_bf16 v[12:15], v[180:183], v[104:107], v[12:15]
    ds_read_b64_tr_b16 v[176:177], v192 offset:12544
    v_mfma_f32_16x16x32_bf16 v[60:63], v[180:183], v[108:111], v[60:63]
    ds_read_b64_tr_b16 v[178:179], v192 offset:14080
    buffer_load_dwordx4 v215, s[24:27], s69 offen offset:2048 nt lds
    s_add_u32 s55, s55, 1
    s_waitcnt lgkmcnt(6)
    v_mfma_f32_16x16x32_bf16 v[16:19], v[184:187], v[104:107], v[16:19]
    ds_read_b64_tr_b16 v[180:181], v193 offset:12544
    v_mfma_f32_16x16x32_bf16 v[64:67], v[184:187], v[108:111], v[64:67]
    ds_read_b64_tr_b16 v[182:183], v193 offset:14080
    s_add_u32 m0, s45, 86016
    s_nop 0
    buffer_load_dwordx4 v216, s[28:31], s50 offen lds
    ds_read_b128 v[112:115], v196 offset:14336
    v_mfma_f32_16x16x32_bf16 v[20:23], v[188:191], v[104:107], v[20:23]
    ds_read_b64_tr_b16 v[184:185], v194 offset:12544
    v_mfma_f32_16x16x32_bf16 v[68:71], v[188:191], v[108:111], v[68:71]
    ds_read_b64_tr_b16 v[186:187], v194 offset:14080
    buffer_load_dwordx4 v217, s[28:31], s50 offen offset:1024 lds
    ds_read_b128 v[116:119], v196 offset:16384
    s_waitcnt lgkmcnt(8)
    v_mfma_f32_16x16x32_bf16 v[24:27], v[168:171], v[104:107], v[24:27]
    ds_read_b64_tr_b16 v[188:189], v195 offset:12544
    v_mfma_f32_16x16x32_bf16 v[72:75], v[168:171], v[108:111], v[72:75]
    ds_read_b64_tr_b16 v[190:191], v195 offset:14080
    buffer_load_dwordx4 v218, s[28:31], s50 offen offset:2048 lds
    s_add_u32 s50, s50, 393216
    ds_read_b128 v[120:123], v197 offset:14336
    v_mfma_f32_16x16x32_bf16 v[28:31], v[172:175], v[104:107], v[28:31]
    v_mfma_f32_16x16x32_bf16 v[76:79], v[172:175], v[108:111], v[76:79]
    ds_read_b128 v[124:127], v197 offset:16384
    s_waitcnt lgkmcnt(10)
    v_mfma_f32_16x16x32_bf16 v[32:35], v[176:179], v[104:107], v[32:35]
    v_mfma_f32_16x16x32_bf16 v[80:83], v[176:179], v[108:111], v[80:83]
    s_waitcnt vmcnt(11) lgkmcnt(0)
    s_barrier
    ds_read_b64_tr_b16 v[168:169], v192 offset:24576
    ds_read_b64_tr_b16 v[170:171], v192 offset:26112
    ds_read_b64_tr_b16 v[172:173], v193 offset:24576
    ds_read_b64_tr_b16 v[174:175], v193 offset:26112
    v_mfma_f32_16x16x32_bf16 v[36:39], v[180:183], v[104:107], v[36:39]
    ds_read_b64_tr_b16 v[176:177], v194 offset:24576
    v_mfma_f32_16x16x32_bf16 v[84:87], v[180:183], v[108:111], v[84:87]
    ds_read_b64_tr_b16 v[178:179], v194 offset:26112
    s_add_u32 s69, s63, s54
    s_and_b32 s69, s69, 15
    s_and_b32 s68, s54, 16
    s_or_b32 s69, s69, s68
    s_xor_b32 s69, s69, s73
    s_add_u32 m0, s45, s53
    s_mul_i32 s69, s69, 12288
    buffer_load_dwordx4 v210, s[20:23], s69 offen nt lds
    v_mfma_f32_16x16x32_bf16 v[40:43], v[184:187], v[104:107], v[40:43]
    ds_read_b64_tr_b16 v[180:181], v195 offset:24576
    v_mfma_f32_16x16x32_bf16 v[88:91], v[184:187], v[108:111], v[88:91]
    ds_read_b64_tr_b16 v[182:183], v195 offset:26112
    s_add_u32 s53, s53, 12288
    s_cmp_ge_u32 s53, 86016
    s_cselect_b32 s53, 0, s53
    buffer_load_dwordx4 v211, s[20:23], s69 offen offset:1024 nt lds
    v_mfma_f32_16x16x32_bf16 v[44:47], v[188:191], v[104:107], v[44:47]
    ds_read_b64_tr_b16 v[184:185], v192 offset:24704
    v_mfma_f32_16x16x32_bf16 v[92:95], v[188:191], v[108:111], v[92:95]
    ds_read_b64_tr_b16 v[186:187], v192 offset:26240
    buffer_load_dwordx4 v212, s[20:23], s69 offen offset:2048 nt lds
    s_add_u32 s54, s54, 1
    s_waitcnt lgkmcnt(6)
    v_mfma_f32_16x16x32_bf16 v[0:3], v[168:171], v[112:115], v[0:3]
    ds_read_b64_tr_b16 v[188:189], v193 offset:24704
    v_mfma_f32_16x16x32_bf16 v[48:51], v[168:171], v[116:119], v[48:51]
    ds_read_b64_tr_b16 v[190:191], v193 offset:26240
    s_add_u32 m0, s45, 98304
    s_nop 0
    buffer_load_dwordx4 v216, s[28:31], s50 offen lds
    v_mfma_f32_16x16x32_bf16 v[4:7], v[172:175], v[112:115], v[4:7]
    ds_read_b64_tr_b16 v[168:169], v194 offset:24704
    v_mfma_f32_16x16x32_bf16 v[52:55], v[172:175], v[116:119], v[52:55]
    ds_read_b64_tr_b16 v[170:171], v194 offset:26240
    buffer_load_dwordx4 v217, s[28:31], s50 offen offset:1024 lds
    s_waitcnt lgkmcnt(6)
    v_mfma_f32_16x16x32_bf16 v[8:11], v[176:179], v[112:115], v[8:11]
    ds_read_b64_tr_b16 v[172:173], v195 offset:24704
    v_mfma_f32_16x16x32_bf16 v[56:59], v[176:179], v[116:119], v[56:59]
    ds_read_b64_tr_b16 v[174:175], v195 offset:26240
    buffer_load_dwordx4 v218, s[28:31], s50 offen offset:2048 lds
    s_add_u32 s50, s50, 393216
    v_mfma_f32_16x16x32_bf16 v[12:15], v[180:183], v[112:115], v[12:15]
    v_mfma_f32_16x16x32_bf16 v[60:63], v[180:183], v[116:119], v[60:63]
    s_waitcnt lgkmcnt(6)
    v_mfma_f32_16x16x32_bf16 v[16:19], v[184:187], v[112:115], v[16:19]
    v_mfma_f32_16x16x32_bf16 v[64:67], v[184:187], v[116:119], v[64:67]
    s_waitcnt vmcnt(11) lgkmcnt(0)
    s_barrier
    ds_read_b64_tr_b16 v[176:177], v192 offset:24832
    ds_read_b64_tr_b16 v[178:179], v192 offset:26368
    ds_read_b64_tr_b16 v[180:181], v193 offset:24832
    ds_read_b64_tr_b16 v[182:183], v193 offset:26368
    v_mfma_f32_16x16x32_bf16 v[20:23], v[188:191], v[112:115], v[20:23]
    ds_read_b64_tr_b16 v[184:185], v194 offset:24832
    v_mfma_f32_16x16x32_bf16 v[68:71], v[188:191], v[116:119], v[68:71]
    ds_read_b64_tr_b16 v[186:187], v194 offset:26368
    s_add_u32 s69, s63, s55
    s_and_b32 s69, s69, 15
    s_and_b32 s68, s55, 16
    s_or_b32 s69, s69, s68
    s_xor_b32 s69, s69, s73
    s_add_u32 m0, s45, s53
    s_mul_i32 s69, s69, 12288
    buffer_load_dwordx4 v213, s[24:27], s69 offen nt lds
    v_mfma_f32_16x16x32_bf16 v[24:27], v[168:171], v[112:115], v[24:27]
    ds_read_b64_tr_b16 v[188:189], v195 offset:24832
    v_mfma_f32_16x16x32_bf16 v[72:75], v[168:171], v[116:119], v[72:75]
    ds_read_b64_tr_b16 v[190:191], v195 offset:26368
    s_add_u32 s53, s53, 12288
    s_cmp_ge_u32 s53, 86016
    s_cselect_b32 s53, 0, s53
    buffer_load_dwordx4 v214, s[24:27], s69 offen offset:1024 nt lds
    v_mfma_f32_16x16x32_bf16 v[28:31], v[172:175], v[112:115], v[28:31]
    ds_read_b64_tr_b16 v[168:169], v192 offset:36864
    v_mfma_f32_16x16x32_bf16 v[76:79], v[172:175], v[116:119], v[76:79]
    ds_read_b64_tr_b16 v[170:171], v192 offset:38400
    buffer_load_dwordx4 v215, s[24:27], s69 offen offset:2048 nt lds
    s_add_u32 s55, s55, 1
    s_waitcnt lgkmcnt(6)
    v_mfma_f32_16x16x32_bf16 v[32:35], v[176:179], v[112:115], v[32:35]
    ds_read_b64_tr_b16 v[172:173], v193 offset:36864
    v_mfma_f32_16x16x32_bf16 v[80:83], v[176:179], v[116:119], v[80:83]
    ds_read_b64_tr_b16 v[174:175], v193 offset:38400
    s_add_u32 m0, s46, 14336
    s_add_u32 s67, s51, s48
    buffer_load_dwordx4 v219, s[16:19], s51 offen lds
    v_mfma_f32_16x16x32_bf16 v[36:39], v[180:183], v[112:115], v[36:39]
    ds_read_b64_tr_b16 v[176:177], v194 offset:36864
    v_mfma_f32_16x16x32_bf16 v[84:87], v[180:183], v[116:119], v[84:87]
    ds_read_b64_tr_b16 v[178:179], v194 offset:38400
    buffer_load_dwordx4 v220, s[16:19], s51 offen offset:1024 lds
    s_waitcnt lgkmcnt(6)
    v_mfma_f32_16x16x32_bf16 v[40:43], v[184:187], v[112:115], v[40:43]
    ds_read_b64_tr_b16 v[180:181], v195 offset:36864
    v_mfma_f32_16x16x32_bf16 v[88:91], v[184:187], v[116:119], v[88:91]
    ds_read_b64_tr_b16 v[182:183], v195 offset:38400
    s_add_u32 m0, s47, 14336
    s_add_u32 s51, s51, 128
    buffer_load_dwordx4 v219, s[16:19], s67 offen lds
    v_mfma_f32_16x16x32_bf16 v[44:47], v[188:191], v[112:115], v[44:47]
    v_mfma_f32_16x16x32_bf16 v[92:95], v[188:191], v[116:119], v[92:95]
    buffer_load_dwordx4 v220, s[16:19], s67 offen offset:1024 lds
    s_cmp_ge_u32 s51, 1280
    s_cselect_b32 s51, 0x40000000, s51
    s_waitcnt lgkmcnt(6)
    v_mfma_f32_16x16x32_bf16 v[0:3], v[168:171], v[120:123], v[0:3]
    v_mfma_f32_16x16x32_bf16 v[48:51], v[168:171], v[124:127], v[48:51]
    s_waitcnt vmcnt(11) lgkmcnt(0)
    s_barrier
    ds_read_b64_tr_b16 v[184:185], v192 offset:36992
    ds_read_b64_tr_b16 v[186:187], v192 offset:38528
    ds_read_b64_tr_b16 v[188:189], v193 offset:36992
    ds_read_b64_tr_b16 v[190:191], v193 offset:38528
    v_mfma_f32_16x16x32_bf16 v[4:7], v[172:175], v[120:123], v[4:7]
    ds_read_b64_tr_b16 v[168:169], v194 offset:36992
    v_mfma_f32_16x16x32_bf16 v[52:55], v[172:175], v[124:127], v[52:55]
    ds_read_b64_tr_b16 v[170:171], v194 offset:38528
    s_add_u32 s69, s63, s54
    s_and_b32 s69, s69, 15
    s_and_b32 s68, s54, 16
    s_or_b32 s69, s69, s68
    s_xor_b32 s69, s69, s73
    s_add_u32 m0, s45, s53
    s_mul_i32 s69, s69, 12288
    buffer_load_dwordx4 v210, s[20:23], s69 offen nt lds
    v_mfma_f32_16x16x32_bf16 v[8:11], v[176:179], v[120:123], v[8:11]
    ds_read_b64_tr_b16 v[172:173], v195 offset:36992
    v_mfma_f32_16x16x32_bf16 v[56:59], v[176:179], v[124:127], v[56:59]
    ds_read_b64_tr_b16 v[174:175], v195 offset:38528
    s_add_u32 s53, s53, 12288
    s_cmp_ge_u32 s53, 86016
    s_cselect_b32 s53, 0, s53
    buffer_load_dwordx4 v211, s[20:23], s69 offen offset:1024 nt lds
    v_mfma_f32_16x16x32_bf16 v[12:15], v[180:183], v[120:123], v[12:15]
    ds_read_b64_tr_b16 v[176:177], v192 offset:37120
    v_mfma_f32_16x16x32_bf16 v[60:63], v[180:183], v[124:127], v[60:63]
    ds_read_b64_tr_b16 v[178:179], v192 offset:38656
    buffer_load_dwordx4 v212, s[20:23], s69 offen offset:2048 nt lds
    s_add_u32 s54, s54, 1
    s_waitcnt lgkmcnt(6)
    v_mfma_f32_16x16x32_bf16 v[16:19], v[184:187], v[120:123], v[16:19]
    ds_read_b64_tr_b16 v[180:181], v193 offset:37120
    v_mfma_f32_16x16x32_bf16 v[64:67], v[184:187], v[124:127], v[64:67]
    ds_read_b64_tr_b16 v[182:183], v193 offset:38656
    s_add_u32 m0, s45, 110592
    s_nop 0
    buffer_load_dwordx4 v216, s[28:31], s50 offen lds
    ds_read_b128 v[96:99], v196
    v_mfma_f32_16x16x32_bf16 v[20:23], v[188:191], v[120:123], v[20:23]
    ds_read_b64_tr_b16 v[184:185], v194 offset:37120
    v_mfma_f32_16x16x32_bf16 v[68:71], v[188:191], v[124:127], v[68:71]
    ds_read_b64_tr_b16 v[186:187], v194 offset:38656
    buffer_load_dwordx4 v217, s[28:31], s50 offen offset:1024 lds
    ds_read_b128 v[100:103], v196 offset:2048
    s_waitcnt lgkmcnt(8)
    v_mfma_f32_16x16x32_bf16 v[24:27], v[168:171], v[120:123], v[24:27]
    ds_read_b64_tr_b16 v[188:189], v195 offset:37120
    v_mfma_f32_16x16x32_bf16 v[72:75], v[168:171], v[124:127], v[72:75]
    ds_read_b64_tr_b16 v[190:191], v195 offset:38656
    buffer_load_dwordx4 v218, s[28:31], s50 offen offset:2048 lds
    s_add_u32 s50, s50, 393216
    ds_read_b128 v[104:107], v197
    v_mfma_f32_16x16x32_bf16 v[28:31], v[172:175], v[120:123], v[28:31]
    v_mfma_f32_16x16x32_bf16 v[76:79], v[172:175], v[124:127], v[76:79]
    ds_read_b128 v[108:111], v197 offset:2048
    s_waitcnt lgkmcnt(10)
    v_mfma_f32_16x16x32_bf16 v[32:35], v[176:179], v[120:123], v[32:35]
    v_mfma_f32_16x16x32_bf16 v[80:83], v[176:179], v[124:127], v[80:83]
    s_add_u32 s49, s49, 1
    s_cmp_lt_u32 s49, 5
    s_cbranch_scc1 L_q2loop
    s_waitcnt vmcnt(19) lgkmcnt(0)
    s_barrier
    s_add_u32 s69, s63, s55
    s_and_b32 s69, s69, 15
    s_and_b32 s68, s55, 16
    s_or_b32 s69, s69, s68
    s_xor_b32 s69, s69, s73
    s_add_u32 m0, s45, s53
    s_mul_i32 s69, s69, 12288
    buffer_load_dwordx4 v213, s[24:27], s69 offen nt lds
    s_add_u32 s53, s53, 12288
    s_cmp_ge_u32 s53, 86016
    s_cselect_b32 s53, 0, s53
    buffer_load_dwordx4 v214, s[24:27], s69 offen offset:1024 nt lds
    buffer_load_dwordx4 v215, s[24:27], s69 offen offset:2048 nt lds
    s_add_u32 s55, s55, 1
L_qend:
    v_mfma_f32_16x16x32_bf16 v[36:39], v[180:183], v[120:123], v[36:39]
    v_add_u32 v205, s52, v204
    v_xor_b32 v206, 64, v205
    v_mfma_f32_16x16x32_bf16 v[84:87], v[180:183], v[124:127], v[84:87]
    v_mov_b32 v160, 0
    v_mov_b32 v161, 0
    v_mfma_f32_16x16x32_bf16 v[40:43], v[184:187], v[120:123], v[40:43]
    v_mov_b32 v162, 0
    v_mov_b32 v163, 0
    v_mfma_f32_16x16x32_bf16 v[88:91], v[184:187], v[124:127], v[88:91]
    v_mov_b32 v164, 0
    v_mov_b32 v165, 0
    v_mfma_f32_16x16x32_bf16 v[44:47], v[188:191], v[120:123], v[44:47]
    v_mov_b32 v166, 0
    v_mov_b32 v167, 0
    v_mfma_f32_16x16x32_bf16 v[92:95], v[188:191], v[124:127], v[92:95]
    v_mul_f32 v0, s56, v0
    v_mul_f32 v1, s56, v1
    v_mul_f32 v2, s56, v2
    v_mul_f32 v3, s56, v3
    v_mul_f32 v4, s56, v4
    v_mul_f32 v5, s56, v5
    v_mul_f32 v6, s56, v6
    v_mul_f32 v7, s56, v7
    v_mul_f32 v48, s56, v48
    v_mul_f32 v49, s56, v49
    v_mul_f32 v50, s56, v50
    v_mul_f32 v51, s56, v51
    v_mul_f32 v52, s56, v52
    v_mul_f32 v53, s56, v53
    v_mul_f32 v54, s56, v54
    v_mul_f32 v55, s56, v55
    v_cvt_pk_bf16_f32 v96, v0, v1
    v_cvt_pk_bf16_f32 v97, v2, v3
    v_cvt_pk_bf16_f32 v98, v4, v5
    v_cvt_pk_bf16_f32 v99, v6, v7
    v_cvt_pk_bf16_f32 v120, v48, v49
    v_cvt_pk_bf16_f32 v121, v50, v51
    v_cvt_pk_bf16_f32 v122, v52, v53
    v_cvt_pk_bf16_f32 v123, v54, v55
    v_permlane32_swap_b32 v96, v98
    v_permlane32_swap_b32 v97, v99
    v_permlane32_swap_b32 v120, v122
    v_permlane32_swap_b32 v121, v123
    v_permlane16_swap_b32 v96, v98
    v_permlane16_swap_b32 v97, v99
    v_permlane16_swap_b32 v120, v122
    v_permlane16_swap_b32 v121, v123
    v_mul_f32 v8, s56, v8
    v_mul_f32 v9, s56, v9
    v_mul_f32 v10, s56, v10
    v_mul_f32 v11, s56, v11
    v_mul_f32 v12, s56, v12
    v_mul_f32 v13, s56, v13
    v_mul_f32 v14, s56, v14
    v_mul_f32 v15, s56, v15
    v_mul_f32 v56, s56, v56
    v_mul_f32 v57, s56, v57
    v_mul_f32 v58, s56, v58
    v_mul_f32 v59, s56, v59
    v_mul_f32 v60, s56, v60
    v_mul_f32 v61, s56, v61
    v_mul_f32 v62, s56, v62
    v_mul_f32 v63, s56, v63
    v_cvt_pk_bf16_f32 v100, v8, v9
    v_cvt_pk_bf16_f32 v101, v10, v11
    v_cvt_pk_bf16_f32 v102, v12, v13
    v_cvt_pk_bf16_f32 v103, v14, v15
    v_cvt_pk_bf16_f32 v124, v56, v57
    v_cvt_pk_bf16_f32 v125, v58, v59
    v_cvt_pk_bf16_f32 v126, v60, v61
    v_cvt_pk_bf16_f32 v127, v62, v63
    v_permlane32_swap_b32 v100, v102
    v_permlane32_swap_b32 v101, v103
    v_permlane32_swap_b32 v124, v126
    v_permlane32_swap_b32 v125, v127
    v_permlane16_swap_b32 v100, v102
    v_permlane16_swap_b32 v101, v103
    v_permlane16_swap_b32 v124, v126
    v_permlane16_swap_b32 v125, v127
    v_mul_f32 v16, s56, v16
    v_mul_f32 v17, s56, v17
    v_mul_f32 v18, s56, v18
    v_mul_f32 v19, s56, v19
    v_mul_f32 v20, s56, v20
    v_mul_f32 v21, s56, v21
    v_mul_f32 v22, s56, v22
    v_mul_f32 v23, s56, v23
    v_mul_f32 v64, s56, v64
    v_mul_f32 v65, s56, v65
    v_mul_f32 v66, s56, v66
    v_mul_f32 v67, s56, v67
    v_mul_f32 v68, s56, v68
    v_mul_f32 v69, s56, v69
    v_mul_f32 v70, s56, v70
    v_mul_f32 v71, s56, v71
    v_cvt_pk_bf16_f32 v104, v16, v17
    v_cvt_pk_bf16_f32 v105, v18, v19
    v_cvt_pk_bf16_f32 v106, v20, v21
    v_cvt_pk_bf16_f32 v107, v22, v23
    v_cvt_pk_bf16_f32 v128, v64, v65
    v_cvt_pk_bf16_f32 v129, v66, v67
    v_cvt_pk_bf16_f32 v130, v68, v69
    v_cvt_pk_bf16_f32 v131, v70, v71
    v_permlane32_swap_b32 v104, v106
    v_permlane32_swap_b32 v105, v107
    v_permlane32_swap_b32 v128, v130
    v_permlane32_swap_b32 v129, v131
    v_permlane16_swap_b32 v104, v106
    v_permlane16_swap_b32 v105, v107
    v_permlane16_swap_b32 v128, v130
    v_permlane16_swap_b32 v129, v131
    s_setprio 1
    s_waitcnt vmcnt(15)
    s_barrier
    ds_read_b128 v[168:171], v205
    ds_read_b128 v[172:175], v205 offset:1536
    ds_read_b128 v[176:179], v206
    ds_read_b128 v[180:183], v206 offset:1536
    ds_read_b128 v[184:187], v205 offset:128
    s_waitcnt lgkmcnt(3)
    v_mfma_f32_16x16x32_bf16 v[144:147], v[168:171], v[96:99], 0
    ds_read_b128 v[188:191], v205 offset:1664
    v_mul_f32 v24, s56, v24
    v_mul_f32 v25, s56, v25
    v_mul_f32 v26, s56, v26
    v_mul_f32 v27, s56, v27
    v_mul_f32 v28, s56, v28
    v_mfma_f32_16x16x32_bf16 v[152:155], v[168:171], v[120:123], 0
    v_mul_f32 v29, s56, v29
    v_mul_f32 v30, s56, v30
    v_mul_f32 v31, s56, v31
    v_mul_f32 v72, s56, v72
    v_mul_f32 v73, s56, v73
    s_add_u32 s52, s52, 12288
    s_cmp_ge_u32 s52, 86016
    s_cselect_b32 s52, 0, s52
    v_mfma_f32_16x16x32_bf16 v[148:151], v[172:175], v[96:99], 0
    ds_read_b128 v[168:171], v206 offset:128
    v_mul_f32 v74, s56, v74
    v_mul_f32 v75, s56, v75
    v_mul_f32 v76, s56, v76
    v_mul_f32 v77, s56, v77
    v_mul_f32 v78, s56, v78
    v_mul_f32 v79, s56, v79
    v_mfma_f32_16x16x32_bf16 v[156:159], v[172:175], v[120:123], 0
    v_cvt_pk_bf16_f32 v108, v24, v25
    v_cvt_pk_bf16_f32 v109, v26, v27
    v_cvt_pk_bf16_f32 v110, v28, v29
    v_cvt_pk_bf16_f32 v111, v30, v31
    v_cvt_pk_bf16_f32 v132, v72, v73
    s_waitcnt lgkmcnt(3)
    v_mfma_f32_16x16x32_bf16 v[144:147], v[176:179], v[100:103], v[144:147]
    ds_read_b128 v[172:175], v206 offset:1664
    v_cvt_pk_bf16_f32 v133, v74, v75
    v_cvt_pk_bf16_f32 v134, v76, v77
    v_cvt_pk_bf16_f32 v135, v78, v79
    v_permlane32_swap_b32 v108, v110
    v_permlane32_swap_b32 v109, v111
    v_mfma_f32_16x16x32_bf16 v[152:155], v[176:179], v[124:127], v[152:155]
    v_permlane32_swap_b32 v132, v134
    v_permlane32_swap_b32 v133, v135
    v_permlane16_swap_b32 v108, v110
    v_permlane16_swap_b32 v109, v111
    v_permlane16_swap_b32 v132, v134
    v_permlane16_swap_b32 v133, v135
    v_mfma_f32_16x16x32_bf16 v[148:151], v[180:183], v[100:103], v[148:151]
    ds_read_b128 v[176:179], v205 offset:256
    v_mul_f32 v32, s56, v32
    v_mul_f32 v33, s56, v33
    v_mul_f32 v34, s56, v34
    v_mul_f32 v35, s56, v35
    v_mul_f32 v36, s56, v36
    v_mfma_f32_16x16x32_bf16 v[156:159], v[180:183], v[124:127], v[156:159]
    v_mul_f32 v37, s56, v37
    v_mul_f32 v38, s56, v38
    v_mul_f32 v39, s56, v39
    v_mul_f32 v80, s56, v80
    v_mul_f32 v81, s56, v81
    s_waitcnt lgkmcnt(3)
    v_mfma_f32_16x16x32_bf16 v[144:147], v[184:187], v[104:107], v[144:147]
    ds_read_b128 v[180:183], v205 offset:1792
    v_mul_f32 v82, s56, v82
    v_mul_f32 v83, s56, v83
    v_mul_f32 v84, s56, v84
    v_mul_f32 v85, s56, v85
    v_mul_f32 v86, s56, v86
    v_mul_f32 v87, s56, v87
    v_mfma_f32_16x16x32_bf16 v[152:155], v[184:187], v[128:131], v[152:155]
    v_cvt_pk_bf16_f32 v112, v32, v33
    v_cvt_pk_bf16_f32 v113, v34, v35
    v_cvt_pk_bf16_f32 v114, v36, v37
    v_cvt_pk_bf16_f32 v115, v38, v39
    v_cvt_pk_bf16_f32 v136, v80, v81
    v_mfma_f32_16x16x32_bf16 v[148:151], v[188:191], v[104:107], v[148:151]
    ds_read_b128 v[184:187], v206 offset:256
    v_cvt_pk_bf16_f32 v137, v82, v83
    v_cvt_pk_bf16_f32 v138, v84, v85
    v_cvt_pk_bf16_f32 v139, v86, v87
    v_permlane32_swap_b32 v112, v114
    v_permlane32_swap_b32 v113, v115
    v_mfma_f32_16x16x32_bf16 v[156:159], v[188:191], v[128:131], v[156:159]
    v_permlane32_swap_b32 v136, v138
    v_permlane32_swap_b32 v137, v139
    v_permlane16_swap_b32 v112, v114
    v_permlane16_swap_b32 v113, v115
    v_permlane16_swap_b32 v136, v138
    v_permlane16_swap_b32 v137, v139
    s_waitcnt lgkmcnt(3)
    v_mfma_f32_16x16x32_bf16 v[144:147], v[168:171], v[108:111], v[144:147]
    ds_read_b128 v[188:191], v206 offset:1792
    v_mul_f32 v40, s56, v40
    v_mul_f32 v41, s56, v41
    v_mul_f32 v42, s56, v42
    v_mul_f32 v43, s56, v43
    v_mul_f32 v44, s56, v44
    v_mfma_f32_16x16x32_bf16 v[152:155], v[168:171], v[132:135], v[152:155]
    v_mul_f32 v45, s56, v45
    v_mul_f32 v46, s56, v46
    v_mul_f32 v47, s56, v47
    v_mul_f32 v88, s56, v88
    v_mul_f32 v89, s56, v89
    v_mfma_f32_16x16x32_bf16 v[148:151], v[172:175], v[108:111], v[148:151]
    v_mul_f32 v90, s56, v90
    v_mul_f32 v91, s56, v91
    v_mul_f32 v92, s56, v92
    v_mul_f32 v93, s56, v93
    v_mul_f32 v94, s56, v94
    v_mul_f32 v95, s56, v95
    v_mfma_f32_16x16x32_bf16 v[156:159], v[172:175], v[132:135], v[156:159]
    v_cvt_pk_bf16_f32 v116, v40, v41
    v_cvt_pk_bf16_f32 v117, v42, v43
    v_cvt_pk_bf16_f32 v118, v44, v45
    v_cvt_pk_bf16_f32 v119, v46, v47
    v_cvt_pk_bf16_f32 v140, v88, v89
    s_waitcnt lgkmcnt(3)
    v_mfma_f32_16x16x32_bf16 v[144:147], v[176:179], v[112:115], v[144:147]
    v_cvt_pk_bf16_f32 v141, v90, v91
    v_cvt_pk_bf16_f32 v142, v92, v93
    v_cvt_pk_bf16_f32 v143, v94, v95
    v_permlane32_swap_b32 v116, v118
    v_permlane32_swap_b32 v117, v119
    v_mfma_f32_16x16x32_bf16 v[152:155], v[176:179], v[136:139], v[152:155]
    v_permlane32_swap_b32 v140, v142
    v_permlane32_swap_b32 v141, v143
    v_permlane16_swap_b32 v116, v118
    v_permlane16_swap_b32 v117, v119
    v_permlane16_swap_b32 v140, v142
    v_permlane16_swap_b32 v141, v143
    s_waitcnt vmcnt(12) lgkmcnt(0)
    s_barrier
    v_mfma_f32_16x16x32_bf16 v[148:151], v[180:183], v[112:115], v[148:151]
    v_mfma_f32_16x16x32_bf16 v[156:159], v[180:183], v[136:139], v[156:159]
    v_mfma_f32_16x16x32_bf16 v[144:147], v[184:187], v[116:119], v[144:147]
    v_mfma_f32_16x16x32_bf16 v[152:155], v[184:187], v[140:143], v[152:155]
    v_mfma_f32_16x16x32_bf16 v[148:151], v[188:191], v[116:119], v[148:151]
    v_mfma_f32_16x16x32_bf16 v[156:159], v[188:191], v[140:143], v[156:159]
    v_mfma_f32_16x16x32_bf16 v[0:3], v[200:203], v[160:163], 0
    v_mfma_f32_16x16x32_bf16 v[4:7], v[200:203], v[160:163], 0
    v_mfma_f32_16x16x32_bf16 v[8:11], v[200:203], v[160:163], 0
    s_add_u32 s52, s52, 12288
    s_cmp_ge_u32 s52, 86016
    s_cselect_b32 s52, 0, s52
    v_add_u32 v205, s52, v204
    v_xor_b32 v206, 64, v205
    v_mfma_f32_16x16x32_bf16 v[12:15], v[200:203], v[160:163], 0
    v_max3_f32 v207, v144, v145, v146
    v_max3_f32 v208, v152, v153, v154
    v_max3_f32 v207, v207, v147, v148
    v_mfma_f32_16x16x32_bf16 v[16:19], v[200:203], v[160:163], 0
    v_max3_f32 v208, v208, v155, v156
    v_max3_f32 v207, v207, v149, v150
    v_max3_f32 v208, v208, v157, v158
    v_mfma_f32_16x16x32_bf16 v[20:23], v[200:203], v[160:163], 0
    v_max_f32 v207, v207, v151
    v_max_f32 v208, v208, v159
    v_mov_b32 v209, v207
    v_mfma_f32_16x16x32_bf16 v[24:27], v[200:203], v[160:163], 0
    s_nop 1
    v_permlane32_swap_b32 v207, v209
    v_max_f32 v207, v207, v209
    v_mfma_f32_16x16x32_bf16 v[28:31], v[200:203], v[160:163], 0
    v_mov_b32 v209, v207
    s_nop 1
    v_permlane16_swap_b32 v207, v209
    v_mfma_f32_16x16x32_bf16 v[32:35], v[200:203], v[160:163], 0
    v_max_f32 v207, v207, v209
    v_mov_b32 v209, v208
    s_nop 1
    v_mfma_f32_16x16x32_bf16 v[36:39], v[200:203], v[160:163], 0
    v_permlane32_swap_b32 v208, v209
    v_max_f32 v208, v208, v209
    v_mov_b32 v209, v208
    v_mfma_f32_16x16x32_bf16 v[40:43], v[200:203], v[160:163], 0
    s_nop 1
    v_permlane16_swap_b32 v208, v209
    v_max_f32 v208, v208, v209
    v_mfma_f32_16x16x32_bf16 v[44:47], v[200:203], v[160:163], 0
    v_sub_f32 v144, v144, v207
    v_sub_f32 v145, v145, v207
    v_sub_f32 v146, v146, v207
    v_mfma_f32_16x16x32_bf16 v[48:51], v[200:203], v[160:163], 0
    v_sub_f32 v147, v147, v207
    v_sub_f32 v148, v148, v207
    v_sub_f32 v149, v149, v207
    v_mfma_f32_16x16x32_bf16 v[52:55], v[200:203], v[160:163], 0
    v_sub_f32 v150, v150, v207
    v_sub_f32 v151, v151, v207
    v_sub_f32 v192, 0, v207
    v_mfma_f32_16x16x32_bf16 v[56:59], v[200:203], v[160:163], 0
    v_sub_f32 v193, 0, v207
    v_sub_f32 v194, 0, v207
    v_sub_f32 v195, 0, v207
    v_mfma_f32_16x16x32_bf16 v[60:63], v[200:203], v[160:163], 0
    v_sub_f32 v152, v152, v208
    v_sub_f32 v153, v153, v208
    v_sub_f32 v154, v154, v208
    v_mfma_f32_16x16x32_bf16 v[64:67], v[200:203], v[160:163], 0
    v_sub_f32 v155, v155, v208
    v_sub_f32 v156, v156, v208
    v_sub_f32 v157, v157, v208
    v_mfma_f32_16x16x32_bf16 v[68:71], v[200:203], v[160:163], 0
    v_sub_f32 v158, v158, v208
    v_sub_f32 v159, v159, v208
    v_sub_f32 v196, 0, v208
    v_mfma_f32_16x16x32_bf16 v[72:75], v[200:203], v[160:163], 0
    v_sub_f32 v197, 0, v208
    v_sub_f32 v198, 0, v208
    v_sub_f32 v199, 0, v208
    v_mfma_f32_16x16x32_bf16 v[76:79], v[200:203], v[160:163], 0
    v_exp_f32 v144, v144
    v_exp_f32 v145, v145
    v_exp_f32 v146, v146
    v_mfma_f32_16x16x32_bf16 v[80:83], v[200:203], v[160:163], 0
    v_exp_f32 v147, v147
    v_exp_f32 v148, v148
    v_mfma_f32_16x16x32_bf16 v[84:87], v[200:203], v[160:163], 0
    v_mfma_f32_16x16x32_bf16 v[88:91], v[200:203], v[160:163], 0
    v_mfma_f32_16x16x32_bf16 v[92:95], v[200:203], v[160:163], 0
    v_mfma_f32_16x16x32_bf16 v[216:219], v[200:203], v[160:163], 0
    v_mfma_f32_16x16x32_bf16 v[220:223], v[200:203], v[160:163], 0
    s_mov_b32 s58, 0
    s_mov_b32 s49, 0
    s_waitcnt vmcnt(0)
L_aloop:
    s_waitcnt lgkmcnt(0)
    s_barrier
    ds_read_b128 v[168:171], v205
    ds_read_b128 v[172:175], v205 offset:1536
    v_mfma_f32_16x16x32_bf16 v[36:39], v[180:183], v[160:163], v[36:39]
    ds_read_b128 v[176:179], v206
    v_mfma_f32_16x16x32_bf16 v[84:87], v[180:183], v[164:167], v[84:87]
    v_exp_f32 v149, v149
    v_exp_f32 v150, v150
    v_mfma_f32_16x16x32_bf16 v[40:43], v[184:187], v[160:163], v[40:43]
    ds_read_b128 v[180:183], v206 offset:1536
    v_mfma_f32_16x16x32_bf16 v[88:91], v[184:187], v[164:167], v[88:91]
    v_exp_f32 v151, v151
    v_mfma_f32_16x16x32_bf16 v[44:47], v[188:191], v[160:163], v[44:47]
    ds_read_b128 v[184:187], v205 offset:128
    v_mfma_f32_16x16x32_bf16 v[92:95], v[188:191], v[164:167], v[92:95]
    v_exp_f32 v152, v152
    s_cmp_lg_u32 s58, 0
    s_cbranch_scc1 L_resc_l0
L_rret_l0:
    s_waitcnt lgkmcnt(3)
    v_mfma_f32_16x16x32_bf16 v[232:235], v[168:171], v[96:99], v[192:195]
    ds_read_b128 v[188:191], v205 offset:1664
    v_mfma_f32_16x16x32_bf16 v[240:243], v[168:171], v[120:123], v[196:199]
    v_exp_f32 v153, v153
    v_exp_f32 v154, v154
    v_mfma_f32_16x16x32_bf16 v[236:239], v[172:175], v[96:99], v[192:195]
    ds_read_b128 v[168:171], v206 offset:128
    v_mfma_f32_16x16x32_bf16 v[244:247], v[172:175], v[120:123], v[196:199]
    v_exp_f32 v155, v155
    s_waitcnt lgkmcnt(3)
    v_mfma_f32_16x16x32_bf16 v[232:235], v[176:179], v[100:103], v[232:235]
    ds_read_b128 v[172:175], v206 offset:1664
    v_mfma_f32_16x16x32_bf16 v[240:243], v[176:179], v[124:127], v[240:243]
    v_exp_f32 v156, v156
    v_mfma_f32_16x16x32_bf16 v[236:239], v[180:183], v[100:103], v[236:239]
    ds_read_b128 v[176:179], v205 offset:256
    v_mfma_f32_16x16x32_bf16 v[244:247], v[180:183], v[124:127], v[244:247]
    v_exp_f32 v157, v157
    v_exp_f32 v158, v158
    s_waitcnt lgkmcnt(3)
    v_mfma_f32_16x16x32_bf16 v[232:235], v[184:187], v[104:107], v[232:235]
    ds_read_b128 v[180:183], v205 offset:1792
    v_mfma_f32_16x16x32_bf16 v[240:243], v[184:187], v[128:131], v[240:243]
    v_exp_f32 v159, v159
    v_mfma_f32_16x16x32_bf16 v[236:239], v[188:191], v[104:107], v[236:239]
    ds_read_b128 v[184:187], v206 offset:256
    v_mfma_f32_16x16x32_bf16 v[244:247], v[188:191], v[128:131], v[244:247]
    v_cvt_pk_bf16_f32 v160, v144, v145
    v_cvt_pk_bf16_f32 v161, v146, v147
    v_cvt_pk_bf16_f32 v162, v148, v149
    s_waitcnt lgkmcnt(3)
    v_mfma_f32_16x16x32_bf16 v[232:235], v[168:171], v[108:111], v[232:235]
    ds_read_b128 v[188:191], v206 offset:1792
    v_mfma_f32_16x16x32_bf16 v[240:243], v[168:171], v[132:135], v[240:243]
    v_cvt_pk_bf16_f32 v163, v150, v151
    v_cvt_pk_bf16_f32 v164, v152, v153
    v_mfma_f32_16x16x32_bf16 v[236:239], v[172:175], v[108:111], v[236:239]
    v_mfma_f32_16x16x32_bf16 v[244:247], v[172:175], v[132:135], v[244:247]
    v_cvt_pk_bf16_f32 v165, v154, v155
    v_cvt_pk_bf16_f32 v166, v156, v157
    v_cvt_pk_bf16_f32 v167, v158, v159
    s_add_u32 s52, s52, 12288
    s_cmp_ge_u32 s52, 86016
    s_cselect_b32 s52, 0, s52
    s_waitcnt lgkmcnt(3)
    v_mfma_f32_16x16x32_bf16 v[232:235], v[176:179], v[112:115], v[232:235]
    v_add_u32 v225, s52, v224
    v_xor_b32 v226, 32, v225
    v_mfma_f32_16x16x32_bf16 v[240:243], v[176:179], v[136:139], v[240:243]
    v_xor_b32 v227, 64, v225
    v_xor_b32 v228, 96, v225
    s_waitcnt lgkmcnt(0)
    s_barrier
    ds_read_b64_tr_b16 v[168:169], v225
    ds_read_b64_tr_b16 v[170:171], v225 offset:1536
    ds_read_b64_tr_b16 v[172:173], v226
    ds_read_b64_tr_b16 v[174:175], v226 offset:1536
    v_mfma_f32_16x16x32_bf16 v[236:239], v[180:183], v[112:115], v[236:239]
    ds_read_b64_tr_b16 v[176:177], v227
    v_mfma_f32_16x16x32_bf16 v[244:247], v[180:183], v[136:139], v[244:247]
    ds_read_b64_tr_b16 v[178:179], v227 offset:1536
    s_add_u32 s52, s52, 12288
    s_cmp_ge_u32 s52, 86016
    s_cselect_b32 s52, 0, s52
    v_mfma_f32_16x16x32_bf16 v[232:235], v[184:187], v[116:119], v[232:235]
    ds_read_b64_tr_b16 v[180:181], v228
    v_mfma_f32_16x16x32_bf16 v[240:243], v[184:187], v[140:143], v[240:243]
    ds_read_b64_tr_b16 v[182:183], v228 offset:1536
    v_mfma_f32_16x16x32_bf16 v[236:239], v[188:191], v[116:119], v[236:239]
    ds_read_b64_tr_b16 v[184:185], v225 offset:128
    v_mfma_f32_16x16x32_bf16 v[244:247], v[188:191], v[140:143], v[244:247]
    ds_read_b64_tr_b16 v[186:187], v225 offset:1664
    v_add_u32 v205, s52, v204
    v_xor_b32 v206, 64, v205
    v_mfma_f32_16x16x32_bf16 v[216:219], v[200:203], v[160:163], v[216:219]
    v_mfma_f32_16x16x32_bf16 v[220:223], v[200:203], v[164:167], v[220:223]
    s_waitcnt lgkmcnt(6)
    v_mfma_f32_16x16x32_bf16 v[0:3], v[168:171], v[160:163], v[0:3]
    ds_read_b64_tr_b16 v[188:189], v226 offset:128
    v_mfma_f32_16x16x32_bf16 v[48:51], v[168:171], v[164:167], v[48:51]
    ds_read_b64_tr_b16 v[190:191], v226 offset:1664
    v_mfma_f32_16x16x32_bf16 v[4:7], v[172:175], v[160:163], v[4:7]
    ds_read_b64_tr_b16 v[168:169], v227 offset:128
    v_max3_f32 v207, v232, v233, v234
    v_max3_f32 v208, v240, v241, v242
    v_mfma_f32_16x16x32_bf16 v[52:55], v[172:175], v[164:167], v[52:55]
    ds_read_b64_tr_b16 v[170:171], v227 offset:1664
    v_max3_f32 v207, v207, v235, v236
    v_max3_f32 v208, v208, v243, v244
    s_waitcnt lgkmcnt(6)
    v_mfma_f32_16x16x32_bf16 v[8:11], v[176:179], v[160:163], v[8:11]
    ds_read_b64_tr_b16 v[172:173], v228 offset:128
    v_mfma_f32_16x16x32_bf16 v[56:59], v[176:179], v[164:167], v[56:59]
    ds_read_b64_tr_b16 v[174:175], v228 offset:1664
    v_max3_f32 v207, v207, v237, v238
    v_max3_f32 v208, v208, v245, v246
    v_max_f32 v207, v207, v239
    v_max_f32 v208, v208, v247
    v_max_f32 v209, v207, v208
    v_cmp_lt_f32 vcc, s57, v209
    s_cbranch_vccnz L_rare_l0
L_ret_l0:
    v_mfma_f32_16x16x32_bf16 v[12:15], v[180:183], v[160:163], v[12:15]
    ds_read_b64_tr_b16 v[176:177], v225 offset:256
    v_mfma_f32_16x16x32_bf16 v[60:63], v[180:183], v[164:167], v[60:63]
    ds_read_b64_tr_b16 v[178:179], v225 offset:1792
    v_exp_f32 v232, v232
    s_waitcnt lgkmcnt(6)
    v_mfma_f32_16x16x32_bf16 v[16:19], v[184:187], v[160:163], v[16:19]
    ds_read_b64_tr_b16 v[180:181], v226 offset:256
    v_mfma_f32_16x16x32_bf16 v[64:67], v[184:187], v[164:167], v[64:67]
    ds_read_b64_tr_b16 v[182:183], v226 offset:1792
    v_exp_f32 v233, v233
    v_mfma_f32_16x16x32_bf16 v[20:23], v[188:191], v[160:163], v[20:23]
    ds_read_b64_tr_b16 v[184:185], v227 offset:256
    v_mfma_f32_16x16x32_bf16 v[68:71], v[188:191], v[164:167], v[68:71]
    ds_read_b64_tr_b16 v[186:187], v227 offset:1792
    v_exp_f32 v234, v234
    s_waitcnt lgkmcnt(6)
    v_mfma_f32_16x16x32_bf16 v[24:27], v[168:171], v[160:163], v[24:27]
    ds_read_b64_tr_b16 v[188:189], v228 offset:256
    v_mfma_f32_16x16x32_bf16 v[72:75], v[168:171], v[164:167], v[72:75]
    ds_read_b64_tr_b16 v[190:191], v228 offset:1792
    v_exp_f32 v235, v235
    v_mfma_f32_16x16x32_bf16 v[28:31], v[172:175], v[160:163], v[28:31]
    v_mfma_f32_16x16x32_bf16 v[76:79], v[172:175], v[164:167], v[76:79]
    s_waitcnt lgkmcnt(6)
    v_mfma_f32_16x16x32_bf16 v[32:35], v[176:179], v[160:163], v[32:35]
    v_mfma_f32_16x16x32_bf16 v[80:83], v[176:179], v[164:167], v[80:83]
    v_exp_f32 v236, v236
    s_add_u32 s49, s49, 1
    s_cmp_eq_u32 s49, 8
    s_cbranch_scc1 L_aexit
    s_waitcnt lgkmcnt(0)
    s_barrier
    ds_read_b128 v[168:171], v205
    ds_read_b128 v[172:175], v205 offset:1536
    v_mfma_f32_16x16x32_bf16 v[36:39], v[180:183], v[160:163], v[36:39]
    ds_read_b128 v[176:179], v206
    v_mfma_f32_16x16x32_bf16 v[84:87], v[180:183], v[164:167], v[84:87]
    v_exp_f32 v237, v237
    v_exp_f32 v238, v238
    v_mfma_f32_16x16x32_bf16 v[40:43], v[184:187], v[160:163], v[40:43]
    ds_read_b128 v[180:183], v206 offset:1536
    v_mfma_f32_16x16x32_bf16 v[88:91], v[184:187], v[164:167], v[88:91]
    v_exp_f32 v239, v239
    v_mfma_f32_16x16x32_bf16 v[44:47], v[188:191], v[160:163], v[44:47]
    ds_read_b128 v[184:187], v205 offset:128
    v_mfma_f32_16x16x32_bf16 v[92:95], v[188:191], v[164:167], v[92:95]
    v_exp_f32 v240, v240
    s_cmp_lg_u32 s58, 0
    s_cbranch_scc1 L_resc_l1
L_rret_l1:
    s_waitcnt lgkmcnt(3)
    v_mfma_f32_16x16x32_bf16 v[144:147], v[168:171], v[96:99], v[192:195]
    ds_read_b128 v[188:191], v205 offset:1664
    v_mfma_f32_16x16x32_bf16 v[152:155], v[168:171], v[120:123], v[196:199]
    v_exp_f32 v241, v241
    v_exp_f32 v242, v242
    v_mfma_f32_16x16x32_bf16 v[148:151], v[172:175], v[96:99], v[192:195]
    ds_read_b128 v[168:171], v206 offset:128
    v_mfma_f32_16x16x32_bf16 v[156:159], v[172:175], v[120:123], v[196:199]
    v_exp_f32 v243, v243
    s_waitcnt lgkmcnt(3)
    v_mfma_f32_16x16x32_bf16 v[144:147], v[176:179], v[100:103], v[144:147]
    ds_read_b128 v[172:175], v206 offset:1664
    v_mfma_f32_16x16x32_bf16 v[152:155], v[176:179], v[124:127], v[152:155]
    v_exp_f32 v244, v244
    v_mfma_f32_16x16x32_bf16 v[148:151], v[180:183], v[100:103], v[148:151]
    ds_read_b128 v[176:179], v205 offset:256
    v_mfma_f32_16x16x32_bf16 v[156:159], v[180:183], v[124:127], v[156:159]
    v_exp_f32 v245, v245
    v_exp_f32 v246, v246
    s_waitcnt lgkmcnt(3)
    v_mfma_f32_16x16x32_bf16 v[144:147], v[184:187], v[104:107], v[144:147]
    ds_read_b128 v[180:183], v205 offset:1792
    v_mfma_f32_16x16x32_bf16 v[152:155], v[184:187], v[128:131], v[152:155]
    v_exp_f32 v247, v247
    v_mfma_f32_16x16x32_bf16 v[148:151], v[188:191], v[104:107], v[148:151]
    ds_read_b128 v[184:187], v206 offset:256
    v_mfma_f32_16x16x32_bf16 v[156:159], v[188:191], v[128:131], v[156:159]
    v_cvt_pk_bf16_f32 v160, v232, v233
    v_cvt_pk_bf16_f32 v161, v234, v235
    v_cvt_pk_bf16_f32 v162, v236, v237
    s_waitcnt lgkmcnt(3)
    v_mfma_f32_16x16x32_bf16 v[144:147], v[168:171], v[108:111], v[144:147]
    ds_read_b128 v[188:191], v206 offset:1792
    v_mfma_f32_16x16x32_bf16 v[152:155], v[168:171], v[132:135], v[152:155]
    v_cvt_pk_bf16_f32 v163, v238, v239
    v_cvt_pk_bf16_f32 v164, v240, v241
    v_mfma_f32_16x16x32_bf16 v[148:151], v[172:175], v[108:111], v[148:151]
    v_mfma_f32_16x16x32_bf16 v[156:159], v[172:175], v[132:135], v[156:159]
    v_cvt_pk_bf16_f32 v165, v242, v243
    v_cvt_pk_bf16_f32 v166, v244, v245
    v_cvt_pk_bf16_f32 v167, v246, v247
    s_add_u32 s52, s52, 12288
    s_cmp_ge_u32 s52, 86016
    s_cselect_b32 s52, 0, s52
    s_waitcnt lgkmcnt(3)
    v_mfma_f32_16x16x32_bf16 v[144:147], v[176:179], v[112:115], v[144:147]
    v_add_u32 v225, s52, v224
    v_xor_b32 v226, 32, v225
    v_mfma_f32_16x16x32_bf16 v[152:155], v[176:179], v[136:139], v[152:155]
    v_xor_b32 v227, 64, v225
    v_xor_b32 v228, 96, v225
    s_waitcnt lgkmcnt(0)
    s_barrier
    ds_read_b64_tr_b16 v[168:169], v225
    ds_read_b64_tr_b16 v[170:171], v225 offset:1536
    ds_read_b64_tr_b16 v[172:173], v226
    ds_read_b64_tr_b16 v[174:175], v226 offset:1536
    v_mfma_f32_16x16x32_bf16 v[148:151], v[180:183], v[112:115], v[148:151]
    ds_read_b64_tr_b16 v[176:177], v227
    v_mfma_f32_16x16x32_bf16 v[156:159], v[180:183], v[136:139], v[156:159]
    ds_read_b64_tr_b16 v[178:179], v227 offset:1536
    s_add_u32 s52, s52, 12288
    s_cmp_ge_u32 s52, 86016
    s_cselect_b32 s52, 0, s52
    v_mfma_f32_16x16x32_bf16 v[144:147], v[184:187], v[116:119], v[144:147]
    ds_read_b64_tr_b16 v[180:181], v228
    v_mfma_f32_16x16x32_bf16 v[152:155], v[184:187], v[140:143], v[152:155]
    ds_read_b64_tr_b16 v[182:183], v228 offset:1536
    v_mfma_f32_16x16x32_bf16 v[148:151], v[188:191], v[116:119], v[148:151]
    ds_read_b64_tr_b16 v[184:185], v225 offset:128
    v_mfma_f32_16x16x32_bf16 v[156:159], v[188:191], v[140:143], v[156:159]
    ds_read_b64_tr_b16 v[186:187], v225 offset:1664
    v_add_u32 v205, s52, v204
    v_xor_b32 v206, 64, v205
    v_mfma_f32_16x16x32_bf16 v[216:219], v[200:203], v[160:163], v[216:219]
    v_mfma_f32_16x16x32_bf16 v[220:223], v[200:203], v[164:167], v[220:223]
    s_waitcnt lgkmcnt(6)
    v_mfma_f32_16x16x32_bf16 v[0:3], v[168:171], v[160:163], v[0:3]
    ds_read_b64_tr_b16 v[188:189], v226 offset:128
    v_mfma_f32_16x16x32_bf16 v[48:51], v[168:171], v[164:167], v[48:51]
    ds_read_b64_tr_b16 v[190:191], v226 offset:1664
    v_mfma_f32_16x16x32_bf16 v[4:7], v[172:175], v[160:163], v[4:7]
    ds_read_b64_tr_b16 v[168:169], v227 offset:128
    v_max3_f32 v207, v144, v145, v146
    v_max3_f32 v208, v152, v153, v154
    v_mfma_f32_16x16x32_bf16 v[52:55], v[172:175], v[164:167], v[52:55]
    ds_read_b64_tr_b16 v[170:171], v227 offset:1664
    v_max3_f32 v207, v207, v147, v148
    v_max3_f32 v208, v208, v155, v156
    s_waitcnt lgkmcnt(6)
    v_mfma_f32_16x16x32_bf16 v[8:11], v[176:179], v[160:163], v[8:11]
    ds_read_b64_tr_b16 v[172:173], v228 offset:128
    v_mfma_f32_16x16x32_bf16 v[56:59], v[176:179], v[164:167], v[56:59]
    ds_read_b64_tr_b16 v[174:175], v228 offset:1664
    v_max3_f32 v207, v207, v149, v150
    v_max3_f32 v208, v208, v157, v158
    v_max_f32 v207, v207, v151
    v_max_f32 v208, v208, v159
    v_max_f32 v209, v207, v208
    v_cmp_lt_f32 vcc, s57, v209
    s_cbranch_vccnz L_rare_l1
L_ret_l1:
    v_mfma_f32_16x16x32_bf16 v[12:15], v[180:183], v[160:163], v[12:15]
    ds_read_b64_tr_b16 v[176:177], v225 offset:256
    v_mfma_f32_16x16x32_bf16 v[60:63], v[180:183], v[164:167], v[60:63]
    ds_read_b64_tr_b16 v[178:179], v225 offset:1792
    v_exp_f32 v144, v144
    s_waitcnt lgkmcnt(6)
    v_mfma_f32_16x16x32_bf16 v[16:19], v[184:187], v[160:163], v[16:19]
    ds_read_b64_tr_b16 v[180:181], v226 offset:256
    v_mfma_f32_16x16x32_bf16 v[64:67], v[184:187], v[164:167], v[64:67]
    ds_read_b64_tr_b16 v[182:183], v226 offset:1792
    v_exp_f32 v145, v145
    v_mfma_f32_16x16x32_bf16 v[20:23], v[188:191], v[160:163], v[20:23]
    ds_read_b64_tr_b16 v[184:185], v227 offset:256
    v_mfma_f32_16x16x32_bf16 v[68:71], v[188:191], v[164:167], v[68:71]
    ds_read_b64_tr_b16 v[186:187], v227 offset:1792
    v_exp_f32 v146, v146
    s_waitcnt lgkmcnt(6)
    v_mfma_f32_16x16x32_bf16 v[24:27], v[168:171], v[160:163], v[24:27]
    ds_read_b64_tr_b16 v[188:189], v228 offset:256
    v_mfma_f32_16x16x32_bf16 v[72:75], v[168:171], v[164:167], v[72:75]
    ds_read_b64_tr_b16 v[190:191], v228 offset:1792
    v_exp_f32 v147, v147
    v_mfma_f32_16x16x32_bf16 v[28:31], v[172:175], v[160:163], v[28:31]
    v_mfma_f32_16x16x32_bf16 v[76:79], v[172:175], v[164:167], v[76:79]
    s_waitcnt lgkmcnt(6)
    v_mfma_f32_16x16x32_bf16 v[32:35], v[176:179], v[160:163], v[32:35]
    v_mfma_f32_16x16x32_bf16 v[80:83], v[176:179], v[164:167], v[80:83]
    v_exp_f32 v148, v148
    s_branch L_aloop
L_aexit:
    s_cmp_lg_u32 s41, 0
    s_cbranch_scc1 L_g2tail
    s_waitcnt lgkmcnt(0)
    s_barrier
    v_mfma_f32_16x16x32_bf16 v[36:39], v[180:183], v[160:163], v[36:39]
    v_mfma_f32_16x16x32_bf16 v[84:87], v[180:183], v[164:167], v[84:87]
    v_exp_f32 v237, v237
    v_exp_f32 v238, v238
    v_mfma_f32_16x16x32_bf16 v[40:43], v[184:187], v[160:163], v[40:43]
    v_mfma_f32_16x16x32_bf16 v[88:91], v[184:187], v[164:167], v[88:91]
    v_exp_f32 v239, v239
    v_exp_f32 v240, v240
    v_mfma_f32_16x16x32_bf16 v[44:47], v[188:191], v[160:163], v[44:47]
    v_mfma_f32_16x16x32_bf16 v[92:95], v[188:191], v[164:167], v[92:95]
    s_add_u32 s69, s63, 2
    s_and_b32 s69, s69, 15
    s_or_b32 s69, s69, s74
    s_add_u32 m0, s45, 12288
    s_mul_i32 s69, s69, 12288
    buffer_load_dwordx4 v210, s[20:23], s69 offen nt lds
    buffer_load_dwordx4 v211, s[20:23], s69 offen offset:1024 nt lds
    buffer_load_dwordx4 v212, s[20:23], s69 offen offset:2048 nt lds
    v_exp_f32 v241, v241
    v_exp_f32 v242, v242
    v_exp_f32 v243, v243
    v_exp_f32 v244, v244
    v_exp_f32 v245, v245
    v_exp_f32 v246, v246
    v_exp_f32 v247, v247
    v_cvt_pk_bf16_f32 v160, v232, v233
    v_cvt_pk_bf16_f32 v161, v234, v235
    v_cvt_pk_bf16_f32 v162, v236, v237
    v_cvt_pk_bf16_f32 v163, v238, v239
    v_cvt_pk_bf16_f32 v164, v240, v241
    v_cvt_pk_bf16_f32 v165, v242, v243
    v_cvt_pk_bf16_f32 v166, v244, v245
    v_cvt_pk_bf16_f32 v167, v246, v247
    s_cmp_lg_u32 s58, 0
    s_cbranch_scc1 L_resc_e0
L_rret_e0:
    s_add_u32 s52, s52, 12288
    s_cmp_ge_u32 s52, 86016
    s_cselect_b32 s52, 0, s52
    v_mfma_f32_16x16x32_bf16 v[216:219], v[200:203], v[160:163], v[216:219]
    v_mfma_f32_16x16x32_bf16 v[220:223], v[200:203], v[164:167], v[220:223]
    v_add_u32 v225, s52, v224
    v_xor_b32 v226, 32, v225
    v_xor_b32 v227, 64, v225
    v_xor_b32 v228, 96, v225
    s_add_u32 s68, s65, 1
    s_sub_u32 s64, s68, 10
    s_cselect_b32 s68, s68, s64
    s_lshl_b32 s68, s68, 7
    s_add_u32 s68, s68, s60
    s_add_u32 m0, s59, 86016
    s_add_u32 s66, s68, 0
    buffer_load_dwordx4 v248, s[32:35], s66 offen lds
    s_add_u32 s67, s68, 9216
    buffer_load_dwordx4 v248, s[32:35], s67 offen offset:1024 lds
    s_add_u32 s68, s68, 18432
    buffer_load_dwordx4 v248, s[32:35], s68 offen offset:2048 lds
    v_rcp_f32 v230, v216
    v_rcp_f32 v231, v220
    s_barrier
    ds_read_b64_tr_b16 v[168:169], v225
    ds_read_b64_tr_b16 v[170:171], v225 offset:1536
    ds_read_b64_tr_b16 v[172:173], v226
    ds_read_b64_tr_b16 v[174:175], v226 offset:1536
    ds_read_b64_tr_b16 v[176:177], v227
    ds_read_b64_tr_b16 v[178:179], v227 offset:1536
    ds_read_b64_tr_b16 v[180:181], v228
    ds_read_b64_tr_b16 v[182:183], v228 offset:1536
    ds_read_b64_tr_b16 v[184:185], v225 offset:128
    ds_read_b64_tr_b16 v[186:187], v225 offset:1664
    s_waitcnt lgkmcnt(6)
    v_mfma_f32_16x16x32_bf16 v[0:3], v[168:171], v[160:163], v[0:3]
    ds_read_b64_tr_b16 v[188:189], v226 offset:128
    v_mfma_f32_16x16x32_bf16 v[48:51], v[168:171], v[164:167], v[48:51]
    ds_read_b64_tr_b16 v[190:191], v226 offset:1664
    s_add_u32 s69, s63, 1
    s_and_b32 s69, s69, 15
    s_or_b32 s69, s69, s74
    s_add_u32 m0, s45, 24576
    s_mul_i32 s69, s69, 12288
    buffer_load_dwordx4 v213, s[24:27], s69 offen nt lds
    v_mfma_f32_16x16x32_bf16 v[4:7], v[172:175], v[160:163], v[4:7]
    ds_read_b64_tr_b16 v[168:169], v227 offset:128
    v_mfma_f32_16x16x32_bf16 v[52:55], v[172:175], v[164:167], v[52:55]
    ds_read_b64_tr_b16 v[170:171], v227 offset:1664
    buffer_load_dwordx4 v214, s[24:27], s69 offen offset:1024 nt lds
    s_waitcnt lgkmcnt(6)
    v_mfma_f32_16x16x32_bf16 v[8:11], v[176:179], v[160:163], v[8:11]
    ds_read_b64_tr_b16 v[172:173], v228 offset:128
    v_mfma_f32_16x16x32_bf16 v[56:59], v[176:179], v[164:167], v[56:59]
    ds_read_b64_tr_b16 v[174:175], v228 offset:1664
    buffer_load_dwordx4 v215, s[24:27], s69 offen offset:2048 nt lds
    v_mfma_f32_16x16x32_bf16 v[12:15], v[180:183], v[160:163], v[12:15]
    ds_read_b64_tr_b16 v[176:177], v225 offset:256
    v_mfma_f32_16x16x32_bf16 v[60:63], v[180:183], v[164:167], v[60:63]
    ds_read_b64_tr_b16 v[178:179], v225 offset:1792
    s_add_u32 s68, s65, 1
    s_sub_u32 s64, s68, 10
    s_cselect_b32 s68, s68, s64
    s_lshl_b32 s68, s68, 7
    s_add_u32 s68, s68, s60
    s_add_u32 m0, s59, 89088
    s_add_u32 s66, s68, 30720
    buffer_load_dwordx4 v248, s[32:35], s66 offen lds
    s_waitcnt lgkmcnt(6)
    v_mfma_f32_16x16x32_bf16 v[16:19], v[184:187], v[160:163], v[16:19]
    ds_read_b64_tr_b16 v[180:181], v226 offset:256
    v_mfma_f32_16x16x32_bf16 v[64:67], v[184:187], v[164:167], v[64:67]
    ds_read_b64_tr_b16 v[182:183], v226 offset:1792
    s_add_u32 s67, s68, 39936
    buffer_load_dwordx4 v248, s[32:35], s67 offen offset:1024 lds
    v_mfma_f32_16x16x32_bf16 v[20:23], v[188:191], v[160:163], v[20:23]
    ds_read_b64_tr_b16 v[184:185], v227 offset:256
    v_mfma_f32_16x16x32_bf16 v[68:71], v[188:191], v[164:167], v[68:71]
    ds_read_b64_tr_b16 v[186:187], v227 offset:1792
    s_add_u32 s68, s68, 49152
    buffer_load_dwordx4 v248, s[32:35], s68 offen offset:2048 lds
    s_waitcnt lgkmcnt(6)
    v_mfma_f32_16x16x32_bf16 v[24:27], v[168:171], v[160:163], v[24:27]
    ds_read_b64_tr_b16 v[188:189], v228 offset:256
    v_mfma_f32_16x16x32_bf16 v[72:75], v[168:171], v[164:167], v[72:75]
    ds_read_b64_tr_b16 v[190:191], v228 offset:1792
    v_mfma_f32_16x16x32_bf16 v[28:31], v[172:175], v[160:163], v[28:31]
    v_mfma_f32_16x16x32_bf16 v[76:79], v[172:175], v[164:167], v[76:79]
    s_waitcnt lgkmcnt(6)
    v_mfma_f32_16x16x32_bf16 v[32:35], v[176:179], v[160:163], v[32:35]
    v_mfma_f32_16x16x32_bf16 v[80:83], v[176:179], v[164:167], v[80:83]
    s_setprio 0
    s_waitcnt lgkmcnt(0)
    s_barrier
    v_mfma_f32_16x16x32_bf16 v[36:39], v[180:183], v[160:163], v[36:39]
    v_mfma_f32_16x16x32_bf16 v[84:87], v[180:183], v[164:167], v[84:87]
    v_mfma_f32_16x16x32_bf16 v[40:43], v[184:187], v[160:163], v[40:43]
    v_mfma_f32_16x16x32_bf16 v[88:91], v[184:187], v[164:167], v[88:91]
    v_mfma_f32_16x16x32_bf16 v[44:47], v[188:191], v[160:163], v[44:47]
    v_mfma_f32_16x16x32_bf16 v[92:95], v[188:191], v[164:167], v[92:95]
    s_add_u32 s69, s63, 3
    s_and_b32 s69, s69, 15
    s_or_b32 s69, s69, s74
    s_add_u32 m0, s45, 36864
    s_mul_i32 s69, s69, 12288
    buffer_load_dwordx4 v210, s[20:23], s69 offen nt lds
    v_mul_f32 v0, v0, v230
    v_mul_f32 v1, v1, v230
    v_mul_f32 v2, v2, v230
    v_mul_f32 v3, v3, v230
    v_mul_f32 v4, v4, v230
    v_mul_f32 v5, v5, v230
    v_mul_f32 v6, v6, v230
    v_mul_f32 v7, v7, v230
    v_mul_f32 v48, v48, v231
    v_mul_f32 v49, v49, v231
    v_mul_f32 v50, v50, v231
    v_mul_f32 v51, v51, v231
    v_mul_f32 v52, v52, v231
    v_mul_f32 v53, v53, v231
    v_mul_f32 v54, v54, v231
    v_mul_f32 v55, v55, v231
    buffer_load_dwordx4 v211, s[20:23], s69 offen offset:1024 nt lds
    v_cvt_pk_bf16_f32 v96, v0, v1
    v_cvt_pk_bf16_f32 v97, v2, v3
    v_cvt_pk_bf16_f32 v98, v4, v5
    v_cvt_pk_bf16_f32 v99, v6, v7
    v_cvt_pk_bf16_f32 v120, v48, v49
    v_cvt_pk_bf16_f32 v121, v50, v51
    v_cvt_pk_bf16_f32 v122, v52, v53
    v_cvt_pk_bf16_f32 v123, v54, v55
    buffer_load_dwordx4 v212, s[20:23], s69 offen offset:2048 nt lds
    v_mul_f32 v8, v8, v230
    v_mul_f32 v9, v9, v230
    v_mul_f32 v10, v10, v230
    v_mul_f32 v11, v11, v230
    v_mul_f32 v12, v12, v230
    v_mul_f32 v13, v13, v230
    v_mul_f32 v14, v14, v230
    v_mul_f32 v15, v15, v230
    v_mul_f32 v56, v56, v231
    v_mul_f32 v57, v57, v231
    v_mul_f32 v58, v58, v231
    v_mul_f32 v59, v59, v231
    v_mul_f32 v60, v60, v231
    v_mul_f32 v61, v61, v231
    v_mul_f32 v62, v62, v231
    v_mul_f32 v63, v63, v231
    s_add_u32 s68, s65, 2
    s_sub_u32 s64, s68, 10
    s_cselect_b32 s68, s68, s64
    s_lshl_b32 s68, s68, 7
    s_add_u32 s68, s68, s60
    s_add_u32 m0, s59, 110592
    s_add_u32 s66, s68, 0
    buffer_load_dwordx4 v248, s[32:35], s66 offen lds
    v_cvt_pk_bf16_f32 v100, v8, v9
    v_cvt_pk_bf16_f32 v101, v10, v11
    v_cvt_pk_bf16_f32 v102, v12, v13
    v_cvt_pk_bf16_f32 v103, v14, v15
    v_cvt_pk_bf16_f32 v124, v56, v57
    v_cvt_pk_bf16_f32 v125, v58, v59
    v_cvt_pk_bf16_f32 v126, v60, v61
    v_cvt_pk_bf16_f32 v127, v62, v63
    s_add_u32 s67, s68, 9216
    buffer_load_dwordx4 v248, s[32:35], s67 offen offset:1024 lds
    v_mul_f32 v16, v16, v230
    v_mul_f32 v17, v17, v230
    v_mul_f32 v18, v18, v230
    v_mul_f32 v19, v19, v230
    v_mul_f32 v20, v20, v230
    v_mul_f32 v21, v21, v230
    v_mul_f32 v22, v22, v230
    v_mul_f32 v23, v23, v230
    v_mul_f32 v64, v64, v231
    v_mul_f32 v65, v65, v231
    v_mul_f32 v66, v66, v231
    v_mul_f32 v67, v67, v231
    v_mul_f32 v68, v68, v231
    v_mul_f32 v69, v69, v231
    v_mul_f32 v70, v70, v231
    v_mul_f32 v71, v71, v231
    s_add_u32 s68, s68, 18432
    buffer_load_dwordx4 v248, s[32:35], s68 offen offset:2048 lds
    v_cvt_pk_bf16_f32 v104, v16, v17
    v_cvt_pk_bf16_f32 v105, v18, v19
    v_cvt_pk_bf16_f32 v106, v20, v21
    v_cvt_pk_bf16_f32 v107, v22, v23
    v_cvt_pk_bf16_f32 v128, v64, v65
    v_cvt_pk_bf16_f32 v129, v66, v67
    v_cvt_pk_bf16_f32 v130, v68, v69
    v_cvt_pk_bf16_f32 v131, v70, v71
    v_mov_b32 v160, 0
    v_mov_b32 v161, 0
    v_mov_b32 v162, 0
    v_mov_b32 v163, 0
    v_mov_b32 v164, 159744
    ds_write_b128 v164, v[160:163]
    s_waitcnt lgkmcnt(0)
    s_waitcnt vmcnt(7)
    s_barrier
    s_add_u32 s69, s63, 2
    s_and_b32 s69, s69, 15
    s_or_b32 s69, s69, s74
    s_add_u32 m0, s45, 49152
    s_mul_i32 s69, s69, 12288
    buffer_load_dwordx4 v213, s[24:27], s69 offen nt lds
    v_mul_f32 v24, v24, v230
    v_mul_f32 v25, v25, v230
    v_mul_f32 v26, v26, v230
    v_mul_f32 v27, v27, v230
    v_mul_f32 v28, v28, v230
    v_mul_f32 v29, v29, v230
    v_mul_f32 v30, v30, v230
    v_mul_f32 v31, v31, v230
    v_mul_f32 v72, v72, v231
    v_mul_f32 v73, v73, v231
    v_mul_f32 v74, v74, v231
    v_mul_f32 v75, v75, v231
    v_mul_f32 v76, v76, v231
    v_mul_f32 v77, v77, v231
    v_mul_f32 v78, v78, v231
    v_mul_f32 v79, v79, v231
    buffer_load_dwordx4 v214, s[24:27], s69 offen offset:1024 nt lds
    v_cvt_pk_bf16_f32 v108, v24, v25
    v_cvt_pk_bf16_f32 v109, v26, v27
    v_cvt_pk_bf16_f32 v110, v28, v29
    v_cvt_pk_bf16_f32 v111, v30, v31
    v_cvt_pk_bf16_f32 v132, v72, v73
    v_cvt_pk_bf16_f32 v133, v74, v75
    v_cvt_pk_bf16_f32 v134, v76, v77
    v_cvt_pk_bf16_f32 v135, v78, v79
    buffer_load_dwordx4 v215, s[24:27], s69 offen offset:2048 nt lds
    v_mul_f32 v32, v32, v230
    v_mul_f32 v33, v33, v230
    v_mul_f32 v34, v34, v230
    v_mul_f32 v35, v35, v230
    v_mul_f32 v36, v36, v230
    v_mul_f32 v37, v37, v230
    v_mul_f32 v38, v38, v230
    v_mul_f32 v39, v39, v230
    v_mul_f32 v80, v80, v231
    v_mul_f32 v81, v81, v231
    v_mul_f32 v82, v82, v231
    v_mul_f32 v83, v83, v231
    v_mul_f32 v84, v84, v231
    v_mul_f32 v85, v85, v231
    v_mul_f32 v86, v86, v231
    v_mul_f32 v87, v87, v231
    s_add_u32 s68, s65, 2
    s_sub_u32 s64, s68, 10
    s_cselect_b32 s68, s68, s64
    s_lshl_b32 s68, s68, 7
    s_add_u32 s68, s68, s60
    s_add_u32 m0, s59, 113664
    s_add_u32 s66, s68, 30720
    buffer_load_dwordx4 v248, s[32:35], s66 offen lds
    v_cvt_pk_bf16_f32 v112, v32, v33
    v_cvt_pk_bf16_f32 v113, v34, v35
    v_cvt_pk_bf16_f32 v114, v36, v37
    v_cvt_pk_bf16_f32 v115, v38, v39
    v_cvt_pk_bf16_f32 v136, v80, v81
    v_cvt_pk_bf16_f32 v137, v82, v83
    v_cvt_pk_bf16_f32 v138, v84, v85
    v_cvt_pk_bf16_f32 v139, v86, v87
    s_add_u32 s67, s68, 39936
    buffer_load_dwordx4 v248, s[32:35], s67 offen offset:1024 lds
    v_mul_f32 v40, v40, v230
    v_mul_f32 v41, v41, v230
    v_mul_f32 v42, v42, v230
    v_mul_f32 v43, v43, v230
    v_mul_f32 v44, v44, v230
    v_mul_f32 v45, v45, v230
    v_mul_f32 v46, v46, v230
    v_mul_f32 v47, v47, v230
    v_mul_f32 v88, v88, v231
    v_mul_f32 v89, v89, v231
    v_mul_f32 v90, v90, v231
    v_mul_f32 v91, v91, v231
    v_mul_f32 v92, v92, v231
    v_mul_f32 v93, v93, v231
    v_mul_f32 v94, v94, v231
    v_mul_f32 v95, v95, v231
    s_add_u32 s68, s68, 49152
    buffer_load_dwordx4 v248, s[32:35], s68 offen offset:2048 lds
    v_cvt_pk_bf16_f32 v116, v40, v41
    v_cvt_pk_bf16_f32 v117, v42, v43
    v_cvt_pk_bf16_f32 v118, v44, v45
    v_cvt_pk_bf16_f32 v119, v46, v47
    v_cvt_pk_bf16_f32 v140, v88, v89
    v_cvt_pk_bf16_f32 v141, v90, v91
    v_cvt_pk_bf16_f32 v142, v92, v93
    v_cvt_pk_bf16_f32 v143, v94, v95
    s_waitcnt vmcnt(6)
    s_barrier
    v_add_u32 v250, 86016, v249
    ds_read_b64_tr_b16 v[168:169], v250
    ds_read_b64_tr_b16 v[170:171], v250 offset:2048
    ds_read_b64_tr_b16 v[172:173], v250 offset:4096
    ds_read_b64_tr_b16 v[174:175], v250 offset:6144
    ds_read_b64_tr_b16 v[176:177], v250 offset:8192
    ds_read_b64_tr_b16 v[178:179], v250 offset:10240
    ds_read_b64_tr_b16 v[180:181], v250 offset:12288
    ds_read_b64_tr_b16 v[182:183], v250 offset:14336
    ds_read_b64_tr_b16 v[184:185], v250 offset:16384
    ds_read_b64_tr_b16 v[186:187], v250 offset:18432
    s_waitcnt lgkmcnt(6)
    v_mfma_f32_16x16x32_bf16 v[216:219], v[168:171], v[96:99], 0
    ds_read_b64_tr_b16 v[188:189], v250 offset:20480
    v_mfma_f32_16x16x32_bf16 v[224:227], v[168:171], v[120:123], 0
    ds_read_b64_tr_b16 v[190:191], v250 offset:22528
    s_add_u32 s69, s63, 4
    s_and_b32 s69, s69, 15
    s_or_b32 s69, s69, s74
    s_add_u32 m0, s45, 61440
    s_mul_i32 s69, s69, 12288
    buffer_load_dwordx4 v210, s[20:23], s69 offen nt lds
    v_mfma_f32_16x16x32_bf16 v[216:219], v[172:175], v[100:103], v[216:219]
    v_xor_b32 v250, 32, v250
    ds_read_b64_tr_b16 v[168:169], v250
    v_mfma_f32_16x16x32_bf16 v[224:227], v[172:175], v[124:127], v[224:227]
    ds_read_b64_tr_b16 v[170:171], v250 offset:2048
    buffer_load_dwordx4 v211, s[20:23], s69 offen offset:1024 nt lds
    s_waitcnt lgkmcnt(6)
    v_mfma_f32_16x16x32_bf16 v[216:219], v[176:179], v[104:107], v[216:219]
    v_mfma_f32_16x16x32_bf16 v[224:227], v[176:179], v[128:131], v[224:227]
    buffer_load_dwordx4 v212, s[20:23], s69 offen offset:2048 nt lds
    v_mfma_f32_16x16x32_bf16 v[216:219], v[180:183], v[108:111], v[216:219]
    v_mfma_f32_16x16x32_bf16 v[224:227], v[180:183], v[132:135], v[224:227]
    s_add_u32 s68, s65, 3
    s_sub_u32 s64, s68, 10
    s_cselect_b32 s68, s68, s64
    s_lshl_b32 s68, s68, 7
    s_add_u32 s68, s68, s60
    s_add_u32 m0, s59, 135168
    s_add_u32 s66, s68, 0
    buffer_load_dwordx4 v248, s[32:35], s66 offen lds
    s_add_u32 s67, s68, 9216
    buffer_load_dwordx4 v248, s[32:35], s67 offen offset:1024 lds
    s_add_u32 s68, s68, 18432
    buffer_load_dwordx4 v248, s[32:35], s68 offen offset:2048 lds
    s_waitcnt vmcnt(6) lgkmcnt(0)
    s_barrier
    ds_read_b64_tr_b16 v[172:173], v250 offset:4096
    ds_read_b64_tr_b16 v[174:175], v250 offset:6144
    ds_read_b64_tr_b16 v[176:177], v250 offset:8192
    ds_read_b64_tr_b16 v[178:179], v250 offset:10240
    v_mfma_f32_16x16x32_bf16 v[216:219], v[184:187], v[112:115], v[216:219]
    ds_read_b64_tr_b16 v[180:181], v250 offset:12288
    v_mfma_f32_16x16x32_bf16 v[224:227], v[184:187], v[136:139], v[224:227]
    ds_read_b64_tr_b16 v[182:183], v250 offset:14336
    s_add_u32 s69, s63, 3
    s_and_b32 s69, s69, 15
    s_or_b32 s69, s69, s74
    s_add_u32 m0, s45, 73728
    s_mul_i32 s69, s69, 12288
    buffer_load_dwordx4 v213, s[24:27], s69 offen nt lds
    v_mfma_f32_16x16x32_bf16 v[216:219], v[188:191], v[116:119], v[216:219]
    ds_read_b64_tr_b16 v[184:185], v250 offset:16384
    v_mfma_f32_16x16x32_bf16 v[224:227], v[188:191], v[140:143], v[224:227]
    ds_read_b64_tr_b16 v[186:187], v250 offset:18432
    buffer_load_dwordx4 v214, s[24:27], s69 offen offset:1024 nt lds
    v_mfma_f32_16x16x32_bf16 v[220:223], v[168:171], v[96:99], 0
    ds_read_b64_tr_b16 v[188:189], v250 offset:20480
    v_mfma_f32_16x16x32_bf16 v[228:231], v[168:171], v[120:123], 0
    ds_read_b64_tr_b16 v[190:191], v250 offset:22528
    buffer_load_dwordx4 v215, s[24:27], s69 offen offset:2048 nt lds
    s_waitcnt lgkmcnt(6)
    v_mfma_f32_16x16x32_bf16 v[220:223], v[172:175], v[100:103], v[220:223]
    v_xor_b32 v250, 96, v250
    ds_read_b64_tr_b16 v[168:169], v250
    v_mfma_f32_16x16x32_bf16 v[228:231], v[172:175], v[124:127], v[228:231]
    ds_read_b64_tr_b16 v[170:171], v250 offset:2048
    s_add_u32 s68, s65, 3
    s_sub_u32 s64, s68, 10
    s_cselect_b32 s68, s68, s64
    s_lshl_b32 s68, s68, 7
    s_add_u32 s68, s68, s60
    s_add_u32 m0, s59, 138240
    s_add_u32 s66, s68, 30720
    buffer_load_dwordx4 v248, s[32:35], s66 offen lds
    v_mfma_f32_16x16x32_bf16 v[220:223], v[176:179], v[104:107], v[220:223]
    ds_read_b64_tr_b16 v[172:173], v250 offset:4096
    v_mfma_f32_16x16x32_bf16 v[228:231], v[176:179], v[128:131], v[228:231]
    ds_read_b64_tr_b16 v[174:175], v250 offset:6144
    s_add_u32 s67, s68, 39936
    buffer_load_dwordx4 v248, s[32:35], s67 offen offset:1024 lds
    s_waitcnt lgkmcnt(6)
    v_mfma_f32_16x16x32_bf16 v[220:223], v[180:183], v[108:111], v[220:223]
    ds_read_b64_tr_b16 v[176:177], v250 offset:8192
    v_mfma_f32_16x16x32_bf16 v[228:231], v[180:183], v[132:135], v[228:231]
    ds_read_b64_tr_b16 v[178:179], v250 offset:10240
    s_add_u32 s68, s68, 49152
    buffer_load_dwordx4 v248, s[32:35], s68 offen offset:2048 lds
    v_mfma_f32_16x16x32_bf16 v[220:223], v[184:187], v[112:115], v[220:223]
    v_mfma_f32_16x16x32_bf16 v[228:231], v[184:187], v[136:139], v[228:231]
    s_waitcnt lgkmcnt(6)
    v_mfma_f32_16x16x32_bf16 v[220:223], v[188:191], v[116:119], v[220:223]
    v_mfma_f32_16x16x32_bf16 v[228:231], v[188:191], v[140:143], v[228:231]
    s_waitcnt vmcnt(6) lgkmcnt(0)
    s_barrier
    ds_read_b64_tr_b16 v[180:181], v250 offset:12288
    ds_read_b64_tr_b16 v[182:183], v250 offset:14336
    ds_read_b64_tr_b16 v[184:185], v250 offset:16384
    ds_read_b64_tr_b16 v[186:187], v250 offset:18432
    v_mfma_f32_16x16x32_bf16 v[232:235], v[168:171], v[96:99], 0
    ds_read_b64_tr_b16 v[188:189], v250 offset:20480
    v_mfma_f32_16x16x32_bf16 v[240:243], v[168:171], v[120:123], 0
    ds_read_b64_tr_b16 v[190:191], v250 offset:22528
    s_add_u32 s69, s63, 5
    s_and_b32 s69, s69, 15
    s_or_b32 s69, s69, s74
    s_add_u32 m0, s45, 0
    s_mul_i32 s69, s69, 12288
    buffer_load_dwordx4 v210, s[20:23], s69 offen nt lds
    v_mfma_f32_16x16x32_bf16 v[232:235], v[172:175], v[100:103], v[232:235]
    v_xor_b32 v250, 32, v250
    ds_read_b64_tr_b16 v[168:169], v250
    v_mfma_f32_16x16x32_bf16 v[240:243], v[172:175], v[124:127], v[240:243]
    ds_read_b64_tr_b16 v[170:171], v250 offset:2048
    buffer_load_dwordx4 v211, s[20:23], s69 offen offset:1024 nt lds
    v_mfma_f32_16x16x32_bf16 v[232:235], v[176:179], v[104:107], v[232:235]
    ds_read_b64_tr_b16 v[172:173], v250 offset:4096
    v_mfma_f32_16x16x32_bf16 v[240:243], v[176:179], v[128:131], v[240:243]
    ds_read_b64_tr_b16 v[174:175], v250 offset:6144
    buffer_load_dwordx4 v212, s[20:23], s69 offen offset:2048 nt lds
    s_waitcnt lgkmcnt(6)
    v_mfma_f32_16x16x32_bf16 v[232:235], v[180:183], v[108:111], v[232:235]
    ds_read_b64_tr_b16 v[176:177], v250 offset:8192
    v_mfma_f32_16x16x32_bf16 v[240:243], v[180:183], v[132:135], v[240:243]
    ds_read_b64_tr_b16 v[178:179], v250 offset:10240
    v_cvt_pk_bf16_f32 v0, v216, v217
    v_cvt_pk_bf16_f32 v1, v218, v219
    v_cvt_pk_bf16_f32 v2, v220, v221
    v_cvt_pk_bf16_f32 v3, v222, v223
    v_mfma_f32_16x16x32_bf16 v[232:235], v[184:187], v[112:115], v[232:235]
    ds_read_b64_tr_b16 v[180:181], v250 offset:12288
    v_mfma_f32_16x16x32_bf16 v[240:243], v[184:187], v[136:139], v[240:243]
    ds_read_b64_tr_b16 v[182:183], v250 offset:14336
    v_cvt_pk_bf16_f32 v4, v224, v225
    v_cvt_pk_bf16_f32 v5, v226, v227
    v_cvt_pk_bf16_f32 v6, v228, v229
    v_cvt_pk_bf16_f32 v7, v230, v231
    s_waitcnt lgkmcnt(6)
    v_mfma_f32_16x16x32_bf16 v[232:235], v[188:191], v[116:119], v[232:235]
    v_mfma_f32_16x16x32_bf16 v[240:243], v[188:191], v[140:143], v[240:243]
    v_mfma_f32_16x16x32_bf16 v[236:239], v[168:171], v[96:99], 0
    v_mfma_f32_16x16x32_bf16 v[244:247], v[168:171], v[120:123], 0
    s_waitcnt vmcnt(6) lgkmcnt(0)
    s_barrier
    ds_read_b64_tr_b16 v[184:185], v250 offset:16384
    ds_read_b64_tr_b16 v[186:187], v250 offset:18432
    ds_read_b64_tr_b16 v[188:189], v250 offset:20480
    ds_read_b64_tr_b16 v[190:191], v250 offset:22528
    v_mfma_f32_16x16x32_bf16 v[236:239], v[172:175], v[100:103], v[236:239]
    v_add_u32 v250, 110592, v249
    ds_read_b64_tr_b16 v[168:169], v250
    v_mfma_f32_16x16x32_bf16 v[244:247], v[172:175], v[124:127], v[244:247]
    ds_read_b64_tr_b16 v[170:171], v250 offset:2048
    s_add_u32 s69, s63, 4
    s_and_b32 s69, s69, 15
    s_or_b32 s69, s69, s74
    s_add_u32 m0, s45, 12288
    s_mul_i32 s69, s69, 12288
    buffer_load_dwordx4 v213, s[24:27], s69 offen nt lds
    v_mfma_f32_16x16x32_bf16 v[236:239], v[176:179], v[104:107], v[236:239]
    ds_read_b64_tr_b16 v[172:173], v250 offset:4096
    v_mfma_f32_16x16x32_bf16 v[244:247], v[176:179], v[128:131], v[244:247]
    ds_read_b64_tr_b16 v[174:175], v250 offset:6144
    buffer_load_dwordx4 v214, s[24:27], s69 offen offset:1024 nt lds
    v_mfma_f32_16x16x32_bf16 v[236:239], v[180:183], v[108:111], v[236:239]
    ds_read_b64_tr_b16 v[176:177], v250 offset:8192
    v_mfma_f32_16x16x32_bf16 v[244:247], v[180:183], v[132:135], v[244:247]
    ds_read_b64_tr_b16 v[178:179], v250 offset:10240
    buffer_load_dwordx4 v215, s[24:27], s69 offen offset:2048 nt lds
    s_waitcnt lgkmcnt(6)
    v_mfma_f32_16x16x32_bf16 v[236:239], v[184:187], v[112:115], v[236:239]
    ds_read_b64_tr_b16 v[180:181], v250 offset:12288
    v_mfma_f32_16x16x32_bf16 v[244:247], v[184:187], v[136:139], v[244:247]
    ds_read_b64_tr_b16 v[182:183], v250 offset:14336
    v_mfma_f32_16x16x32_bf16 v[236:239], v[188:191], v[116:119], v[236:239]
    ds_read_b64_tr_b16 v[184:185], v250 offset:16384
    v_mfma_f32_16x16x32_bf16 v[244:247], v[188:191], v[140:143], v[244:247]
    ds_read_b64_tr_b16 v[186:187], v250 offset:18432
    s_waitcnt lgkmcnt(6)
    v_mfma_f32_16x16x32_bf16 v[216:219], v[168:171], v[96:99], 0
    ds_read_b64_tr_b16 v[188:189], v250 offset:20480
    v_mfma_f32_16x16x32_bf16 v[224:227], v[168:171], v[120:123], 0
    ds_read_b64_tr_b16 v[190:191], v250 offset:22528
    v_mfma_f32_16x16x32_bf16 v[216:219], v[172:175], v[100:103], v[216:219]
    v_mfma_f32_16x16x32_bf16 v[224:227], v[172:175], v[124:127], v[224:227]
    s_waitcnt lgkmcnt(6)
    v_mfma_f32_16x16x32_bf16 v[216:219], v[176:179], v[104:107], v[216:219]
    v_mfma_f32_16x16x32_bf16 v[224:227], v[176:179], v[128:131], v[224:227]
    s_waitcnt vmcnt(6) lgkmcnt(0)
    s_barrier
    v_xor_b32 v250, 32, v250
    ds_read_b64_tr_b16 v[168:169], v250
    ds_read_b64_tr_b16 v[170:171], v250 offset:2048
    ds_read_b64_tr_b16 v[172:173], v250 offset:4096
    ds_read_b64_tr_b16 v[174:175], v250 offset:6144
    v_mfma_f32_16x16x32_bf16 v[216:219], v[180:183], v[108:111], v[216:219]
    ds_read_b64_tr_b16 v[176:177], v250 offset:8192
    v_mfma_f32_16x16x32_bf16 v[224:227], v[180:183], v[132:135], v[224:227]
    ds_read_b64_tr_b16 v[178:179], v250 offset:10240
    s_add_u32 s69, s63, 6
    s_and_b32 s69, s69, 15
    s_or_b32 s69, s69, s74
    s_add_u32 m0, s45, 24576
    s_mul_i32 s69, s69, 12288
    buffer_load_dwordx4 v210, s[20:23], s69 offen nt lds
    v_cvt_pk_bf16_f32 v8, v232, v233
    v_cvt_pk_bf16_f32 v9, v234, v235
    v_cvt_pk_bf16_f32 v10, v236, v237
    v_cvt_pk_bf16_f32 v11, v238, v239
    v_mfma_f32_16x16x32_bf16 v[216:219], v[184:187], v[112:115], v[216:219]
    ds_read_b64_tr_b16 v[180:181], v250 offset:12288
    v_mfma_f32_16x16x32_bf16 v[224:227], v[184:187], v[136:139], v[224:227]
    ds_read_b64_tr_b16 v[182:183], v250 offset:14336
    buffer_load_dwordx4 v211, s[20:23], s69 offen offset:1024 nt lds
    v_cvt_pk_bf16_f32 v12, v240, v241
    v_cvt_pk_bf16_f32 v13, v242, v243
    v_cvt_pk_bf16_f32 v14, v244, v245
    v_cvt_pk_bf16_f32 v15, v246, v247
    v_mfma_f32_16x16x32_bf16 v[216:219], v[188:191], v[116:119], v[216:219]
    ds_read_b64_tr_b16 v[184:185], v250 offset:16384
    v_mfma_f32_16x16x32_bf16 v[224:227], v[188:191], v[140:143], v[224:227]
    ds_read_b64_tr_b16 v[186:187], v250 offset:18432
    buffer_load_dwordx4 v212, s[20:23], s69 offen offset:2048 nt lds
    s_waitcnt lgkmcnt(6)
    v_mfma_f32_16x16x32_bf16 v[220:223], v[168:171], v[96:99], 0
    ds_read_b64_tr_b16 v[188:189], v250 offset:20480
    v_mfma_f32_16x16x32_bf16 v[228:231], v[168:171], v[120:123], 0
    ds_read_b64_tr_b16 v[190:191], v250 offset:22528
    s_add_u32 s68, s65, 4
    s_sub_u32 s64, s68, 10
    s_cselect_b32 s68, s68, s64
    s_lshl_b32 s68, s68, 7
    s_add_u32 s68, s68, s60
    s_add_u32 m0, s59, 86016
    s_add_u32 s66, s68, 0
    buffer_load_dwordx4 v248, s[32:35], s66 offen lds
    v_mfma_f32_16x16x32_bf16 v[220:223], v[172:175], v[100:103], v[220:223]
    v_xor_b32 v250, 96, v250
    ds_read_b64_tr_b16 v[168:169], v250
    v_mfma_f32_16x16x32_bf16 v[228:231], v[172:175], v[124:127], v[228:231]
    ds_read_b64_tr_b16 v[170:171], v250 offset:2048
    s_add_u32 s67, s68, 9216
    buffer_load_dwordx4 v248, s[32:35], s67 offen offset:1024 lds
    s_waitcnt lgkmcnt(6)
    v_mfma_f32_16x16x32_bf16 v[220:223], v[176:179], v[104:107], v[220:223]
    ds_read_b64_tr_b16 v[172:173], v250 offset:4096
    v_mfma_f32_16x16x32_bf16 v[228:231], v[176:179], v[128:131], v[228:231]
    ds_read_b64_tr_b16 v[174:175], v250 offset:6144
    s_add_u32 s68, s68, 18432
    buffer_load_dwordx4 v248, s[32:35], s68 offen offset:2048 lds
    v_mfma_f32_16x16x32_bf16 v[220:223], v[180:183], v[108:111], v[220:223]
    v_mfma_f32_16x16x32_bf16 v[228:231], v[180:183], v[132:135], v[228:231]
    s_waitcnt lgkmcnt(6)
    v_mfma_f32_16x16x32_bf16 v[220:223], v[184:187], v[112:115], v[220:223]
    v_mfma_f32_16x16x32_bf16 v[228:231], v[184:187], v[136:139], v[228:231]
    s_waitcnt vmcnt(6) lgkmcnt(0)
    s_barrier
    ds_read_b64_tr_b16 v[176:177], v250 offset:8192
    ds_read_b64_tr_b16 v[178:179], v250 offset:10240
    ds_read_b64_tr_b16 v[180:181], v250 offset:12288
    ds_read_b64_tr_b16 v[182:183], v250 offset:14336
    v_mfma_f32_16x16x32_bf16 v[220:223], v[188:191], v[116:119], v[220:223]
    ds_read_b64_tr_b16 v[184:185], v250 offset:16384
    v_mfma_f32_16x16x32_bf16 v[228:231], v[188:191], v[140:143], v[228:231]
    ds_read_b64_tr_b16 v[186:187], v250 offset:18432
    s_add_u32 s69, s63, 5
    s_and_b32 s69, s69, 15
    s_or_b32 s69, s69, s74
    s_add_u32 m0, s45, 36864
    s_mul_i32 s69, s69, 12288
    buffer_load_dwordx4 v213, s[24:27], s69 offen nt lds
    v_mfma_f32_16x16x32_bf16 v[232:235], v[168:171], v[96:99], 0
    ds_read_b64_tr_b16 v[188:189], v250 offset:20480
    v_mfma_f32_16x16x32_bf16 v[240:243], v[168:171], v[120:123], 0
    ds_read_b64_tr_b16 v[190:191], v250 offset:22528
    buffer_load_dwordx4 v214, s[24:27], s69 offen offset:1024 nt lds
    v_mfma_f32_16x16x32_bf16 v[232:235], v[172:175], v[100:103], v[232:235]
    v_xor_b32 v250, 32, v250
    ds_read_b64_tr_b16 v[168:169], v250
    v_mfma_f32_16x16x32_bf16 v[240:243], v[172:175], v[124:127], v[240:243]
    ds_read_b64_tr_b16 v[170:171], v250 offset:2048
    buffer_load_dwordx4 v215, s[24:27], s69 offen offset:2048 nt lds
    s_waitcnt lgkmcnt(6)
    v_mfma_f32_16x16x32_bf16 v[232:235], v[176:179], v[104:107], v[232:235]
    ds_read_b64_tr_b16 v[172:173], v250 offset:4096
    v_mfma_f32_16x16x32_bf16 v[240:243], v[176:179], v[128:131], v[240:243]
    ds_read_b64_tr_b16 v[174:175], v250 offset:6144
    s_add_u32 s68, s65, 4
    s_sub_u32 s64, s68, 10
    s_cselect_b32 s68, s68, s64
    s_lshl_b32 s68, s68, 7
    s_add_u32 s68, s68, s60
    s_add_u32 m0, s59, 89088
    s_add_u32 s66, s68, 30720
    buffer_load_dwordx4 v248, s[32:35], s66 offen lds
    v_mfma_f32_16x16x32_bf16 v[232:235], v[180:183], v[108:111], v[232:235]
    ds_read_b64_tr_b16 v[176:177], v250 offset:8192
    v_mfma_f32_16x16x32_bf16 v[240:243], v[180:183], v[132:135], v[240:243]
    ds_read_b64_tr_b16 v[178:179], v250 offset:10240
    s_add_u32 s67, s68, 39936
    buffer_load_dwordx4 v248, s[32:35], s67 offen offset:1024 lds
    v_cvt_pk_bf16_f32 v16, v216, v217
    v_cvt_pk_bf16_f32 v17, v218, v219
    v_cvt_pk_bf16_f32 v18, v220, v221
    v_cvt_pk_bf16_f32 v19, v222, v223
    s_waitcnt lgkmcnt(6)
    v_mfma_f32_16x16x32_bf16 v[232:235], v[184:187], v[112:115], v[232:235]
    v_mfma_f32_16x16x32_bf16 v[240:243], v[184:187], v[136:139], v[240:243]
    s_add_u32 s68, s68, 49152
    buffer_load_dwordx4 v248, s[32:35], s68 offen offset:2048 lds
    v_cvt_pk_bf16_f32 v20, v224, v225
    v_cvt_pk_bf16_f32 v21, v226, v227
    v_cvt_pk_bf16_f32 v22, v228, v229
    v_cvt_pk_bf16_f32 v23, v230, v231
    v_mfma_f32_16x16x32_bf16 v[232:235], v[188:191], v[116:119], v[232:235]
    v_mfma_f32_16x16x32_bf16 v[240:243], v[188:191], v[140:143], v[240:243]
    s_waitcnt vmcnt(6) lgkmcnt(0)
    s_barrier
    ds_read_b64_tr_b16 v[180:181], v250 offset:12288
    ds_read_b64_tr_b16 v[182:183], v250 offset:14336
    ds_read_b64_tr_b16 v[184:185], v250 offset:16384
    ds_read_b64_tr_b16 v[186:187], v250 offset:18432
    v_mfma_f32_16x16x32_bf16 v[236:239], v[168:171], v[96:99], 0
    ds_read_b64_tr_b16 v[188:189], v250 offset:20480
    v_mfma_f32_16x16x32_bf16 v[244:247], v[168:171], v[120:123], 0
    ds_read_b64_tr_b16 v[190:191], v250 offset:22528
    s_add_u32 s69, s63, 7
    s_and_b32 s69, s69, 15
    s_or_b32 s69, s69, s74
    s_add_u32 m0, s45, 49152
    s_mul_i32 s69, s69, 12288
    buffer_load_dwordx4 v210, s[20:23], s69 offen nt lds
    v_mfma_f32_16x16x32_bf16 v[236:239], v[172:175], v[100:103], v[236:239]
    v_add_u32 v250, 135168, v249
    ds_read_b64_tr_b16 v[168:169], v250
    v_mfma_f32_16x16x32_bf16 v[244:247], v[172:175], v[124:127], v[244:247]
    ds_read_b64_tr_b16 v[170:171], v250 offset:2048
    buffer_load_dwordx4 v211, s[20:23], s69 offen offset:1024 nt lds
    v_mfma_f32_16x16x32_bf16 v[236:239], v[176:179], v[104:107], v[236:239]
    ds_read_b64_tr_b16 v[172:173], v250 offset:4096
    v_mfma_f32_16x16x32_bf16 v[244:247], v[176:179], v[128:131], v[244:247]
    ds_read_b64_tr_b16 v[174:175], v250 offset:6144
    buffer_load_dwordx4 v212, s[20:23], s69 offen offset:2048 nt lds
    s_waitcnt lgkmcnt(6)
    v_mfma_f32_16x16x32_bf16 v[236:239], v[180:183], v[108:111], v[236:239]
    ds_read_b64_tr_b16 v[176:177], v250 offset:8192
    v_mfma_f32_16x16x32_bf16 v[244:247], v[180:183], v[132:135], v[244:247]
    ds_read_b64_tr_b16 v[178:179], v250 offset:10240
    v_mfma_f32_16x16x32_bf16 v[236:239], v[184:187], v[112:115], v[236:239]
    ds_read_b64_tr_b16 v[180:181], v250 offset:12288
    v_mfma_f32_16x16x32_bf16 v[244:247], v[184:187], v[136:139], v[244:247]
    ds_read_b64_tr_b16 v[182:183], v250 offset:14336
    s_waitcnt lgkmcnt(6)
    v_mfma_f32_16x16x32_bf16 v[236:239], v[188:191], v[116:119], v[236:239]
    ds_read_b64_tr_b16 v[184:185], v250 offset:16384
    v_mfma_f32_16x16x32_bf16 v[244:247], v[188:191], v[140:143], v[244:247]
    ds_read_b64_tr_b16 v[186:187], v250 offset:18432
    v_mfma_f32_16x16x32_bf16 v[216:219], v[168:171], v[96:99], 0
    v_mfma_f32_16x16x32_bf16 v[224:227], v[168:171], v[120:123], 0
    s_waitcnt lgkmcnt(6)
    v_mfma_f32_16x16x32_bf16 v[216:219], v[172:175], v[100:103], v[216:219]
    v_mfma_f32_16x16x32_bf16 v[224:227], v[172:175], v[124:127], v[224:227]
    s_waitcnt vmcnt(6) lgkmcnt(0)
    s_barrier
    ds_read_b64_tr_b16 v[188:189], v250 offset:20480
    ds_read_b64_tr_b16 v[190:191], v250 offset:22528
    v_xor_b32 v250, 32, v250
    ds_read_b64_tr_b16 v[168:169], v250
    ds_read_b64_tr_b16 v[170:171], v250 offset:2048
    v_mfma_f32_16x16x32_bf16 v[216:219], v[176:179], v[104:107], v[216:219]
    ds_read_b64_tr_b16 v[172:173], v250 offset:4096
    v_mfma_f32_16x16x32_bf16 v[224:227], v[176:179], v[128:131], v[224:227]
    ds_read_b64_tr_b16 v[174:175], v250 offset:6144
    s_add_u32 s69, s63, 6
    s_and_b32 s69, s69, 15
    s_or_b32 s69, s69, s74
    s_add_u32 m0, s45, 61440
    s_mul_i32 s69, s69, 12288
    buffer_load_dwordx4 v213, s[24:27], s69 offen nt lds
    v_mfma_f32_16x16x32_bf16 v[216:219], v[180:183], v[108:111], v[216:219]
    ds_read_b64_tr_b16 v[176:177], v250 offset:8192
    v_mfma_f32_16x16x32_bf16 v[224:227], v[180:183], v[132:135], v[224:227]
    ds_read_b64_tr_b16 v[178:179], v250 offset:10240
    buffer_load_dwordx4 v214, s[24:27], s69 offen offset:1024 nt lds
    v_cvt_pk_bf16_f32 v24, v232, v233
    v_cvt_pk_bf16_f32 v25, v234, v235
    v_cvt_pk_bf16_f32 v26, v236, v237
    v_cvt_pk_bf16_f32 v27, v238, v239
    v_mfma_f32_16x16x32_bf16 v[216:219], v[184:187], v[112:115], v[216:219]
    ds_read_b64_tr_b16 v[180:181], v250 offset:12288
    v_mfma_f32_16x16x32_bf16 v[224:227], v[184:187], v[136:139], v[224:227]
    ds_read_b64_tr_b16 v[182:183], v250 offset:14336
    buffer_load_dwordx4 v215, s[24:27], s69 offen offset:2048 nt lds
    v_cvt_pk_bf16_f32 v28, v240, v241
    v_cvt_pk_bf16_f32 v29, v242, v243
    v_cvt_pk_bf16_f32 v30, v244, v245
    v_cvt_pk_bf16_f32 v31, v246, v247
    s_waitcnt lgkmcnt(6)
    v_mfma_f32_16x16x32_bf16 v[216:219], v[188:191], v[116:119], v[216:219]
    ds_read_b64_tr_b16 v[184:185], v250 offset:16384
    v_mfma_f32_16x16x32_bf16 v[224:227], v[188:191], v[140:143], v[224:227]
    ds_read_b64_tr_b16 v[186:187], v250 offset:18432
    s_add_u32 s68, s65, 5
    s_sub_u32 s64, s68, 10
    s_cselect_b32 s68, s68, s64
    s_lshl_b32 s68, s68, 7
    s_add_u32 s68, s68, s60
    s_add_u32 m0, s59, 110592
    s_add_u32 s66, s68, 0
    buffer_load_dwordx4 v248, s[32:35], s66 offen lds
    v_mfma_f32_16x16x32_bf16 v[220:223], v[168:171], v[96:99], 0
    ds_read_b64_tr_b16 v[188:189], v250 offset:20480
    v_mfma_f32_16x16x32_bf16 v[228:231], v[168:171], v[120:123], 0
    ds_read_b64_tr_b16 v[190:191], v250 offset:22528
    s_add_u32 s67, s68, 9216
    buffer_load_dwordx4 v248, s[32:35], s67 offen offset:1024 lds
    s_waitcnt lgkmcnt(6)
    v_mfma_f32_16x16x32_bf16 v[220:223], v[172:175], v[100:103], v[220:223]
    v_xor_b32 v250, 96, v250
    ds_read_b64_tr_b16 v[168:169], v250
    v_mfma_f32_16x16x32_bf16 v[228:231], v[172:175], v[124:127], v[228:231]
    ds_read_b64_tr_b16 v[170:171], v250 offset:2048
    s_add_u32 s68, s68, 18432
    buffer_load_dwordx4 v248, s[32:35], s68 offen offset:2048 lds
    v_mfma_f32_16x16x32_bf16 v[220:223], v[176:179], v[104:107], v[220:223]
    v_mfma_f32_16x16x32_bf16 v[228:231], v[176:179], v[128:131], v[228:231]
    s_waitcnt lgkmcnt(6)
    v_mfma_f32_16x16x32_bf16 v[220:223], v[180:183], v[108:111], v[220:223]
    v_mfma_f32_16x16x32_bf16 v[228:231], v[180:183], v[132:135], v[228:231]
    s_waitcnt vmcnt(6) lgkmcnt(0)
    s_barrier
    ds_read_b64_tr_b16 v[172:173], v250 offset:4096
    ds_read_b64_tr_b16 v[174:175], v250 offset:6144
    ds_read_b64_tr_b16 v[176:177], v250 offset:8192
    ds_read_b64_tr_b16 v[178:179], v250 offset:10240
    v_mfma_f32_16x16x32_bf16 v[220:223], v[184:187], v[112:115], v[220:223]
    ds_read_b64_tr_b16 v[180:181], v250 offset:12288
    v_mfma_f32_16x16x32_bf16 v[228:231], v[184:187], v[136:139], v[228:231]
    ds_read_b64_tr_b16 v[182:183], v250 offset:14336
    s_add_u32 s69, s63, 8
    s_and_b32 s69, s69, 15
    s_or_b32 s69, s69, s74
    s_add_u32 m0, s45, 73728
    s_mul_i32 s69, s69, 12288
    buffer_load_dwordx4 v210, s[20:23], s69 offen nt lds
    v_mfma_f32_16x16x32_bf16 v[220:223], v[188:191], v[116:119], v[220:223]
    ds_read_b64_tr_b16 v[184:185], v250 offset:16384
    v_mfma_f32_16x16x32_bf16 v[228:231], v[188:191], v[140:143], v[228:231]
    ds_read_b64_tr_b16 v[186:187], v250 offset:18432
    buffer_load_dwordx4 v211, s[20:23], s69 offen offset:1024 nt lds
    v_mfma_f32_16x16x32_bf16 v[232:235], v[168:171], v[96:99], 0
    ds_read_b64_tr_b16 v[188:189], v250 offset:20480
    v_mfma_f32_16x16x32_bf16 v[240:243], v[168:171], v[120:123], 0
    ds_read_b64_tr_b16 v[190:191], v250 offset:22528
    buffer_load_dwordx4 v212, s[20:23], s69 offen offset:2048 nt lds
    s_waitcnt lgkmcnt(6)
    v_mfma_f32_16x16x32_bf16 v[232:235], v[172:175], v[100:103], v[232:235]
    v_xor_b32 v250, 32, v250
    ds_read_b64_tr_b16 v[168:169], v250
    v_mfma_f32_16x16x32_bf16 v[240:243], v[172:175], v[124:127], v[240:243]
    ds_read_b64_tr_b16 v[170:171], v250 offset:2048
    s_add_u32 s68, s65, 5
    s_sub_u32 s64, s68, 10
    s_cselect_b32 s68, s68, s64
    s_lshl_b32 s68, s68, 7
    s_add_u32 s68, s68, s60
    s_add_u32 m0, s59, 113664
    s_add_u32 s66, s68, 30720
    buffer_load_dwordx4 v248, s[32:35], s66 offen lds
    v_mfma_f32_16x16x32_bf16 v[232:235], v[176:179], v[104:107], v[232:235]
    ds_read_b64_tr_b16 v[172:173], v250 offset:4096
    v_mfma_f32_16x16x32_bf16 v[240:243], v[176:179], v[128:131], v[240:243]
    ds_read_b64_tr_b16 v[174:175], v250 offset:6144
    s_add_u32 s67, s68, 39936
    buffer_load_dwordx4 v248, s[32:35], s67 offen offset:1024 lds
    s_waitcnt lgkmcnt(6)
    v_mfma_f32_16x16x32_bf16 v[232:235], v[180:183], v[108:111], v[232:235]
    v_mfma_f32_16x16x32_bf16 v[240:243], v[180:183], v[132:135], v[240:243]
    s_add_u32 s68, s68, 49152
    buffer_load_dwordx4 v248, s[32:35], s68 offen offset:2048 lds
    v_cvt_pk_bf16_f32 v32, v216, v217
    v_cvt_pk_bf16_f32 v33, v218, v219
    v_cvt_pk_bf16_f32 v34, v220, v221
    v_cvt_pk_bf16_f32 v35, v222, v223
    v_mfma_f32_16x16x32_bf16 v[232:235], v[184:187], v[112:115], v[232:235]
    v_mfma_f32_16x16x32_bf16 v[240:243], v[184:187], v[136:139], v[240:243]
    v_cvt_pk_bf16_f32 v36, v224, v225
    v_cvt_pk_bf16_f32 v37, v226, v227
    v_cvt_pk_bf16_f32 v38, v228, v229
    v_cvt_pk_bf16_f32 v39, v230, v231
    s_waitcnt vmcnt(6) lgkmcnt(0)
    s_barrier
    ds_read_b64_tr_b16 v[176:177], v250 offset:8192
    ds_read_b64_tr_b16 v[178:179], v250 offset:10240
    ds_read_b64_tr_b16 v[180:181], v250 offset:12288
    ds_read_b64_tr_b16 v[182:183], v250 offset:14336
    v_mfma_f32_16x16x32_bf16 v[232:235], v[188:191], v[116:119], v[232:235]
    ds_read_b64_tr_b16 v[184:185], v250 offset:16384
    v_mfma_f32_16x16x32_bf16 v[240:243], v[188:191], v[140:143], v[240:243]
    ds_read_b64_tr_b16 v[186:187], v250 offset:18432
    s_add_u32 s69, s63, 7
    s_and_b32 s69, s69, 15
    s_or_b32 s69, s69, s74
    s_add_u32 m0, s45, 0
    s_mul_i32 s69, s69, 12288
    buffer_load_dwordx4 v213, s[24:27], s69 offen nt lds
    v_mfma_f32_16x16x32_bf16 v[236:239], v[168:171], v[96:99], 0
    ds_read_b64_tr_b16 v[188:189], v250 offset:20480
    v_mfma_f32_16x16x32_bf16 v[244:247], v[168:171], v[120:123], 0
    ds_read_b64_tr_b16 v[190:191], v250 offset:22528
    buffer_load_dwordx4 v214, s[24:27], s69 offen offset:1024 nt lds
    v_mfma_f32_16x16x32_bf16 v[236:239], v[172:175], v[100:103], v[236:239]
    v_add_u32 v250, 86016, v249
    ds_read_b64_tr_b16 v[168:169], v250
    v_mfma_f32_16x16x32_bf16 v[244:247], v[172:175], v[124:127], v[244:247]
    ds_read_b64_tr_b16 v[170:171], v250 offset:2048
    buffer_load_dwordx4 v215, s[24:27], s69 offen offset:2048 nt lds
    s_waitcnt lgkmcnt(6)
    v_mfma_f32_16x16x32_bf16 v[236:239], v[176:179], v[104:107], v[236:239]
    ds_read_b64_tr_b16 v[172:173], v250 offset:4096
    v_mfma_f32_16x16x32_bf16 v[244:247], v[176:179], v[128:131], v[244:247]
    ds_read_b64_tr_b16 v[174:175], v250 offset:6144
    v_mfma_f32_16x16x32_bf16 v[236:239], v[180:183], v[108:111], v[236:239]
    ds_read_b64_tr_b16 v[176:177], v250 offset:8192
    v_mfma_f32_16x16x32_bf16 v[244:247], v[180:183], v[132:135], v[244:247]
    ds_read_b64_tr_b16 v[178:179], v250 offset:10240
    s_waitcnt lgkmcnt(6)
    v_mfma_f32_16x16x32_bf16 v[236:239], v[184:187], v[112:115], v[236:239]
    ds_read_b64_tr_b16 v[180:181], v250 offset:12288
    v_mfma_f32_16x16x32_bf16 v[244:247], v[184:187], v[136:139], v[244:247]
    ds_read_b64_tr_b16 v[182:183], v250 offset:14336
    v_mfma_f32_16x16x32_bf16 v[236:239], v[188:191], v[116:119], v[236:239]
    v_mfma_f32_16x16x32_bf16 v[244:247], v[188:191], v[140:143], v[244:247]
    s_waitcnt lgkmcnt(6)
    v_mfma_f32_16x16x32_bf16 v[216:219], v[168:171], v[96:99], 0
    v_mfma_f32_16x16x32_bf16 v[224:227], v[168:171], v[120:123], 0
    s_waitcnt vmcnt(6) lgkmcnt(0)
    s_barrier
    ds_read_b64_tr_b16 v[184:185], v250 offset:16384
    ds_read_b64_tr_b16 v[186:187], v250 offset:18432
    ds_read_b64_tr_b16 v[188:189], v250 offset:20480
    ds_read_b64_tr_b16 v[190:191], v250 offset:22528
    v_mfma_f32_16x16x32_bf16 v[216:219], v[172:175], v[100:103], v[216:219]
    v_xor_b32 v250, 32, v250
    ds_read_b64_tr_b16 v[168:169], v250
    v_mfma_f32_16x16x32_bf16 v[224:227], v[172:175], v[124:127], v[224:227]
    ds_read_b64_tr_b16 v[170:171], v250 offset:2048
    s_add_u32 s69, s63, 9
    s_and_b32 s69, s69, 15
    s_or_b32 s69, s69, s74
    s_add_u32 m0, s45, 12288
    s_mul_i32 s69, s69, 12288
    buffer_load_dwordx4 v210, s[20:23], s69 offen nt lds
    v_mfma_f32_16x16x32_bf16 v[216:219], v[176:179], v[104:107], v[216:219]
    ds_read_b64_tr_b16 v[172:173], v250 offset:4096
    v_mfma_f32_16x16x32_bf16 v[224:227], v[176:179], v[128:131], v[224:227]
    ds_read_b64_tr_b16 v[174:175], v250 offset:6144
    buffer_load_dwordx4 v211, s[20:23], s69 offen offset:1024 nt lds
    v_mfma_f32_16x16x32_bf16 v[216:219], v[180:183], v[108:111], v[216:219]
    ds_read_b64_tr_b16 v[176:177], v250 offset:8192
    v_mfma_f32_16x16x32_bf16 v[224:227], v[180:183], v[132:135], v[224:227]
    ds_read_b64_tr_b16 v[178:179], v250 offset:10240
    buffer_load_dwordx4 v212, s[20:23], s69 offen offset:2048 nt lds
    v_cvt_pk_bf16_f32 v40, v232, v233
    v_cvt_pk_bf16_f32 v41, v234, v235
    v_cvt_pk_bf16_f32 v42, v236, v237
    v_cvt_pk_bf16_f32 v43, v238, v239
    s_waitcnt lgkmcnt(6)
    v_mfma_f32_16x16x32_bf16 v[216:219], v[184:187], v[112:115], v[216:219]
    ds_read_b64_tr_b16 v[180:181], v250 offset:12288
    v_mfma_f32_16x16x32_bf16 v[224:227], v[184:187], v[136:139], v[224:227]
    ds_read_b64_tr_b16 v[182:183], v250 offset:14336
    s_add_u32 s68, s65, 6
    s_sub_u32 s64, s68, 10
    s_cselect_b32 s68, s68, s64
    s_lshl_b32 s68, s68, 7
    s_add_u32 s68, s68, s60
    s_add_u32 m0, s59, 135168
    s_add_u32 s66, s68, 0
    buffer_load_dwordx4 v248, s[32:35], s66 offen lds
    v_cvt_pk_bf16_f32 v44, v240, v241
    v_cvt_pk_bf16_f32 v45, v242, v243
    v_cvt_pk_bf16_f32 v46, v244, v245
    v_cvt_pk_bf16_f32 v47, v246, v247
    v_mfma_f32_16x16x32_bf16 v[216:219], v[188:191], v[116:119], v[216:219]
    ds_read_b64_tr_b16 v[184:185], v250 offset:16384
    v_mfma_f32_16x16x32_bf16 v[224:227], v[188:191], v[140:143], v[224:227]
    ds_read_b64_tr_b16 v[186:187], v250 offset:18432
    s_add_u32 s67, s68, 9216
    buffer_load_dwordx4 v248, s[32:35], s67 offen offset:1024 lds
    s_waitcnt lgkmcnt(6)
    v_mfma_f32_16x16x32_bf16 v[220:223], v[168:171], v[96:99], 0
    ds_read_b64_tr_b16 v[188:189], v250 offset:20480
    v_mfma_f32_16x16x32_bf16 v[228:231], v[168:171], v[120:123], 0
    ds_read_b64_tr_b16 v[190:191], v250 offset:22528
    s_add_u32 s68, s68, 18432
    buffer_load_dwordx4 v248, s[32:35], s68 offen offset:2048 lds
    v_mfma_f32_16x16x32_bf16 v[220:223], v[172:175], v[100:103], v[220:223]
    v_mfma_f32_16x16x32_bf16 v[228:231], v[172:175], v[124:127], v[228:231]
    s_waitcnt lgkmcnt(6)
    v_mfma_f32_16x16x32_bf16 v[220:223], v[176:179], v[104:107], v[220:223]
    v_mfma_f32_16x16x32_bf16 v[228:231], v[176:179], v[128:131], v[228:231]
    s_waitcnt vmcnt(6) lgkmcnt(0)
    s_barrier
    v_xor_b32 v250, 96, v250
    ds_read_b64_tr_b16 v[168:169], v250
    ds_read_b64_tr_b16 v[170:171], v250 offset:2048
    ds_read_b64_tr_b16 v[172:173], v250 offset:4096
    ds_read_b64_tr_b16 v[174:175], v250 offset:6144
    v_mfma_f32_16x16x32_bf16 v[220:223], v[180:183], v[108:111], v[220:223]
    ds_read_b64_tr_b16 v[176:177], v250 offset:8192
    v_mfma_f32_16x16x32_bf16 v[228:231], v[180:183], v[132:135], v[228:231]
    ds_read_b64_tr_b16 v[178:179], v250 offset:10240
    s_add_u32 s69, s63, 8
    s_and_b32 s69, s69, 15
    s_or_b32 s69, s69, s74
    s_add_u32 m0, s45, 24576
    s_mul_i32 s69, s69, 12288
    buffer_load_dwordx4 v213, s[24:27], s69 offen nt lds
    v_mfma_f32_16x16x32_bf16 v[220:223], v[184:187], v[112:115], v[220:223]
    ds_read_b64_tr_b16 v[180:181], v250 offset:12288
    v_mfma_f32_16x16x32_bf16 v[228:231], v[184:187], v[136:139], v[228:231]
    ds_read_b64_tr_b16 v[182:183], v250 offset:14336
    buffer_load_dwordx4 v214, s[24:27], s69 offen offset:1024 nt lds
    v_mfma_f32_16x16x32_bf16 v[220:223], v[188:191], v[116:119], v[220:223]
    ds_read_b64_tr_b16 v[184:185], v250 offset:16384
    v_mfma_f32_16x16x32_bf16 v[228:231], v[188:191], v[140:143], v[228:231]
    ds_read_b64_tr_b16 v[186:187], v250 offset:18432
    buffer_load_dwordx4 v215, s[24:27], s69 offen offset:2048 nt lds
    s_waitcnt lgkmcnt(6)
    v_mfma_f32_16x16x32_bf16 v[232:235], v[168:171], v[96:99], 0
    ds_read_b64_tr_b16 v[188:189], v250 offset:20480
    v_mfma_f32_16x16x32_bf16 v[240:243], v[168:171], v[120:123], 0
    ds_read_b64_tr_b16 v[190:191], v250 offset:22528
    s_add_u32 s68, s65, 6
    s_sub_u32 s64, s68, 10
    s_cselect_b32 s68, s68, s64
    s_lshl_b32 s68, s68, 7
    s_add_u32 s68, s68, s60
    s_add_u32 m0, s59, 138240
    s_add_u32 s66, s68, 30720
    buffer_load_dwordx4 v248, s[32:35], s66 offen lds
    v_mfma_f32_16x16x32_bf16 v[232:235], v[172:175], v[100:103], v[232:235]
    v_xor_b32 v250, 32, v250
    ds_read_b64_tr_b16 v[168:169], v250
    v_mfma_f32_16x16x32_bf16 v[240:243], v[172:175], v[124:127], v[240:243]
    ds_read_b64_tr_b16 v[170:171], v250 offset:2048
    s_add_u32 s67, s68, 39936
    buffer_load_dwordx4 v248, s[32:35], s67 offen offset:1024 lds
    s_waitcnt lgkmcnt(6)
    v_mfma_f32_16x16x32_bf16 v[232:235], v[176:179], v[104:107], v[232:235]
    v_mfma_f32_16x16x32_bf16 v[240:243], v[176:179], v[128:131], v[240:243]
    s_add_u32 s68, s68, 49152
    buffer_load_dwordx4 v248, s[32:35], s68 offen offset:2048 lds
    v_mfma_f32_16x16x32_bf16 v[232:235], v[180:183], v[108:111], v[232:235]
    v_mfma_f32_16x16x32_bf16 v[240:243], v[180:183], v[132:135], v[240:243]
    v_cvt_pk_bf16_f32 v48, v216, v217
    v_cvt_pk_bf16_f32 v49, v218, v219
    v_cvt_pk_bf16_f32 v50, v220, v221
    v_cvt_pk_bf16_f32 v51, v222, v223
    s_waitcnt vmcnt(6) lgkmcnt(0)
    s_barrier
    ds_read_b64_tr_b16 v[172:173], v250 offset:4096
    ds_read_b64_tr_b16 v[174:175], v250 offset:6144
    ds_read_b64_tr_b16 v[176:177], v250 offset:8192
    ds_read_b64_tr_b16 v[178:179], v250 offset:10240
    v_mfma_f32_16x16x32_bf16 v[232:235], v[184:187], v[112:115], v[232:235]
    ds_read_b64_tr_b16 v[180:181], v250 offset:12288
    v_mfma_f32_16x16x32_bf16 v[240:243], v[184:187], v[136:139], v[240:243]
    ds_read_b64_tr_b16 v[182:183], v250 offset:14336
    s_add_u32 s69, s63, 10
    s_and_b32 s69, s69, 15
    s_or_b32 s69, s69, s74
    s_add_u32 m0, s45, 36864
    s_mul_i32 s69, s69, 12288
    buffer_load_dwordx4 v210, s[20:23], s69 offen nt lds
    v_cvt_pk_bf16_f32 v52, v224, v225
    v_cvt_pk_bf16_f32 v53, v226, v227
    v_cvt_pk_bf16_f32 v54, v228, v229
    v_cvt_pk_bf16_f32 v55, v230, v231
    v_mfma_f32_16x16x32_bf16 v[232:235], v[188:191], v[116:119], v[232:235]
    ds_read_b64_tr_b16 v[184:185], v250 offset:16384
    v_mfma_f32_16x16x32_bf16 v[240:243], v[188:191], v[140:143], v[240:243]
    ds_read_b64_tr_b16 v[186:187], v250 offset:18432
    buffer_load_dwordx4 v211, s[20:23], s69 offen offset:1024 nt lds
    v_mfma_f32_16x16x32_bf16 v[236:239], v[168:171], v[96:99], 0
    ds_read_b64_tr_b16 v[188:189], v250 offset:20480
    v_mfma_f32_16x16x32_bf16 v[244:247], v[168:171], v[120:123], 0
    ds_read_b64_tr_b16 v[190:191], v250 offset:22528
    buffer_load_dwordx4 v212, s[20:23], s69 offen offset:2048 nt lds
    s_waitcnt lgkmcnt(6)
    v_mfma_f32_16x16x32_bf16 v[236:239], v[172:175], v[100:103], v[236:239]
    v_add_u32 v250, 110592, v249
    ds_read_b64_tr_b16 v[168:169], v250
    v_mfma_f32_16x16x32_bf16 v[244:247], v[172:175], v[124:127], v[244:247]
    ds_read_b64_tr_b16 v[170:171], v250 offset:2048
    v_mfma_f32_16x16x32_bf16 v[236:239], v[176:179], v[104:107], v[236:239]
    ds_read_b64_tr_b16 v[172:173], v250 offset:4096
    v_mfma_f32_16x16x32_bf16 v[244:247], v[176:179], v[128:131], v[244:247]
    ds_read_b64_tr_b16 v[174:175], v250 offset:6144
    s_waitcnt lgkmcnt(6)
    v_mfma_f32_16x16x32_bf16 v[236:239], v[180:183], v[108:111], v[236:239]
    ds_read_b64_tr_b16 v[176:177], v250 offset:8192
    v_mfma_f32_16x16x32_bf16 v[244:247], v[180:183], v[132:135], v[244:247]
    ds_read_b64_tr_b16 v[178:179], v250 offset:10240
    v_mfma_f32_16x16x32_bf16 v[236:239], v[184:187], v[112:115], v[236:239]
    v_mfma_f32_16x16x32_bf16 v[244:247], v[184:187], v[136:139], v[244:247]
    s_waitcnt lgkmcnt(6)
    v_mfma_f32_16x16x32_bf16 v[236:239], v[188:191], v[116:119], v[236:239]
    v_mfma_f32_16x16x32_bf16 v[244:247], v[188:191], v[140:143], v[244:247]
    s_waitcnt vmcnt(6) lgkmcnt(0)
    s_barrier
    ds_read_b64_tr_b16 v[180:181], v250 offset:12288
    ds_read_b64_tr_b16 v[182:183], v250 offset:14336
    ds_read_b64_tr_b16 v[184:185], v250 offset:16384
    ds_read_b64_tr_b16 v[186:187], v250 offset:18432
    v_mfma_f32_16x16x32_bf16 v[216:219], v[168:171], v[96:99], 0
    ds_read_b64_tr_b16 v[188:189], v250 offset:20480
    v_mfma_f32_16x16x32_bf16 v[224:227], v[168:171], v[120:123], 0
    ds_read_b64_tr_b16 v[190:191], v250 offset:22528
    s_add_u32 s69, s63, 9
    s_and_b32 s69, s69, 15
    s_or_b32 s69, s69, s74
    s_add_u32 m0, s45, 49152
    s_mul_i32 s69, s69, 12288
    buffer_load_dwordx4 v213, s[24:27], s69 offen nt lds
    v_mfma_f32_16x16x32_bf16 v[216:219], v[172:175], v[100:103], v[216:219]
    v_xor_b32 v250, 32, v250
    ds_read_b64_tr_b16 v[168:169], v250
    v_mfma_f32_16x16x32_bf16 v[224:227], v[172:175], v[124:127], v[224:227]
    ds_read_b64_tr_b16 v[170:171], v250 offset:2048
    buffer_load_dwordx4 v214, s[24:27], s69 offen offset:1024 nt lds
    v_mfma_f32_16x16x32_bf16 v[216:219], v[176:179], v[104:107], v[216:219]
    ds_read_b64_tr_b16 v[172:173], v250 offset:4096
    v_mfma_f32_16x16x32_bf16 v[224:227], v[176:179], v[128:131], v[224:227]
    ds_read_b64_tr_b16 v[174:175], v250 offset:6144
    buffer_load_dwordx4 v215, s[24:27], s69 offen offset:2048 nt lds
    s_waitcnt lgkmcnt(6)
    v_mfma_f32_16x16x32_bf16 v[216:219], v[180:183], v[108:111], v[216:219]
    ds_read_b64_tr_b16 v[176:177], v250 offset:8192
    v_mfma_f32_16x16x32_bf16 v[224:227], v[180:183], v[132:135], v[224:227]
    ds_read_b64_tr_b16 v[178:179], v250 offset:10240
    s_add_u32 s68, s65, 7
    s_sub_u32 s64, s68, 10
    s_cselect_b32 s68, s68, s64
    s_lshl_b32 s68, s68, 7
    s_add_u32 s68, s68, s60
    s_add_u32 m0, s59, 86016
    s_add_u32 s66, s68, 0
    buffer_load_dwordx4 v248, s[32:35], s66 offen lds
    v_cvt_pk_bf16_f32 v56, v232, v233
    v_cvt_pk_bf16_f32 v57, v234, v235
    v_cvt_pk_bf16_f32 v58, v236, v237
    v_cvt_pk_bf16_f32 v59, v238, v239
    v_mfma_f32_16x16x32_bf16 v[216:219], v[184:187], v[112:115], v[216:219]
    ds_read_b64_tr_b16 v[180:181], v250 offset:12288
    v_mfma_f32_16x16x32_bf16 v[224:227], v[184:187], v[136:139], v[224:227]
    ds_read_b64_tr_b16 v[182:183], v250 offset:14336
    s_add_u32 s67, s68, 9216
    buffer_load_dwordx4 v248, s[32:35], s67 offen offset:1024 lds
    v_cvt_pk_bf16_f32 v60, v240, v241
    v_cvt_pk_bf16_f32 v61, v242, v243
    v_cvt_pk_bf16_f32 v62, v244, v245
    v_cvt_pk_bf16_f32 v63, v246, v247
    s_waitcnt lgkmcnt(6)
    v_mfma_f32_16x16x32_bf16 v[216:219], v[188:191], v[116:119], v[216:219]
    ds_read_b64_tr_b16 v[184:185], v250 offset:16384
    v_mfma_f32_16x16x32_bf16 v[224:227], v[188:191], v[140:143], v[224:227]
    ds_read_b64_tr_b16 v[186:187], v250 offset:18432
    s_add_u32 s68, s68, 18432
    buffer_load_dwordx4 v248, s[32:35], s68 offen offset:2048 lds
    v_mfma_f32_16x16x32_bf16 v[220:223], v[168:171], v[96:99], 0
    v_mfma_f32_16x16x32_bf16 v[228:231], v[168:171], v[120:123], 0
    s_waitcnt lgkmcnt(6)
    v_mfma_f32_16x16x32_bf16 v[220:223], v[172:175], v[100:103], v[220:223]
    v_mfma_f32_16x16x32_bf16 v[228:231], v[172:175], v[124:127], v[228:231]
    s_waitcnt vmcnt(6) lgkmcnt(0)
    s_barrier
    ds_read_b64_tr_b16 v[188:189], v250 offset:20480
    ds_read_b64_tr_b16 v[190:191], v250 offset:22528
    v_xor_b32 v250, 96, v250
    ds_read_b64_tr_b16 v[168:169], v250
    ds_read_b64_tr_b16 v[170:171], v250 offset:2048
    v_mfma_f32_16x16x32_bf16 v[220:223], v[176:179], v[104:107], v[220:223]
    ds_read_b64_tr_b16 v[172:173], v250 offset:4096
    v_mfma_f32_16x16x32_bf16 v[228:231], v[176:179], v[128:131], v[228:231]
    ds_read_b64_tr_b16 v[174:175], v250 offset:6144
    s_add_u32 s69, s63, 11
    s_and_b32 s69, s69, 15
    s_or_b32 s69, s69, s74
    s_add_u32 m0, s45, 61440
    s_mul_i32 s69, s69, 12288
    buffer_load_dwordx4 v210, s[20:23], s69 offen nt lds
    v_mfma_f32_16x16x32_bf16 v[220:223], v[180:183], v[108:111], v[220:223]
    ds_read_b64_tr_b16 v[176:177], v250 offset:8192
    v_mfma_f32_16x16x32_bf16 v[228:231], v[180:183], v[132:135], v[228:231]
    ds_read_b64_tr_b16 v[178:179], v250 offset:10240
    buffer_load_dwordx4 v211, s[20:23], s69 offen offset:1024 nt lds
    v_mfma_f32_16x16x32_bf16 v[220:223], v[184:187], v[112:115], v[220:223]
    ds_read_b64_tr_b16 v[180:181], v250 offset:12288
    v_mfma_f32_16x16x32_bf16 v[228:231], v[184:187], v[136:139], v[228:231]
    ds_read_b64_tr_b16 v[182:183], v250 offset:14336
    buffer_load_dwordx4 v212, s[20:23], s69 offen offset:2048 nt lds
    s_waitcnt lgkmcnt(6)
    v_mfma_f32_16x16x32_bf16 v[220:223], v[188:191], v[116:119], v[220:223]
    ds_read_b64_tr_b16 v[184:185], v250 offset:16384
    v_mfma_f32_16x16x32_bf16 v[228:231], v[188:191], v[140:143], v[228:231]
    ds_read_b64_tr_b16 v[186:187], v250 offset:18432
    s_add_u32 s68, s65, 7
    s_sub_u32 s64, s68, 10
    s_cselect_b32 s68, s68, s64
    s_lshl_b32 s68, s68, 7
    s_add_u32 s68, s68, s60
    s_add_u32 m0, s59, 89088
    s_add_u32 s66, s68, 30720
    buffer_load_dwordx4 v248, s[32:35], s66 offen lds
    v_mfma_f32_16x16x32_bf16 v[232:235], v[168:171], v[96:99], 0
    ds_read_b64_tr_b16 v[188:189], v250 offset:20480
    v_mfma_f32_16x16x32_bf16 v[240:243], v[168:171], v[120:123], 0
    ds_read_b64_tr_b16 v[190:191], v250 offset:22528
    s_add_u32 s67, s68, 39936
    buffer_load_dwordx4 v248, s[32:35], s67 offen offset:1024 lds
    s_waitcnt lgkmcnt(6)
    v_mfma_f32_16x16x32_bf16 v[232:235], v[172:175], v[100:103], v[232:235]
    v_mfma_f32_16x16x32_bf16 v[240:243], v[172:175], v[124:127], v[240:243]
    s_add_u32 s68, s68, 49152
    buffer_load_dwordx4 v248, s[32:35], s68 offen offset:2048 lds
    v_mfma_f32_16x16x32_bf16 v[232:235], v[176:179], v[104:107], v[232:235]
    v_mfma_f32_16x16x32_bf16 v[240:243], v[176:179], v[128:131], v[240:243]
    s_waitcnt vmcnt(6) lgkmcnt(0)
    s_barrier
    v_xor_b32 v250, 32, v250
    ds_read_b64_tr_b16 v[168:169], v250
    ds_read_b64_tr_b16 v[170:171], v250 offset:2048
    ds_read_b64_tr_b16 v[172:173], v250 offset:4096
    ds_read_b64_tr_b16 v[174:175], v250 offset:6144
    v_mfma_f32_16x16x32_bf16 v[232:235], v[180:183], v[108:111], v[232:235]
    ds_read_b64_tr_b16 v[176:177], v250 offset:8192
    v_mfma_f32_16x16x32_bf16 v[240:243], v[180:183], v[132:135], v[240:243]
    ds_read_b64_tr_b16 v[178:179], v250 offset:10240
    s_add_u32 s69, s63, 10
    s_and_b32 s69, s69, 15
    s_or_b32 s69, s69, s74
    s_add_u32 m0, s45, 73728
    s_mul_i32 s69, s69, 12288
    buffer_load_dwordx4 v213, s[24:27], s69 offen nt lds
    v_cvt_pk_bf16_f32 v64, v216, v217
    v_cvt_pk_bf16_f32 v65, v218, v219
    v_cvt_pk_bf16_f32 v66, v220, v221
    v_cvt_pk_bf16_f32 v67, v222, v223
    v_mfma_f32_16x16x32_bf16 v[232:235], v[184:187], v[112:115], v[232:235]
    ds_read_b64_tr_b16 v[180:181], v250 offset:12288
    v_mfma_f32_16x16x32_bf16 v[240:243], v[184:187], v[136:139], v[240:243]
    ds_read_b64_tr_b16 v[182:183], v250 offset:14336
    buffer_load_dwordx4 v214, s[24:27], s69 offen offset:1024 nt lds
    v_cvt_pk_bf16_f32 v68, v224, v225
    v_cvt_pk_bf16_f32 v69, v226, v227
    v_cvt_pk_bf16_f32 v70, v228, v229
    v_cvt_pk_bf16_f32 v71, v230, v231
    v_mfma_f32_16x16x32_bf16 v[232:235], v[188:191], v[116:119], v[232:235]
    ds_read_b64_tr_b16 v[184:185], v250 offset:16384
    v_mfma_f32_16x16x32_bf16 v[240:243], v[188:191], v[140:143], v[240:243]
    ds_read_b64_tr_b16 v[186:187], v250 offset:18432
    buffer_load_dwordx4 v215, s[24:27], s69 offen offset:2048 nt lds
    s_waitcnt lgkmcnt(6)
    v_mfma_f32_16x16x32_bf16 v[236:239], v[168:171], v[96:99], 0
    ds_read_b64_tr_b16 v[188:189], v250 offset:20480
    v_mfma_f32_16x16x32_bf16 v[244:247], v[168:171], v[120:123], 0
    ds_read_b64_tr_b16 v[190:191], v250 offset:22528
    v_mfma_f32_16x16x32_bf16 v[236:239], v[172:175], v[100:103], v[236:239]
    v_add_u32 v250, 135168, v249
    ds_read_b64_tr_b16 v[168:169], v250
    v_mfma_f32_16x16x32_bf16 v[244:247], v[172:175], v[124:127], v[244:247]
    ds_read_b64_tr_b16 v[170:171], v250 offset:2048
    s_waitcnt lgkmcnt(6)
    v_mfma_f32_16x16x32_bf16 v[236:239], v[176:179], v[104:107], v[236:239]
    ds_read_b64_tr_b16 v[172:173], v250 offset:4096
    v_mfma_f32_16x16x32_bf16 v[244:247], v[176:179], v[128:131], v[244:247]
    ds_read_b64_tr_b16 v[174:175], v250 offset:6144
    v_mfma_f32_16x16x32_bf16 v[236:239], v[180:183], v[108:111], v[236:239]
    v_mfma_f32_16x16x32_bf16 v[244:247], v[180:183], v[132:135], v[244:247]
    s_waitcnt lgkmcnt(6)
    v_mfma_f32_16x16x32_bf16 v[236:239], v[184:187], v[112:115], v[236:239]
    v_mfma_f32_16x16x32_bf16 v[244:247], v[184:187], v[136:139], v[244:247]
    s_waitcnt vmcnt(6) lgkmcnt(0)
    s_barrier
    ds_read_b64_tr_b16 v[176:177], v250 offset:8192
    ds_read_b64_tr_b16 v[178:179], v250 offset:10240
    ds_read_b64_tr_b16 v[180:181], v250 offset:12288
    ds_read_b64_tr_b16 v[182:183], v250 offset:14336
    v_mfma_f32_16x16x32_bf16 v[236:239], v[188:191], v[116:119], v[236:239]
    ds_read_b64_tr_b16 v[184:185], v250 offset:16384
    v_mfma_f32_16x16x32_bf16 v[244:247], v[188:191], v[140:143], v[244:247]
    ds_read_b64_tr_b16 v[186:187], v250 offset:18432
    s_add_u32 s69, s63, 12
    s_and_b32 s69, s69, 15
    s_or_b32 s69, s69, s74
    s_add_u32 m0, s45, 0
    s_mul_i32 s69, s69, 12288
    buffer_load_dwordx4 v210, s[20:23], s69 offen nt lds
    v_mfma_f32_16x16x32_bf16 v[216:219], v[168:171], v[96:99], 0
    ds_read_b64_tr_b16 v[188:189], v250 offset:20480
    v_mfma_f32_16x16x32_bf16 v[224:227], v[168:171], v[120:123], 0
    ds_read_b64_tr_b16 v[190:191], v250 offset:22528
    buffer_load_dwordx4 v211, s[20:23], s69 offen offset:1024 nt lds
    v_mfma_f32_16x16x32_bf16 v[216:219], v[172:175], v[100:103], v[216:219]
    v_xor_b32 v250, 32, v250
    ds_read_b64_tr_b16 v[168:169], v250
    v_mfma_f32_16x16x32_bf16 v[224:227], v[172:175], v[124:127], v[224:227]
    ds_read_b64_tr_b16 v[170:171], v250 offset:2048
    buffer_load_dwordx4 v212, s[20:23], s69 offen offset:2048 nt lds
    s_waitcnt lgkmcnt(6)
    v_mfma_f32_16x16x32_bf16 v[216:219], v[176:179], v[104:107], v[216:219]
    ds_read_b64_tr_b16 v[172:173], v250 offset:4096
    v_mfma_f32_16x16x32_bf16 v[224:227], v[176:179], v[128:131], v[224:227]
    ds_read_b64_tr_b16 v[174:175], v250 offset:6144
    s_add_u32 s68, s65, 8
    s_sub_u32 s64, s68, 10
    s_cselect_b32 s68, s68, s64
    s_lshl_b32 s68, s68, 7
    s_add_u32 s68, s68, s60
    s_add_u32 m0, s59, 110592
    s_add_u32 s66, s68, 0
    buffer_load_dwordx4 v248, s[32:35], s66 offen lds
    v_mfma_f32_16x16x32_bf16 v[216:219], v[180:183], v[108:111], v[216:219]
    ds_read_b64_tr_b16 v[176:177], v250 offset:8192
    v_mfma_f32_16x16x32_bf16 v[224:227], v[180:183], v[132:135], v[224:227]
    ds_read_b64_tr_b16 v[178:179], v250 offset:10240
    s_add_u32 s67, s68, 9216
    buffer_load_dwordx4 v248, s[32:35], s67 offen offset:1024 lds
    v_cvt_pk_bf16_f32 v72, v232, v233
    v_cvt_pk_bf16_f32 v73, v234, v235
    v_cvt_pk_bf16_f32 v74, v236, v237
    v_cvt_pk_bf16_f32 v75, v238, v239
    s_waitcnt lgkmcnt(6)
    v_mfma_f32_16x16x32_bf16 v[216:219], v[184:187], v[112:115], v[216:219]
    ds_read_b64_tr_b16 v[180:181], v250 offset:12288
    v_mfma_f32_16x16x32_bf16 v[224:227], v[184:187], v[136:139], v[224:227]
    ds_read_b64_tr_b16 v[182:183], v250 offset:14336
    s_add_u32 s68, s68, 18432
    buffer_load_dwordx4 v248, s[32:35], s68 offen offset:2048 lds
    v_cvt_pk_bf16_f32 v76, v240, v241
    v_cvt_pk_bf16_f32 v77, v242, v243
    v_cvt_pk_bf16_f32 v78, v244, v245
    v_cvt_pk_bf16_f32 v79, v246, v247
    v_mfma_f32_16x16x32_bf16 v[216:219], v[188:191], v[116:119], v[216:219]
    v_mfma_f32_16x16x32_bf16 v[224:227], v[188:191], v[140:143], v[224:227]
    s_waitcnt lgkmcnt(6)
    v_mfma_f32_16x16x32_bf16 v[220:223], v[168:171], v[96:99], 0
    v_mfma_f32_16x16x32_bf16 v[228:231], v[168:171], v[120:123], 0
    s_waitcnt vmcnt(6) lgkmcnt(0)
    s_barrier
    ds_read_b64_tr_b16 v[184:185], v250 offset:16384
    ds_read_b64_tr_b16 v[186:187], v250 offset:18432
    ds_read_b64_tr_b16 v[188:189], v250 offset:20480
    ds_read_b64_tr_b16 v[190:191], v250 offset:22528
    v_mfma_f32_16x16x32_bf16 v[220:223], v[172:175], v[100:103], v[220:223]
    v_xor_b32 v250, 96, v250
    ds_read_b64_tr_b16 v[168:169], v250
    v_mfma_f32_16x16x32_bf16 v[228:231], v[172:175], v[124:127], v[228:231]
    ds_read_b64_tr_b16 v[170:171], v250 offset:2048
    s_add_u32 s69, s63, 11
    s_and_b32 s69, s69, 15
    s_or_b32 s69, s69, s74
    s_add_u32 m0, s45, 12288
    s_mul_i32 s69, s69, 12288
    buffer_load_dwordx4 v213, s[24:27], s69 offen nt lds
    v_mfma_f32_16x16x32_bf16 v[220:223], v[176:179], v[104:107], v[220:223]
    ds_read_b64_tr_b16 v[172:173], v250 offset:4096
    v_mfma_f32_16x16x32_bf16 v[228:231], v[176:179], v[128:131], v[228:231]
    ds_read_b64_tr_b16 v[174:175], v250 offset:6144
    buffer_load_dwordx4 v214, s[24:27], s69 offen offset:1024 nt lds
    v_mfma_f32_16x16x32_bf16 v[220:223], v[180:183], v[108:111], v[220:223]
    ds_read_b64_tr_b16 v[176:177], v250 offset:8192
    v_mfma_f32_16x16x32_bf16 v[228:231], v[180:183], v[132:135], v[228:231]
    ds_read_b64_tr_b16 v[178:179], v250 offset:10240
    buffer_load_dwordx4 v215, s[24:27], s69 offen offset:2048 nt lds
    s_waitcnt lgkmcnt(6)
    v_mfma_f32_16x16x32_bf16 v[220:223], v[184:187], v[112:115], v[220:223]
    ds_read_b64_tr_b16 v[180:181], v250 offset:12288
    v_mfma_f32_16x16x32_bf16 v[228:231], v[184:187], v[136:139], v[228:231]
    ds_read_b64_tr_b16 v[182:183], v250 offset:14336
    s_add_u32 s68, s65, 8
    s_sub_u32 s64, s68, 10
    s_cselect_b32 s68, s68, s64
    s_lshl_b32 s68, s68, 7
    s_add_u32 s68, s68, s60
    s_add_u32 m0, s59, 113664
    s_add_u32 s66, s68, 30720
    buffer_load_dwordx4 v248, s[32:35], s66 offen lds
    v_mfma_f32_16x16x32_bf16 v[220:223], v[188:191], v[116:119], v[220:223]
    ds_read_b64_tr_b16 v[184:185], v250 offset:16384
    v_mfma_f32_16x16x32_bf16 v[228:231], v[188:191], v[140:143], v[228:231]
    ds_read_b64_tr_b16 v[186:187], v250 offset:18432
    s_add_u32 s67, s68, 39936
    buffer_load_dwordx4 v248, s[32:35], s67 offen offset:1024 lds
    s_waitcnt lgkmcnt(6)
    v_mfma_f32_16x16x32_bf16 v[232:235], v[168:171], v[96:99], 0
    v_mfma_f32_16x16x32_bf16 v[240:243], v[168:171], v[120:123], 0
    s_add_u32 s68, s68, 49152
    buffer_load_dwordx4 v248, s[32:35], s68 offen offset:2048 lds
    v_mfma_f32_16x16x32_bf16 v[232:235], v[172:175], v[100:103], v[232:235]
    v_mfma_f32_16x16x32_bf16 v[240:243], v[172:175], v[124:127], v[240:243]
    s_waitcnt vmcnt(6) lgkmcnt(0)
    s_barrier
    ds_read_b64_tr_b16 v[188:189], v250 offset:20480
    ds_read_b64_tr_b16 v[190:191], v250 offset:22528
    v_xor_b32 v250, 32, v250
    ds_read_b64_tr_b16 v[168:169], v250
    ds_read_b64_tr_b16 v[170:171], v250 offset:2048
    v_mfma_f32_16x16x32_bf16 v[232:235], v[176:179], v[104:107], v[232:235]
    ds_read_b64_tr_b16 v[172:173], v250 offset:4096
    v_mfma_f32_16x16x32_bf16 v[240:243], v[176:179], v[128:131], v[240:243]
    ds_read_b64_tr_b16 v[174:175], v250 offset:6144
    s_add_u32 s69, s63, 13
    s_and_b32 s69, s69, 15
    s_or_b32 s69, s69, s74
    s_add_u32 m0, s45, 24576
    s_mul_i32 s69, s69, 12288
    buffer_load_dwordx4 v210, s[20:23], s69 offen nt lds
    v_mfma_f32_16x16x32_bf16 v[232:235], v[180:183], v[108:111], v[232:235]
    ds_read_b64_tr_b16 v[176:177], v250 offset:8192
    v_mfma_f32_16x16x32_bf16 v[240:243], v[180:183], v[132:135], v[240:243]
    ds_read_b64_tr_b16 v[178:179], v250 offset:10240
    buffer_load_dwordx4 v211, s[20:23], s69 offen offset:1024 nt lds
    v_cvt_pk_bf16_f32 v80, v216, v217
    v_cvt_pk_bf16_f32 v81, v218, v219
    v_cvt_pk_bf16_f32 v82, v220, v221
    v_cvt_pk_bf16_f32 v83, v222, v223
    v_mfma_f32_16x16x32_bf16 v[232:235], v[184:187], v[112:115], v[232:235]
    ds_read_b64_tr_b16 v[180:181], v250 offset:12288
    v_mfma_f32_16x16x32_bf16 v[240:243], v[184:187], v[136:139], v[240:243]
    ds_read_b64_tr_b16 v[182:183], v250 offset:14336
    buffer_load_dwordx4 v212, s[20:23], s69 offen offset:2048 nt lds
    v_cvt_pk_bf16_f32 v84, v224, v225
    v_cvt_pk_bf16_f32 v85, v226, v227
    v_cvt_pk_bf16_f32 v86, v228, v229
    v_cvt_pk_bf16_f32 v87, v230, v231
    s_waitcnt lgkmcnt(6)
    v_mfma_f32_16x16x32_bf16 v[232:235], v[188:191], v[116:119], v[232:235]
    ds_read_b64_tr_b16 v[184:185], v250 offset:16384
    v_mfma_f32_16x16x32_bf16 v[240:243], v[188:191], v[140:143], v[240:243]
    ds_read_b64_tr_b16 v[186:187], v250 offset:18432
    v_mfma_f32_16x16x32_bf16 v[236:239], v[168:171], v[96:99], 0
    ds_read_b64_tr_b16 v[188:189], v250 offset:20480
    v_mfma_f32_16x16x32_bf16 v[244:247], v[168:171], v[120:123], 0
    ds_read_b64_tr_b16 v[190:191], v250 offset:22528
    s_waitcnt lgkmcnt(6)
    v_mfma_f32_16x16x32_bf16 v[236:239], v[172:175], v[100:103], v[236:239]
    v_add_u32 v250, 86016, v249
    ds_read_b64_tr_b16 v[168:169], v250
    v_mfma_f32_16x16x32_bf16 v[244:247], v[172:175], v[124:127], v[244:247]
    ds_read_b64_tr_b16 v[170:171], v250 offset:2048
    v_mfma_f32_16x16x32_bf16 v[236:239], v[176:179], v[104:107], v[236:239]
    v_mfma_f32_16x16x32_bf16 v[244:247], v[176:179], v[128:131], v[244:247]
    s_waitcnt lgkmcnt(6)
    v_mfma_f32_16x16x32_bf16 v[236:239], v[180:183], v[108:111], v[236:239]
    v_mfma_f32_16x16x32_bf16 v[244:247], v[180:183], v[132:135], v[244:247]
    s_waitcnt vmcnt(6) lgkmcnt(0)
    s_barrier
    ds_read_b64_tr_b16 v[172:173], v250 offset:4096
    ds_read_b64_tr_b16 v[174:175], v250 offset:6144
    ds_read_b64_tr_b16 v[176:177], v250 offset:8192
    ds_read_b64_tr_b16 v[178:179], v250 offset:10240
    v_mfma_f32_16x16x32_bf16 v[236:239], v[184:187], v[112:115], v[236:239]
    ds_read_b64_tr_b16 v[180:181], v250 offset:12288
    v_mfma_f32_16x16x32_bf16 v[244:247], v[184:187], v[136:139], v[244:247]
    ds_read_b64_tr_b16 v[182:183], v250 offset:14336
    s_add_u32 s69, s63, 12
    s_and_b32 s69, s69, 15
    s_or_b32 s69, s69, s74
    s_add_u32 m0, s45, 36864
    s_mul_i32 s69, s69, 12288
    buffer_load_dwordx4 v213, s[24:27], s69 offen nt lds
    v_mfma_f32_16x16x32_bf16 v[236:239], v[188:191], v[116:119], v[236:239]
    ds_read_b64_tr_b16 v[184:185], v250 offset:16384
    v_mfma_f32_16x16x32_bf16 v[244:247], v[188:191], v[140:143], v[244:247]
    ds_read_b64_tr_b16 v[186:187], v250 offset:18432
    buffer_load_dwordx4 v214, s[24:27], s69 offen offset:1024 nt lds
    v_mfma_f32_16x16x32_bf16 v[216:219], v[168:171], v[96:99], 0
    ds_read_b64_tr_b16 v[188:189], v250 offset:20480
    v_mfma_f32_16x16x32_bf16 v[224:227], v[168:171], v[120:123], 0
    ds_read_b64_tr_b16 v[190:191], v250 offset:22528
    buffer_load_dwordx4 v215, s[24:27], s69 offen offset:2048 nt lds
    s_waitcnt lgkmcnt(6)
    v_mfma_f32_16x16x32_bf16 v[216:219], v[172:175], v[100:103], v[216:219]
    v_xor_b32 v250, 32, v250
    ds_read_b64_tr_b16 v[168:169], v250
    v_mfma_f32_16x16x32_bf16 v[224:227], v[172:175], v[124:127], v[224:227]
    ds_read_b64_tr_b16 v[170:171], v250 offset:2048
    s_add_u32 s68, s65, 9
    s_sub_u32 s64, s68, 10
    s_cselect_b32 s68, s68, s64
    s_lshl_b32 s68, s68, 7
    s_add_u32 s68, s68, s60
    s_add_u32 m0, s59, 135168
    s_add_u32 s66, s68, 0
    buffer_load_dwordx4 v248, s[32:35], s66 offen lds
    v_mfma_f32_16x16x32_bf16 v[216:219], v[176:179], v[104:107], v[216:219]
    ds_read_b64_tr_b16 v[172:173], v250 offset:4096
    v_mfma_f32_16x16x32_bf16 v[224:227], v[176:179], v[128:131], v[224:227]
    ds_read_b64_tr_b16 v[174:175], v250 offset:6144
    s_add_u32 s67, s68, 9216
    buffer_load_dwordx4 v248, s[32:35], s67 offen offset:1024 lds
    s_waitcnt lgkmcnt(6)
    v_mfma_f32_16x16x32_bf16 v[216:219], v[180:183], v[108:111], v[216:219]
    ds_read_b64_tr_b16 v[176:177], v250 offset:8192
    v_mfma_f32_16x16x32_bf16 v[224:227], v[180:183], v[132:135], v[224:227]
    ds_read_b64_tr_b16 v[178:179], v250 offset:10240
    s_add_u32 s68, s68, 18432
    buffer_load_dwordx4 v248, s[32:35], s68 offen offset:2048 lds
    v_cvt_pk_bf16_f32 v88, v232, v233
    v_cvt_pk_bf16_f32 v89, v234, v235
    v_cvt_pk_bf16_f32 v90, v236, v237
    v_cvt_pk_bf16_f32 v91, v238, v239
    v_mfma_f32_16x16x32_bf16 v[216:219], v[184:187], v[112:115], v[216:219]
    v_mfma_f32_16x16x32_bf16 v[224:227], v[184:187], v[136:139], v[224:227]
    v_cvt_pk_bf16_f32 v92, v240, v241
    v_cvt_pk_bf16_f32 v93, v242, v243
    v_cvt_pk_bf16_f32 v94, v244, v245
    v_cvt_pk_bf16_f32 v95, v246, v247
    s_waitcnt lgkmcnt(6)
    v_mfma_f32_16x16x32_bf16 v[216:219], v[188:191], v[116:119], v[216:219]
    v_mfma_f32_16x16x32_bf16 v[224:227], v[188:191], v[140:143], v[224:227]
    s_waitcnt vmcnt(6) lgkmcnt(0)
    s_barrier
    ds_read_b64_tr_b16 v[180:181], v250 offset:12288
    ds_read_b64_tr_b16 v[182:183], v250 offset:14336
    ds_read_b64_tr_b16 v[184:185], v250 offset:16384
    ds_read_b64_tr_b16 v[186:187], v250 offset:18432
    v_mfma_f32_16x16x32_bf16 v[220:223], v[168:171], v[96:99], 0
    ds_read_b64_tr_b16 v[188:189], v250 offset:20480
    v_mfma_f32_16x16x32_bf16 v[228:231], v[168:171], v[120:123], 0
    ds_read_b64_tr_b16 v[190:191], v250 offset:22528
    s_add_u32 s69, s63, 14
    s_and_b32 s69, s69, 15
    s_or_b32 s69, s69, s74
    s_add_u32 m0, s45, 49152
    s_mul_i32 s69, s69, 12288
    buffer_load_dwordx4 v210, s[20:23], s69 offen nt lds
    v_mfma_f32_16x16x32_bf16 v[220:223], v[172:175], v[100:103], v[220:223]
    v_xor_b32 v250, 96, v250
    ds_read_b64_tr_b16 v[168:169], v250
    v_mfma_f32_16x16x32_bf16 v[228:231], v[172:175], v[124:127], v[228:231]
    ds_read_b64_tr_b16 v[170:171], v250 offset:2048
    buffer_load_dwordx4 v211, s[20:23], s69 offen offset:1024 nt lds
    v_mfma_f32_16x16x32_bf16 v[220:223], v[176:179], v[104:107], v[220:223]
    ds_read_b64_tr_b16 v[172:173], v250 offset:4096
    v_mfma_f32_16x16x32_bf16 v[228:231], v[176:179], v[128:131], v[228:231]
    ds_read_b64_tr_b16 v[174:175], v250 offset:6144
    buffer_load_dwordx4 v212, s[20:23], s69 offen offset:2048 nt lds
    s_waitcnt lgkmcnt(6)
    v_mfma_f32_16x16x32_bf16 v[220:223], v[180:183], v[108:111], v[220:223]
    ds_read_b64_tr_b16 v[176:177], v250 offset:8192
    v_mfma_f32_16x16x32_bf16 v[228:231], v[180:183], v[132:135], v[228:231]
    ds_read_b64_tr_b16 v[178:179], v250 offset:10240
    s_add_u32 s68, s65, 9
    s_sub_u32 s64, s68, 10
    s_cselect_b32 s68, s68, s64
    s_lshl_b32 s68, s68, 7
    s_add_u32 s68, s68, s60
    s_add_u32 m0, s59, 138240
    s_add_u32 s66, s68, 30720
    buffer_load_dwordx4 v248, s[32:35], s66 offen lds
    v_mfma_f32_16x16x32_bf16 v[220:223], v[184:187], v[112:115], v[220:223]
    ds_read_b64_tr_b16 v[180:181], v250 offset:12288
    v_mfma_f32_16x16x32_bf16 v[228:231], v[184:187], v[136:139], v[228:231]
    ds_read_b64_tr_b16 v[182:183], v250 offset:14336
    s_add_u32 s67, s68, 39936
    buffer_load_dwordx4 v248, s[32:35], s67 offen offset:1024 lds
    s_waitcnt lgkmcnt(6)
    v_mfma_f32_16x16x32_bf16 v[220:223], v[188:191], v[116:119], v[220:223]
    v_mfma_f32_16x16x32_bf16 v[228:231], v[188:191], v[140:143], v[228:231]
    s_add_u32 s68, s68, 49152
    buffer_load_dwordx4 v248, s[32:35], s68 offen offset:2048 lds
    v_mfma_f32_16x16x32_bf16 v[232:235], v[168:171], v[96:99], 0
    v_mfma_f32_16x16x32_bf16 v[240:243], v[168:171], v[120:123], 0
    s_waitcnt vmcnt(6) lgkmcnt(0)
    s_barrier
    ds_read_b64_tr_b16 v[184:185], v250 offset:16384
    ds_read_b64_tr_b16 v[186:187], v250 offset:18432
    ds_read_b64_tr_b16 v[188:189], v250 offset:20480
    ds_read_b64_tr_b16 v[190:191], v250 offset:22528
    v_mfma_f32_16x16x32_bf16 v[232:235], v[172:175], v[100:103], v[232:235]
    v_xor_b32 v250, 32, v250
    ds_read_b64_tr_b16 v[168:169], v250
    v_mfma_f32_16x16x32_bf16 v[240:243], v[172:175], v[124:127], v[240:243]
    ds_read_b64_tr_b16 v[170:171], v250 offset:2048
    s_add_u32 s69, s63, 13
    s_and_b32 s69, s69, 15
    s_or_b32 s69, s69, s74
    s_add_u32 m0, s45, 61440
    s_mul_i32 s69, s69, 12288
    buffer_load_dwordx4 v213, s[24:27], s69 offen nt lds
    v_mfma_f32_16x16x32_bf16 v[232:235], v[176:179], v[104:107], v[232:235]
    ds_read_b64_tr_b16 v[172:173], v250 offset:4096
    v_mfma_f32_16x16x32_bf16 v[240:243], v[176:179], v[128:131], v[240:243]
    ds_read_b64_tr_b16 v[174:175], v250 offset:6144
    buffer_load_dwordx4 v214, s[24:27], s69 offen offset:1024 nt lds
    v_mfma_f32_16x16x32_bf16 v[232:235], v[180:183], v[108:111], v[232:235]
    ds_read_b64_tr_b16 v[176:177], v250 offset:8192
    v_mfma_f32_16x16x32_bf16 v[240:243], v[180:183], v[132:135], v[240:243]
    ds_read_b64_tr_b16 v[178:179], v250 offset:10240
    buffer_load_dwordx4 v215, s[24:27], s69 offen offset:2048 nt lds
    v_cvt_pk_bf16_f32 v144, v216, v217
    v_cvt_pk_bf16_f32 v145, v218, v219
    v_cvt_pk_bf16_f32 v146, v220, v221
    v_cvt_pk_bf16_f32 v147, v222, v223
    s_waitcnt lgkmcnt(6)
    v_mfma_f32_16x16x32_bf16 v[232:235], v[184:187], v[112:115], v[232:235]
    ds_read_b64_tr_b16 v[180:181], v250 offset:12288
    v_mfma_f32_16x16x32_bf16 v[240:243], v[184:187], v[136:139], v[240:243]
    ds_read_b64_tr_b16 v[182:183], v250 offset:14336
    v_cvt_pk_bf16_f32 v148, v224, v225
    v_cvt_pk_bf16_f32 v149, v226, v227
    v_cvt_pk_bf16_f32 v150, v228, v229
    v_cvt_pk_bf16_f32 v151, v230, v231
    v_mfma_f32_16x16x32_bf16 v[232:235], v[188:191], v[116:119], v[232:235]
    ds_read_b64_tr_b16 v[184:185], v250 offset:16384
    v_mfma_f32_16x16x32_bf16 v[240:243], v[188:191], v[140:143], v[240:243]
    ds_read_b64_tr_b16 v[186:187], v250 offset:18432
    s_waitcnt lgkmcnt(6)
    v_mfma_f32_16x16x32_bf16 v[236:239], v[168:171], v[96:99], 0
    ds_read_b64_tr_b16 v[188:189], v250 offset:20480
    v_mfma_f32_16x16x32_bf16 v[244:247], v[168:171], v[120:123], 0
    ds_read_b64_tr_b16 v[190:191], v250 offset:22528
    v_mfma_f32_16x16x32_bf16 v[236:239], v[172:175], v[100:103], v[236:239]
    v_mfma_f32_16x16x32_bf16 v[244:247], v[172:175], v[124:127], v[244:247]
    s_waitcnt lgkmcnt(6)
    v_mfma_f32_16x16x32_bf16 v[236:239], v[176:179], v[104:107], v[236:239]
    v_mfma_f32_16x16x32_bf16 v[244:247], v[176:179], v[128:131], v[244:247]
    s_waitcnt vmcnt(6) lgkmcnt(0)
    s_barrier
    v_add_u32 v250, 110592, v249
    ds_read_b64_tr_b16 v[168:169], v250
    ds_read_b64_tr_b16 v[170:171], v250 offset:2048
    ds_read_b64_tr_b16 v[172:173], v250 offset:4096
    ds_read_b64_tr_b16 v[174:175], v250 offset:6144
    v_mfma_f32_16x16x32_bf16 v[236:239], v[180:183], v[108:111], v[236:239]
    ds_read_b64_tr_b16 v[176:177], v250 offset:8192
    v_mfma_f32_16x16x32_bf16 v[244:247], v[180:183], v[132:135], v[244:247]
    ds_read_b64_tr_b16 v[178:179], v250 offset:10240
    s_add_u32 s69, s63, 15
    s_and_b32 s69, s69, 15
    s_or_b32 s69, s69, s74
    s_add_u32 m0, s45, 73728
    s_mul_i32 s69, s69, 12288
    buffer_load_dwordx4 v210, s[20:23], s69 offen nt lds
    v_mfma_f32_16x16x32_bf16 v[236:239], v[184:187], v[112:115], v[236:239]
    ds_read_b64_tr_b16 v[180:181], v250 offset:12288
    v_mfma_f32_16x16x32_bf16 v[244:247], v[184:187], v[136:139], v[244:247]
    ds_read_b64_tr_b16 v[182:183], v250 offset:14336
    buffer_load_dwordx4 v211, s[20:23], s69 offen offset:1024 nt lds
    v_mfma_f32_16x16x32_bf16 v[236:239], v[188:191], v[116:119], v[236:239]
    ds_read_b64_tr_b16 v[184:185], v250 offset:16384
    v_mfma_f32_16x16x32_bf16 v[244:247], v[188:191], v[140:143], v[244:247]
    ds_read_b64_tr_b16 v[186:187], v250 offset:18432
    buffer_load_dwordx4 v212, s[20:23], s69 offen offset:2048 nt lds
    s_waitcnt lgkmcnt(6)
    v_mfma_f32_16x16x32_bf16 v[216:219], v[168:171], v[96:99], 0
    ds_read_b64_tr_b16 v[188:189], v250 offset:20480
    v_mfma_f32_16x16x32_bf16 v[224:227], v[168:171], v[120:123], 0
    ds_read_b64_tr_b16 v[190:191], v250 offset:22528
    s_add_u32 s68, s65, 0
    s_sub_u32 s64, s68, 10
    s_cselect_b32 s68, s68, s64
    s_lshl_b32 s68, s68, 7
    s_add_u32 s68, s68, s60
    s_add_u32 m0, s59, 86016
    s_add_u32 s66, s68, 0
    buffer_load_dwordx4 v248, s[32:35], s66 offen lds
    v_mfma_f32_16x16x32_bf16 v[216:219], v[172:175], v[100:103], v[216:219]
    v_xor_b32 v250, 32, v250
    ds_read_b64_tr_b16 v[168:169], v250
    v_mfma_f32_16x16x32_bf16 v[224:227], v[172:175], v[124:127], v[224:227]
    ds_read_b64_tr_b16 v[170:171], v250 offset:2048
    s_add_u32 s67, s68, 9216
    buffer_load_dwordx4 v248, s[32:35], s67 offen offset:1024 lds
    s_waitcnt lgkmcnt(6)
    v_mfma_f32_16x16x32_bf16 v[216:219], v[176:179], v[104:107], v[216:219]
    ds_read_b64_tr_b16 v[172:173], v250 offset:4096
    v_mfma_f32_16x16x32_bf16 v[224:227], v[176:179], v[128:131], v[224:227]
    ds_read_b64_tr_b16 v[174:175], v250 offset:6144
    s_add_u32 s68, s68, 18432
    buffer_load_dwordx4 v248, s[32:35], s68 offen offset:2048 lds
    v_mfma_f32_16x16x32_bf16 v[216:219], v[180:183], v[108:111], v[216:219]
    v_mfma_f32_16x16x32_bf16 v[224:227], v[180:183], v[132:135], v[224:227]
    v_cvt_pk_bf16_f32 v152, v232, v233
    v_cvt_pk_bf16_f32 v153, v234, v235
    v_cvt_pk_bf16_f32 v154, v236, v237
    v_cvt_pk_bf16_f32 v155, v238, v239
    s_waitcnt lgkmcnt(6)
    v_mfma_f32_16x16x32_bf16 v[216:219], v[184:187], v[112:115], v[216:219]
    v_mfma_f32_16x16x32_bf16 v[224:227], v[184:187], v[136:139], v[224:227]
    v_cvt_pk_bf16_f32 v156, v240, v241
    v_cvt_pk_bf16_f32 v157, v242, v243
    v_cvt_pk_bf16_f32 v158, v244, v245
    v_cvt_pk_bf16_f32 v159, v246, v247
    s_waitcnt vmcnt(6) lgkmcnt(0)
    s_barrier
    ds_read_b64_tr_b16 v[176:177], v250 offset:8192
    ds_read_b64_tr_b16 v[178:179], v250 offset:10240
    ds_read_b64_tr_b16 v[180:181], v250 offset:12288
    ds_read_b64_tr_b16 v[182:183], v250 offset:14336
    v_mfma_f32_16x16x32_bf16 v[216:219], v[188:191], v[116:119], v[216:219]
    ds_read_b64_tr_b16 v[184:185], v250 offset:16384
    v_mfma_f32_16x16x32_bf16 v[224:227], v[188:191], v[140:143], v[224:227]
    ds_read_b64_tr_b16 v[186:187], v250 offset:18432
    s_add_u32 s69, s63, 14
    s_and_b32 s69, s69, 15
    s_or_b32 s69, s69, s74
    s_add_u32 m0, s45, 0
    s_mul_i32 s69, s69, 12288
    buffer_load_dwordx4 v213, s[24:27], s69 offen nt lds
    v_mfma_f32_16x16x32_bf16 v[220:223], v[168:171], v[96:99], 0
    ds_read_b64_tr_b16 v[188:189], v250 offset:20480
    v_mfma_f32_16x16x32_bf16 v[228:231], v[168:171], v[120:123], 0
    ds_read_b64_tr_b16 v[190:191], v250 offset:22528
    buffer_load_dwordx4 v214, s[24:27], s69 offen offset:1024 nt lds
    v_mfma_f32_16x16x32_bf16 v[220:223], v[172:175], v[100:103], v[220:223]
    v_xor_b32 v250, 96, v250
    ds_read_b64_tr_b16 v[168:169], v250
    v_mfma_f32_16x16x32_bf16 v[228:231], v[172:175], v[124:127], v[228:231]
    ds_read_b64_tr_b16 v[170:171], v250 offset:2048
    buffer_load_dwordx4 v215, s[24:27], s69 offen offset:2048 nt lds
    s_waitcnt lgkmcnt(6)
    v_mfma_f32_16x16x32_bf16 v[220:223], v[176:179], v[104:107], v[220:223]
    ds_read_b64_tr_b16 v[172:173], v250 offset:4096
    v_mfma_f32_16x16x32_bf16 v[228:231], v[176:179], v[128:131], v[228:231]
    ds_read_b64_tr_b16 v[174:175], v250 offset:6144
    s_add_u32 s68, s65, 0
    s_sub_u32 s64, s68, 10
    s_cselect_b32 s68, s68, s64
    s_lshl_b32 s68, s68, 7
    s_add_u32 s68, s68, s60
    s_add_u32 m0, s59, 89088
    s_add_u32 s66, s68, 30720
    buffer_load_dwordx4 v248, s[32:35], s66 offen lds
    v_mfma_f32_16x16x32_bf16 v[220:223], v[180:183], v[108:111], v[220:223]
    ds_read_b64_tr_b16 v[176:177], v250 offset:8192
    v_mfma_f32_16x16x32_bf16 v[228:231], v[180:183], v[132:135], v[228:231]
    ds_read_b64_tr_b16 v[178:179], v250 offset:10240
    s_add_u32 s67, s68, 39936
    buffer_load_dwordx4 v248, s[32:35], s67 offen offset:1024 lds
    s_waitcnt lgkmcnt(6)
    v_mfma_f32_16x16x32_bf16 v[220:223], v[184:187], v[112:115], v[220:223]
    ds_read_b64_tr_b16 v[180:181], v250 offset:12288
    v_mfma_f32_16x16x32_bf16 v[228:231], v[184:187], v[136:139], v[228:231]
    ds_read_b64_tr_b16 v[182:183], v250 offset:14336
    s_add_u32 s68, s68, 49152
    buffer_load_dwordx4 v248, s[32:35], s68 offen offset:2048 lds
    v_mfma_f32_16x16x32_bf16 v[220:223], v[188:191], v[116:119], v[220:223]
    v_mfma_f32_16x16x32_bf16 v[228:231], v[188:191], v[140:143], v[228:231]
    s_waitcnt lgkmcnt(6)
    v_mfma_f32_16x16x32_bf16 v[232:235], v[168:171], v[96:99], 0
    v_mfma_f32_16x16x32_bf16 v[240:243], v[168:171], v[120:123], 0
    s_waitcnt vmcnt(6) lgkmcnt(0)
    s_barrier
    ds_read_b64_tr_b16 v[184:185], v250 offset:16384
    ds_read_b64_tr_b16 v[186:187], v250 offset:18432
    ds_read_b64_tr_b16 v[188:189], v250 offset:20480
    ds_read_b64_tr_b16 v[190:191], v250 offset:22528
    v_mfma_f32_16x16x32_bf16 v[232:235], v[172:175], v[100:103], v[232:235]
    v_xor_b32 v250, 32, v250
    ds_read_b64_tr_b16 v[168:169], v250
    v_mfma_f32_16x16x32_bf16 v[240:243], v[172:175], v[124:127], v[240:243]
    ds_read_b64_tr_b16 v[170:171], v250 offset:2048
    s_add_u32 s69, s63, 15
    s_and_b32 s69, s69, 15
    s_or_b32 s69, s69, s74
    s_add_u32 m0, s45, 12288
    s_mul_i32 s69, s69, 12288
    buffer_load_dwordx4 v213, s[24:27], s69 offen nt lds
    v_mfma_f32_16x16x32_bf16 v[232:235], v[176:179], v[104:107], v[232:235]
    ds_read_b64_tr_b16 v[172:173], v250 offset:4096
    v_mfma_f32_16x16x32_bf16 v[240:243], v[176:179], v[128:131], v[240:243]
    ds_read_b64_tr_b16 v[174:175], v250 offset:6144
    buffer_load_dwordx4 v214, s[24:27], s69 offen offset:1024 nt lds
    v_mfma_f32_16x16x32_bf16 v[232:235], v[180:183], v[108:111], v[232:235]
    ds_read_b64_tr_b16 v[176:177], v250 offset:8192
    v_mfma_f32_16x16x32_bf16 v[240:243], v[180:183], v[132:135], v[240:243]
    ds_read_b64_tr_b16 v[178:179], v250 offset:10240
    buffer_load_dwordx4 v215, s[24:27], s69 offen offset:2048 nt lds
    v_cvt_pk_bf16_f32 v160, v216, v217
    v_cvt_pk_bf16_f32 v161, v218, v219
    v_cvt_pk_bf16_f32 v162, v220, v221
    v_cvt_pk_bf16_f32 v163, v222, v223
    s_waitcnt lgkmcnt(6)
    v_mfma_f32_16x16x32_bf16 v[232:235], v[184:187], v[112:115], v[232:235]
    ds_read_b64_tr_b16 v[180:181], v250 offset:12288
    v_mfma_f32_16x16x32_bf16 v[240:243], v[184:187], v[136:139], v[240:243]
    ds_read_b64_tr_b16 v[182:183], v250 offset:14336
    v_cvt_pk_bf16_f32 v164, v224, v225
    v_cvt_pk_bf16_f32 v165, v226, v227
    v_cvt_pk_bf16_f32 v166, v228, v229
    v_cvt_pk_bf16_f32 v167, v230, v231
    v_mfma_f32_16x16x32_bf16 v[232:235], v[188:191], v[116:119], v[232:235]
    ds_read_b64_tr_b16 v[184:185], v250 offset:16384
    v_mfma_f32_16x16x32_bf16 v[240:243], v[188:191], v[140:143], v[240:243]
    ds_read_b64_tr_b16 v[186:187], v250 offset:18432
    s_waitcnt lgkmcnt(6)
    v_mfma_f32_16x16x32_bf16 v[236:239], v[168:171], v[96:99], 0
    ds_read_b64_tr_b16 v[188:189], v250 offset:20480
    v_mfma_f32_16x16x32_bf16 v[244:247], v[168:171], v[120:123], 0
    ds_read_b64_tr_b16 v[190:191], v250 offset:22528
    v_mfma_f32_16x16x32_bf16 v[236:239], v[172:175], v[100:103], v[236:239]
    v_mfma_f32_16x16x32_bf16 v[244:247], v[172:175], v[124:127], v[244:247]
    s_waitcnt lgkmcnt(6)
    v_mfma_f32_16x16x32_bf16 v[236:239], v[176:179], v[104:107], v[236:239]
    v_mfma_f32_16x16x32_bf16 v[244:247], v[176:179], v[128:131], v[244:247]
    s_waitcnt vmcnt(6) lgkmcnt(0)
    s_barrier
    v_add_u32 v250, 135168, v249
    ds_read_b64_tr_b16 v[168:169], v250
    ds_read_b64_tr_b16 v[170:171], v250 offset:2048
    ds_read_b64_tr_b16 v[172:173], v250 offset:4096
    ds_read_b64_tr_b16 v[174:175], v250 offset:6144
    v_mfma_f32_16x16x32_bf16 v[236:239], v[180:183], v[108:111], v[236:239]
    ds_read_b64_tr_b16 v[176:177], v250 offset:8192
    v_mfma_f32_16x16x32_bf16 v[244:247], v[180:183], v[132:135], v[244:247]
    ds_read_b64_tr_b16 v[178:179], v250 offset:10240
    s_add_u32 s68, s65, 0
    s_sub_u32 s64, s68, 10
    s_cselect_b32 s68, s68, s64
    s_lshl_b32 s68, s68, 7
    s_add_u32 s68, s68, s70
    s_add_u32 m0, s59, 110592
    s_add_u32 s66, s68, 0
    buffer_load_dwordx4 v248, s[32:35], s66 offen lds
    v_mfma_f32_16x16x32_bf16 v[236:239], v[184:187], v[112:115], v[236:239]
    ds_read_b64_tr_b16 v[180:181], v250 offset:12288
    v_mfma_f32_16x16x32_bf16 v[244:247], v[184:187], v[136:139], v[244:247]
    ds_read_b64_tr_b16 v[182:183], v250 offset:14336
    s_add_u32 s67, s68, 9216
    buffer_load_dwordx4 v248, s[32:35], s67 offen offset:1024 lds
    v_mfma_f32_16x16x32_bf16 v[236:239], v[188:191], v[116:119], v[236:239]
    ds_read_b64_tr_b16 v[184:185], v250 offset:16384
    v_mfma_f32_16x16x32_bf16 v[244:247], v[188:191], v[140:143], v[244:247]
    ds_read_b64_tr_b16 v[186:187], v250 offset:18432
    s_add_u32 s68, s68, 18432
    buffer_load_dwordx4 v248, s[32:35], s68 offen offset:2048 lds
    s_waitcnt lgkmcnt(6)
    v_mfma_f32_16x16x32_bf16 v[216:219], v[168:171], v[96:99], 0
    ds_read_b64_tr_b16 v[188:189], v250 offset:20480
    v_mfma_f32_16x16x32_bf16 v[224:227], v[168:171], v[120:123], 0
    ds_read_b64_tr_b16 v[190:191], v250 offset:22528
    s_add_u32 s68, s65, 0
    s_sub_u32 s64, s68, 10
    s_cselect_b32 s68, s68, s64
    s_lshl_b32 s68, s68, 7
    s_add_u32 s68, s68, s70
    s_add_u32 m0, s59, 113664
    s_add_u32 s66, s68, 30720
    buffer_load_dwordx4 v248, s[32:35], s66 offen lds
    v_mfma_f32_16x16x32_bf16 v[216:219], v[172:175], v[100:103], v[216:219]
    v_xor_b32 v250, 32, v250
    ds_read_b64_tr_b16 v[168:169], v250
    v_mfma_f32_16x16x32_bf16 v[224:227], v[172:175], v[124:127], v[224:227]
    ds_read_b64_tr_b16 v[170:171], v250 offset:2048
    s_add_u32 s67, s68, 39936
    buffer_load_dwordx4 v248, s[32:35], s67 offen offset:1024 lds
    s_waitcnt lgkmcnt(6)
    v_mfma_f32_16x16x32_bf16 v[216:219], v[176:179], v[104:107], v[216:219]
    ds_read_b64_tr_b16 v[172:173], v250 offset:4096
    v_mfma_f32_16x16x32_bf16 v[224:227], v[176:179], v[128:131], v[224:227]
    ds_read_b64_tr_b16 v[174:175], v250 offset:6144
    s_add_u32 s68, s68, 49152
    buffer_load_dwordx4 v248, s[32:35], s68 offen offset:2048 lds
    v_mfma_f32_16x16x32_bf16 v[216:219], v[180:183], v[108:111], v[216:219]
    v_mfma_f32_16x16x32_bf16 v[224:227], v[180:183], v[132:135], v[224:227]
    v_cvt_pk_bf16_f32 v192, v232, v233
    v_cvt_pk_bf16_f32 v193, v234, v235
    v_cvt_pk_bf16_f32 v194, v236, v237
    v_cvt_pk_bf16_f32 v195, v238, v239
    s_waitcnt lgkmcnt(6)
    v_mfma_f32_16x16x32_bf16 v[216:219], v[184:187], v[112:115], v[216:219]
    v_mfma_f32_16x16x32_bf16 v[224:227], v[184:187], v[136:139], v[224:227]
    v_cvt_pk_bf16_f32 v196, v240, v241
    v_cvt_pk_bf16_f32 v197, v242, v243
    v_cvt_pk_bf16_f32 v198, v244, v245
    v_cvt_pk_bf16_f32 v199, v246, v247
    s_waitcnt vmcnt(18) lgkmcnt(0)
    s_barrier
    ds_read_b64_tr_b16 v[176:177], v250 offset:8192
    ds_read_b64_tr_b16 v[178:179], v250 offset:10240
    ds_read_b64_tr_b16 v[180:181], v250 offset:12288
    ds_read_b64_tr_b16 v[182:183], v250 offset:14336
    v_mfma_f32_16x16x32_bf16 v[216:219], v[188:191], v[116:119], v[216:219]
    ds_read_b64_tr_b16 v[184:185], v250 offset:16384
    v_mfma_f32_16x16x32_bf16 v[224:227], v[188:191], v[140:143], v[224:227]
    ds_read_b64_tr_b16 v[186:187], v250 offset:18432
    s_add_u32 s68, s65, 1
    s_sub_u32 s64, s68, 10
    s_cselect_b32 s68, s68, s64
    s_lshl_b32 s68, s68, 7
    s_add_u32 s68, s68, s70
    s_add_u32 m0, s59, 49152
    s_add_u32 s66, s68, 0
    buffer_load_dwordx4 v248, s[32:35], s66 offen lds
    v_mfma_f32_16x16x32_bf16 v[220:223], v[168:171], v[96:99], 0
    ds_read_b64_tr_b16 v[188:189], v250 offset:20480
    v_mfma_f32_16x16x32_bf16 v[228:231], v[168:171], v[120:123], 0
    ds_read_b64_tr_b16 v[190:191], v250 offset:22528
    s_add_u32 s67, s68, 9216
    buffer_load_dwordx4 v248, s[32:35], s67 offen offset:1024 lds
    v_mfma_f32_16x16x32_bf16 v[220:223], v[172:175], v[100:103], v[220:223]
    v_xor_b32 v250, 96, v250
    ds_read_b64_tr_b16 v[168:169], v250
    v_mfma_f32_16x16x32_bf16 v[228:231], v[172:175], v[124:127], v[228:231]
    ds_read_b64_tr_b16 v[170:171], v250 offset:2048
    s_add_u32 s68, s68, 18432
    buffer_load_dwordx4 v248, s[32:35], s68 offen offset:2048 lds
    s_waitcnt lgkmcnt(6)
    v_mfma_f32_16x16x32_bf16 v[220:223], v[176:179], v[104:107], v[220:223]
    ds_read_b64_tr_b16 v[172:173], v250 offset:4096
    v_mfma_f32_16x16x32_bf16 v[228:231], v[176:179], v[128:131], v[228:231]
    ds_read_b64_tr_b16 v[174:175], v250 offset:6144
    s_add_u32 s68, s65, 1
    s_sub_u32 s64, s68, 10
    s_cselect_b32 s68, s68, s64
    s_lshl_b32 s68, s68, 7
    s_add_u32 s68, s68, s70
    s_add_u32 m0, s59, 52224
    s_add_u32 s66, s68, 30720
    buffer_load_dwordx4 v248, s[32:35], s66 offen lds
    v_mfma_f32_16x16x32_bf16 v[220:223], v[180:183], v[108:111], v[220:223]
    ds_read_b64_tr_b16 v[176:177], v250 offset:8192
    v_mfma_f32_16x16x32_bf16 v[228:231], v[180:183], v[132:135], v[228:231]
    ds_read_b64_tr_b16 v[178:179], v250 offset:10240
    s_add_u32 s67, s68, 39936
    buffer_load_dwordx4 v248, s[32:35], s67 offen offset:1024 lds
    s_waitcnt lgkmcnt(6)
    v_mfma_f32_16x16x32_bf16 v[220:223], v[184:187], v[112:115], v[220:223]
    ds_read_b64_tr_b16 v[180:181], v250 offset:12288
    v_mfma_f32_16x16x32_bf16 v[228:231], v[184:187], v[136:139], v[228:231]
    ds_read_b64_tr_b16 v[182:183], v250 offset:14336
    s_add_u32 s68, s68, 49152
    buffer_load_dwordx4 v248, s[32:35], s68 offen offset:2048 lds
    v_mfma_f32_16x16x32_bf16 v[220:223], v[188:191], v[116:119], v[220:223]
    v_mfma_f32_16x16x32_bf16 v[228:231], v[188:191], v[140:143], v[228:231]
    s_waitcnt lgkmcnt(6)
    v_mfma_f32_16x16x32_bf16 v[232:235], v[168:171], v[96:99], 0
    v_mfma_f32_16x16x32_bf16 v[240:243], v[168:171], v[120:123], 0
    s_waitcnt vmcnt(18) lgkmcnt(0)
    s_barrier
    ds_read_b64_tr_b16 v[184:185], v250 offset:16384
    ds_read_b64_tr_b16 v[186:187], v250 offset:18432
    ds_read_b64_tr_b16 v[188:189], v250 offset:20480
    ds_read_b64_tr_b16 v[190:191], v250 offset:22528
    v_mfma_f32_16x16x32_bf16 v[232:235], v[172:175], v[100:103], v[232:235]
    v_xor_b32 v250, 32, v250
    ds_read_b64_tr_b16 v[168:169], v250
    v_mfma_f32_16x16x32_bf16 v[240:243], v[172:175], v[124:127], v[240:243]
    ds_read_b64_tr_b16 v[170:171], v250 offset:2048
    v_mfma_f32_16x16x32_bf16 v[232:235], v[176:179], v[104:107], v[232:235]
    ds_read_b64_tr_b16 v[172:173], v250 offset:4096
    v_mfma_f32_16x16x32_bf16 v[240:243], v[176:179], v[128:131], v[240:243]
    ds_read_b64_tr_b16 v[174:175], v250 offset:6144
    v_mfma_f32_16x16x32_bf16 v[232:235], v[180:183], v[108:111], v[232:235]
    ds_read_b64_tr_b16 v[176:177], v250 offset:8192
    v_mfma_f32_16x16x32_bf16 v[240:243], v[180:183], v[132:135], v[240:243]
    ds_read_b64_tr_b16 v[178:179], v250 offset:10240
    v_cvt_pk_bf16_f32 v200, v216, v217
    v_cvt_pk_bf16_f32 v201, v218, v219
    v_cvt_pk_bf16_f32 v202, v220, v221
    v_cvt_pk_bf16_f32 v203, v222, v223
    s_waitcnt lgkmcnt(6)
    v_mfma_f32_16x16x32_bf16 v[232:235], v[184:187], v[112:115], v[232:235]
    ds_read_b64_tr_b16 v[180:181], v250 offset:12288
    v_mfma_f32_16x16x32_bf16 v[240:243], v[184:187], v[136:139], v[240:243]
    ds_read_b64_tr_b16 v[182:183], v250 offset:14336
    v_cvt_pk_bf16_f32 v204, v224, v225
    v_cvt_pk_bf16_f32 v205, v226, v227
    v_cvt_pk_bf16_f32 v206, v228, v229
    v_cvt_pk_bf16_f32 v207, v230, v231
    v_mfma_f32_16x16x32_bf16 v[232:235], v[188:191], v[116:119], v[232:235]
    ds_read_b64_tr_b16 v[184:185], v250 offset:16384
    v_mfma_f32_16x16x32_bf16 v[240:243], v[188:191], v[140:143], v[240:243]
    ds_read_b64_tr_b16 v[186:187], v250 offset:18432
    s_waitcnt lgkmcnt(6)
    v_mfma_f32_16x16x32_bf16 v[236:239], v[168:171], v[96:99], 0
    ds_read_b64_tr_b16 v[188:189], v250 offset:20480
    v_mfma_f32_16x16x32_bf16 v[244:247], v[168:171], v[120:123], 0
    ds_read_b64_tr_b16 v[190:191], v250 offset:22528
    v_mfma_f32_16x16x32_bf16 v[236:239], v[172:175], v[100:103], v[236:239]
    v_mfma_f32_16x16x32_bf16 v[244:247], v[172:175], v[124:127], v[244:247]
    s_waitcnt lgkmcnt(6)
    v_mfma_f32_16x16x32_bf16 v[236:239], v[176:179], v[104:107], v[236:239]
    v_mfma_f32_16x16x32_bf16 v[244:247], v[176:179], v[128:131], v[244:247]
    s_waitcnt vmcnt(12) lgkmcnt(0)
    s_barrier
    v_add_u32 v250, 86016, v249
    ds_read_b64_tr_b16 v[168:169], v250
    ds_read_b64_tr_b16 v[170:171], v250 offset:2048
    ds_read_b64_tr_b16 v[172:173], v250 offset:4096
    ds_read_b64_tr_b16 v[174:175], v250 offset:6144
    v_mfma_f32_16x16x32_bf16 v[236:239], v[180:183], v[108:111], v[236:239]
    ds_read_b64_tr_b16 v[176:177], v250 offset:8192
    v_mfma_f32_16x16x32_bf16 v[244:247], v[180:183], v[132:135], v[244:247]
    ds_read_b64_tr_b16 v[178:179], v250 offset:10240
    s_add_u32 s68, s65, 2
    s_sub_u32 s64, s68, 10
    s_cselect_b32 s68, s68, s64
    s_lshl_b32 s68, s68, 7
    s_add_u32 s68, s68, s70
    s_add_u32 m0, s59, 135168
    s_add_u32 s66, s68, 0
    buffer_load_dwordx4 v248, s[32:35], s66 offen lds
    v_mfma_f32_16x16x32_bf16 v[236:239], v[184:187], v[112:115], v[236:239]
    ds_read_b64_tr_b16 v[180:181], v250 offset:12288
    v_mfma_f32_16x16x32_bf16 v[244:247], v[184:187], v[136:139], v[244:247]
    ds_read_b64_tr_b16 v[182:183], v250 offset:14336
    s_add_u32 s67, s68, 9216
    buffer_load_dwordx4 v248, s[32:35], s67 offen offset:1024 lds
    v_mfma_f32_16x16x32_bf16 v[236:239], v[188:191], v[116:119], v[236:239]
    ds_read_b64_tr_b16 v[184:185], v250 offset:16384
    v_mfma_f32_16x16x32_bf16 v[244:247], v[188:191], v[140:143], v[244:247]
    ds_read_b64_tr_b16 v[186:187], v250 offset:18432
    s_add_u32 s68, s68, 18432
    buffer_load_dwordx4 v248, s[32:35], s68 offen offset:2048 lds
    s_waitcnt lgkmcnt(6)
    v_mfma_f32_16x16x32_bf16 v[216:219], v[168:171], v[96:99], 0
    ds_read_b64_tr_b16 v[188:189], v250 offset:20480
    v_mfma_f32_16x16x32_bf16 v[224:227], v[168:171], v[120:123], 0
    ds_read_b64_tr_b16 v[190:191], v250 offset:22528
    s_add_u32 s68, s65, 2
    s_sub_u32 s64, s68, 10
    s_cselect_b32 s68, s68, s64
    s_lshl_b32 s68, s68, 7
    s_add_u32 s68, s68, s70
    s_add_u32 m0, s59, 138240
    s_add_u32 s66, s68, 30720
    buffer_load_dwordx4 v248, s[32:35], s66 offen lds
    v_mfma_f32_16x16x32_bf16 v[216:219], v[172:175], v[100:103], v[216:219]
    v_xor_b32 v250, 32, v250
    ds_read_b64_tr_b16 v[168:169], v250
    v_mfma_f32_16x16x32_bf16 v[224:227], v[172:175], v[124:127], v[224:227]
    ds_read_b64_tr_b16 v[170:171], v250 offset:2048
    s_add_u32 s67, s68, 39936
    buffer_load_dwordx4 v248, s[32:35], s67 offen offset:1024 lds
    s_waitcnt lgkmcnt(6)
    v_mfma_f32_16x16x32_bf16 v[216:219], v[176:179], v[104:107], v[216:219]
    ds_read_b64_tr_b16 v[172:173], v250 offset:4096
    v_mfma_f32_16x16x32_bf16 v[224:227], v[176:179], v[128:131], v[224:227]
    ds_read_b64_tr_b16 v[174:175], v250 offset:6144
    s_add_u32 s68, s68, 49152
    buffer_load_dwordx4 v248, s[32:35], s68 offen offset:2048 lds
    v_mfma_f32_16x16x32_bf16 v[216:219], v[180:183], v[108:111], v[216:219]
    ds_read_b64_tr_b16 v[176:177], v250 offset:8192
    v_mfma_f32_16x16x32_bf16 v[224:227], v[180:183], v[132:135], v[224:227]
    ds_read_b64_tr_b16 v[178:179], v250 offset:10240
    v_cvt_pk_bf16_f32 v208, v232, v233
    v_cvt_pk_bf16_f32 v209, v234, v235
    v_cvt_pk_bf16_f32 v210, v236, v237
    v_cvt_pk_bf16_f32 v211, v238, v239
    s_waitcnt lgkmcnt(6)
    v_mfma_f32_16x16x32_bf16 v[216:219], v[184:187], v[112:115], v[216:219]
    ds_read_b64_tr_b16 v[180:181], v250 offset:12288
    v_mfma_f32_16x16x32_bf16 v[224:227], v[184:187], v[136:139], v[224:227]
    ds_read_b64_tr_b16 v[182:183], v250 offset:14336
    v_cvt_pk_bf16_f32 v212, v240, v241
    v_cvt_pk_bf16_f32 v213, v242, v243
    v_cvt_pk_bf16_f32 v214, v244, v245
    v_cvt_pk_bf16_f32 v215, v246, v247
    v_mfma_f32_16x16x32_bf16 v[216:219], v[188:191], v[116:119], v[216:219]
    ds_read_b64_tr_b16 v[184:185], v250 offset:16384
    v_mfma_f32_16x16x32_bf16 v[224:227], v[188:191], v[140:143], v[224:227]
    ds_read_b64_tr_b16 v[186:187], v250 offset:18432
    s_waitcnt lgkmcnt(6)
    v_mfma_f32_16x16x32_bf16 v[220:223], v[168:171], v[96:99], 0
    ds_read_b64_tr_b16 v[188:189], v250 offset:20480
    v_mfma_f32_16x16x32_bf16 v[228:231], v[168:171], v[120:123], 0
    ds_read_b64_tr_b16 v[190:191], v250 offset:22528
    v_mfma_f32_16x16x32_bf16 v[220:223], v[172:175], v[100:103], v[220:223]
    v_xor_b32 v250, 96, v250
    ds_read_b64_tr_b16 v[168:169], v250
    v_mfma_f32_16x16x32_bf16 v[228:231], v[172:175], v[124:127], v[228:231]
    ds_read_b64_tr_b16 v[170:171], v250 offset:2048
    s_waitcnt lgkmcnt(6)
    v_mfma_f32_16x16x32_bf16 v[220:223], v[176:179], v[104:107], v[220:223]
    ds_read_b64_tr_b16 v[172:173], v250 offset:4096
    v_mfma_f32_16x16x32_bf16 v[228:231], v[176:179], v[128:131], v[228:231]
    ds_read_b64_tr_b16 v[174:175], v250 offset:6144
    v_mfma_f32_16x16x32_bf16 v[220:223], v[180:183], v[108:111], v[220:223]
    ds_read_b64_tr_b16 v[176:177], v250 offset:8192
    v_mfma_f32_16x16x32_bf16 v[228:231], v[180:183], v[132:135], v[228:231]
    ds_read_b64_tr_b16 v[178:179], v250 offset:10240
    s_waitcnt lgkmcnt(6)
    v_mfma_f32_16x16x32_bf16 v[220:223], v[184:187], v[112:115], v[220:223]
    ds_read_b64_tr_b16 v[180:181], v250 offset:12288
    v_mfma_f32_16x16x32_bf16 v[228:231], v[184:187], v[136:139], v[228:231]
    ds_read_b64_tr_b16 v[182:183], v250 offset:14336
    v_mfma_f32_16x16x32_bf16 v[220:223], v[188:191], v[116:119], v[220:223]
    ds_read_b64_tr_b16 v[184:185], v250 offset:16384
    v_mfma_f32_16x16x32_bf16 v[228:231], v[188:191], v[140:143], v[228:231]
    ds_read_b64_tr_b16 v[186:187], v250 offset:18432
    s_waitcnt lgkmcnt(6)
    v_mfma_f32_16x16x32_bf16 v[232:235], v[168:171], v[96:99], 0
    ds_read_b64_tr_b16 v[188:189], v250 offset:20480
    v_mfma_f32_16x16x32_bf16 v[240:243], v[168:171], v[120:123], 0
    ds_read_b64_tr_b16 v[190:191], v250 offset:22528
    v_mfma_f32_16x16x32_bf16 v[232:235], v[172:175], v[100:103], v[232:235]
    v_xor_b32 v250, 32, v250
    ds_read_b64_tr_b16 v[168:169], v250
    v_mfma_f32_16x16x32_bf16 v[240:243], v[172:175], v[124:127], v[240:243]
    ds_read_b64_tr_b16 v[170:171], v250 offset:2048
    s_waitcnt lgkmcnt(6)
    v_mfma_f32_16x16x32_bf16 v[232:235], v[176:179], v[104:107], v[232:235]
    ds_read_b64_tr_b16 v[172:173], v250 offset:4096
    v_mfma_f32_16x16x32_bf16 v[240:243], v[176:179], v[128:131], v[240:243]
    ds_read_b64_tr_b16 v[174:175], v250 offset:6144
    v_mfma_f32_16x16x32_bf16 v[232:235], v[180:183], v[108:111], v[232:235]
    ds_read_b64_tr_b16 v[176:177], v250 offset:8192
    v_mfma_f32_16x16x32_bf16 v[240:243], v[180:183], v[132:135], v[240:243]
    ds_read_b64_tr_b16 v[178:179], v250 offset:10240
    s_waitcnt lgkmcnt(6)
    v_mfma_f32_16x16x32_bf16 v[232:235], v[184:187], v[112:115], v[232:235]
    ds_read_b64_tr_b16 v[180:181], v250 offset:12288
    v_mfma_f32_16x16x32_bf16 v[240:243], v[184:187], v[136:139], v[240:243]
    ds_read_b64_tr_b16 v[182:183], v250 offset:14336
    v_mfma_f32_16x16x32_bf16 v[232:235], v[188:191], v[116:119], v[232:235]
    ds_read_b64_tr_b16 v[184:185], v250 offset:16384
    v_mfma_f32_16x16x32_bf16 v[240:243], v[188:191], v[140:143], v[240:243]
    ds_read_b64_tr_b16 v[186:187], v250 offset:18432
    s_waitcnt lgkmcnt(6)
    v_mfma_f32_16x16x32_bf16 v[236:239], v[168:171], v[96:99], 0
    ds_read_b64_tr_b16 v[188:189], v250 offset:20480
    v_mfma_f32_16x16x32_bf16 v[244:247], v[168:171], v[120:123], 0
    ds_read_b64_tr_b16 v[190:191], v250 offset:22528
    v_mfma_f32_16x16x32_bf16 v[236:239], v[172:175], v[100:103], v[236:239]
    v_mfma_f32_16x16x32_bf16 v[244:247], v[172:175], v[124:127], v[244:247]
    s_waitcnt lgkmcnt(4)
    v_mfma_f32_16x16x32_bf16 v[236:239], v[176:179], v[104:107], v[236:239]
    v_mfma_f32_16x16x32_bf16 v[244:247], v[176:179], v[128:131], v[244:247]
    v_mfma_f32_16x16x32_bf16 v[236:239], v[180:183], v[108:111], v[236:239]
    v_mfma_f32_16x16x32_bf16 v[244:247], v[180:183], v[132:135], v[244:247]
    s_waitcnt lgkmcnt(0)
    v_mfma_f32_16x16x32_bf16 v[236:239], v[184:187], v[112:115], v[236:239]
    v_mfma_f32_16x16x32_bf16 v[244:247], v[184:187], v[136:139], v[244:247]
    v_mfma_f32_16x16x32_bf16 v[236:239], v[188:191], v[116:119], v[236:239]
    v_mfma_f32_16x16x32_bf16 v[244:247], v[188:191], v[140:143], v[244:247]
    v_add_u32 v248, s62, v251
    s_waitcnt vmcnt(12) lgkmcnt(0)
    s_barrier
    v_add_u32 v250, 110592, v249
    ds_read_b128 v[96:99], v248
    ds_read_b128 v[120:123], v248 offset:6144
    ds_read_b64_tr_b16 v[168:169], v250
    ds_read_b64_tr_b16 v[170:171], v250 offset:2048
    ds_read_b128 v[100:103], v248 offset:1024
    ds_read_b128 v[124:127], v248 offset:7168
    ds_read_b64_tr_b16 v[172:173], v250 offset:4096
    ds_read_b64_tr_b16 v[174:175], v250 offset:6144
    ds_read_b128 v[104:107], v248 offset:2048
    ds_read_b128 v[128:131], v248 offset:8192
    ds_read_b64_tr_b16 v[176:177], v250 offset:8192
    ds_read_b64_tr_b16 v[178:179], v250 offset:10240
    ds_read_b128 v[108:111], v248 offset:3072
    ds_read_b128 v[132:135], v248 offset:9216
    ds_read_b64_tr_b16 v[180:181], v250 offset:12288
    ds_read_b64_tr_b16 v[182:183], v250 offset:14336
    ds_read_b128 v[112:115], v248 offset:4096
    ds_read_b128 v[136:139], v248 offset:10240
    ds_read_b64_tr_b16 v[184:185], v250 offset:16384
    ds_read_b64_tr_b16 v[186:187], v250 offset:18432
    s_waitcnt lgkmcnt(8)
    v_mfma_f32_16x16x32_bf16 v[216:219], v[168:171], v[96:99], v[216:219]
    ds_read_b128 v[116:119], v248 offset:5120
    ds_read_b128 v[140:143], v248 offset:11264
    v_mfma_f32_16x16x32_bf16 v[224:227], v[168:171], v[120:123], v[224:227]
    ds_read_b64_tr_b16 v[188:189], v250 offset:20480
    ds_read_b64_tr_b16 v[190:191], v250 offset:22528
    v_mfma_f32_16x16x32_bf16 v[216:219], v[172:175], v[100:103], v[216:219]
    v_xor_b32 v250, 32, v250
    ds_read_b64_tr_b16 v[168:169], v250
    v_mfma_f32_16x16x32_bf16 v[224:227], v[172:175], v[124:127], v[224:227]
    ds_read_b64_tr_b16 v[170:171], v250 offset:2048
    v_mfma_f32_16x16x32_bf16 v[216:219], v[176:179], v[104:107], v[216:219]
    ds_read_b64_tr_b16 v[172:173], v250 offset:4096
    v_mfma_f32_16x16x32_bf16 v[224:227], v[176:179], v[128:131], v[224:227]
    ds_read_b64_tr_b16 v[174:175], v250 offset:6144
    s_waitcnt lgkmcnt(4)
    v_mfma_f32_16x16x32_bf16 v[216:219], v[180:183], v[108:111], v[216:219]
    ds_read_b64_tr_b16 v[176:177], v250 offset:8192
    v_mfma_f32_16x16x32_bf16 v[224:227], v[180:183], v[132:135], v[224:227]
    ds_read_b64_tr_b16 v[178:179], v250 offset:10240
    v_mfma_f32_16x16x32_bf16 v[216:219], v[184:187], v[112:115], v[216:219]
    ds_read_b64_tr_b16 v[180:181], v250 offset:12288
    v_mfma_f32_16x16x32_bf16 v[224:227], v[184:187], v[136:139], v[224:227]
    ds_read_b64_tr_b16 v[182:183], v250 offset:14336
    v_mfma_f32_16x16x32_bf16 v[216:219], v[188:191], v[116:119], v[216:219]
    ds_read_b64_tr_b16 v[184:185], v250 offset:16384
    v_mfma_f32_16x16x32_bf16 v[224:227], v[188:191], v[140:143], v[224:227]
    ds_read_b64_tr_b16 v[186:187], v250 offset:18432
    s_waitcnt lgkmcnt(4)
    v_mfma_f32_16x16x32_bf16 v[220:223], v[168:171], v[96:99], v[220:223]
    ds_read_b64_tr_b16 v[188:189], v250 offset:20480
    v_mfma_f32_16x16x32_bf16 v[228:231], v[168:171], v[120:123], v[228:231]
    ds_read_b64_tr_b16 v[190:191], v250 offset:22528
    v_mfma_f32_16x16x32_bf16 v[220:223], v[172:175], v[100:103], v[220:223]
    v_xor_b32 v250, 96, v250
    ds_read_b64_tr_b16 v[168:169], v250
    v_mfma_f32_16x16x32_bf16 v[228:231], v[172:175], v[124:127], v[228:231]
    ds_read_b64_tr_b16 v[170:171], v250 offset:2048
    v_mfma_f32_16x16x32_bf16 v[220:223], v[176:179], v[104:107], v[220:223]
    ds_read_b64_tr_b16 v[172:173], v250 offset:4096
    v_mfma_f32_16x16x32_bf16 v[228:231], v[176:179], v[128:131], v[228:231]
    ds_read_b64_tr_b16 v[174:175], v250 offset:6144
    s_waitcnt lgkmcnt(4)
    v_mfma_f32_16x16x32_bf16 v[220:223], v[180:183], v[108:111], v[220:223]
    ds_read_b64_tr_b16 v[176:177], v250 offset:8192
    v_mfma_f32_16x16x32_bf16 v[228:231], v[180:183], v[132:135], v[228:231]
    ds_read_b64_tr_b16 v[178:179], v250 offset:10240
    v_mfma_f32_16x16x32_bf16 v[220:223], v[184:187], v[112:115], v[220:223]
    ds_read_b64_tr_b16 v[180:181], v250 offset:12288
    v_cvt_pk_bf16_f32 v216, v216, v217
    v_mfma_f32_16x16x32_bf16 v[228:231], v[184:187], v[136:139], v[228:231]
    ds_read_b64_tr_b16 v[182:183], v250 offset:14336
    v_cvt_pk_bf16_f32 v217, v218, v219
    v_mfma_f32_16x16x32_bf16 v[220:223], v[188:191], v[116:119], v[220:223]
    ds_read_b64_tr_b16 v[184:185], v250 offset:16384
    v_cvt_pk_bf16_f32 v224, v224, v225
    v_mfma_f32_16x16x32_bf16 v[228:231], v[188:191], v[140:143], v[228:231]
    ds_read_b64_tr_b16 v[186:187], v250 offset:18432
    v_cvt_pk_bf16_f32 v225, v226, v227
    s_waitcnt lgkmcnt(4)
    v_mfma_f32_16x16x32_bf16 v[232:235], v[168:171], v[96:99], v[232:235]
    ds_read_b64_tr_b16 v[188:189], v250 offset:20480
    v_mfma_f32_16x16x32_bf16 v[240:243], v[168:171], v[120:123], v[240:243]
    ds_read_b64_tr_b16 v[190:191], v250 offset:22528
    v_mfma_f32_16x16x32_bf16 v[232:235], v[172:175], v[100:103], v[232:235]
    v_xor_b32 v250, 32, v250
    ds_read_b64_tr_b16 v[168:169], v250
    v_mfma_f32_16x16x32_bf16 v[240:243], v[172:175], v[124:127], v[240:243]
    ds_read_b64_tr_b16 v[170:171], v250 offset:2048
    v_mfma_f32_16x16x32_bf16 v[232:235], v[176:179], v[104:107], v[232:235]
    ds_read_b64_tr_b16 v[172:173], v250 offset:4096
    v_mfma_f32_16x16x32_bf16 v[240:243], v[176:179], v[128:131], v[240:243]
    ds_read_b64_tr_b16 v[174:175], v250 offset:6144
    s_waitcnt lgkmcnt(4)
    v_mfma_f32_16x16x32_bf16 v[232:235], v[180:183], v[108:111], v[232:235]
    ds_read_b64_tr_b16 v[176:177], v250 offset:8192
    v_mfma_f32_16x16x32_bf16 v[240:243], v[180:183], v[132:135], v[240:243]
    ds_read_b64_tr_b16 v[178:179], v250 offset:10240
    v_mfma_f32_16x16x32_bf16 v[232:235], v[184:187], v[112:115], v[232:235]
    ds_read_b64_tr_b16 v[180:181], v250 offset:12288
    v_cvt_pk_bf16_f32 v218, v220, v221
    v_mfma_f32_16x16x32_bf16 v[240:243], v[184:187], v[136:139], v[240:243]
    ds_read_b64_tr_b16 v[182:183], v250 offset:14336
    v_cvt_pk_bf16_f32 v219, v222, v223
    v_mfma_f32_16x16x32_bf16 v[232:235], v[188:191], v[116:119], v[232:235]
    ds_read_b64_tr_b16 v[184:185], v250 offset:16384
    v_cvt_pk_bf16_f32 v226, v228, v229
    v_mfma_f32_16x16x32_bf16 v[240:243], v[188:191], v[140:143], v[240:243]
    ds_read_b64_tr_b16 v[186:187], v250 offset:18432
    v_cvt_pk_bf16_f32 v227, v230, v231
    s_waitcnt lgkmcnt(8)
    v_mfma_f32_16x16x32_bf16 v[236:239], v[168:171], v[96:99], v[236:239]
    ds_read_b64_tr_b16 v[188:189], v250 offset:20480
    s_add_u32 s66, s72, 0
    buffer_store_dwordx4 v[224:227], v251, s[36:39], s66 offen sc1
    s_add_u32 s66, s61, 0
    buffer_store_dwordx4 v[216:219], v251, s[36:39], s66 offen sc1
    v_lshlrev_b32 v220, 16, v2
    v_mfma_f32_16x16x32_bf16 v[244:247], v[168:171], v[120:123], v[244:247]
    ds_read_b64_tr_b16 v[190:191], v250 offset:22528
    v_and_b32 v221, 0xffff0000, v2
    v_lshlrev_b32 v216, 16, v0
    s_waitcnt vmcnt(8)
    s_barrier
    s_waitcnt lgkmcnt(4)
    v_mfma_f32_16x16x32_bf16 v[236:239], v[172:175], v[100:103], v[236:239]
    v_add_u32 v250, 49152, v249
    ds_read_b64_tr_b16 v[168:169], v250
    v_lshlrev_b32 v222, 16, v3
    v_and_b32 v217, 0xffff0000, v0
    v_mfma_f32_16x16x32_bf16 v[244:247], v[172:175], v[124:127], v[244:247]
    ds_read_b64_tr_b16 v[170:171], v250 offset:2048
    v_and_b32 v223, 0xffff0000, v3
    v_lshlrev_b32 v218, 16, v1
    v_mfma_f32_16x16x32_bf16 v[236:239], v[176:179], v[104:107], v[236:239]
    ds_read_b64_tr_b16 v[172:173], v250 offset:4096
    v_lshlrev_b32 v228, 16, v6
    v_and_b32 v219, 0xffff0000, v1
    v_mfma_f32_16x16x32_bf16 v[244:247], v[176:179], v[128:131], v[244:247]
    ds_read_b64_tr_b16 v[174:175], v250 offset:6144
    v_and_b32 v229, 0xffff0000, v6
    v_lshlrev_b32 v224, 16, v4
    v_mfma_f32_16x16x32_bf16 v[236:239], v[180:183], v[108:111], v[236:239]
    ds_read_b64_tr_b16 v[176:177], v250 offset:8192
    v_lshlrev_b32 v230, 16, v7
    v_and_b32 v225, 0xffff0000, v4
    v_mfma_f32_16x16x32_bf16 v[244:247], v[180:183], v[132:135], v[244:247]
    ds_read_b64_tr_b16 v[178:179], v250 offset:10240
    v_and_b32 v231, 0xffff0000, v7
    v_lshlrev_b32 v226, 16, v5
    s_waitcnt lgkmcnt(4)
    v_mfma_f32_16x16x32_bf16 v[236:239], v[184:187], v[112:115], v[236:239]
    ds_read_b64_tr_b16 v[180:181], v250 offset:12288
    v_cvt_pk_bf16_f32 v0, v232, v233
    v_and_b32 v227, 0xffff0000, v5
    v_mfma_f32_16x16x32_bf16 v[244:247], v[184:187], v[136:139], v[244:247]
    ds_read_b64_tr_b16 v[182:183], v250 offset:14336
    v_cvt_pk_bf16_f32 v1, v234, v235
    v_mfma_f32_16x16x32_bf16 v[236:239], v[188:191], v[116:119], v[236:239]
    ds_read_b64_tr_b16 v[184:185], v250 offset:16384
    v_cvt_pk_bf16_f32 v4, v240, v241
    v_mfma_f32_16x16x32_bf16 v[244:247], v[188:191], v[140:143], v[244:247]
    ds_read_b64_tr_b16 v[186:187], v250 offset:18432
    v_cvt_pk_bf16_f32 v5, v242, v243
    v_mfma_f32_16x16x32_bf16 v[216:219], v[168:171], v[96:99], v[216:219]
    ds_read_b64_tr_b16 v[188:189], v250 offset:20480
    v_lshlrev_b32 v232, 16, v8
    v_mfma_f32_16x16x32_bf16 v[224:227], v[168:171], v[120:123], v[224:227]
    ds_read_b64_tr_b16 v[190:191], v250 offset:22528
    v_and_b32 v233, 0xffff0000, v8
    s_waitcnt lgkmcnt(4)
    v_mfma_f32_16x16x32_bf16 v[216:219], v[172:175], v[100:103], v[216:219]
    v_xor_b32 v250, 32, v250
    ds_read_b64_tr_b16 v[168:169], v250
    v_lshlrev_b32 v234, 16, v9
    v_mfma_f32_16x16x32_bf16 v[224:227], v[172:175], v[124:127], v[224:227]
    ds_read_b64_tr_b16 v[170:171], v250 offset:2048
    v_and_b32 v235, 0xffff0000, v9
    v_mfma_f32_16x16x32_bf16 v[216:219], v[176:179], v[104:107], v[216:219]
    ds_read_b64_tr_b16 v[172:173], v250 offset:4096
    v_lshlrev_b32 v240, 16, v12
    v_mfma_f32_16x16x32_bf16 v[224:227], v[176:179], v[128:131], v[224:227]
    ds_read_b64_tr_b16 v[174:175], v250 offset:6144
    v_and_b32 v241, 0xffff0000, v12
    v_mfma_f32_16x16x32_bf16 v[216:219], v[180:183], v[108:111], v[216:219]
    ds_read_b64_tr_b16 v[176:177], v250 offset:8192
    v_lshlrev_b32 v242, 16, v13
    v_mfma_f32_16x16x32_bf16 v[224:227], v[180:183], v[132:135], v[224:227]
    ds_read_b64_tr_b16 v[178:179], v250 offset:10240
    v_and_b32 v243, 0xffff0000, v13
    s_waitcnt lgkmcnt(4)
    v_mfma_f32_16x16x32_bf16 v[216:219], v[184:187], v[112:115], v[216:219]
    ds_read_b64_tr_b16 v[180:181], v250 offset:12288
    v_cvt_pk_bf16_f32 v2, v236, v237
    v_mfma_f32_16x16x32_bf16 v[224:227], v[184:187], v[136:139], v[224:227]
    ds_read_b64_tr_b16 v[182:183], v250 offset:14336
    v_cvt_pk_bf16_f32 v3, v238, v239
    v_mfma_f32_16x16x32_bf16 v[216:219], v[188:191], v[116:119], v[216:219]
    ds_read_b64_tr_b16 v[184:185], v250 offset:16384
    v_cvt_pk_bf16_f32 v6, v244, v245
    v_mfma_f32_16x16x32_bf16 v[224:227], v[188:191], v[140:143], v[224:227]
    ds_read_b64_tr_b16 v[186:187], v250 offset:18432
    v_cvt_pk_bf16_f32 v7, v246, v247
    v_mfma_f32_16x16x32_bf16 v[220:223], v[168:171], v[96:99], v[220:223]
    ds_read_b64_tr_b16 v[188:189], v250 offset:20480
    v_lshlrev_b32 v236, 16, v10
    v_mfma_f32_16x16x32_bf16 v[228:231], v[168:171], v[120:123], v[228:231]
    ds_read_b64_tr_b16 v[190:191], v250 offset:22528
    v_and_b32 v237, 0xffff0000, v10
    s_add_u32 s66, s61, 8192
    buffer_store_dwordx4 v[0:3], v251, s[36:39], s66 offen sc1
    s_waitcnt lgkmcnt(4)
    v_mfma_f32_16x16x32_bf16 v[220:223], v[172:175], v[100:103], v[220:223]
    v_xor_b32 v250, 96, v250
    ds_read_b64_tr_b16 v[168:169], v250
    v_lshlrev_b32 v238, 16, v11
    v_mfma_f32_16x16x32_bf16 v[228:231], v[172:175], v[124:127], v[228:231]
    ds_read_b64_tr_b16 v[170:171], v250 offset:2048
    v_and_b32 v239, 0xffff0000, v11
    v_mfma_f32_16x16x32_bf16 v[220:223], v[176:179], v[104:107], v[220:223]
    ds_read_b64_tr_b16 v[172:173], v250 offset:4096
    v_lshlrev_b32 v244, 16, v14
    v_mfma_f32_16x16x32_bf16 v[228:231], v[176:179], v[128:131], v[228:231]
    ds_read_b64_tr_b16 v[174:175], v250 offset:6144
    v_and_b32 v245, 0xffff0000, v14
    v_mfma_f32_16x16x32_bf16 v[220:223], v[180:183], v[108:111], v[220:223]
    ds_read_b64_tr_b16 v[176:177], v250 offset:8192
    v_lshlrev_b32 v246, 16, v15
    v_mfma_f32_16x16x32_bf16 v[228:231], v[180:183], v[132:135], v[228:231]
    ds_read_b64_tr_b16 v[178:179], v250 offset:10240
    v_and_b32 v247, 0xffff0000, v15
    s_add_u32 s66, s72, 8192
    buffer_store_dwordx4 v[4:7], v251, s[36:39], s66 offen sc1
    s_waitcnt lgkmcnt(4)
    v_mfma_f32_16x16x32_bf16 v[220:223], v[184:187], v[112:115], v[220:223]
    ds_read_b64_tr_b16 v[180:181], v250 offset:12288
    v_cvt_pk_bf16_f32 v8, v216, v217
    v_mfma_f32_16x16x32_bf16 v[228:231], v[184:187], v[136:139], v[228:231]
    ds_read_b64_tr_b16 v[182:183], v250 offset:14336
    v_cvt_pk_bf16_f32 v9, v218, v219
    v_mfma_f32_16x16x32_bf16 v[220:223], v[188:191], v[116:119], v[220:223]
    ds_read_b64_tr_b16 v[184:185], v250 offset:16384
    v_cvt_pk_bf16_f32 v12, v224, v225
    v_mfma_f32_16x16x32_bf16 v[228:231], v[188:191], v[140:143], v[228:231]
    ds_read_b64_tr_b16 v[186:187], v250 offset:18432
    v_cvt_pk_bf16_f32 v13, v226, v227
    v_mfma_f32_16x16x32_bf16 v[232:235], v[168:171], v[96:99], v[232:235]
    ds_read_b64_tr_b16 v[188:189], v250 offset:20480
    v_lshlrev_b32 v216, 16, v16
    v_mfma_f32_16x16x32_bf16 v[240:243], v[168:171], v[120:123], v[240:243]
    ds_read_b64_tr_b16 v[190:191], v250 offset:22528
    v_and_b32 v217, 0xffff0000, v16
    s_waitcnt lgkmcnt(4)
    v_mfma_f32_16x16x32_bf16 v[232:235], v[172:175], v[100:103], v[232:235]
    v_xor_b32 v250, 32, v250
    ds_read_b64_tr_b16 v[168:169], v250
    v_lshlrev_b32 v218, 16, v17
    v_mfma_f32_16x16x32_bf16 v[240:243], v[172:175], v[124:127], v[240:243]
    ds_read_b64_tr_b16 v[170:171], v250 offset:2048
    v_and_b32 v219, 0xffff0000, v17
    v_mfma_f32_16x16x32_bf16 v[232:235], v[176:179], v[104:107], v[232:235]
    ds_read_b64_tr_b16 v[172:173], v250 offset:4096
    v_lshlrev_b32 v224, 16, v20
    v_mfma_f32_16x16x32_bf16 v[240:243], v[176:179], v[128:131], v[240:243]
    ds_read_b64_tr_b16 v[174:175], v250 offset:6144
    v_and_b32 v225, 0xffff0000, v20
    v_mfma_f32_16x16x32_bf16 v[232:235], v[180:183], v[108:111], v[232:235]
    ds_read_b64_tr_b16 v[176:177], v250 offset:8192
    v_lshlrev_b32 v226, 16, v21
    v_mfma_f32_16x16x32_bf16 v[240:243], v[180:183], v[132:135], v[240:243]
    ds_read_b64_tr_b16 v[178:179], v250 offset:10240
    v_and_b32 v227, 0xffff0000, v21
    s_waitcnt lgkmcnt(4)
    v_mfma_f32_16x16x32_bf16 v[232:235], v[184:187], v[112:115], v[232:235]
    ds_read_b64_tr_b16 v[180:181], v250 offset:12288
    v_cvt_pk_bf16_f32 v10, v220, v221
    v_mfma_f32_16x16x32_bf16 v[240:243], v[184:187], v[136:139], v[240:243]
    ds_read_b64_tr_b16 v[182:183], v250 offset:14336
    v_cvt_pk_bf16_f32 v11, v222, v223
    v_mfma_f32_16x16x32_bf16 v[232:235], v[188:191], v[116:119], v[232:235]
    ds_read_b64_tr_b16 v[184:185], v250 offset:16384
    v_cvt_pk_bf16_f32 v14, v228, v229
    v_mfma_f32_16x16x32_bf16 v[240:243], v[188:191], v[140:143], v[240:243]
    ds_read_b64_tr_b16 v[186:187], v250 offset:18432
    v_cvt_pk_bf16_f32 v15, v230, v231
    v_mfma_f32_16x16x32_bf16 v[236:239], v[168:171], v[96:99], v[236:239]
    ds_read_b64_tr_b16 v[188:189], v250 offset:20480
    v_lshlrev_b32 v220, 16, v18
    v_mfma_f32_16x16x32_bf16 v[244:247], v[168:171], v[120:123], v[244:247]
    ds_read_b64_tr_b16 v[190:191], v250 offset:22528
    v_and_b32 v221, 0xffff0000, v18
    s_add_u32 s66, s61, 16384
    buffer_store_dwordx4 v[8:11], v251, s[36:39], s66 offen sc1
    s_waitcnt vmcnt(5)
    s_barrier
    s_waitcnt lgkmcnt(4)
    v_mfma_f32_16x16x32_bf16 v[236:239], v[172:175], v[100:103], v[236:239]
    v_add_u32 v250, 135168, v249
    ds_read_b64_tr_b16 v[168:169], v250
    v_lshlrev_b32 v222, 16, v19
    v_mfma_f32_16x16x32_bf16 v[244:247], v[172:175], v[124:127], v[244:247]
    ds_read_b64_tr_b16 v[170:171], v250 offset:2048
    v_and_b32 v223, 0xffff0000, v19
    v_mfma_f32_16x16x32_bf16 v[236:239], v[176:179], v[104:107], v[236:239]
    ds_read_b64_tr_b16 v[172:173], v250 offset:4096
    v_lshlrev_b32 v228, 16, v22
    v_mfma_f32_16x16x32_bf16 v[244:247], v[176:179], v[128:131], v[244:247]
    ds_read_b64_tr_b16 v[174:175], v250 offset:6144
    v_and_b32 v229, 0xffff0000, v22
    v_mfma_f32_16x16x32_bf16 v[236:239], v[180:183], v[108:111], v[236:239]
    ds_read_b64_tr_b16 v[176:177], v250 offset:8192
    v_lshlrev_b32 v230, 16, v23
    v_mfma_f32_16x16x32_bf16 v[244:247], v[180:183], v[132:135], v[244:247]
    ds_read_b64_tr_b16 v[178:179], v250 offset:10240
    v_and_b32 v231, 0xffff0000, v23
    s_add_u32 s66, s72, 16384
    buffer_store_dwordx4 v[12:15], v251, s[36:39], s66 offen sc1
    s_waitcnt lgkmcnt(4)
    v_mfma_f32_16x16x32_bf16 v[236:239], v[184:187], v[112:115], v[236:239]
    ds_read_b64_tr_b16 v[180:181], v250 offset:12288
    v_cvt_pk_bf16_f32 v16, v232, v233
    v_mfma_f32_16x16x32_bf16 v[244:247], v[184:187], v[136:139], v[244:247]
    ds_read_b64_tr_b16 v[182:183], v250 offset:14336
    v_cvt_pk_bf16_f32 v17, v234, v235
    v_mfma_f32_16x16x32_bf16 v[236:239], v[188:191], v[116:119], v[236:239]
    ds_read_b64_tr_b16 v[184:185], v250 offset:16384
    v_cvt_pk_bf16_f32 v20, v240, v241
    v_mfma_f32_16x16x32_bf16 v[244:247], v[188:191], v[140:143], v[244:247]
    ds_read_b64_tr_b16 v[186:187], v250 offset:18432
    v_cvt_pk_bf16_f32 v21, v242, v243
    v_mfma_f32_16x16x32_bf16 v[216:219], v[168:171], v[96:99], v[216:219]
    ds_read_b64_tr_b16 v[188:189], v250 offset:20480
    v_lshlrev_b32 v232, 16, v24
    v_mfma_f32_16x16x32_bf16 v[224:227], v[168:171], v[120:123], v[224:227]
    ds_read_b64_tr_b16 v[190:191], v250 offset:22528
    v_and_b32 v233, 0xffff0000, v24
    s_waitcnt lgkmcnt(4)
    v_mfma_f32_16x16x32_bf16 v[216:219], v[172:175], v[100:103], v[216:219]
    v_xor_b32 v250, 32, v250
    ds_read_b64_tr_b16 v[168:169], v250
    v_lshlrev_b32 v234, 16, v25
    v_mfma_f32_16x16x32_bf16 v[224:227], v[172:175], v[124:127], v[224:227]
    ds_read_b64_tr_b16 v[170:171], v250 offset:2048
    v_and_b32 v235, 0xffff0000, v25
    v_mfma_f32_16x16x32_bf16 v[216:219], v[176:179], v[104:107], v[216:219]
    ds_read_b64_tr_b16 v[172:173], v250 offset:4096
    v_lshlrev_b32 v240, 16, v28
    v_mfma_f32_16x16x32_bf16 v[224:227], v[176:179], v[128:131], v[224:227]
    ds_read_b64_tr_b16 v[174:175], v250 offset:6144
    v_and_b32 v241, 0xffff0000, v28
    v_mfma_f32_16x16x32_bf16 v[216:219], v[180:183], v[108:111], v[216:219]
    ds_read_b64_tr_b16 v[176:177], v250 offset:8192
    v_lshlrev_b32 v242, 16, v29
    v_mfma_f32_16x16x32_bf16 v[224:227], v[180:183], v[132:135], v[224:227]
    ds_read_b64_tr_b16 v[178:179], v250 offset:10240
    v_and_b32 v243, 0xffff0000, v29
    s_waitcnt lgkmcnt(4)
    v_mfma_f32_16x16x32_bf16 v[216:219], v[184:187], v[112:115], v[216:219]
    ds_read_b64_tr_b16 v[180:181], v250 offset:12288
    v_cvt_pk_bf16_f32 v18, v236, v237
    v_mfma_f32_16x16x32_bf16 v[224:227], v[184:187], v[136:139], v[224:227]
    ds_read_b64_tr_b16 v[182:183], v250 offset:14336
    v_cvt_pk_bf16_f32 v19, v238, v239
    v_mfma_f32_16x16x32_bf16 v[216:219], v[188:191], v[116:119], v[216:219]
    ds_read_b64_tr_b16 v[184:185], v250 offset:16384
    v_cvt_pk_bf16_f32 v22, v244, v245
    v_mfma_f32_16x16x32_bf16 v[224:227], v[188:191], v[140:143], v[224:227]
    ds_read_b64_tr_b16 v[186:187], v250 offset:18432
    v_cvt_pk_bf16_f32 v23, v246, v247
    v_mfma_f32_16x16x32_bf16 v[220:223], v[168:171], v[96:99], v[220:223]
    ds_read_b64_tr_b16 v[188:189], v250 offset:20480
    v_lshlrev_b32 v236, 16, v26
    v_mfma_f32_16x16x32_bf16 v[228:231], v[168:171], v[120:123], v[228:231]
    ds_read_b64_tr_b16 v[190:191], v250 offset:22528
    v_and_b32 v237, 0xffff0000, v26
    s_add_u32 s66, s61, 24576
    buffer_store_dwordx4 v[16:19], v251, s[36:39], s66 offen sc1
    s_waitcnt lgkmcnt(4)
    v_mfma_f32_16x16x32_bf16 v[220:223], v[172:175], v[100:103], v[220:223]
    v_xor_b32 v250, 96, v250
    ds_read_b64_tr_b16 v[168:169], v250
    v_lshlrev_b32 v238, 16, v27
    v_mfma_f32_16x16x32_bf16 v[228:231], v[172:175], v[124:127], v[228:231]
    ds_read_b64_tr_b16 v[170:171], v250 offset:2048
    v_and_b32 v239, 0xffff0000, v27
    v_mfma_f32_16x16x32_bf16 v[220:223], v[176:179], v[104:107], v[220:223]
    ds_read_b64_tr_b16 v[172:173], v250 offset:4096
    v_lshlrev_b32 v244, 16, v30
    v_mfma_f32_16x16x32_bf16 v[228:231], v[176:179], v[128:131], v[228:231]
    ds_read_b64_tr_b16 v[174:175], v250 offset:6144
    v_and_b32 v245, 0xffff0000, v30
    v_mfma_f32_16x16x32_bf16 v[220:223], v[180:183], v[108:111], v[220:223]
    ds_read_b64_tr_b16 v[176:177], v250 offset:8192
    v_lshlrev_b32 v246, 16, v31
    v_mfma_f32_16x16x32_bf16 v[228:231], v[180:183], v[132:135], v[228:231]
    ds_read_b64_tr_b16 v[178:179], v250 offset:10240
    v_and_b32 v247, 0xffff0000, v31
    s_add_u32 s66, s72, 24576
    buffer_store_dwordx4 v[20:23], v251, s[36:39], s66 offen sc1
    s_waitcnt lgkmcnt(4)
    v_mfma_f32_16x16x32_bf16 v[220:223], v[184:187], v[112:115], v[220:223]
    ds_read_b64_tr_b16 v[180:181], v250 offset:12288
    v_cvt_pk_bf16_f32 v24, v216, v217
    v_mfma_f32_16x16x32_bf16 v[228:231], v[184:187], v[136:139], v[228:231]
    ds_read_b64_tr_b16 v[182:183], v250 offset:14336
    v_cvt_pk_bf16_f32 v25, v218, v219
    v_mfma_f32_16x16x32_bf16 v[220:223], v[188:191], v[116:119], v[220:223]
    ds_read_b64_tr_b16 v[184:185], v250 offset:16384
    v_cvt_pk_bf16_f32 v28, v224, v225
    v_mfma_f32_16x16x32_bf16 v[228:231], v[188:191], v[140:143], v[228:231]
    ds_read_b64_tr_b16 v[186:187], v250 offset:18432
    v_cvt_pk_bf16_f32 v29, v226, v227
    v_mfma_f32_16x16x32_bf16 v[232:235], v[168:171], v[96:99], v[232:235]
    ds_read_b64_tr_b16 v[188:189], v250 offset:20480
    v_lshlrev_b32 v216, 16, v32
    v_mfma_f32_16x16x32_bf16 v[240:243], v[168:171], v[120:123], v[240:243]
    ds_read_b64_tr_b16 v[190:191], v250 offset:22528
    v_and_b32 v217, 0xffff0000, v32
    s_waitcnt lgkmcnt(4)
    v_mfma_f32_16x16x32_bf16 v[232:235], v[172:175], v[100:103], v[232:235]
    v_xor_b32 v250, 32, v250
    ds_read_b64_tr_b16 v[168:169], v250
    v_lshlrev_b32 v218, 16, v33
    v_mfma_f32_16x16x32_bf16 v[240:243], v[172:175], v[124:127], v[240:243]
    ds_read_b64_tr_b16 v[170:171], v250 offset:2048
    v_and_b32 v219, 0xffff0000, v33
    v_mfma_f32_16x16x32_bf16 v[232:235], v[176:179], v[104:107], v[232:235]
    ds_read_b64_tr_b16 v[172:173], v250 offset:4096
    v_lshlrev_b32 v224, 16, v36
    v_mfma_f32_16x16x32_bf16 v[240:243], v[176:179], v[128:131], v[240:243]
    ds_read_b64_tr_b16 v[174:175], v250 offset:6144
    v_and_b32 v225, 0xffff0000, v36
    v_mfma_f32_16x16x32_bf16 v[232:235], v[180:183], v[108:111], v[232:235]
    ds_read_b64_tr_b16 v[176:177], v250 offset:8192
    v_lshlrev_b32 v226, 16, v37
    v_mfma_f32_16x16x32_bf16 v[240:243], v[180:183], v[132:135], v[240:243]
    ds_read_b64_tr_b16 v[178:179], v250 offset:10240
    v_and_b32 v227, 0xffff0000, v37
    s_waitcnt lgkmcnt(4)
    v_mfma_f32_16x16x32_bf16 v[232:235], v[184:187], v[112:115], v[232:235]
    ds_read_b64_tr_b16 v[180:181], v250 offset:12288
    v_cvt_pk_bf16_f32 v26, v220, v221
    v_mfma_f32_16x16x32_bf16 v[240:243], v[184:187], v[136:139], v[240:243]
    ds_read_b64_tr_b16 v[182:183], v250 offset:14336
    v_cvt_pk_bf16_f32 v27, v222, v223
    v_mfma_f32_16x16x32_bf16 v[232:235], v[188:191], v[116:119], v[232:235]
    ds_read_b64_tr_b16 v[184:185], v250 offset:16384
    v_cvt_pk_bf16_f32 v30, v228, v229
    v_mfma_f32_16x16x32_bf16 v[240:243], v[188:191], v[140:143], v[240:243]
    ds_read_b64_tr_b16 v[186:187], v250 offset:18432
    v_cvt_pk_bf16_f32 v31, v230, v231
    v_mfma_f32_16x16x32_bf16 v[236:239], v[168:171], v[96:99], v[236:239]
    ds_read_b64_tr_b16 v[188:189], v250 offset:20480
    v_lshlrev_b32 v220, 16, v34
    v_mfma_f32_16x16x32_bf16 v[244:247], v[168:171], v[120:123], v[244:247]
    ds_read_b64_tr_b16 v[190:191], v250 offset:22528
    v_and_b32 v221, 0xffff0000, v34
    s_add_u32 s66, s61, 32768
    buffer_store_dwordx4 v[24:27], v251, s[36:39], s66 offen sc1
    s_barrier
    s_waitcnt lgkmcnt(4)
    v_mfma_f32_16x16x32_bf16 v[236:239], v[172:175], v[100:103], v[236:239]
    v_add_u32 v250, 86016, v249
    ds_read_b64_tr_b16 v[168:169], v250
    v_lshlrev_b32 v222, 16, v35
    v_mfma_f32_16x16x32_bf16 v[244:247], v[172:175], v[124:127], v[244:247]
    ds_read_b64_tr_b16 v[170:171], v250 offset:2048
    v_and_b32 v223, 0xffff0000, v35
    v_mfma_f32_16x16x32_bf16 v[236:239], v[176:179], v[104:107], v[236:239]
    ds_read_b64_tr_b16 v[172:173], v250 offset:4096
    v_lshlrev_b32 v228, 16, v38
    v_mfma_f32_16x16x32_bf16 v[244:247], v[176:179], v[128:131], v[244:247]
    ds_read_b64_tr_b16 v[174:175], v250 offset:6144
    v_and_b32 v229, 0xffff0000, v38
    v_mfma_f32_16x16x32_bf16 v[236:239], v[180:183], v[108:111], v[236:239]
    ds_read_b64_tr_b16 v[176:177], v250 offset:8192
    v_lshlrev_b32 v230, 16, v39
    v_mfma_f32_16x16x32_bf16 v[244:247], v[180:183], v[132:135], v[244:247]
    ds_read_b64_tr_b16 v[178:179], v250 offset:10240
    v_and_b32 v231, 0xffff0000, v39
    s_add_u32 s66, s72, 32768
    buffer_store_dwordx4 v[28:31], v251, s[36:39], s66 offen sc1
    s_waitcnt lgkmcnt(4)
    v_mfma_f32_16x16x32_bf16 v[236:239], v[184:187], v[112:115], v[236:239]
    ds_read_b64_tr_b16 v[180:181], v250 offset:12288
    v_cvt_pk_bf16_f32 v32, v232, v233
    v_mfma_f32_16x16x32_bf16 v[244:247], v[184:187], v[136:139], v[244:247]
    ds_read_b64_tr_b16 v[182:183], v250 offset:14336
    v_cvt_pk_bf16_f32 v33, v234, v235
    v_mfma_f32_16x16x32_bf16 v[236:239], v[188:191], v[116:119], v[236:239]
    ds_read_b64_tr_b16 v[184:185], v250 offset:16384
    v_cvt_pk_bf16_f32 v36, v240, v241
    v_mfma_f32_16x16x32_bf16 v[244:247], v[188:191], v[140:143], v[244:247]
    ds_read_b64_tr_b16 v[186:187], v250 offset:18432
    v_cvt_pk_bf16_f32 v37, v242, v243
    v_mfma_f32_16x16x32_bf16 v[216:219], v[168:171], v[96:99], v[216:219]
    ds_read_b64_tr_b16 v[188:189], v250 offset:20480
    v_lshlrev_b32 v232, 16, v40
    v_mfma_f32_16x16x32_bf16 v[224:227], v[168:171], v[120:123], v[224:227]
    ds_read_b64_tr_b16 v[190:191], v250 offset:22528
    v_and_b32 v233, 0xffff0000, v40
    s_waitcnt lgkmcnt(4)
    v_mfma_f32_16x16x32_bf16 v[216:219], v[172:175], v[100:103], v[216:219]
    v_xor_b32 v250, 32, v250
    ds_read_b64_tr_b16 v[168:169], v250
    v_lshlrev_b32 v234, 16, v41
    v_mfma_f32_16x16x32_bf16 v[224:227], v[172:175], v[124:127], v[224:227]
    ds_read_b64_tr_b16 v[170:171], v250 offset:2048
    v_and_b32 v235, 0xffff0000, v41
    v_mfma_f32_16x16x32_bf16 v[216:219], v[176:179], v[104:107], v[216:219]
    ds_read_b64_tr_b16 v[172:173], v250 offset:4096
    v_lshlrev_b32 v240, 16, v44
    v_mfma_f32_16x16x32_bf16 v[224:227], v[176:179], v[128:131], v[224:227]
    ds_read_b64_tr_b16 v[174:175], v250 offset:6144
    v_and_b32 v241, 0xffff0000, v44
    v_mfma_f32_16x16x32_bf16 v[216:219], v[180:183], v[108:111], v[216:219]
    ds_read_b64_tr_b16 v[176:177], v250 offset:8192
    v_lshlrev_b32 v242, 16, v45
    v_mfma_f32_16x16x32_bf16 v[224:227], v[180:183], v[132:135], v[224:227]
    ds_read_b64_tr_b16 v[178:179], v250 offset:10240
    v_and_b32 v243, 0xffff0000, v45
    s_waitcnt lgkmcnt(4)
    v_mfma_f32_16x16x32_bf16 v[216:219], v[184:187], v[112:115], v[216:219]
    ds_read_b64_tr_b16 v[180:181], v250 offset:12288
    v_cvt_pk_bf16_f32 v34, v236, v237
    v_mfma_f32_16x16x32_bf16 v[224:227], v[184:187], v[136:139], v[224:227]
    ds_read_b64_tr_b16 v[182:183], v250 offset:14336
    v_cvt_pk_bf16_f32 v35, v238, v239
    v_mfma_f32_16x16x32_bf16 v[216:219], v[188:191], v[116:119], v[216:219]
    ds_read_b64_tr_b16 v[184:185], v250 offset:16384
    v_cvt_pk_bf16_f32 v38, v244, v245
    v_mfma_f32_16x16x32_bf16 v[224:227], v[188:191], v[140:143], v[224:227]
    ds_read_b64_tr_b16 v[186:187], v250 offset:18432
    v_cvt_pk_bf16_f32 v39, v246, v247
    v_mfma_f32_16x16x32_bf16 v[220:223], v[168:171], v[96:99], v[220:223]
    ds_read_b64_tr_b16 v[188:189], v250 offset:20480
    v_lshlrev_b32 v236, 16, v42
    v_mfma_f32_16x16x32_bf16 v[228:231], v[168:171], v[120:123], v[228:231]
    ds_read_b64_tr_b16 v[190:191], v250 offset:22528
    v_and_b32 v237, 0xffff0000, v42
    s_add_u32 s66, s61, 40960
    buffer_store_dwordx4 v[32:35], v251, s[36:39], s66 offen sc1
    s_waitcnt lgkmcnt(4)
    v_mfma_f32_16x16x32_bf16 v[220:223], v[172:175], v[100:103], v[220:223]
    v_xor_b32 v250, 96, v250
    ds_read_b64_tr_b16 v[168:169], v250
    v_lshlrev_b32 v238, 16, v43
    v_mfma_f32_16x16x32_bf16 v[228:231], v[172:175], v[124:127], v[228:231]
    ds_read_b64_tr_b16 v[170:171], v250 offset:2048
    v_and_b32 v239, 0xffff0000, v43
    v_mfma_f32_16x16x32_bf16 v[220:223], v[176:179], v[104:107], v[220:223]
    ds_read_b64_tr_b16 v[172:173], v250 offset:4096
    v_lshlrev_b32 v244, 16, v46
    v_mfma_f32_16x16x32_bf16 v[228:231], v[176:179], v[128:131], v[228:231]
    ds_read_b64_tr_b16 v[174:175], v250 offset:6144
    v_and_b32 v245, 0xffff0000, v46
    v_mfma_f32_16x16x32_bf16 v[220:223], v[180:183], v[108:111], v[220:223]
    ds_read_b64_tr_b16 v[176:177], v250 offset:8192
    v_lshlrev_b32 v246, 16, v47
    v_mfma_f32_16x16x32_bf16 v[228:231], v[180:183], v[132:135], v[228:231]
    ds_read_b64_tr_b16 v[178:179], v250 offset:10240
    v_and_b32 v247, 0xffff0000, v47
    s_add_u32 s66, s72, 40960
    buffer_store_dwordx4 v[36:39], v251, s[36:39], s66 offen sc1
    s_waitcnt lgkmcnt(4)
    v_mfma_f32_16x16x32_bf16 v[220:223], v[184:187], v[112:115], v[220:223]
    ds_read_b64_tr_b16 v[180:181], v250 offset:12288
    v_cvt_pk_bf16_f32 v40, v216, v217
    v_mfma_f32_16x16x32_bf16 v[228:231], v[184:187], v[136:139], v[228:231]
    ds_read_b64_tr_b16 v[182:183], v250 offset:14336
    v_cvt_pk_bf16_f32 v41, v218, v219
    v_mfma_f32_16x16x32_bf16 v[220:223], v[188:191], v[116:119], v[220:223]
    ds_read_b64_tr_b16 v[184:185], v250 offset:16384
    v_cvt_pk_bf16_f32 v44, v224, v225
    v_mfma_f32_16x16x32_bf16 v[228:231], v[188:191], v[140:143], v[228:231]
    ds_read_b64_tr_b16 v[186:187], v250 offset:18432
    v_cvt_pk_bf16_f32 v45, v226, v227
    v_mfma_f32_16x16x32_bf16 v[232:235], v[168:171], v[96:99], v[232:235]
    ds_read_b64_tr_b16 v[188:189], v250 offset:20480
    v_lshlrev_b32 v216, 16, v48
    v_mfma_f32_16x16x32_bf16 v[240:243], v[168:171], v[120:123], v[240:243]
    ds_read_b64_tr_b16 v[190:191], v250 offset:22528
    v_and_b32 v217, 0xffff0000, v48
    s_waitcnt lgkmcnt(4)
    v_mfma_f32_16x16x32_bf16 v[232:235], v[172:175], v[100:103], v[232:235]
    v_xor_b32 v250, 32, v250
    ds_read_b64_tr_b16 v[168:169], v250
    v_lshlrev_b32 v218, 16, v49
    v_mfma_f32_16x16x32_bf16 v[240:243], v[172:175], v[124:127], v[240:243]
    ds_read_b64_tr_b16 v[170:171], v250 offset:2048
    v_and_b32 v219, 0xffff0000, v49
    v_mfma_f32_16x16x32_bf16 v[232:235], v[176:179], v[104:107], v[232:235]
    ds_read_b64_tr_b16 v[172:173], v250 offset:4096
    v_lshlrev_b32 v224, 16, v52
    v_mfma_f32_16x16x32_bf16 v[240:243], v[176:179], v[128:131], v[240:243]
    ds_read_b64_tr_b16 v[174:175], v250 offset:6144
    v_and_b32 v225, 0xffff0000, v52
    v_mfma_f32_16x16x32_bf16 v[232:235], v[180:183], v[108:111], v[232:235]
    ds_read_b64_tr_b16 v[176:177], v250 offset:8192
    v_lshlrev_b32 v226, 16, v53
    v_mfma_f32_16x16x32_bf16 v[240:243], v[180:183], v[132:135], v[240:243]
    ds_read_b64_tr_b16 v[178:179], v250 offset:10240
    v_and_b32 v227, 0xffff0000, v53
    s_waitcnt lgkmcnt(4)
    v_mfma_f32_16x16x32_bf16 v[232:235], v[184:187], v[112:115], v[232:235]
    ds_read_b64_tr_b16 v[180:181], v250 offset:12288
    v_cvt_pk_bf16_f32 v42, v220, v221
    v_mfma_f32_16x16x32_bf16 v[240:243], v[184:187], v[136:139], v[240:243]
    ds_read_b64_tr_b16 v[182:183], v250 offset:14336
    v_cvt_pk_bf16_f32 v43, v222, v223
    v_mfma_f32_16x16x32_bf16 v[232:235], v[188:191], v[116:119], v[232:235]
    ds_read_b64_tr_b16 v[184:185], v250 offset:16384
    v_cvt_pk_bf16_f32 v46, v228, v229
    v_mfma_f32_16x16x32_bf16 v[240:243], v[188:191], v[140:143], v[240:243]
    ds_read_b64_tr_b16 v[186:187], v250 offset:18432
    v_cvt_pk_bf16_f32 v47, v230, v231
    v_mfma_f32_16x16x32_bf16 v[236:239], v[168:171], v[96:99], v[236:239]
    ds_read_b64_tr_b16 v[188:189], v250 offset:20480
    v_lshlrev_b32 v220, 16, v50
    v_mfma_f32_16x16x32_bf16 v[244:247], v[168:171], v[120:123], v[244:247]
    ds_read_b64_tr_b16 v[190:191], v250 offset:22528
    v_and_b32 v221, 0xffff0000, v50
    s_add_u32 s66, s61, 49152
    buffer_store_dwordx4 v[40:43], v251, s[36:39], s66 offen sc1
    s_barrier
    s_waitcnt lgkmcnt(4)
    v_mfma_f32_16x16x32_bf16 v[236:239], v[172:175], v[100:103], v[236:239]
    v_add_u32 v250, 0, v249
    ds_read_b64_tr_b16 v[168:169], v250
    v_lshlrev_b32 v222, 16, v51
    v_mfma_f32_16x16x32_bf16 v[244:247], v[172:175], v[124:127], v[244:247]
    ds_read_b64_tr_b16 v[170:171], v250 offset:2048
    v_and_b32 v223, 0xffff0000, v51
    v_mfma_f32_16x16x32_bf16 v[236:239], v[176:179], v[104:107], v[236:239]
    ds_read_b64_tr_b16 v[172:173], v250 offset:4096
    v_lshlrev_b32 v228, 16, v54
    v_mfma_f32_16x16x32_bf16 v[244:247], v[176:179], v[128:131], v[244:247]
    ds_read_b64_tr_b16 v[174:175], v250 offset:6144
    v_and_b32 v229, 0xffff0000, v54
    v_mfma_f32_16x16x32_bf16 v[236:239], v[180:183], v[108:111], v[236:239]
    ds_read_b64_tr_b16 v[176:177], v250 offset:8192
    v_lshlrev_b32 v230, 16, v55
    v_mfma_f32_16x16x32_bf16 v[244:247], v[180:183], v[132:135], v[244:247]
    ds_read_b64_tr_b16 v[178:179], v250 offset:10240
    v_and_b32 v231, 0xffff0000, v55
    s_add_u32 s66, s72, 49152
    buffer_store_dwordx4 v[44:47], v251, s[36:39], s66 offen sc1
    s_waitcnt lgkmcnt(4)
    v_mfma_f32_16x16x32_bf16 v[236:239], v[184:187], v[112:115], v[236:239]
    ds_read_b64_tr_b16 v[180:181], v250 offset:12288
    v_cvt_pk_bf16_f32 v48, v232, v233
    v_mfma_f32_16x16x32_bf16 v[244:247], v[184:187], v[136:139], v[244:247]
    ds_read_b64_tr_b16 v[182:183], v250 offset:14336
    v_cvt_pk_bf16_f32 v49, v234, v235
    v_mfma_f32_16x16x32_bf16 v[236:239], v[188:191], v[116:119], v[236:239]
    ds_read_b64_tr_b16 v[184:185], v250 offset:16384
    v_cvt_pk_bf16_f32 v52, v240, v241
    v_mfma_f32_16x16x32_bf16 v[244:247], v[188:191], v[140:143], v[244:247]
    ds_read_b64_tr_b16 v[186:187], v250 offset:18432
    v_cvt_pk_bf16_f32 v53, v242, v243
    v_mfma_f32_16x16x32_bf16 v[216:219], v[168:171], v[96:99], v[216:219]
    ds_read_b64_tr_b16 v[188:189], v250 offset:20480
    v_lshlrev_b32 v232, 16, v56
    v_mfma_f32_16x16x32_bf16 v[224:227], v[168:171], v[120:123], v[224:227]
    ds_read_b64_tr_b16 v[190:191], v250 offset:22528
    v_and_b32 v233, 0xffff0000, v56
    s_waitcnt lgkmcnt(4)
    v_mfma_f32_16x16x32_bf16 v[216:219], v[172:175], v[100:103], v[216:219]
    v_xor_b32 v250, 32, v250
    ds_read_b64_tr_b16 v[168:169], v250
    v_lshlrev_b32 v234, 16, v57
    v_mfma_f32_16x16x32_bf16 v[224:227], v[172:175], v[124:127], v[224:227]
    ds_read_b64_tr_b16 v[170:171], v250 offset:2048
    v_and_b32 v235, 0xffff0000, v57
    v_mfma_f32_16x16x32_bf16 v[216:219], v[176:179], v[104:107], v[216:219]
    ds_read_b64_tr_b16 v[172:173], v250 offset:4096
    v_lshlrev_b32 v240, 16, v60
    v_mfma_f32_16x16x32_bf16 v[224:227], v[176:179], v[128:131], v[224:227]
    ds_read_b64_tr_b16 v[174:175], v250 offset:6144
    v_and_b32 v241, 0xffff0000, v60
    v_mfma_f32_16x16x32_bf16 v[216:219], v[180:183], v[108:111], v[216:219]
    ds_read_b64_tr_b16 v[176:177], v250 offset:8192
    v_lshlrev_b32 v242, 16, v61
    v_mfma_f32_16x16x32_bf16 v[224:227], v[180:183], v[132:135], v[224:227]
    ds_read_b64_tr_b16 v[178:179], v250 offset:10240
    v_and_b32 v243, 0xffff0000, v61
    s_waitcnt lgkmcnt(4)
    v_mfma_f32_16x16x32_bf16 v[216:219], v[184:187], v[112:115], v[216:219]
    ds_read_b64_tr_b16 v[180:181], v250 offset:12288
    v_cvt_pk_bf16_f32 v50, v236, v237
    v_mfma_f32_16x16x32_bf16 v[224:227], v[184:187], v[136:139], v[224:227]
    ds_read_b64_tr_b16 v[182:183], v250 offset:14336
    v_cvt_pk_bf16_f32 v51, v238, v239
    v_mfma_f32_16x16x32_bf16 v[216:219], v[188:191], v[116:119], v[216:219]
    ds_read_b64_tr_b16 v[184:185], v250 offset:16384
    v_cvt_pk_bf16_f32 v54, v244, v245
    v_mfma_f32_16x16x32_bf16 v[224:227], v[188:191], v[140:143], v[224:227]
    ds_read_b64_tr_b16 v[186:187], v250 offset:18432
    v_cvt_pk_bf16_f32 v55, v246, v247
    v_mfma_f32_16x16x32_bf16 v[220:223], v[168:171], v[96:99], v[220:223]
    ds_read_b64_tr_b16 v[188:189], v250 offset:20480
    v_lshlrev_b32 v236, 16, v58
    v_mfma_f32_16x16x32_bf16 v[228:231], v[168:171], v[120:123], v[228:231]
    ds_read_b64_tr_b16 v[190:191], v250 offset:22528
    v_and_b32 v237, 0xffff0000, v58
    s_add_u32 s66, s61, 57344
    buffer_store_dwordx4 v[48:51], v251, s[36:39], s66 offen sc1
    s_waitcnt lgkmcnt(4)
    v_mfma_f32_16x16x32_bf16 v[220:223], v[172:175], v[100:103], v[220:223]
    v_xor_b32 v250, 96, v250
    ds_read_b64_tr_b16 v[168:169], v250
    v_lshlrev_b32 v238, 16, v59
    v_mfma_f32_16x16x32_bf16 v[228:231], v[172:175], v[124:127], v[228:231]
    ds_read_b64_tr_b16 v[170:171], v250 offset:2048
    v_and_b32 v239, 0xffff0000, v59
    v_mfma_f32_16x16x32_bf16 v[220:223], v[176:179], v[104:107], v[220:223]
    ds_read_b64_tr_b16 v[172:173], v250 offset:4096
    v_lshlrev_b32 v244, 16, v62
    v_mfma_f32_16x16x32_bf16 v[228:231], v[176:179], v[128:131], v[228:231]
    ds_read_b64_tr_b16 v[174:175], v250 offset:6144
    v_and_b32 v245, 0xffff0000, v62
    v_mfma_f32_16x16x32_bf16 v[220:223], v[180:183], v[108:111], v[220:223]
    ds_read_b64_tr_b16 v[176:177], v250 offset:8192
    v_lshlrev_b32 v246, 16, v63
    v_mfma_f32_16x16x32_bf16 v[228:231], v[180:183], v[132:135], v[228:231]
    ds_read_b64_tr_b16 v[178:179], v250 offset:10240
    v_and_b32 v247, 0xffff0000, v63
    s_add_u32 s66, s72, 57344
    buffer_store_dwordx4 v[52:55], v251, s[36:39], s66 offen sc1
    s_waitcnt lgkmcnt(4)
    v_mfma_f32_16x16x32_bf16 v[220:223], v[184:187], v[112:115], v[220:223]
    ds_read_b64_tr_b16 v[180:181], v250 offset:12288
    v_cvt_pk_bf16_f32 v56, v216, v217
    v_mfma_f32_16x16x32_bf16 v[228:231], v[184:187], v[136:139], v[228:231]
    ds_read_b64_tr_b16 v[182:183], v250 offset:14336
    v_cvt_pk_bf16_f32 v57, v218, v219
    v_mfma_f32_16x16x32_bf16 v[220:223], v[188:191], v[116:119], v[220:223]
    ds_read_b64_tr_b16 v[184:185], v250 offset:16384
    v_cvt_pk_bf16_f32 v60, v224, v225
    v_mfma_f32_16x16x32_bf16 v[228:231], v[188:191], v[140:143], v[228:231]
    ds_read_b64_tr_b16 v[186:187], v250 offset:18432
    v_cvt_pk_bf16_f32 v61, v226, v227
    v_mfma_f32_16x16x32_bf16 v[232:235], v[168:171], v[96:99], v[232:235]
    ds_read_b64_tr_b16 v[188:189], v250 offset:20480
    v_lshlrev_b32 v216, 16, v64
    v_mfma_f32_16x16x32_bf16 v[240:243], v[168:171], v[120:123], v[240:243]
    ds_read_b64_tr_b16 v[190:191], v250 offset:22528
    v_and_b32 v217, 0xffff0000, v64
    s_waitcnt lgkmcnt(4)
    v_mfma_f32_16x16x32_bf16 v[232:235], v[172:175], v[100:103], v[232:235]
    v_xor_b32 v250, 32, v250
    ds_read_b64_tr_b16 v[168:169], v250
    v_lshlrev_b32 v218, 16, v65
    v_mfma_f32_16x16x32_bf16 v[240:243], v[172:175], v[124:127], v[240:243]
    ds_read_b64_tr_b16 v[170:171], v250 offset:2048
    v_and_b32 v219, 0xffff0000, v65
    v_mfma_f32_16x16x32_bf16 v[232:235], v[176:179], v[104:107], v[232:235]
    ds_read_b64_tr_b16 v[172:173], v250 offset:4096
    v_lshlrev_b32 v224, 16, v68
    v_mfma_f32_16x16x32_bf16 v[240:243], v[176:179], v[128:131], v[240:243]
    ds_read_b64_tr_b16 v[174:175], v250 offset:6144
    v_and_b32 v225, 0xffff0000, v68
    v_mfma_f32_16x16x32_bf16 v[232:235], v[180:183], v[108:111], v[232:235]
    ds_read_b64_tr_b16 v[176:177], v250 offset:8192
    v_lshlrev_b32 v226, 16, v69
    v_mfma_f32_16x16x32_bf16 v[240:243], v[180:183], v[132:135], v[240:243]
    ds_read_b64_tr_b16 v[178:179], v250 offset:10240
    v_and_b32 v227, 0xffff0000, v69
    s_waitcnt lgkmcnt(4)
    v_mfma_f32_16x16x32_bf16 v[232:235], v[184:187], v[112:115], v[232:235]
    ds_read_b64_tr_b16 v[180:181], v250 offset:12288
    v_cvt_pk_bf16_f32 v58, v220, v221
    v_mfma_f32_16x16x32_bf16 v[240:243], v[184:187], v[136:139], v[240:243]
    ds_read_b64_tr_b16 v[182:183], v250 offset:14336
    v_cvt_pk_bf16_f32 v59, v222, v223
    v_mfma_f32_16x16x32_bf16 v[232:235], v[188:191], v[116:119], v[232:235]
    ds_read_b64_tr_b16 v[184:185], v250 offset:16384
    v_cvt_pk_bf16_f32 v62, v228, v229
    v_mfma_f32_16x16x32_bf16 v[240:243], v[188:191], v[140:143], v[240:243]
    ds_read_b64_tr_b16 v[186:187], v250 offset:18432
    v_cvt_pk_bf16_f32 v63, v230, v231
    v_mfma_f32_16x16x32_bf16 v[236:239], v[168:171], v[96:99], v[236:239]
    ds_read_b64_tr_b16 v[188:189], v250 offset:20480
    v_lshlrev_b32 v220, 16, v66
    v_mfma_f32_16x16x32_bf16 v[244:247], v[168:171], v[120:123], v[244:247]
    ds_read_b64_tr_b16 v[190:191], v250 offset:22528
    v_and_b32 v221, 0xffff0000, v66
    s_add_u32 s66, s61, 65536
    buffer_store_dwordx4 v[56:59], v251, s[36:39], s66 offen sc1
    s_barrier
    s_waitcnt lgkmcnt(4)
    v_mfma_f32_16x16x32_bf16 v[236:239], v[172:175], v[100:103], v[236:239]
    v_add_u32 v250, 24576, v249
    ds_read_b64_tr_b16 v[168:169], v250
    v_lshlrev_b32 v222, 16, v67
    v_mfma_f32_16x16x32_bf16 v[244:247], v[172:175], v[124:127], v[244:247]
    ds_read_b64_tr_b16 v[170:171], v250 offset:2048
    v_and_b32 v223, 0xffff0000, v67
    v_mfma_f32_16x16x32_bf16 v[236:239], v[176:179], v[104:107], v[236:239]
    ds_read_b64_tr_b16 v[172:173], v250 offset:4096
    v_lshlrev_b32 v228, 16, v70
    v_mfma_f32_16x16x32_bf16 v[244:247], v[176:179], v[128:131], v[244:247]
    ds_read_b64_tr_b16 v[174:175], v250 offset:6144
    v_and_b32 v229, 0xffff0000, v70
    v_mfma_f32_16x16x32_bf16 v[236:239], v[180:183], v[108:111], v[236:239]
    ds_read_b64_tr_b16 v[176:177], v250 offset:8192
    v_lshlrev_b32 v230, 16, v71
    v_mfma_f32_16x16x32_bf16 v[244:247], v[180:183], v[132:135], v[244:247]
    ds_read_b64_tr_b16 v[178:179], v250 offset:10240
    v_and_b32 v231, 0xffff0000, v71
    s_add_u32 s66, s72, 65536
    buffer_store_dwordx4 v[60:63], v251, s[36:39], s66 offen sc1
    s_waitcnt lgkmcnt(4)
    v_mfma_f32_16x16x32_bf16 v[236:239], v[184:187], v[112:115], v[236:239]
    ds_read_b64_tr_b16 v[180:181], v250 offset:12288
    v_cvt_pk_bf16_f32 v64, v232, v233
    v_mfma_f32_16x16x32_bf16 v[244:247], v[184:187], v[136:139], v[244:247]
    ds_read_b64_tr_b16 v[182:183], v250 offset:14336
    v_cvt_pk_bf16_f32 v65, v234, v235
    v_mfma_f32_16x16x32_bf16 v[236:239], v[188:191], v[116:119], v[236:239]
    ds_read_b64_tr_b16 v[184:185], v250 offset:16384
    v_cvt_pk_bf16_f32 v68, v240, v241
    v_mfma_f32_16x16x32_bf16 v[244:247], v[188:191], v[140:143], v[244:247]
    ds_read_b64_tr_b16 v[186:187], v250 offset:18432
    v_cvt_pk_bf16_f32 v69, v242, v243
    v_mfma_f32_16x16x32_bf16 v[216:219], v[168:171], v[96:99], v[216:219]
    ds_read_b64_tr_b16 v[188:189], v250 offset:20480
    v_lshlrev_b32 v232, 16, v72
    v_mfma_f32_16x16x32_bf16 v[224:227], v[168:171], v[120:123], v[224:227]
    ds_read_b64_tr_b16 v[190:191], v250 offset:22528
    v_and_b32 v233, 0xffff0000, v72
    s_waitcnt lgkmcnt(4)
    v_mfma_f32_16x16x32_bf16 v[216:219], v[172:175], v[100:103], v[216:219]
    v_xor_b32 v250, 32, v250
    ds_read_b64_tr_b16 v[168:169], v250
    v_lshlrev_b32 v234, 16, v73
    v_mfma_f32_16x16x32_bf16 v[224:227], v[172:175], v[124:127], v[224:227]
    ds_read_b64_tr_b16 v[170:171], v250 offset:2048
    v_and_b32 v235, 0xffff0000, v73
    v_mfma_f32_16x16x32_bf16 v[216:219], v[176:179], v[104:107], v[216:219]
    ds_read_b64_tr_b16 v[172:173], v250 offset:4096
    v_lshlrev_b32 v240, 16, v76
    v_mfma_f32_16x16x32_bf16 v[224:227], v[176:179], v[128:131], v[224:227]
    ds_read_b64_tr_b16 v[174:175], v250 offset:6144
    v_and_b32 v241, 0xffff0000, v76
    v_mfma_f32_16x16x32_bf16 v[216:219], v[180:183], v[108:111], v[216:219]
    ds_read_b64_tr_b16 v[176:177], v250 offset:8192
    v_lshlrev_b32 v242, 16, v77
    v_mfma_f32_16x16x32_bf16 v[224:227], v[180:183], v[132:135], v[224:227]
    ds_read_b64_tr_b16 v[178:179], v250 offset:10240
    v_and_b32 v243, 0xffff0000, v77
    s_waitcnt lgkmcnt(4)
    v_mfma_f32_16x16x32_bf16 v[216:219], v[184:187], v[112:115], v[216:219]
    ds_read_b64_tr_b16 v[180:181], v250 offset:12288
    v_cvt_pk_bf16_f32 v66, v236, v237
    v_mfma_f32_16x16x32_bf16 v[224:227], v[184:187], v[136:139], v[224:227]
    ds_read_b64_tr_b16 v[182:183], v250 offset:14336
    v_cvt_pk_bf16_f32 v67, v238, v239
    v_mfma_f32_16x16x32_bf16 v[216:219], v[188:191], v[116:119], v[216:219]
    ds_read_b64_tr_b16 v[184:185], v250 offset:16384
    v_cvt_pk_bf16_f32 v70, v244, v245
    v_mfma_f32_16x16x32_bf16 v[224:227], v[188:191], v[140:143], v[224:227]
    ds_read_b64_tr_b16 v[186:187], v250 offset:18432
    v_cvt_pk_bf16_f32 v71, v246, v247
    v_mfma_f32_16x16x32_bf16 v[220:223], v[168:171], v[96:99], v[220:223]
    ds_read_b64_tr_b16 v[188:189], v250 offset:20480
    v_lshlrev_b32 v236, 16, v74
    v_mfma_f32_16x16x32_bf16 v[228:231], v[168:171], v[120:123], v[228:231]
    ds_read_b64_tr_b16 v[190:191], v250 offset:22528
    v_and_b32 v237, 0xffff0000, v74
    s_add_u32 s66, s61, 73728
    buffer_store_dwordx4 v[64:67], v251, s[36:39], s66 offen sc1
    s_waitcnt lgkmcnt(4)
    v_mfma_f32_16x16x32_bf16 v[220:223], v[172:175], v[100:103], v[220:223]
    v_xor_b32 v250, 96, v250
    ds_read_b64_tr_b16 v[168:169], v250
    v_lshlrev_b32 v238, 16, v75
    v_mfma_f32_16x16x32_bf16 v[228:231], v[172:175], v[124:127], v[228:231]
    ds_read_b64_tr_b16 v[170:171], v250 offset:2048
    v_and_b32 v239, 0xffff0000, v75
    v_mfma_f32_16x16x32_bf16 v[220:223], v[176:179], v[104:107], v[220:223]
    ds_read_b64_tr_b16 v[172:173], v250 offset:4096
    v_lshlrev_b32 v244, 16, v78
    v_mfma_f32_16x16x32_bf16 v[228:231], v[176:179], v[128:131], v[228:231]
    ds_read_b64_tr_b16 v[174:175], v250 offset:6144
    v_and_b32 v245, 0xffff0000, v78
    v_mfma_f32_16x16x32_bf16 v[220:223], v[180:183], v[108:111], v[220:223]
    ds_read_b64_tr_b16 v[176:177], v250 offset:8192
    v_lshlrev_b32 v246, 16, v79
    v_mfma_f32_16x16x32_bf16 v[228:231], v[180:183], v[132:135], v[228:231]
    ds_read_b64_tr_b16 v[178:179], v250 offset:10240
    v_and_b32 v247, 0xffff0000, v79
    s_add_u32 s66, s72, 73728
    buffer_store_dwordx4 v[68:71], v251, s[36:39], s66 offen sc1
    s_waitcnt lgkmcnt(4)
    v_mfma_f32_16x16x32_bf16 v[220:223], v[184:187], v[112:115], v[220:223]
    ds_read_b64_tr_b16 v[180:181], v250 offset:12288
    v_cvt_pk_bf16_f32 v72, v216, v217
    v_mfma_f32_16x16x32_bf16 v[228:231], v[184:187], v[136:139], v[228:231]
    ds_read_b64_tr_b16 v[182:183], v250 offset:14336
    v_cvt_pk_bf16_f32 v73, v218, v219
    v_mfma_f32_16x16x32_bf16 v[220:223], v[188:191], v[116:119], v[220:223]
    ds_read_b64_tr_b16 v[184:185], v250 offset:16384
    v_cvt_pk_bf16_f32 v76, v224, v225
    v_mfma_f32_16x16x32_bf16 v[228:231], v[188:191], v[140:143], v[228:231]
    ds_read_b64_tr_b16 v[186:187], v250 offset:18432
    v_cvt_pk_bf16_f32 v77, v226, v227
    v_mfma_f32_16x16x32_bf16 v[232:235], v[168:171], v[96:99], v[232:235]
    ds_read_b64_tr_b16 v[188:189], v250 offset:20480
    v_lshlrev_b32 v216, 16, v80
    v_mfma_f32_16x16x32_bf16 v[240:243], v[168:171], v[120:123], v[240:243]
    ds_read_b64_tr_b16 v[190:191], v250 offset:22528
    v_and_b32 v217, 0xffff0000, v80
    s_waitcnt lgkmcnt(4)
    v_mfma_f32_16x16x32_bf16 v[232:235], v[172:175], v[100:103], v[232:235]
    v_xor_b32 v250, 32, v250
    ds_read_b64_tr_b16 v[168:169], v250
    v_lshlrev_b32 v218, 16, v81
    v_mfma_f32_16x16x32_bf16 v[240:243], v[172:175], v[124:127], v[240:243]
    ds_read_b64_tr_b16 v[170:171], v250 offset:2048
    v_and_b32 v219, 0xffff0000, v81
    v_mfma_f32_16x16x32_bf16 v[232:235], v[176:179], v[104:107], v[232:235]
    ds_read_b64_tr_b16 v[172:173], v250 offset:4096
    v_lshlrev_b32 v224, 16, v84
    v_mfma_f32_16x16x32_bf16 v[240:243], v[176:179], v[128:131], v[240:243]
    ds_read_b64_tr_b16 v[174:175], v250 offset:6144
    v_and_b32 v225, 0xffff0000, v84
    v_mfma_f32_16x16x32_bf16 v[232:235], v[180:183], v[108:111], v[232:235]
    ds_read_b64_tr_b16 v[176:177], v250 offset:8192
    v_lshlrev_b32 v226, 16, v85
    v_mfma_f32_16x16x32_bf16 v[240:243], v[180:183], v[132:135], v[240:243]
    ds_read_b64_tr_b16 v[178:179], v250 offset:10240
    v_and_b32 v227, 0xffff0000, v85
    s_waitcnt lgkmcnt(4)
    v_mfma_f32_16x16x32_bf16 v[232:235], v[184:187], v[112:115], v[232:235]
    ds_read_b64_tr_b16 v[180:181], v250 offset:12288
    v_cvt_pk_bf16_f32 v74, v220, v221
    v_mfma_f32_16x16x32_bf16 v[240:243], v[184:187], v[136:139], v[240:243]
    ds_read_b64_tr_b16 v[182:183], v250 offset:14336
    v_cvt_pk_bf16_f32 v75, v222, v223
    v_mfma_f32_16x16x32_bf16 v[232:235], v[188:191], v[116:119], v[232:235]
    ds_read_b64_tr_b16 v[184:185], v250 offset:16384
    v_cvt_pk_bf16_f32 v78, v228, v229
    v_mfma_f32_16x16x32_bf16 v[240:243], v[188:191], v[140:143], v[240:243]
    ds_read_b64_tr_b16 v[186:187], v250 offset:18432
    v_cvt_pk_bf16_f32 v79, v230, v231
    v_mfma_f32_16x16x32_bf16 v[236:239], v[168:171], v[96:99], v[236:239]
    ds_read_b64_tr_b16 v[188:189], v250 offset:20480
    v_lshlrev_b32 v220, 16, v82
    v_mfma_f32_16x16x32_bf16 v[244:247], v[168:171], v[120:123], v[244:247]
    ds_read_b64_tr_b16 v[190:191], v250 offset:22528
    v_and_b32 v221, 0xffff0000, v82
    s_add_u32 s66, s61, 81920
    buffer_store_dwordx4 v[72:75], v251, s[36:39], s66 offen sc1
    s_barrier
    s_waitcnt lgkmcnt(4)
    v_mfma_f32_16x16x32_bf16 v[236:239], v[172:175], v[100:103], v[236:239]
    v_add_u32 v250, 110592, v249
    ds_read_b64_tr_b16 v[168:169], v250
    v_lshlrev_b32 v222, 16, v83
    v_mfma_f32_16x16x32_bf16 v[244:247], v[172:175], v[124:127], v[244:247]
    ds_read_b64_tr_b16 v[170:171], v250 offset:2048
    v_and_b32 v223, 0xffff0000, v83
    v_mfma_f32_16x16x32_bf16 v[236:239], v[176:179], v[104:107], v[236:239]
    ds_read_b64_tr_b16 v[172:173], v250 offset:4096
    v_lshlrev_b32 v228, 16, v86
    v_mfma_f32_16x16x32_bf16 v[244:247], v[176:179], v[128:131], v[244:247]
    ds_read_b64_tr_b16 v[174:175], v250 offset:6144
    v_and_b32 v229, 0xffff0000, v86
    v_mfma_f32_16x16x32_bf16 v[236:239], v[180:183], v[108:111], v[236:239]
    ds_read_b64_tr_b16 v[176:177], v250 offset:8192
    v_lshlrev_b32 v230, 16, v87
    v_mfma_f32_16x16x32_bf16 v[244:247], v[180:183], v[132:135], v[244:247]
    ds_read_b64_tr_b16 v[178:179], v250 offset:10240
    v_and_b32 v231, 0xffff0000, v87
    s_add_u32 s66, s72, 81920
    buffer_store_dwordx4 v[76:79], v251, s[36:39], s66 offen sc1
    s_waitcnt lgkmcnt(4)
    v_mfma_f32_16x16x32_bf16 v[236:239], v[184:187], v[112:115], v[236:239]
    ds_read_b64_tr_b16 v[180:181], v250 offset:12288
    v_cvt_pk_bf16_f32 v80, v232, v233
    v_mfma_f32_16x16x32_bf16 v[244:247], v[184:187], v[136:139], v[244:247]
    ds_read_b64_tr_b16 v[182:183], v250 offset:14336
    v_cvt_pk_bf16_f32 v81, v234, v235
    v_mfma_f32_16x16x32_bf16 v[236:239], v[188:191], v[116:119], v[236:239]
    ds_read_b64_tr_b16 v[184:185], v250 offset:16384
    v_cvt_pk_bf16_f32 v84, v240, v241
    v_mfma_f32_16x16x32_bf16 v[244:247], v[188:191], v[140:143], v[244:247]
    ds_read_b64_tr_b16 v[186:187], v250 offset:18432
    v_cvt_pk_bf16_f32 v85, v242, v243
    v_mfma_f32_16x16x32_bf16 v[216:219], v[168:171], v[96:99], v[216:219]
    ds_read_b64_tr_b16 v[188:189], v250 offset:20480
    v_lshlrev_b32 v232, 16, v88
    v_mfma_f32_16x16x32_bf16 v[224:227], v[168:171], v[120:123], v[224:227]
    ds_read_b64_tr_b16 v[190:191], v250 offset:22528
    v_and_b32 v233, 0xffff0000, v88
    s_waitcnt lgkmcnt(4)
    v_mfma_f32_16x16x32_bf16 v[216:219], v[172:175], v[100:103], v[216:219]
    v_xor_b32 v250, 32, v250
    ds_read_b64_tr_b16 v[168:169], v250
    v_lshlrev_b32 v234, 16, v89
    v_mfma_f32_16x16x32_bf16 v[224:227], v[172:175], v[124:127], v[224:227]
    ds_read_b64_tr_b16 v[170:171], v250 offset:2048
    v_and_b32 v235, 0xffff0000, v89
    v_mfma_f32_16x16x32_bf16 v[216:219], v[176:179], v[104:107], v[216:219]
    ds_read_b64_tr_b16 v[172:173], v250 offset:4096
    v_lshlrev_b32 v240, 16, v92
    v_mfma_f32_16x16x32_bf16 v[224:227], v[176:179], v[128:131], v[224:227]
    ds_read_b64_tr_b16 v[174:175], v250 offset:6144
    v_and_b32 v241, 0xffff0000, v92
    v_mfma_f32_16x16x32_bf16 v[216:219], v[180:183], v[108:111], v[216:219]
    ds_read_b64_tr_b16 v[176:177], v250 offset:8192
    v_lshlrev_b32 v242, 16, v93
    v_mfma_f32_16x16x32_bf16 v[224:227], v[180:183], v[132:135], v[224:227]
    ds_read_b64_tr_b16 v[178:179], v250 offset:10240
    v_and_b32 v243, 0xffff0000, v93
    s_waitcnt lgkmcnt(4)
    v_mfma_f32_16x16x32_bf16 v[216:219], v[184:187], v[112:115], v[216:219]
    ds_read_b64_tr_b16 v[180:181], v250 offset:12288
    v_cvt_pk_bf16_f32 v82, v236, v237
    v_mfma_f32_16x16x32_bf16 v[224:227], v[184:187], v[136:139], v[224:227]
    ds_read_b64_tr_b16 v[182:183], v250 offset:14336
    v_cvt_pk_bf16_f32 v83, v238, v239
    v_mfma_f32_16x16x32_bf16 v[216:219], v[188:191], v[116:119], v[216:219]
    ds_read_b64_tr_b16 v[184:185], v250 offset:16384
    v_cvt_pk_bf16_f32 v86, v244, v245
    v_mfma_f32_16x16x32_bf16 v[224:227], v[188:191], v[140:143], v[224:227]
    ds_read_b64_tr_b16 v[186:187], v250 offset:18432
    v_cvt_pk_bf16_f32 v87, v246, v247
    v_mfma_f32_16x16x32_bf16 v[220:223], v[168:171], v[96:99], v[220:223]
    ds_read_b64_tr_b16 v[188:189], v250 offset:20480
    v_lshlrev_b32 v236, 16, v90
    v_mfma_f32_16x16x32_bf16 v[228:231], v[168:171], v[120:123], v[228:231]
    ds_read_b64_tr_b16 v[190:191], v250 offset:22528
    v_and_b32 v237, 0xffff0000, v90
    s_add_u32 s66, s61, 90112
    buffer_store_dwordx4 v[80:83], v251, s[36:39], s66 offen sc1
    s_waitcnt lgkmcnt(4)
    v_mfma_f32_16x16x32_bf16 v[220:223], v[172:175], v[100:103], v[220:223]
    v_xor_b32 v250, 96, v250
    ds_read_b64_tr_b16 v[168:169], v250
    v_lshlrev_b32 v238, 16, v91
    v_mfma_f32_16x16x32_bf16 v[228:231], v[172:175], v[124:127], v[228:231]
    ds_read_b64_tr_b16 v[170:171], v250 offset:2048
    v_and_b32 v239, 0xffff0000, v91
    v_mfma_f32_16x16x32_bf16 v[220:223], v[176:179], v[104:107], v[220:223]
    ds_read_b64_tr_b16 v[172:173], v250 offset:4096
    v_lshlrev_b32 v244, 16, v94
    v_mfma_f32_16x16x32_bf16 v[228:231], v[176:179], v[128:131], v[228:231]
    ds_read_b64_tr_b16 v[174:175], v250 offset:6144
    v_and_b32 v245, 0xffff0000, v94
    v_mfma_f32_16x16x32_bf16 v[220:223], v[180:183], v[108:111], v[220:223]
    ds_read_b64_tr_b16 v[176:177], v250 offset:8192
    v_lshlrev_b32 v246, 16, v95
    v_mfma_f32_16x16x32_bf16 v[228:231], v[180:183], v[132:135], v[228:231]
    ds_read_b64_tr_b16 v[178:179], v250 offset:10240
    v_and_b32 v247, 0xffff0000, v95
    s_add_u32 s66, s72, 90112
    buffer_store_dwordx4 v[84:87], v251, s[36:39], s66 offen sc1
    s_waitcnt lgkmcnt(4)
    v_mfma_f32_16x16x32_bf16 v[220:223], v[184:187], v[112:115], v[220:223]
    ds_read_b64_tr_b16 v[180:181], v250 offset:12288
    v_cvt_pk_bf16_f32 v88, v216, v217
    v_mfma_f32_16x16x32_bf16 v[228:231], v[184:187], v[136:139], v[228:231]
    ds_read_b64_tr_b16 v[182:183], v250 offset:14336
    v_cvt_pk_bf16_f32 v89, v218, v219
    v_mfma_f32_16x16x32_bf16 v[220:223], v[188:191], v[116:119], v[220:223]
    ds_read_b64_tr_b16 v[184:185], v250 offset:16384
    v_cvt_pk_bf16_f32 v92, v224, v225
    v_mfma_f32_16x16x32_bf16 v[228:231], v[188:191], v[140:143], v[228:231]
    ds_read_b64_tr_b16 v[186:187], v250 offset:18432
    v_cvt_pk_bf16_f32 v93, v226, v227
    v_mfma_f32_16x16x32_bf16 v[232:235], v[168:171], v[96:99], v[232:235]
    ds_read_b64_tr_b16 v[188:189], v250 offset:20480
    v_lshlrev_b32 v216, 16, v144
    v_mfma_f32_16x16x32_bf16 v[240:243], v[168:171], v[120:123], v[240:243]
    ds_read_b64_tr_b16 v[190:191], v250 offset:22528
    v_and_b32 v217, 0xffff0000, v144
    s_waitcnt lgkmcnt(4)
    v_mfma_f32_16x16x32_bf16 v[232:235], v[172:175], v[100:103], v[232:235]
    v_xor_b32 v250, 32, v250
    ds_read_b64_tr_b16 v[168:169], v250
    v_lshlrev_b32 v218, 16, v145
    v_mfma_f32_16x16x32_bf16 v[240:243], v[172:175], v[124:127], v[240:243]
    ds_read_b64_tr_b16 v[170:171], v250 offset:2048
    v_and_b32 v219, 0xffff0000, v145
    v_mfma_f32_16x16x32_bf16 v[232:235], v[176:179], v[104:107], v[232:235]
    ds_read_b64_tr_b16 v[172:173], v250 offset:4096
    v_lshlrev_b32 v224, 16, v148
    v_mfma_f32_16x16x32_bf16 v[240:243], v[176:179], v[128:131], v[240:243]
    ds_read_b64_tr_b16 v[174:175], v250 offset:6144
    v_and_b32 v225, 0xffff0000, v148
    v_mfma_f32_16x16x32_bf16 v[232:235], v[180:183], v[108:111], v[232:235]
    ds_read_b64_tr_b16 v[176:177], v250 offset:8192
    v_lshlrev_b32 v226, 16, v149
    v_mfma_f32_16x16x32_bf16 v[240:243], v[180:183], v[132:135], v[240:243]
    ds_read_b64_tr_b16 v[178:179], v250 offset:10240
    v_and_b32 v227, 0xffff0000, v149
    s_waitcnt lgkmcnt(4)
    v_mfma_f32_16x16x32_bf16 v[232:235], v[184:187], v[112:115], v[232:235]
    ds_read_b64_tr_b16 v[180:181], v250 offset:12288
    v_cvt_pk_bf16_f32 v90, v220, v221
    v_mfma_f32_16x16x32_bf16 v[240:243], v[184:187], v[136:139], v[240:243]
    ds_read_b64_tr_b16 v[182:183], v250 offset:14336
    v_cvt_pk_bf16_f32 v91, v222, v223
    v_mfma_f32_16x16x32_bf16 v[232:235], v[188:191], v[116:119], v[232:235]
    ds_read_b64_tr_b16 v[184:185], v250 offset:16384
    v_cvt_pk_bf16_f32 v94, v228, v229
    v_mfma_f32_16x16x32_bf16 v[240:243], v[188:191], v[140:143], v[240:243]
    ds_read_b64_tr_b16 v[186:187], v250 offset:18432
    v_cvt_pk_bf16_f32 v95, v230, v231
    v_mfma_f32_16x16x32_bf16 v[236:239], v[168:171], v[96:99], v[236:239]
    ds_read_b64_tr_b16 v[188:189], v250 offset:20480
    v_lshlrev_b32 v220, 16, v146
    v_mfma_f32_16x16x32_bf16 v[244:247], v[168:171], v[120:123], v[244:247]
    ds_read_b64_tr_b16 v[190:191], v250 offset:22528
    v_and_b32 v221, 0xffff0000, v146
    s_add_u32 s66, s61, 98304
    buffer_store_dwordx4 v[88:91], v251, s[36:39], s66 offen sc1
    s_barrier
    s_waitcnt lgkmcnt(4)
    v_mfma_f32_16x16x32_bf16 v[236:239], v[172:175], v[100:103], v[236:239]
    v_add_u32 v250, 49152, v249
    ds_read_b64_tr_b16 v[168:169], v250
    v_lshlrev_b32 v222, 16, v147
    v_mfma_f32_16x16x32_bf16 v[244:247], v[172:175], v[124:127], v[244:247]
    ds_read_b64_tr_b16 v[170:171], v250 offset:2048
    v_and_b32 v223, 0xffff0000, v147
    v_mfma_f32_16x16x32_bf16 v[236:239], v[176:179], v[104:107], v[236:239]
    ds_read_b64_tr_b16 v[172:173], v250 offset:4096
    v_lshlrev_b32 v228, 16, v150
    v_mfma_f32_16x16x32_bf16 v[244:247], v[176:179], v[128:131], v[244:247]
    ds_read_b64_tr_b16 v[174:175], v250 offset:6144
    v_and_b32 v229, 0xffff0000, v150
    v_mfma_f32_16x16x32_bf16 v[236:239], v[180:183], v[108:111], v[236:239]
    ds_read_b64_tr_b16 v[176:177], v250 offset:8192
    v_lshlrev_b32 v230, 16, v151
    v_mfma_f32_16x16x32_bf16 v[244:247], v[180:183], v[132:135], v[244:247]
    ds_read_b64_tr_b16 v[178:179], v250 offset:10240
    v_and_b32 v231, 0xffff0000, v151
    s_add_u32 s66, s72, 98304
    buffer_store_dwordx4 v[92:95], v251, s[36:39], s66 offen sc1
    s_waitcnt lgkmcnt(4)
    v_mfma_f32_16x16x32_bf16 v[236:239], v[184:187], v[112:115], v[236:239]
    ds_read_b64_tr_b16 v[180:181], v250 offset:12288
    v_cvt_pk_bf16_f32 v144, v232, v233
    v_mfma_f32_16x16x32_bf16 v[244:247], v[184:187], v[136:139], v[244:247]
    ds_read_b64_tr_b16 v[182:183], v250 offset:14336
    v_cvt_pk_bf16_f32 v145, v234, v235
    v_mfma_f32_16x16x32_bf16 v[236:239], v[188:191], v[116:119], v[236:239]
    ds_read_b64_tr_b16 v[184:185], v250 offset:16384
    v_cvt_pk_bf16_f32 v148, v240, v241
    v_mfma_f32_16x16x32_bf16 v[244:247], v[188:191], v[140:143], v[244:247]
    ds_read_b64_tr_b16 v[186:187], v250 offset:18432
    v_cvt_pk_bf16_f32 v149, v242, v243
    v_mfma_f32_16x16x32_bf16 v[216:219], v[168:171], v[96:99], v[216:219]
    ds_read_b64_tr_b16 v[188:189], v250 offset:20480
    v_lshlrev_b32 v232, 16, v152
    v_mfma_f32_16x16x32_bf16 v[224:227], v[168:171], v[120:123], v[224:227]
    ds_read_b64_tr_b16 v[190:191], v250 offset:22528
    v_and_b32 v233, 0xffff0000, v152
    s_waitcnt lgkmcnt(4)
    v_mfma_f32_16x16x32_bf16 v[216:219], v[172:175], v[100:103], v[216:219]
    v_xor_b32 v250, 32, v250
    ds_read_b64_tr_b16 v[168:169], v250
    v_lshlrev_b32 v234, 16, v153
    v_mfma_f32_16x16x32_bf16 v[224:227], v[172:175], v[124:127], v[224:227]
    ds_read_b64_tr_b16 v[170:171], v250 offset:2048
    v_and_b32 v235, 0xffff0000, v153
    v_mfma_f32_16x16x32_bf16 v[216:219], v[176:179], v[104:107], v[216:219]
    ds_read_b64_tr_b16 v[172:173], v250 offset:4096
    v_lshlrev_b32 v240, 16, v156
    v_mfma_f32_16x16x32_bf16 v[224:227], v[176:179], v[128:131], v[224:227]
    ds_read_b64_tr_b16 v[174:175], v250 offset:6144
    v_and_b32 v241, 0xffff0000, v156
    v_mfma_f32_16x16x32_bf16 v[216:219], v[180:183], v[108:111], v[216:219]
    ds_read_b64_tr_b16 v[176:177], v250 offset:8192
    v_lshlrev_b32 v242, 16, v157
    v_mfma_f32_16x16x32_bf16 v[224:227], v[180:183], v[132:135], v[224:227]
    ds_read_b64_tr_b16 v[178:179], v250 offset:10240
    v_and_b32 v243, 0xffff0000, v157
    s_waitcnt lgkmcnt(4)
    v_mfma_f32_16x16x32_bf16 v[216:219], v[184:187], v[112:115], v[216:219]
    ds_read_b64_tr_b16 v[180:181], v250 offset:12288
    v_cvt_pk_bf16_f32 v146, v236, v237
    v_mfma_f32_16x16x32_bf16 v[224:227], v[184:187], v[136:139], v[224:227]
    ds_read_b64_tr_b16 v[182:183], v250 offset:14336
    v_cvt_pk_bf16_f32 v147, v238, v239
    v_mfma_f32_16x16x32_bf16 v[216:219], v[188:191], v[116:119], v[216:219]
    ds_read_b64_tr_b16 v[184:185], v250 offset:16384
    v_cvt_pk_bf16_f32 v150, v244, v245
    v_mfma_f32_16x16x32_bf16 v[224:227], v[188:191], v[140:143], v[224:227]
    ds_read_b64_tr_b16 v[186:187], v250 offset:18432
    v_cvt_pk_bf16_f32 v151, v246, v247
    v_mfma_f32_16x16x32_bf16 v[220:223], v[168:171], v[96:99], v[220:223]
    ds_read_b64_tr_b16 v[188:189], v250 offset:20480
    v_lshlrev_b32 v236, 16, v154
    v_mfma_f32_16x16x32_bf16 v[228:231], v[168:171], v[120:123], v[228:231]
    ds_read_b64_tr_b16 v[190:191], v250 offset:22528
    v_and_b32 v237, 0xffff0000, v154
    s_add_u32 s66, s61, 106496
    buffer_store_dwordx4 v[144:147], v251, s[36:39], s66 offen sc1
    s_waitcnt lgkmcnt(4)
    v_mfma_f32_16x16x32_bf16 v[220:223], v[172:175], v[100:103], v[220:223]
    v_xor_b32 v250, 96, v250
    ds_read_b64_tr_b16 v[168:169], v250
    v_lshlrev_b32 v238, 16, v155
    v_mfma_f32_16x16x32_bf16 v[228:231], v[172:175], v[124:127], v[228:231]
    ds_read_b64_tr_b16 v[170:171], v250 offset:2048
    v_and_b32 v239, 0xffff0000, v155
    v_mfma_f32_16x16x32_bf16 v[220:223], v[176:179], v[104:107], v[220:223]
    ds_read_b64_tr_b16 v[172:173], v250 offset:4096
    v_lshlrev_b32 v244, 16, v158
    v_mfma_f32_16x16x32_bf16 v[228:231], v[176:179], v[128:131], v[228:231]
    ds_read_b64_tr_b16 v[174:175], v250 offset:6144
    v_and_b32 v245, 0xffff0000, v158
    v_mfma_f32_16x16x32_bf16 v[220:223], v[180:183], v[108:111], v[220:223]
    ds_read_b64_tr_b16 v[176:177], v250 offset:8192
    v_lshlrev_b32 v246, 16, v159
    v_mfma_f32_16x16x32_bf16 v[228:231], v[180:183], v[132:135], v[228:231]
    ds_read_b64_tr_b16 v[178:179], v250 offset:10240
    v_and_b32 v247, 0xffff0000, v159
    s_add_u32 s66, s72, 106496
    buffer_store_dwordx4 v[148:151], v251, s[36:39], s66 offen sc1
    s_waitcnt lgkmcnt(4)
    v_mfma_f32_16x16x32_bf16 v[220:223], v[184:187], v[112:115], v[220:223]
    ds_read_b64_tr_b16 v[180:181], v250 offset:12288
    v_cvt_pk_bf16_f32 v152, v216, v217
    v_mfma_f32_16x16x32_bf16 v[228:231], v[184:187], v[136:139], v[228:231]
    ds_read_b64_tr_b16 v[182:183], v250 offset:14336
    v_cvt_pk_bf16_f32 v153, v218, v219
    v_mfma_f32_16x16x32_bf16 v[220:223], v[188:191], v[116:119], v[220:223]
    ds_read_b64_tr_b16 v[184:185], v250 offset:16384
    v_cvt_pk_bf16_f32 v156, v224, v225
    v_mfma_f32_16x16x32_bf16 v[228:231], v[188:191], v[140:143], v[228:231]
    ds_read_b64_tr_b16 v[186:187], v250 offset:18432
    v_cvt_pk_bf16_f32 v157, v226, v227
    v_mfma_f32_16x16x32_bf16 v[232:235], v[168:171], v[96:99], v[232:235]
    ds_read_b64_tr_b16 v[188:189], v250 offset:20480
    v_lshlrev_b32 v216, 16, v160
    v_mfma_f32_16x16x32_bf16 v[240:243], v[168:171], v[120:123], v[240:243]
    ds_read_b64_tr_b16 v[190:191], v250 offset:22528
    v_and_b32 v217, 0xffff0000, v160
    s_waitcnt lgkmcnt(4)
    v_mfma_f32_16x16x32_bf16 v[232:235], v[172:175], v[100:103], v[232:235]
    v_xor_b32 v250, 32, v250
    ds_read_b64_tr_b16 v[168:169], v250
    v_lshlrev_b32 v218, 16, v161
    v_mfma_f32_16x16x32_bf16 v[240:243], v[172:175], v[124:127], v[240:243]
    ds_read_b64_tr_b16 v[170:171], v250 offset:2048
    v_and_b32 v219, 0xffff0000, v161
    v_mfma_f32_16x16x32_bf16 v[232:235], v[176:179], v[104:107], v[232:235]
    ds_read_b64_tr_b16 v[172:173], v250 offset:4096
    v_lshlrev_b32 v224, 16, v164
    v_mfma_f32_16x16x32_bf16 v[240:243], v[176:179], v[128:131], v[240:243]
    ds_read_b64_tr_b16 v[174:175], v250 offset:6144
    v_and_b32 v225, 0xffff0000, v164
    v_mfma_f32_16x16x32_bf16 v[232:235], v[180:183], v[108:111], v[232:235]
    ds_read_b64_tr_b16 v[176:177], v250 offset:8192
    v_lshlrev_b32 v226, 16, v165
    v_mfma_f32_16x16x32_bf16 v[240:243], v[180:183], v[132:135], v[240:243]
    ds_read_b64_tr_b16 v[178:179], v250 offset:10240
    v_and_b32 v227, 0xffff0000, v165
    s_waitcnt lgkmcnt(4)
    v_mfma_f32_16x16x32_bf16 v[232:235], v[184:187], v[112:115], v[232:235]
    ds_read_b64_tr_b16 v[180:181], v250 offset:12288
    v_cvt_pk_bf16_f32 v154, v220, v221
    v_mfma_f32_16x16x32_bf16 v[240:243], v[184:187], v[136:139], v[240:243]
    ds_read_b64_tr_b16 v[182:183], v250 offset:14336
    v_cvt_pk_bf16_f32 v155, v222, v223
    v_mfma_f32_16x16x32_bf16 v[232:235], v[188:191], v[116:119], v[232:235]
    ds_read_b64_tr_b16 v[184:185], v250 offset:16384
    v_cvt_pk_bf16_f32 v158, v228, v229
    v_mfma_f32_16x16x32_bf16 v[240:243], v[188:191], v[140:143], v[240:243]
    ds_read_b64_tr_b16 v[186:187], v250 offset:18432
    v_cvt_pk_bf16_f32 v159, v230, v231
    v_mfma_f32_16x16x32_bf16 v[236:239], v[168:171], v[96:99], v[236:239]
    ds_read_b64_tr_b16 v[188:189], v250 offset:20480
    v_lshlrev_b32 v220, 16, v162
    v_mfma_f32_16x16x32_bf16 v[244:247], v[168:171], v[120:123], v[244:247]
    ds_read_b64_tr_b16 v[190:191], v250 offset:22528
    v_and_b32 v221, 0xffff0000, v162
    s_add_u32 s66, s61, 114688
    buffer_store_dwordx4 v[152:155], v251, s[36:39], s66 offen sc1
    s_waitcnt vmcnt(5)
    s_barrier
    s_waitcnt lgkmcnt(4)
    v_mfma_f32_16x16x32_bf16 v[236:239], v[172:175], v[100:103], v[236:239]
    v_add_u32 v250, 135168, v249
    ds_read_b64_tr_b16 v[168:169], v250
    v_lshlrev_b32 v222, 16, v163
    v_mfma_f32_16x16x32_bf16 v[244:247], v[172:175], v[124:127], v[244:247]
    ds_read_b64_tr_b16 v[170:171], v250 offset:2048
    v_and_b32 v223, 0xffff0000, v163
    v_mfma_f32_16x16x32_bf16 v[236:239], v[176:179], v[104:107], v[236:239]
    ds_read_b64_tr_b16 v[172:173], v250 offset:4096
    v_lshlrev_b32 v228, 16, v166
    v_mfma_f32_16x16x32_bf16 v[244:247], v[176:179], v[128:131], v[244:247]
    ds_read_b64_tr_b16 v[174:175], v250 offset:6144
    v_and_b32 v229, 0xffff0000, v166
    v_mfma_f32_16x16x32_bf16 v[236:239], v[180:183], v[108:111], v[236:239]
    ds_read_b64_tr_b16 v[176:177], v250 offset:8192
    v_lshlrev_b32 v230, 16, v167
    v_mfma_f32_16x16x32_bf16 v[244:247], v[180:183], v[132:135], v[244:247]
    ds_read_b64_tr_b16 v[178:179], v250 offset:10240
    v_and_b32 v231, 0xffff0000, v167
    s_add_u32 s66, s72, 114688
    buffer_store_dwordx4 v[156:159], v251, s[36:39], s66 offen sc1
    s_waitcnt lgkmcnt(4)
    v_mfma_f32_16x16x32_bf16 v[236:239], v[184:187], v[112:115], v[236:239]
    ds_read_b64_tr_b16 v[180:181], v250 offset:12288
    v_cvt_pk_bf16_f32 v160, v232, v233
    v_mfma_f32_16x16x32_bf16 v[244:247], v[184:187], v[136:139], v[244:247]
    ds_read_b64_tr_b16 v[182:183], v250 offset:14336
    v_cvt_pk_bf16_f32 v161, v234, v235
    v_mfma_f32_16x16x32_bf16 v[236:239], v[188:191], v[116:119], v[236:239]
    ds_read_b64_tr_b16 v[184:185], v250 offset:16384
    v_cvt_pk_bf16_f32 v164, v240, v241
    v_mfma_f32_16x16x32_bf16 v[244:247], v[188:191], v[140:143], v[244:247]
    ds_read_b64_tr_b16 v[186:187], v250 offset:18432
    v_cvt_pk_bf16_f32 v165, v242, v243
    v_mfma_f32_16x16x32_bf16 v[216:219], v[168:171], v[96:99], v[216:219]
    ds_read_b64_tr_b16 v[188:189], v250 offset:20480
    v_lshlrev_b32 v232, 16, v192
    v_mfma_f32_16x16x32_bf16 v[224:227], v[168:171], v[120:123], v[224:227]
    ds_read_b64_tr_b16 v[190:191], v250 offset:22528
    v_and_b32 v233, 0xffff0000, v192
    s_waitcnt lgkmcnt(4)
    v_mfma_f32_16x16x32_bf16 v[216:219], v[172:175], v[100:103], v[216:219]
    v_xor_b32 v250, 32, v250
    ds_read_b64_tr_b16 v[168:169], v250
    v_lshlrev_b32 v234, 16, v193
    v_mfma_f32_16x16x32_bf16 v[224:227], v[172:175], v[124:127], v[224:227]
    ds_read_b64_tr_b16 v[170:171], v250 offset:2048
    v_and_b32 v235, 0xffff0000, v193
    v_mfma_f32_16x16x32_bf16 v[216:219], v[176:179], v[104:107], v[216:219]
    ds_read_b64_tr_b16 v[172:173], v250 offset:4096
    v_lshlrev_b32 v240, 16, v196
    v_mfma_f32_16x16x32_bf16 v[224:227], v[176:179], v[128:131], v[224:227]
    ds_read_b64_tr_b16 v[174:175], v250 offset:6144
    v_and_b32 v241, 0xffff0000, v196
    v_mfma_f32_16x16x32_bf16 v[216:219], v[180:183], v[108:111], v[216:219]
    ds_read_b64_tr_b16 v[176:177], v250 offset:8192
    v_lshlrev_b32 v242, 16, v197
    v_mfma_f32_16x16x32_bf16 v[224:227], v[180:183], v[132:135], v[224:227]
    ds_read_b64_tr_b16 v[178:179], v250 offset:10240
    v_and_b32 v243, 0xffff0000, v197
    s_waitcnt lgkmcnt(4)
    v_mfma_f32_16x16x32_bf16 v[216:219], v[184:187], v[112:115], v[216:219]
    ds_read_b64_tr_b16 v[180:181], v250 offset:12288
    v_cvt_pk_bf16_f32 v162, v236, v237
    v_mfma_f32_16x16x32_bf16 v[224:227], v[184:187], v[136:139], v[224:227]
    ds_read_b64_tr_b16 v[182:183], v250 offset:14336
    v_cvt_pk_bf16_f32 v163, v238, v239
    v_mfma_f32_16x16x32_bf16 v[216:219], v[188:191], v[116:119], v[216:219]
    ds_read_b64_tr_b16 v[184:185], v250 offset:16384
    v_cvt_pk_bf16_f32 v166, v244, v245
    v_mfma_f32_16x16x32_bf16 v[224:227], v[188:191], v[140:143], v[224:227]
    ds_read_b64_tr_b16 v[186:187], v250 offset:18432
    v_cvt_pk_bf16_f32 v167, v246, v247
    v_mfma_f32_16x16x32_bf16 v[220:223], v[168:171], v[96:99], v[220:223]
    ds_read_b64_tr_b16 v[188:189], v250 offset:20480
    v_lshlrev_b32 v236, 16, v194
    v_mfma_f32_16x16x32_bf16 v[228:231], v[168:171], v[120:123], v[228:231]
    ds_read_b64_tr_b16 v[190:191], v250 offset:22528
    v_and_b32 v237, 0xffff0000, v194
    s_add_u32 s66, s61, 122880
    buffer_store_dwordx4 v[160:163], v251, s[36:39], s66 offen sc1
    s_waitcnt lgkmcnt(4)
    v_mfma_f32_16x16x32_bf16 v[220:223], v[172:175], v[100:103], v[220:223]
    v_xor_b32 v250, 96, v250
    ds_read_b64_tr_b16 v[168:169], v250
    v_lshlrev_b32 v238, 16, v195
    v_mfma_f32_16x16x32_bf16 v[228:231], v[172:175], v[124:127], v[228:231]
    ds_read_b64_tr_b16 v[170:171], v250 offset:2048
    v_and_b32 v239, 0xffff0000, v195
    v_mfma_f32_16x16x32_bf16 v[220:223], v[176:179], v[104:107], v[220:223]
    ds_read_b64_tr_b16 v[172:173], v250 offset:4096
    v_lshlrev_b32 v244, 16, v198
    v_mfma_f32_16x16x32_bf16 v[228:231], v[176:179], v[128:131], v[228:231]
    ds_read_b64_tr_b16 v[174:175], v250 offset:6144
    v_and_b32 v245, 0xffff0000, v198
    v_mfma_f32_16x16x32_bf16 v[220:223], v[180:183], v[108:111], v[220:223]
    ds_read_b64_tr_b16 v[176:177], v250 offset:8192
    v_lshlrev_b32 v246, 16, v199
    v_mfma_f32_16x16x32_bf16 v[228:231], v[180:183], v[132:135], v[228:231]
    ds_read_b64_tr_b16 v[178:179], v250 offset:10240
    v_and_b32 v247, 0xffff0000, v199
    s_add_u32 s66, s72, 122880
    buffer_store_dwordx4 v[164:167], v251, s[36:39], s66 offen sc1
    s_waitcnt lgkmcnt(4)
    v_mfma_f32_16x16x32_bf16 v[220:223], v[184:187], v[112:115], v[220:223]
    ds_read_b64_tr_b16 v[180:181], v250 offset:12288
    v_cvt_pk_bf16_f32 v192, v216, v217
    v_mfma_f32_16x16x32_bf16 v[228:231], v[184:187], v[136:139], v[228:231]
    ds_read_b64_tr_b16 v[182:183], v250 offset:14336
    v_cvt_pk_bf16_f32 v193, v218, v219
    v_mfma_f32_16x16x32_bf16 v[220:223], v[188:191], v[116:119], v[220:223]
    ds_read_b64_tr_b16 v[184:185], v250 offset:16384
    v_cvt_pk_bf16_f32 v196, v224, v225
    v_mfma_f32_16x16x32_bf16 v[228:231], v[188:191], v[140:143], v[228:231]
    ds_read_b64_tr_b16 v[186:187], v250 offset:18432
    v_cvt_pk_bf16_f32 v197, v226, v227
    v_mfma_f32_16x16x32_bf16 v[232:235], v[168:171], v[96:99], v[232:235]
    ds_read_b64_tr_b16 v[188:189], v250 offset:20480
    v_lshlrev_b32 v216, 16, v200
    v_mfma_f32_16x16x32_bf16 v[240:243], v[168:171], v[120:123], v[240:243]
    ds_read_b64_tr_b16 v[190:191], v250 offset:22528
    v_and_b32 v217, 0xffff0000, v200
    s_waitcnt lgkmcnt(4)
    v_mfma_f32_16x16x32_bf16 v[232:235], v[172:175], v[100:103], v[232:235]
    v_xor_b32 v250, 32, v250
    ds_read_b64_tr_b16 v[168:169], v250
    v_lshlrev_b32 v218, 16, v201
    v_mfma_f32_16x16x32_bf16 v[240:243], v[172:175], v[124:127], v[240:243]
    ds_read_b64_tr_b16 v[170:171], v250 offset:2048
    v_and_b32 v219, 0xffff0000, v201
    v_mfma_f32_16x16x32_bf16 v[232:235], v[176:179], v[104:107], v[232:235]
    ds_read_b64_tr_b16 v[172:173], v250 offset:4096
    v_lshlrev_b32 v224, 16, v204
    v_mfma_f32_16x16x32_bf16 v[240:243], v[176:179], v[128:131], v[240:243]
    ds_read_b64_tr_b16 v[174:175], v250 offset:6144
    v_and_b32 v225, 0xffff0000, v204
    v_mfma_f32_16x16x32_bf16 v[232:235], v[180:183], v[108:111], v[232:235]
    ds_read_b64_tr_b16 v[176:177], v250 offset:8192
    v_lshlrev_b32 v226, 16, v205
    v_mfma_f32_16x16x32_bf16 v[240:243], v[180:183], v[132:135], v[240:243]
    ds_read_b64_tr_b16 v[178:179], v250 offset:10240
    v_and_b32 v227, 0xffff0000, v205
    s_waitcnt lgkmcnt(4)
    v_mfma_f32_16x16x32_bf16 v[232:235], v[184:187], v[112:115], v[232:235]
    ds_read_b64_tr_b16 v[180:181], v250 offset:12288
    v_cvt_pk_bf16_f32 v194, v220, v221
    v_mfma_f32_16x16x32_bf16 v[240:243], v[184:187], v[136:139], v[240:243]
    ds_read_b64_tr_b16 v[182:183], v250 offset:14336
    v_cvt_pk_bf16_f32 v195, v222, v223
    v_mfma_f32_16x16x32_bf16 v[232:235], v[188:191], v[116:119], v[232:235]
    ds_read_b64_tr_b16 v[184:185], v250 offset:16384
    v_cvt_pk_bf16_f32 v198, v228, v229
    v_mfma_f32_16x16x32_bf16 v[240:243], v[188:191], v[140:143], v[240:243]
    ds_read_b64_tr_b16 v[186:187], v250 offset:18432
    v_cvt_pk_bf16_f32 v199, v230, v231
    v_mfma_f32_16x16x32_bf16 v[236:239], v[168:171], v[96:99], v[236:239]
    ds_read_b64_tr_b16 v[188:189], v250 offset:20480
    v_lshlrev_b32 v220, 16, v202
    v_mfma_f32_16x16x32_bf16 v[244:247], v[168:171], v[120:123], v[244:247]
    ds_read_b64_tr_b16 v[190:191], v250 offset:22528
    v_and_b32 v221, 0xffff0000, v202
    s_add_u32 s66, s61, 131072
    buffer_store_dwordx4 v[192:195], v251, s[36:39], s66 offen sc1
    s_waitcnt lgkmcnt(4)
    v_mfma_f32_16x16x32_bf16 v[236:239], v[172:175], v[100:103], v[236:239]
    v_add_u32 v250, 86016, v249
    ds_read_b64_tr_b16 v[168:169], v250
    v_lshlrev_b32 v222, 16, v203
    v_mfma_f32_16x16x32_bf16 v[244:247], v[172:175], v[124:127], v[244:247]
    ds_read_b64_tr_b16 v[170:171], v250 offset:2048
    v_and_b32 v223, 0xffff0000, v203
    v_mfma_f32_16x16x32_bf16 v[236:239], v[176:179], v[104:107], v[236:239]
    ds_read_b64_tr_b16 v[172:173], v250 offset:4096
    v_lshlrev_b32 v228, 16, v206
    v_mfma_f32_16x16x32_bf16 v[244:247], v[176:179], v[128:131], v[244:247]
    ds_read_b64_tr_b16 v[174:175], v250 offset:6144
    v_and_b32 v229, 0xffff0000, v206
    v_mfma_f32_16x16x32_bf16 v[236:239], v[180:183], v[108:111], v[236:239]
    ds_read_b64_tr_b16 v[176:177], v250 offset:8192
    v_lshlrev_b32 v230, 16, v207
    v_mfma_f32_16x16x32_bf16 v[244:247], v[180:183], v[132:135], v[244:247]
    ds_read_b64_tr_b16 v[178:179], v250 offset:10240
    v_and_b32 v231, 0xffff0000, v207
    s_add_u32 s66, s72, 131072
    buffer_store_dwordx4 v[196:199], v251, s[36:39], s66 offen sc1
    s_waitcnt lgkmcnt(4)
    v_mfma_f32_16x16x32_bf16 v[236:239], v[184:187], v[112:115], v[236:239]
    ds_read_b64_tr_b16 v[180:181], v250 offset:12288
    v_cvt_pk_bf16_f32 v200, v232, v233
    v_mfma_f32_16x16x32_bf16 v[244:247], v[184:187], v[136:139], v[244:247]
    ds_read_b64_tr_b16 v[182:183], v250 offset:14336
    v_cvt_pk_bf16_f32 v201, v234, v235
    v_mfma_f32_16x16x32_bf16 v[236:239], v[188:191], v[116:119], v[236:239]
    ds_read_b64_tr_b16 v[184:185], v250 offset:16384
    v_cvt_pk_bf16_f32 v204, v240, v241
    v_mfma_f32_16x16x32_bf16 v[244:247], v[188:191], v[140:143], v[244:247]
    ds_read_b64_tr_b16 v[186:187], v250 offset:18432
    v_cvt_pk_bf16_f32 v205, v242, v243
    v_mfma_f32_16x16x32_bf16 v[216:219], v[168:171], v[96:99], v[216:219]
    ds_read_b64_tr_b16 v[188:189], v250 offset:20480
    v_lshlrev_b32 v232, 16, v208
    v_mfma_f32_16x16x32_bf16 v[224:227], v[168:171], v[120:123], v[224:227]
    ds_read_b64_tr_b16 v[190:191], v250 offset:22528
    v_and_b32 v233, 0xffff0000, v208
    s_waitcnt lgkmcnt(4)
    v_mfma_f32_16x16x32_bf16 v[216:219], v[172:175], v[100:103], v[216:219]
    v_xor_b32 v250, 32, v250
    ds_read_b64_tr_b16 v[168:169], v250
    v_lshlrev_b32 v234, 16, v209
    v_mfma_f32_16x16x32_bf16 v[224:227], v[172:175], v[124:127], v[224:227]
    ds_read_b64_tr_b16 v[170:171], v250 offset:2048
    v_and_b32 v235, 0xffff0000, v209
    v_mfma_f32_16x16x32_bf16 v[216:219], v[176:179], v[104:107], v[216:219]
    ds_read_b64_tr_b16 v[172:173], v250 offset:4096
    v_lshlrev_b32 v240, 16, v212
    v_mfma_f32_16x16x32_bf16 v[224:227], v[176:179], v[128:131], v[224:227]
    ds_read_b64_tr_b16 v[174:175], v250 offset:6144
    v_and_b32 v241, 0xffff0000, v212
    v_mfma_f32_16x16x32_bf16 v[216:219], v[180:183], v[108:111], v[216:219]
    ds_read_b64_tr_b16 v[176:177], v250 offset:8192
    v_lshlrev_b32 v242, 16, v213
    v_mfma_f32_16x16x32_bf16 v[224:227], v[180:183], v[132:135], v[224:227]
    ds_read_b64_tr_b16 v[178:179], v250 offset:10240
    v_and_b32 v243, 0xffff0000, v213
    s_waitcnt lgkmcnt(4)
    v_mfma_f32_16x16x32_bf16 v[216:219], v[184:187], v[112:115], v[216:219]
    ds_read_b64_tr_b16 v[180:181], v250 offset:12288
    v_cvt_pk_bf16_f32 v202, v236, v237
    v_mfma_f32_16x16x32_bf16 v[224:227], v[184:187], v[136:139], v[224:227]
    ds_read_b64_tr_b16 v[182:183], v250 offset:14336
    v_cvt_pk_bf16_f32 v203, v238, v239
    v_mfma_f32_16x16x32_bf16 v[216:219], v[188:191], v[116:119], v[216:219]
    ds_read_b64_tr_b16 v[184:185], v250 offset:16384
    v_cvt_pk_bf16_f32 v206, v244, v245
    v_mfma_f32_16x16x32_bf16 v[224:227], v[188:191], v[140:143], v[224:227]
    ds_read_b64_tr_b16 v[186:187], v250 offset:18432
    v_cvt_pk_bf16_f32 v207, v246, v247
    v_mfma_f32_16x16x32_bf16 v[220:223], v[168:171], v[96:99], v[220:223]
    ds_read_b64_tr_b16 v[188:189], v250 offset:20480
    v_lshlrev_b32 v236, 16, v210
    v_mfma_f32_16x16x32_bf16 v[228:231], v[168:171], v[120:123], v[228:231]
    ds_read_b64_tr_b16 v[190:191], v250 offset:22528
    v_and_b32 v237, 0xffff0000, v210
    s_add_u32 s66, s61, 139264
    buffer_store_dwordx4 v[200:203], v251, s[36:39], s66 offen sc1
    s_waitcnt lgkmcnt(4)
    v_mfma_f32_16x16x32_bf16 v[220:223], v[172:175], v[100:103], v[220:223]
    v_xor_b32 v250, 96, v250
    ds_read_b64_tr_b16 v[168:169], v250
    v_lshlrev_b32 v238, 16, v211
    v_mfma_f32_16x16x32_bf16 v[228:231], v[172:175], v[124:127], v[228:231]
    ds_read_b64_tr_b16 v[170:171], v250 offset:2048
    v_and_b32 v239, 0xffff0000, v211
    v_mfma_f32_16x16x32_bf16 v[220:223], v[176:179], v[104:107], v[220:223]
    ds_read_b64_tr_b16 v[172:173], v250 offset:4096
    v_lshlrev_b32 v244, 16, v214
    v_mfma_f32_16x16x32_bf16 v[228:231], v[176:179], v[128:131], v[228:231]
    ds_read_b64_tr_b16 v[174:175], v250 offset:6144
    v_and_b32 v245, 0xffff0000, v214
    v_mfma_f32_16x16x32_bf16 v[220:223], v[180:183], v[108:111], v[220:223]
    ds_read_b64_tr_b16 v[176:177], v250 offset:8192
    v_lshlrev_b32 v246, 16, v215
    v_mfma_f32_16x16x32_bf16 v[228:231], v[180:183], v[132:135], v[228:231]
    ds_read_b64_tr_b16 v[178:179], v250 offset:10240
    v_and_b32 v247, 0xffff0000, v215
    s_add_u32 s66, s72, 139264
    buffer_store_dwordx4 v[204:207], v251, s[36:39], s66 offen sc1
    s_waitcnt lgkmcnt(4)
    v_mfma_f32_16x16x32_bf16 v[220:223], v[184:187], v[112:115], v[220:223]
    ds_read_b64_tr_b16 v[180:181], v250 offset:12288
    v_cvt_pk_bf16_f32 v208, v216, v217
    v_mfma_f32_16x16x32_bf16 v[228:231], v[184:187], v[136:139], v[228:231]
    ds_read_b64_tr_b16 v[182:183], v250 offset:14336
    v_cvt_pk_bf16_f32 v209, v218, v219
    v_mfma_f32_16x16x32_bf16 v[220:223], v[188:191], v[116:119], v[220:223]
    ds_read_b64_tr_b16 v[184:185], v250 offset:16384
    v_cvt_pk_bf16_f32 v212, v224, v225
    v_mfma_f32_16x16x32_bf16 v[228:231], v[188:191], v[140:143], v[228:231]
    ds_read_b64_tr_b16 v[186:187], v250 offset:18432
    v_cvt_pk_bf16_f32 v213, v226, v227
    v_mfma_f32_16x16x32_bf16 v[232:235], v[168:171], v[96:99], v[232:235]
    ds_read_b64_tr_b16 v[188:189], v250 offset:20480
    v_mfma_f32_16x16x32_bf16 v[240:243], v[168:171], v[120:123], v[240:243]
    ds_read_b64_tr_b16 v[190:191], v250 offset:22528
    s_waitcnt lgkmcnt(4)
    v_mfma_f32_16x16x32_bf16 v[232:235], v[172:175], v[100:103], v[232:235]
    v_xor_b32 v250, 32, v250
    ds_read_b64_tr_b16 v[168:169], v250
    v_mfma_f32_16x16x32_bf16 v[240:243], v[172:175], v[124:127], v[240:243]
    ds_read_b64_tr_b16 v[170:171], v250 offset:2048
    v_mfma_f32_16x16x32_bf16 v[232:235], v[176:179], v[104:107], v[232:235]
    ds_read_b64_tr_b16 v[172:173], v250 offset:4096
    v_mfma_f32_16x16x32_bf16 v[240:243], v[176:179], v[128:131], v[240:243]
    ds_read_b64_tr_b16 v[174:175], v250 offset:6144
    v_mfma_f32_16x16x32_bf16 v[232:235], v[180:183], v[108:111], v[232:235]
    ds_read_b64_tr_b16 v[176:177], v250 offset:8192
    v_mfma_f32_16x16x32_bf16 v[240:243], v[180:183], v[132:135], v[240:243]
    ds_read_b64_tr_b16 v[178:179], v250 offset:10240
    s_waitcnt lgkmcnt(4)
    v_mfma_f32_16x16x32_bf16 v[232:235], v[184:187], v[112:115], v[232:235]
    ds_read_b64_tr_b16 v[180:181], v250 offset:12288
    v_cvt_pk_bf16_f32 v210, v220, v221
    v_mfma_f32_16x16x32_bf16 v[240:243], v[184:187], v[136:139], v[240:243]
    ds_read_b64_tr_b16 v[182:183], v250 offset:14336
    v_cvt_pk_bf16_f32 v211, v222, v223
    v_mfma_f32_16x16x32_bf16 v[232:235], v[188:191], v[116:119], v[232:235]
    ds_read_b64_tr_b16 v[184:185], v250 offset:16384
    v_cvt_pk_bf16_f32 v214, v228, v229
    v_mfma_f32_16x16x32_bf16 v[240:243], v[188:191], v[140:143], v[240:243]
    ds_read_b64_tr_b16 v[186:187], v250 offset:18432
    v_cvt_pk_bf16_f32 v215, v230, v231
    v_mfma_f32_16x16x32_bf16 v[236:239], v[168:171], v[96:99], v[236:239]
    ds_read_b64_tr_b16 v[188:189], v250 offset:20480
    v_mfma_f32_16x16x32_bf16 v[244:247], v[168:171], v[120:123], v[244:247]
    ds_read_b64_tr_b16 v[190:191], v250 offset:22528
    s_add_u32 s66, s61, 147456
    buffer_store_dwordx4 v[208:211], v251, s[36:39], s66 offen sc1
    s_waitcnt lgkmcnt(4)
    v_mfma_f32_16x16x32_bf16 v[236:239], v[172:175], v[100:103], v[236:239]
    v_mfma_f32_16x16x32_bf16 v[244:247], v[172:175], v[124:127], v[244:247]
    v_mfma_f32_16x16x32_bf16 v[236:239], v[176:179], v[104:107], v[236:239]
    v_mfma_f32_16x16x32_bf16 v[244:247], v[176:179], v[128:131], v[244:247]
    v_mfma_f32_16x16x32_bf16 v[236:239], v[180:183], v[108:111], v[236:239]
    v_mfma_f32_16x16x32_bf16 v[244:247], v[180:183], v[132:135], v[244:247]
    s_add_u32 s66, s72, 147456
    buffer_store_dwordx4 v[212:215], v251, s[36:39], s66 offen sc1
    s_waitcnt lgkmcnt(0)
    v_mfma_f32_16x16x32_bf16 v[236:239], v[184:187], v[112:115], v[236:239]
    v_cvt_pk_bf16_f32 v232, v232, v233
    v_mfma_f32_16x16x32_bf16 v[244:247], v[184:187], v[136:139], v[244:247]
    v_cvt_pk_bf16_f32 v233, v234, v235
    v_mfma_f32_16x16x32_bf16 v[236:239], v[188:191], v[116:119], v[236:239]
    v_cvt_pk_bf16_f32 v240, v240, v241
    v_mfma_f32_16x16x32_bf16 v[244:247], v[188:191], v[140:143], v[244:247]
    v_cvt_pk_bf16_f32 v241, v242, v243
    s_nop 7
    v_cvt_pk_bf16_f32 v234, v236, v237
    v_cvt_pk_bf16_f32 v235, v238, v239
    v_cvt_pk_bf16_f32 v242, v244, v245
    v_cvt_pk_bf16_f32 v243, v246, v247
    s_add_u32 s66, s61, 155648
    buffer_store_dwordx4 v[232:235], v251, s[36:39], s66 offen sc1
    s_add_u32 s66, s72, 155648
    buffer_store_dwordx4 v[240:243], v251, s[36:39], s66 offen sc1
    s_branch L_fin
L_g2tail:
    v_add_u32 v225, s52, v224
    v_xor_b32 v226, 32, v225
    v_xor_b32 v227, 64, v225
    v_xor_b32 v228, 96, v225
    v_add_u32 v250, s62, v251
    s_waitcnt lgkmcnt(0)
    s_barrier
    ds_read_b64_tr_b16 v[168:169], v225
    ds_read_b64_tr_b16 v[170:171], v225 offset:1536
    ds_read_b64_tr_b16 v[172:173], v226
    ds_read_b64_tr_b16 v[174:175], v226 offset:1536
    v_mfma_f32_16x16x32_bf16 v[36:39], v[180:183], v[160:163], v[36:39]
    ds_read_b64_tr_b16 v[176:177], v227
    v_exp_f32 v237, v237
    v_mfma_f32_16x16x32_bf16 v[84:87], v[180:183], v[164:167], v[84:87]
    ds_read_b64_tr_b16 v[178:179], v227 offset:1536
    v_exp_f32 v238, v238
    v_mfma_f32_16x16x32_bf16 v[40:43], v[184:187], v[160:163], v[40:43]
    ds_read_b64_tr_b16 v[180:181], v228
    v_exp_f32 v239, v239
    v_mfma_f32_16x16x32_bf16 v[88:91], v[184:187], v[164:167], v[88:91]
    ds_read_b64_tr_b16 v[182:183], v228 offset:1536
    v_exp_f32 v240, v240
    v_mfma_f32_16x16x32_bf16 v[44:47], v[188:191], v[160:163], v[44:47]
    ds_read_b64_tr_b16 v[184:185], v225 offset:128
    v_mfma_f32_16x16x32_bf16 v[92:95], v[188:191], v[164:167], v[92:95]
    ds_read_b64_tr_b16 v[186:187], v225 offset:1664
    v_exp_f32 v241, v241
    v_exp_f32 v242, v242
    v_exp_f32 v243, v243
    v_exp_f32 v244, v244
    v_exp_f32 v245, v245
    v_exp_f32 v246, v246
    v_exp_f32 v247, v247
    v_cvt_pk_bf16_f32 v160, v232, v233
    v_cvt_pk_bf16_f32 v161, v234, v235
    v_cvt_pk_bf16_f32 v162, v236, v237
    v_cvt_pk_bf16_f32 v163, v238, v239
    v_cvt_pk_bf16_f32 v164, v240, v241
    v_cvt_pk_bf16_f32 v165, v242, v243
    v_cvt_pk_bf16_f32 v166, v244, v245
    v_cvt_pk_bf16_f32 v167, v246, v247
    s_cmp_lg_u32 s58, 0
    s_cbranch_scc1 L_resc_e1
L_rret_e1:
    s_nop 0
    v_mfma_f32_16x16x32_bf16 v[216:219], v[200:203], v[160:163], v[216:219]
    v_mfma_f32_16x16x32_bf16 v[220:223], v[200:203], v[164:167], v[220:223]
    s_waitcnt lgkmcnt(6)
    v_mfma_f32_16x16x32_bf16 v[0:3], v[168:171], v[160:163], v[0:3]
    ds_read_b64_tr_b16 v[188:189], v226 offset:128
    v_mfma_f32_16x16x32_bf16 v[48:51], v[168:171], v[164:167], v[48:51]
    ds_read_b64_tr_b16 v[190:191], v226 offset:1664
    v_mfma_f32_16x16x32_bf16 v[4:7], v[172:175], v[160:163], v[4:7]
    ds_read_b64_tr_b16 v[168:169], v227 offset:128
    v_mfma_f32_16x16x32_bf16 v[52:55], v[172:175], v[164:167], v[52:55]
    ds_read_b64_tr_b16 v[170:171], v227 offset:1664
    s_waitcnt lgkmcnt(6)
    v_mfma_f32_16x16x32_bf16 v[8:11], v[176:179], v[160:163], v[8:11]
    ds_read_b64_tr_b16 v[172:173], v228 offset:128
    v_mfma_f32_16x16x32_bf16 v[56:59], v[176:179], v[164:167], v[56:59]
    ds_read_b64_tr_b16 v[174:175], v228 offset:1664
    v_mfma_f32_16x16x32_bf16 v[12:15], v[180:183], v[160:163], v[12:15]
    ds_read_b64_tr_b16 v[176:177], v225 offset:256
    v_rcp_f32 v230, v216
    v_mfma_f32_16x16x32_bf16 v[60:63], v[180:183], v[164:167], v[60:63]
    ds_read_b64_tr_b16 v[178:179], v225 offset:1792
    v_rcp_f32 v231, v220
    s_waitcnt lgkmcnt(6)
    v_mfma_f32_16x16x32_bf16 v[16:19], v[184:187], v[160:163], v[16:19]
    ds_read_b64_tr_b16 v[180:181], v226 offset:256
    v_mul_f32 v0, v0, v230
    v_mul_f32 v1, v1, v230
    v_mul_f32 v2, v2, v230
    v_mul_f32 v3, v3, v230
    v_mul_f32 v4, v4, v230
    v_mul_f32 v5, v5, v230
    v_mul_f32 v6, v6, v230
    v_mul_f32 v7, v7, v230
    v_mfma_f32_16x16x32_bf16 v[64:67], v[184:187], v[164:167], v[64:67]
    ds_read_b64_tr_b16 v[182:183], v226 offset:1792
    v_mul_f32 v48, v48, v231
    v_mul_f32 v49, v49, v231
    v_mul_f32 v50, v50, v231
    v_mul_f32 v51, v51, v231
    v_mul_f32 v52, v52, v231
    v_mul_f32 v53, v53, v231
    v_mul_f32 v54, v54, v231
    v_mul_f32 v55, v55, v231
    v_mfma_f32_16x16x32_bf16 v[20:23], v[188:191], v[160:163], v[20:23]
    ds_read_b64_tr_b16 v[184:185], v227 offset:256
    v_mfma_f32_16x16x32_bf16 v[68:71], v[188:191], v[164:167], v[68:71]
    ds_read_b64_tr_b16 v[186:187], v227 offset:1792
    v_cvt_pk_bf16_f32 v96, v0, v1
    v_cvt_pk_bf16_f32 v97, v2, v3
    v_cvt_pk_bf16_f32 v98, v4, v5
    v_cvt_pk_bf16_f32 v99, v6, v7
    ds_write_b128 v250, v[96:99]
    v_cvt_pk_bf16_f32 v120, v48, v49
    v_cvt_pk_bf16_f32 v121, v50, v51
    v_cvt_pk_bf16_f32 v122, v52, v53
    v_cvt_pk_bf16_f32 v123, v54, v55
    ds_write_b128 v250, v[120:123] offset:6144
    s_waitcnt lgkmcnt(8)
    v_mfma_f32_16x16x32_bf16 v[24:27], v[168:171], v[160:163], v[24:27]
    ds_read_b64_tr_b16 v[188:189], v228 offset:256
    v_mul_f32 v8, v8, v230
    v_mul_f32 v9, v9, v230
    v_mul_f32 v10, v10, v230
    v_mul_f32 v11, v11, v230
    v_mul_f32 v12, v12, v230
    v_mul_f32 v13, v13, v230
    v_mul_f32 v14, v14, v230
    v_mul_f32 v15, v15, v230
    v_mfma_f32_16x16x32_bf16 v[72:75], v[168:171], v[164:167], v[72:75]
    ds_read_b64_tr_b16 v[190:191], v228 offset:1792
    v_mul_f32 v56, v56, v231
    v_mul_f32 v57, v57, v231
    v_mul_f32 v58, v58, v231
    v_mul_f32 v59, v59, v231
    v_mul_f32 v60, v60, v231
    v_mul_f32 v61, v61, v231
    v_mul_f32 v62, v62, v231
    v_mul_f32 v63, v63, v231
    v_mfma_f32_16x16x32_bf16 v[28:31], v[172:175], v[160:163], v[28:31]
    v_mfma_f32_16x16x32_bf16 v[76:79], v[172:175], v[164:167], v[76:79]
    v_cvt_pk_bf16_f32 v100, v8, v9
    v_cvt_pk_bf16_f32 v101, v10, v11
    v_cvt_pk_bf16_f32 v102, v12, v13
    v_cvt_pk_bf16_f32 v103, v14, v15
    ds_write_b128 v250, v[100:103] offset:1024
    v_cvt_pk_bf16_f32 v124, v56, v57
    v_cvt_pk_bf16_f32 v125, v58, v59
    v_cvt_pk_bf16_f32 v126, v60, v61
    v_cvt_pk_bf16_f32 v127, v62, v63
    ds_write_b128 v250, v[124:127] offset:7168
    s_waitcnt lgkmcnt(8)
    v_mfma_f32_16x16x32_bf16 v[32:35], v[176:179], v[160:163], v[32:35]
    v_mul_f32 v16, v16, v230
    v_mul_f32 v17, v17, v230
    v_mul_f32 v18, v18, v230
    v_mul_f32 v19, v19, v230
    v_mul_f32 v20, v20, v230
    v_mul_f32 v21, v21, v230
    v_mul_f32 v22, v22, v230
    v_mul_f32 v23, v23, v230
    v_mfma_f32_16x16x32_bf16 v[80:83], v[176:179], v[164:167], v[80:83]
    v_mul_f32 v64, v64, v231
    v_mul_f32 v65, v65, v231
    v_mul_f32 v66, v66, v231
    v_mul_f32 v67, v67, v231
    v_mul_f32 v68, v68, v231
    v_mul_f32 v69, v69, v231
    v_mul_f32 v70, v70, v231
    v_mul_f32 v71, v71, v231
    v_mfma_f32_16x16x32_bf16 v[36:39], v[180:183], v[160:163], v[36:39]
    v_mfma_f32_16x16x32_bf16 v[84:87], v[180:183], v[164:167], v[84:87]
    v_cvt_pk_bf16_f32 v104, v16, v17
    v_cvt_pk_bf16_f32 v105, v18, v19
    v_cvt_pk_bf16_f32 v106, v20, v21
    v_cvt_pk_bf16_f32 v107, v22, v23
    ds_write_b128 v250, v[104:107] offset:2048
    v_cvt_pk_bf16_f32 v128, v64, v65
    v_cvt_pk_bf16_f32 v129, v66, v67
    v_cvt_pk_bf16_f32 v130, v68, v69
    v_cvt_pk_bf16_f32 v131, v70, v71
    ds_write_b128 v250, v[128:131] offset:8192
    s_waitcnt lgkmcnt(4)
    v_mfma_f32_16x16x32_bf16 v[40:43], v[184:187], v[160:163], v[40:43]
    v_mul_f32 v24, v24, v230
    v_mul_f32 v25, v25, v230
    v_mul_f32 v26, v26, v230
    v_mul_f32 v27, v27, v230
    v_mul_f32 v28, v28, v230
    v_mul_f32 v29, v29, v230
    v_mul_f32 v30, v30, v230
    v_mul_f32 v31, v31, v230
    v_mfma_f32_16x16x32_bf16 v[88:91], v[184:187], v[164:167], v[88:91]
    v_mul_f32 v72, v72, v231
    v_mul_f32 v73, v73, v231
    v_mul_f32 v74, v74, v231
    v_mul_f32 v75, v75, v231
    v_mul_f32 v76, v76, v231
    v_mul_f32 v77, v77, v231
    v_mul_f32 v78, v78, v231
    v_mul_f32 v79, v79, v231
    v_mfma_f32_16x16x32_bf16 v[44:47], v[188:191], v[160:163], v[44:47]
    v_mfma_f32_16x16x32_bf16 v[92:95], v[188:191], v[164:167], v[92:95]
    v_cvt_pk_bf16_f32 v108, v24, v25
    v_cvt_pk_bf16_f32 v109, v26, v27
    v_cvt_pk_bf16_f32 v110, v28, v29
    v_cvt_pk_bf16_f32 v111, v30, v31
    ds_write_b128 v250, v[108:111] offset:3072
    v_cvt_pk_bf16_f32 v132, v72, v73
    v_cvt_pk_bf16_f32 v133, v74, v75
    v_cvt_pk_bf16_f32 v134, v76, v77
    v_cvt_pk_bf16_f32 v135, v78, v79
    ds_write_b128 v250, v[132:135] offset:9216
    v_mul_f32 v32, v32, v230
    v_mul_f32 v33, v33, v230
    v_mul_f32 v34, v34, v230
    v_mul_f32 v35, v35, v230
    v_mul_f32 v36, v36, v230
    v_mul_f32 v37, v37, v230
    v_mul_f32 v38, v38, v230
    v_mul_f32 v39, v39, v230
    v_mul_f32 v80, v80, v231
    v_mul_f32 v81, v81, v231
    v_mul_f32 v82, v82, v231
    v_mul_f32 v83, v83, v231
    v_mul_f32 v84, v84, v231
    v_mul_f32 v85, v85, v231
    v_mul_f32 v86, v86, v231
    v_mul_f32 v87, v87, v231
    v_cvt_pk_bf16_f32 v112, v32, v33
    v_cvt_pk_bf16_f32 v113, v34, v35
    v_cvt_pk_bf16_f32 v114, v36, v37
    v_cvt_pk_bf16_f32 v115, v38, v39
    ds_write_b128 v250, v[112:115] offset:4096
    v_cvt_pk_bf16_f32 v136, v80, v81
    v_cvt_pk_bf16_f32 v137, v82, v83
    v_cvt_pk_bf16_f32 v138, v84, v85
    v_cvt_pk_bf16_f32 v139, v86, v87
    ds_write_b128 v250, v[136:139] offset:10240
    v_mul_f32 v40, v40, v230
    v_mul_f32 v41, v41, v230
    v_mul_f32 v42, v42, v230
    v_mul_f32 v43, v43, v230
    v_mul_f32 v44, v44, v230
    v_mul_f32 v45, v45, v230
    v_mul_f32 v46, v46, v230
    v_mul_f32 v47, v47, v230
    v_mul_f32 v88, v88, v231
    v_mul_f32 v89, v89, v231
    v_mul_f32 v90, v90, v231
    v_mul_f32 v91, v91, v231
    v_mul_f32 v92, v92, v231
    v_mul_f32 v93, v93, v231
    v_mul_f32 v94, v94, v231
    v_mul_f32 v95, v95, v231
    v_cvt_pk_bf16_f32 v116, v40, v41
    v_cvt_pk_bf16_f32 v117, v42, v43
    v_cvt_pk_bf16_f32 v118, v44, v45
    v_cvt_pk_bf16_f32 v119, v46, v47
    ds_write_b128 v250, v[116:119] offset:5120
    v_cvt_pk_bf16_f32 v140, v88, v89
    v_cvt_pk_bf16_f32 v141, v90, v91
    v_cvt_pk_bf16_f32 v142, v92, v93
    v_cvt_pk_bf16_f32 v143, v94, v95
    ds_write_b128 v250, v[140:143] offset:11264
    s_setprio 0
    s_waitcnt lgkmcnt(0)
    s_barrier
    s_add_u32 s68, s65, 3
    s_sub_u32 s64, s68, 10
    s_cselect_b32 s68, s68, s64
    s_lshl_b32 s68, s68, 7
    s_add_u32 s68, s68, s70
    s_add_u32 m0, s59, 86016
    s_add_u32 s66, s68, 0
    buffer_load_dwordx4 v248, s[32:35], s66 offen lds
    s_add_u32 s67, s68, 9216
    buffer_load_dwordx4 v248, s[32:35], s67 offen offset:1024 lds
    s_add_u32 s68, s68, 18432
    buffer_load_dwordx4 v248, s[32:35], s68 offen offset:2048 lds
    s_add_u32 s68, s65, 3
    s_sub_u32 s64, s68, 10
    s_cselect_b32 s68, s68, s64
    s_lshl_b32 s68, s68, 7
    s_add_u32 s68, s68, s70
    s_add_u32 m0, s59, 89088
    s_add_u32 s66, s68, 30720
    buffer_load_dwordx4 v248, s[32:35], s66 offen lds
    s_add_u32 s67, s68, 39936
    buffer_load_dwordx4 v248, s[32:35], s67 offen offset:1024 lds
    s_add_u32 s68, s68, 49152
    buffer_load_dwordx4 v248, s[32:35], s68 offen offset:2048 lds
    s_barrier
    s_add_u32 s68, s65, 4
    s_sub_u32 s64, s68, 10
    s_cselect_b32 s68, s68, s64
    s_lshl_b32 s68, s68, 7
    s_add_u32 s68, s68, s70
    s_add_u32 m0, s59, 0
    s_add_u32 s66, s68, 0
    buffer_load_dwordx4 v248, s[32:35], s66 offen lds
    s_add_u32 s67, s68, 9216
    buffer_load_dwordx4 v248, s[32:35], s67 offen offset:1024 lds
    s_add_u32 s68, s68, 18432
    buffer_load_dwordx4 v248, s[32:35], s68 offen offset:2048 lds
    s_add_u32 s68, s65, 4
    s_sub_u32 s64, s68, 10
    s_cselect_b32 s68, s68, s64
    s_lshl_b32 s68, s68, 7
    s_add_u32 s68, s68, s70
    s_add_u32 m0, s59, 3072
    s_add_u32 s66, s68, 30720
    buffer_load_dwordx4 v248, s[32:35], s66 offen lds
    s_add_u32 s67, s68, 39936
    buffer_load_dwordx4 v248, s[32:35], s67 offen offset:1024 lds
    s_add_u32 s68, s68, 49152
    buffer_load_dwordx4 v248, s[32:35], s68 offen offset:2048 lds
    s_barrier
    s_add_u32 s68, s65, 5
    s_sub_u32 s64, s68, 10
    s_cselect_b32 s68, s68, s64
    s_lshl_b32 s68, s68, 7
    s_add_u32 s68, s68, s70
    s_add_u32 m0, s59, 24576
    s_add_u32 s66, s68, 0
    buffer_load_dwordx4 v248, s[32:35], s66 offen lds
    s_add_u32 s67, s68, 9216
    buffer_load_dwordx4 v248, s[32:35], s67 offen offset:1024 lds
    s_add_u32 s68, s68, 18432
    buffer_load_dwordx4 v248, s[32:35], s68 offen offset:2048 lds
    s_add_u32 s68, s65, 5
    s_sub_u32 s64, s68, 10
    s_cselect_b32 s68, s68, s64
    s_lshl_b32 s68, s68, 7
    s_add_u32 s68, s68, s70
    s_add_u32 m0, s59, 27648
    s_add_u32 s66, s68, 30720
    buffer_load_dwordx4 v248, s[32:35], s66 offen lds
    s_add_u32 s67, s68, 39936
    buffer_load_dwordx4 v248, s[32:35], s67 offen offset:1024 lds
    s_add_u32 s68, s68, 49152
    buffer_load_dwordx4 v248, s[32:35], s68 offen offset:2048 lds
    s_waitcnt vmcnt(12)
    s_barrier
    s_add_u32 s68, s65, 6
    s_sub_u32 s64, s68, 10
    s_cselect_b32 s68, s68, s64
    s_lshl_b32 s68, s68, 7
    s_add_u32 s68, s68, s70
    s_add_u32 m0, s59, 110592
    s_add_u32 s66, s68, 0
    buffer_load_dwordx4 v248, s[32:35], s66 offen lds
    s_add_u32 s67, s68, 9216
    buffer_load_dwordx4 v248, s[32:35], s67 offen offset:1024 lds
    s_add_u32 s68, s68, 18432
    buffer_load_dwordx4 v248, s[32:35], s68 offen offset:2048 lds
    s_add_u32 s68, s65, 6
    s_sub_u32 s64, s68, 10
    s_cselect_b32 s68, s68, s64
    s_lshl_b32 s68, s68, 7
    s_add_u32 s68, s68, s70
    s_add_u32 m0, s59, 113664
    s_add_u32 s66, s68, 30720
    buffer_load_dwordx4 v248, s[32:35], s66 offen lds
    s_add_u32 s67, s68, 39936
    buffer_load_dwordx4 v248, s[32:35], s67 offen offset:1024 lds
    s_add_u32 s68, s68, 49152
    buffer_load_dwordx4 v248, s[32:35], s68 offen offset:2048 lds
    s_waitcnt vmcnt(12)
    s_barrier
    s_add_u32 s68, s65, 7
    s_sub_u32 s64, s68, 10
    s_cselect_b32 s68, s68, s64
    s_lshl_b32 s68, s68, 7
    s_add_u32 s68, s68, s70
    s_add_u32 m0, s59, 49152
    s_add_u32 s66, s68, 0
    buffer_load_dwordx4 v248, s[32:35], s66 offen lds
    s_add_u32 s67, s68, 9216
    buffer_load_dwordx4 v248, s[32:35], s67 offen offset:1024 lds
    s_add_u32 s68, s68, 18432
    buffer_load_dwordx4 v248, s[32:35], s68 offen offset:2048 lds
    s_add_u32 s68, s65, 7
    s_sub_u32 s64, s68, 10
    s_cselect_b32 s68, s68, s64
    s_lshl_b32 s68, s68, 7
    s_add_u32 s68, s68, s70
    s_add_u32 m0, s59, 52224
    s_add_u32 s66, s68, 30720
    buffer_load_dwordx4 v248, s[32:35], s66 offen lds
    s_add_u32 s67, s68, 39936
    buffer_load_dwordx4 v248, s[32:35], s67 offen offset:1024 lds
    s_add_u32 s68, s68, 49152
    buffer_load_dwordx4 v248, s[32:35], s68 offen offset:2048 lds
    s_waitcnt vmcnt(12)
    s_barrier
    s_add_u32 s68, s65, 8
    s_sub_u32 s64, s68, 10
    s_cselect_b32 s68, s68, s64
    s_lshl_b32 s68, s68, 7
    s_add_u32 s68, s68, s70
    s_add_u32 m0, s59, 135168
    s_add_u32 s66, s68, 0
    buffer_load_dwordx4 v248, s[32:35], s66 offen lds
    s_add_u32 s67, s68, 9216
    buffer_load_dwordx4 v248, s[32:35], s67 offen offset:1024 lds
    s_add_u32 s68, s68, 18432
    buffer_load_dwordx4 v248, s[32:35], s68 offen offset:2048 lds
    s_add_u32 s68, s65, 8
    s_sub_u32 s64, s68, 10
    s_cselect_b32 s68, s68, s64
    s_lshl_b32 s68, s68, 7
    s_add_u32 s68, s68, s70
    s_add_u32 m0, s59, 138240
    s_add_u32 s66, s68, 30720
    buffer_load_dwordx4 v248, s[32:35], s66 offen lds
    s_add_u32 s67, s68, 39936
    buffer_load_dwordx4 v248, s[32:35], s67 offen offset:1024 lds
    s_add_u32 s68, s68, 49152
    buffer_load_dwordx4 v248, s[32:35], s68 offen offset:2048 lds
    s_waitcnt vmcnt(12)
    s_barrier
    s_add_u32 s68, s65, 9
    s_sub_u32 s64, s68, 10
    s_cselect_b32 s68, s68, s64
    s_lshl_b32 s68, s68, 7
    s_add_u32 s68, s68, s70
    s_add_u32 m0, s59, 86016
    s_add_u32 s66, s68, 0
    buffer_load_dwordx4 v248, s[32:35], s66 offen lds
    s_add_u32 s67, s68, 9216
    buffer_load_dwordx4 v248, s[32:35], s67 offen offset:1024 lds
    s_add_u32 s68, s68, 18432
    buffer_load_dwordx4 v248, s[32:35], s68 offen offset:2048 lds
    s_add_u32 s68, s65, 9
    s_sub_u32 s64, s68, 10
    s_cselect_b32 s68, s68, s64
    s_lshl_b32 s68, s68, 7
    s_add_u32 s68, s68, s70
    s_add_u32 m0, s59, 89088
    s_add_u32 s66, s68, 30720
    buffer_load_dwordx4 v248, s[32:35], s66 offen lds
    s_add_u32 s67, s68, 39936
    buffer_load_dwordx4 v248, s[32:35], s67 offen offset:1024 lds
    s_add_u32 s68, s68, 49152
    buffer_load_dwordx4 v248, s[32:35], s68 offen offset:2048 lds
    s_waitcnt vmcnt(12)
    s_barrier
    s_waitcnt vmcnt(0)
    s_barrier
    s_branch L_fin
L_rare_l0:
    v_mov_b32 v209, v207
    s_nop 1
    v_permlane32_swap_b32 v207, v209
    v_max_f32 v207, v207, v209
    v_mov_b32 v209, v207
    s_nop 1
    v_permlane16_swap_b32 v207, v209
    v_max_f32 v207, v207, v209
    v_max_f32 v207, 0, v207
    v_exp_f32 v230, -v207
    v_sub_f32 v192, v192, v207
    v_sub_f32 v193, v193, v207
    v_sub_f32 v194, v194, v207
    v_sub_f32 v195, v195, v207
    v_sub_f32 v232, v232, v207
    v_sub_f32 v233, v233, v207
    v_sub_f32 v234, v234, v207
    v_sub_f32 v235, v235, v207
    v_sub_f32 v236, v236, v207
    v_sub_f32 v237, v237, v207
    v_sub_f32 v238, v238, v207
    v_sub_f32 v239, v239, v207
    v_mov_b32 v209, v208
    s_nop 1
    v_permlane32_swap_b32 v208, v209
    v_max_f32 v208, v208, v209
    v_mov_b32 v209, v208
    s_nop 1
    v_permlane16_swap_b32 v208, v209
    v_max_f32 v208, v208, v209
    v_max_f32 v208, 0, v208
    v_exp_f32 v231, -v208
    v_sub_f32 v196, v196, v208
    v_sub_f32 v197, v197, v208
    v_sub_f32 v198, v198, v208
    v_sub_f32 v199, v199, v208
    v_sub_f32 v240, v240, v208
    v_sub_f32 v241, v241, v208
    v_sub_f32 v242, v242, v208
    v_sub_f32 v243, v243, v208
    v_sub_f32 v244, v244, v208
    v_sub_f32 v245, v245, v208
    v_sub_f32 v246, v246, v208
    v_sub_f32 v247, v247, v208
    s_mov_b32 s58, 1
    s_branch L_ret_l0
L_rare_l1:
    v_mov_b32 v209, v207
    s_nop 1
    v_permlane32_swap_b32 v207, v209
    v_max_f32 v207, v207, v209
    v_mov_b32 v209, v207
    s_nop 1
    v_permlane16_swap_b32 v207, v209
    v_max_f32 v207, v207, v209
    v_max_f32 v207, 0, v207
    v_exp_f32 v230, -v207
    v_sub_f32 v192, v192, v207
    v_sub_f32 v193, v193, v207
    v_sub_f32 v194, v194, v207
    v_sub_f32 v195, v195, v207
    v_sub_f32 v144, v144, v207
    v_sub_f32 v145, v145, v207
    v_sub_f32 v146, v146, v207
    v_sub_f32 v147, v147, v207
    v_sub_f32 v148, v148, v207
    v_sub_f32 v149, v149, v207
    v_sub_f32 v150, v150, v207
    v_sub_f32 v151, v151, v207
    v_mov_b32 v209, v208
    s_nop 1
    v_permlane32_swap_b32 v208, v209
    v_max_f32 v208, v208, v209
    v_mov_b32 v209, v208
    s_nop 1
    v_permlane16_swap_b32 v208, v209
    v_max_f32 v208, v208, v209
    v_max_f32 v208, 0, v208
    v_exp_f32 v231, -v208
    v_sub_f32 v196, v196, v208
    v_sub_f32 v197, v197, v208
    v_sub_f32 v198, v198, v208
    v_sub_f32 v199, v199, v208
    v_sub_f32 v152, v152, v208
    v_sub_f32 v153, v153, v208
    v_sub_f32 v154, v154, v208
    v_sub_f32 v155, v155, v208
    v_sub_f32 v156, v156, v208
    v_sub_f32 v157, v157, v208
    v_sub_f32 v158, v158, v208
    v_sub_f32 v159, v159, v208
    s_mov_b32 s58, 1
    s_branch L_ret_l1
L_resc_l0:
    s_nop 15
    v_mul_f32 v0, v0, v230
    v_mul_f32 v1, v1, v230
    v_mul_f32 v2, v2, v230
    v_mul_f32 v3, v3, v230
    v_mul_f32 v4, v4, v230
    v_mul_f32 v5, v5, v230
    v_mul_f32 v6, v6, v230
    v_mul_f32 v7, v7, v230
    v_mul_f32 v8, v8, v230
    v_mul_f32 v9, v9, v230
    v_mul_f32 v10, v10, v230
    v_mul_f32 v11, v11, v230
    v_mul_f32 v12, v12, v230
    v_mul_f32 v13, v13, v230
    v_mul_f32 v14, v14, v230
    v_mul_f32 v15, v15, v230
    v_mul_f32 v16, v16, v230
    v_mul_f32 v17, v17, v230
    v_mul_f32 v18, v18, v230
    v_mul_f32 v19, v19, v230
    v_mul_f32 v20, v20, v230
    v_mul_f32 v21, v21, v230
    v_mul_f32 v22, v22, v230
    v_mul_f32 v23, v23, v230
    v_mul_f32 v24, v24, v230
    v_mul_f32 v25, v25, v230
    v_mul_f32 v26, v26, v230
    v_mul_f32 v27, v27, v230
    v_mul_f32 v28, v28, v230
    v_mul_f32 v29, v29, v230
    v_mul_f32 v30, v30, v230
    v_mul_f32 v31, v31, v230
    v_mul_f32 v32, v32, v230
    v_mul_f32 v33, v33, v230
    v_mul_f32 v34, v34, v230
    v_mul_f32 v35, v35, v230
    v_mul_f32 v36, v36, v230
    v_mul_f32 v37, v37, v230
    v_mul_f32 v38, v38, v230
    v_mul_f32 v39, v39, v230
    v_mul_f32 v40, v40, v230
    v_mul_f32 v41, v41, v230
    v_mul_f32 v42, v42, v230
    v_mul_f32 v43, v43, v230
    v_mul_f32 v44, v44, v230
    v_mul_f32 v45, v45, v230
    v_mul_f32 v46, v46, v230
    v_mul_f32 v47, v47, v230
    v_mul_f32 v48, v48, v231
    v_mul_f32 v49, v49, v231
    v_mul_f32 v50, v50, v231
    v_mul_f32 v51, v51, v231
    v_mul_f32 v52, v52, v231
    v_mul_f32 v53, v53, v231
    v_mul_f32 v54, v54, v231
    v_mul_f32 v55, v55, v231
    v_mul_f32 v56, v56, v231
    v_mul_f32 v57, v57, v231
    v_mul_f32 v58, v58, v231
    v_mul_f32 v59, v59, v231
    v_mul_f32 v60, v60, v231
    v_mul_f32 v61, v61, v231
    v_mul_f32 v62, v62, v231
    v_mul_f32 v63, v63, v231
    v_mul_f32 v64, v64, v231
    v_mul_f32 v65, v65, v231
    v_mul_f32 v66, v66, v231
    v_mul_f32 v67, v67, v231
    v_mul_f32 v68, v68, v231
    v_mul_f32 v69, v69, v231
    v_mul_f32 v70, v70, v231
    v_mul_f32 v71, v71, v231
    v_mul_f32 v72, v72, v231
    v_mul_f32 v73, v73, v231
    v_mul_f32 v74, v74, v231
    v_mul_f32 v75, v75, v231
    v_mul_f32 v76, v76, v231
    v_mul_f32 v77, v77, v231
    v_mul_f32 v78, v78, v231
    v_mul_f32 v79, v79, v231
    v_mul_f32 v80, v80, v231
    v_mul_f32 v81, v81, v231
    v_mul_f32 v82, v82, v231
    v_mul_f32 v83, v83, v231
    v_mul_f32 v84, v84, v231
    v_mul_f32 v85, v85, v231
    v_mul_f32 v86, v86, v231
    v_mul_f32 v87, v87, v231
    v_mul_f32 v88, v88, v231
    v_mul_f32 v89, v89, v231
    v_mul_f32 v90, v90, v231
    v_mul_f32 v91, v91, v231
    v_mul_f32 v92, v92, v231
    v_mul_f32 v93, v93, v231
    v_mul_f32 v94, v94, v231
    v_mul_f32 v95, v95, v231
    v_mul_f32 v216, v216, v230
    v_mul_f32 v217, v217, v230
    v_mul_f32 v218, v218, v230
    v_mul_f32 v219, v219, v230
    v_mul_f32 v220, v220, v231
    v_mul_f32 v221, v221, v231
    v_mul_f32 v222, v222, v231
    v_mul_f32 v223, v223, v231
    s_mov_b32 s58, 0
    s_nop 1
    s_branch L_rret_l0
L_resc_l1:
    s_nop 15
    v_mul_f32 v0, v0, v230
    v_mul_f32 v1, v1, v230
    v_mul_f32 v2, v2, v230
    v_mul_f32 v3, v3, v230
    v_mul_f32 v4, v4, v230
    v_mul_f32 v5, v5, v230
    v_mul_f32 v6, v6, v230
    v_mul_f32 v7, v7, v230
    v_mul_f32 v8, v8, v230
    v_mul_f32 v9, v9, v230
    v_mul_f32 v10, v10, v230
    v_mul_f32 v11, v11, v230
    v_mul_f32 v12, v12, v230
    v_mul_f32 v13, v13, v230
    v_mul_f32 v14, v14, v230
    v_mul_f32 v15, v15, v230
    v_mul_f32 v16, v16, v230
    v_mul_f32 v17, v17, v230
    v_mul_f32 v18, v18, v230
    v_mul_f32 v19, v19, v230
    v_mul_f32 v20, v20, v230
    v_mul_f32 v21, v21, v230
    v_mul_f32 v22, v22, v230
    v_mul_f32 v23, v23, v230
    v_mul_f32 v24, v24, v230
    v_mul_f32 v25, v25, v230
    v_mul_f32 v26, v26, v230
    v_mul_f32 v27, v27, v230
    v_mul_f32 v28, v28, v230
    v_mul_f32 v29, v29, v230
    v_mul_f32 v30, v30, v230
    v_mul_f32 v31, v31, v230
    v_mul_f32 v32, v32, v230
    v_mul_f32 v33, v33, v230
    v_mul_f32 v34, v34, v230
    v_mul_f32 v35, v35, v230
    v_mul_f32 v36, v36, v230
    v_mul_f32 v37, v37, v230
    v_mul_f32 v38, v38, v230
    v_mul_f32 v39, v39, v230
    v_mul_f32 v40, v40, v230
    v_mul_f32 v41, v41, v230
    v_mul_f32 v42, v42, v230
    v_mul_f32 v43, v43, v230
    v_mul_f32 v44, v44, v230
    v_mul_f32 v45, v45, v230
    v_mul_f32 v46, v46, v230
    v_mul_f32 v47, v47, v230
    v_mul_f32 v48, v48, v231
    v_mul_f32 v49, v49, v231
    v_mul_f32 v50, v50, v231
    v_mul_f32 v51, v51, v231
    v_mul_f32 v52, v52, v231
    v_mul_f32 v53, v53, v231
    v_mul_f32 v54, v54, v231
    v_mul_f32 v55, v55, v231
    v_mul_f32 v56, v56, v231
    v_mul_f32 v57, v57, v231
    v_mul_f32 v58, v58, v231
    v_mul_f32 v59, v59, v231
    v_mul_f32 v60, v60, v231
    v_mul_f32 v61, v61, v231
    v_mul_f32 v62, v62, v231
    v_mul_f32 v63, v63, v231
    v_mul_f32 v64, v64, v231
    v_mul_f32 v65, v65, v231
    v_mul_f32 v66, v66, v231
    v_mul_f32 v67, v67, v231
    v_mul_f32 v68, v68, v231
    v_mul_f32 v69, v69, v231
    v_mul_f32 v70, v70, v231
    v_mul_f32 v71, v71, v231
    v_mul_f32 v72, v72, v231
    v_mul_f32 v73, v73, v231
    v_mul_f32 v74, v74, v231
    v_mul_f32 v75, v75, v231
    v_mul_f32 v76, v76, v231
    v_mul_f32 v77, v77, v231
    v_mul_f32 v78, v78, v231
    v_mul_f32 v79, v79, v231
    v_mul_f32 v80, v80, v231
    v_mul_f32 v81, v81, v231
    v_mul_f32 v82, v82, v231
    v_mul_f32 v83, v83, v231
    v_mul_f32 v84, v84, v231
    v_mul_f32 v85, v85, v231
    v_mul_f32 v86, v86, v231
    v_mul_f32 v87, v87, v231
    v_mul_f32 v88, v88, v231
    v_mul_f32 v89, v89, v231
    v_mul_f32 v90, v90, v231
    v_mul_f32 v91, v91, v231
    v_mul_f32 v92, v92, v231
    v_mul_f32 v93, v93, v231
    v_mul_f32 v94, v94, v231
    v_mul_f32 v95, v95, v231
    v_mul_f32 v216, v216, v230
    v_mul_f32 v217, v217, v230
    v_mul_f32 v218, v218, v230
    v_mul_f32 v219, v219, v230
    v_mul_f32 v220, v220, v231
    v_mul_f32 v221, v221, v231
    v_mul_f32 v222, v222, v231
    v_mul_f32 v223, v223, v231
    s_mov_b32 s58, 0
    s_nop 1
    s_branch L_rret_l1
L_resc_e0:
    s_nop 15
    v_mul_f32 v0, v0, v230
    v_mul_f32 v1, v1, v230
    v_mul_f32 v2, v2, v230
    v_mul_f32 v3, v3, v230
    v_mul_f32 v4, v4, v230
    v_mul_f32 v5, v5, v230
    v_mul_f32 v6, v6, v230
    v_mul_f32 v7, v7, v230
    v_mul_f32 v8, v8, v230
    v_mul_f32 v9, v9, v230
    v_mul_f32 v10, v10, v230
    v_mul_f32 v11, v11, v230
    v_mul_f32 v12, v12, v230
    v_mul_f32 v13, v13, v230
    v_mul_f32 v14, v14, v230
    v_mul_f32 v15, v15, v230
    v_mul_f32 v16, v16, v230
    v_mul_f32 v17, v17, v230
    v_mul_f32 v18, v18, v230
    v_mul_f32 v19, v19, v230
    v_mul_f32 v20, v20, v230
    v_mul_f32 v21, v21, v230
    v_mul_f32 v22, v22, v230
    v_mul_f32 v23, v23, v230
    v_mul_f32 v24, v24, v230
    v_mul_f32 v25, v25, v230
    v_mul_f32 v26, v26, v230
    v_mul_f32 v27, v27, v230
    v_mul_f32 v28, v28, v230
    v_mul_f32 v29, v29, v230
    v_mul_f32 v30, v30, v230
    v_mul_f32 v31, v31, v230
    v_mul_f32 v32, v32, v230
    v_mul_f32 v33, v33, v230
    v_mul_f32 v34, v34, v230
    v_mul_f32 v35, v35, v230
    v_mul_f32 v36, v36, v230
    v_mul_f32 v37, v37, v230
    v_mul_f32 v38, v38, v230
    v_mul_f32 v39, v39, v230
    v_mul_f32 v40, v40, v230
    v_mul_f32 v41, v41, v230
    v_mul_f32 v42, v42, v230
    v_mul_f32 v43, v43, v230
    v_mul_f32 v44, v44, v230
    v_mul_f32 v45, v45, v230
    v_mul_f32 v46, v46, v230
    v_mul_f32 v47, v47, v230
    v_mul_f32 v48, v48, v231
    v_mul_f32 v49, v49, v231
    v_mul_f32 v50, v50, v231
    v_mul_f32 v51, v51, v231
    v_mul_f32 v52, v52, v231
    v_mul_f32 v53, v53, v231
    v_mul_f32 v54, v54, v231
    v_mul_f32 v55, v55, v231
    v_mul_f32 v56, v56, v231
    v_mul_f32 v57, v57, v231
    v_mul_f32 v58, v58, v231
    v_mul_f32 v59, v59, v231
    v_mul_f32 v60, v60, v231
    v_mul_f32 v61, v61, v231
    v_mul_f32 v62, v62, v231
    v_mul_f32 v63, v63, v231
    v_mul_f32 v64, v64, v231
    v_mul_f32 v65, v65, v231
    v_mul_f32 v66, v66, v231
    v_mul_f32 v67, v67, v231
    v_mul_f32 v68, v68, v231
    v_mul_f32 v69, v69, v231
    v_mul_f32 v70, v70, v231
    v_mul_f32 v71, v71, v231
    v_mul_f32 v72, v72, v231
    v_mul_f32 v73, v73, v231
    v_mul_f32 v74, v74, v231
    v_mul_f32 v75, v75, v231
    v_mul_f32 v76, v76, v231
    v_mul_f32 v77, v77, v231
    v_mul_f32 v78, v78, v231
    v_mul_f32 v79, v79, v231
    v_mul_f32 v80, v80, v231
    v_mul_f32 v81, v81, v231
    v_mul_f32 v82, v82, v231
    v_mul_f32 v83, v83, v231
    v_mul_f32 v84, v84, v231
    v_mul_f32 v85, v85, v231
    v_mul_f32 v86, v86, v231
    v_mul_f32 v87, v87, v231
    v_mul_f32 v88, v88, v231
    v_mul_f32 v89, v89, v231
    v_mul_f32 v90, v90, v231
    v_mul_f32 v91, v91, v231
    v_mul_f32 v92, v92, v231
    v_mul_f32 v93, v93, v231
    v_mul_f32 v94, v94, v231
    v_mul_f32 v95, v95, v231
    v_mul_f32 v216, v216, v230
    v_mul_f32 v217, v217, v230
    v_mul_f32 v218, v218, v230
    v_mul_f32 v219, v219, v230
    v_mul_f32 v220, v220, v231
    v_mul_f32 v221, v221, v231
    v_mul_f32 v222, v222, v231
    v_mul_f32 v223, v223, v231
    s_mov_b32 s58, 0
    s_nop 1
    s_branch L_rret_e0
L_resc_e1:
    s_nop 15
    v_mul_f32 v0, v0, v230
    v_mul_f32 v1, v1, v230
    v_mul_f32 v2, v2, v230
    v_mul_f32 v3, v3, v230
    v_mul_f32 v4, v4, v230
    v_mul_f32 v5, v5, v230
    v_mul_f32 v6, v6, v230
    v_mul_f32 v7, v7, v230
    v_mul_f32 v8, v8, v230
    v_mul_f32 v9, v9, v230
    v_mul_f32 v10, v10, v230
    v_mul_f32 v11, v11, v230
    v_mul_f32 v12, v12, v230
    v_mul_f32 v13, v13, v230
    v_mul_f32 v14, v14, v230
    v_mul_f32 v15, v15, v230
    v_mul_f32 v16, v16, v230
    v_mul_f32 v17, v17, v230
    v_mul_f32 v18, v18, v230
    v_mul_f32 v19, v19, v230
    v_mul_f32 v20, v20, v230
    v_mul_f32 v21, v21, v230
    v_mul_f32 v22, v22, v230
    v_mul_f32 v23, v23, v230
    v_mul_f32 v24, v24, v230
    v_mul_f32 v25, v25, v230
    v_mul_f32 v26, v26, v230
    v_mul_f32 v27, v27, v230
    v_mul_f32 v28, v28, v230
    v_mul_f32 v29, v29, v230
    v_mul_f32 v30, v30, v230
    v_mul_f32 v31, v31, v230
    v_mul_f32 v32, v32, v230
    v_mul_f32 v33, v33, v230
    v_mul_f32 v34, v34, v230
    v_mul_f32 v35, v35, v230
    v_mul_f32 v36, v36, v230
    v_mul_f32 v37, v37, v230
    v_mul_f32 v38, v38, v230
    v_mul_f32 v39, v39, v230
    v_mul_f32 v40, v40, v230
    v_mul_f32 v41, v41, v230
    v_mul_f32 v42, v42, v230
    v_mul_f32 v43, v43, v230
    v_mul_f32 v44, v44, v230
    v_mul_f32 v45, v45, v230
    v_mul_f32 v46, v46, v230
    v_mul_f32 v47, v47, v230
    v_mul_f32 v48, v48, v231
    v_mul_f32 v49, v49, v231
    v_mul_f32 v50, v50, v231
    v_mul_f32 v51, v51, v231
    v_mul_f32 v52, v52, v231
    v_mul_f32 v53, v53, v231
    v_mul_f32 v54, v54, v231
    v_mul_f32 v55, v55, v231
    v_mul_f32 v56, v56, v231
    v_mul_f32 v57, v57, v231
    v_mul_f32 v58, v58, v231
    v_mul_f32 v59, v59, v231
    v_mul_f32 v60, v60, v231
    v_mul_f32 v61, v61, v231
    v_mul_f32 v62, v62, v231
    v_mul_f32 v63, v63, v231
    v_mul_f32 v64, v64, v231
    v_mul_f32 v65, v65, v231
    v_mul_f32 v66, v66, v231
    v_mul_f32 v67, v67, v231
    v_mul_f32 v68, v68, v231
    v_mul_f32 v69, v69, v231
    v_mul_f32 v70, v70, v231
    v_mul_f32 v71, v71, v231
    v_mul_f32 v72, v72, v231
    v_mul_f32 v73, v73, v231
    v_mul_f32 v74, v74, v231
    v_mul_f32 v75, v75, v231
    v_mul_f32 v76, v76, v231
    v_mul_f32 v77, v77, v231
    v_mul_f32 v78, v78, v231
    v_mul_f32 v79, v79, v231
    v_mul_f32 v80, v80, v231
    v_mul_f32 v81, v81, v231
    v_mul_f32 v82, v82, v231
    v_mul_f32 v83, v83, v231
    v_mul_f32 v84, v84, v231
    v_mul_f32 v85, v85, v231
    v_mul_f32 v86, v86, v231
    v_mul_f32 v87, v87, v231
    v_mul_f32 v88, v88, v231
    v_mul_f32 v89, v89, v231
    v_mul_f32 v90, v90, v231
    v_mul_f32 v91, v91, v231
    v_mul_f32 v92, v92, v231
    v_mul_f32 v93, v93, v231
    v_mul_f32 v94, v94, v231
    v_mul_f32 v95, v95, v231
    v_mul_f32 v216, v216, v230
    v_mul_f32 v217, v217, v230
    v_mul_f32 v218, v218, v230
    v_mul_f32 v219, v219, v230
    v_mul_f32 v220, v220, v231
    v_mul_f32 v221, v221, v231
    v_mul_f32 v222, v222, v231
    v_mul_f32 v223, v223, v231
    s_mov_b32 s58, 0
    s_nop 1
    s_branch L_rret_e1
L_q2loop_L:
    s_cmp_eq_u32 s49, 0
    s_cbranch_scc0 L_fw0_L
    s_waitcnt vmcnt(6)
L_fw0_L:
    s_waitcnt vmcnt(11) lgkmcnt(0)
    s_barrier
    ds_read_b64_tr_b16 v[168:169], v192
    ds_read_b64_tr_b16 v[170:171], v192 offset:1536
    ds_read_b64_tr_b16 v[172:173], v193
    ds_read_b64_tr_b16 v[174:175], v193 offset:1536
    v_mfma_f32_16x16x32_bf16 v[36:39], v[180:183], v[120:123], v[36:39]
    ds_read_b64_tr_b16 v[176:177], v194
    ds_read_b64_tr_b16 v[178:179], v194 offset:1536
    s_add_u32 s69, s63, s55
    s_and_b32 s69, s69, 15
    s_and_b32 s68, s55, 16
    s_or_b32 s69, s69, s68
    s_xor_b32 s69, s69, s73
    s_add_u32 m0, s45, s53
    s_mul_i32 s69, s69, 12288
    buffer_load_dwordx4 v213, s[24:27], s69 offen nt lds
    v_mfma_f32_16x16x32_bf16 v[40:43], v[184:187], v[120:123], v[40:43]
    ds_read_b64_tr_b16 v[180:181], v195
    ds_read_b64_tr_b16 v[182:183], v195 offset:1536
    s_add_u32 s53, s53, 12288
    s_cmp_ge_u32 s53, 86016
    s_cselect_b32 s53, 0, s53
    buffer_load_dwordx4 v214, s[24:27], s69 offen offset:1024 nt lds
    v_mfma_f32_16x16x32_bf16 v[44:47], v[188:191], v[120:123], v[44:47]
    ds_read_b64_tr_b16 v[184:185], v192 offset:128
    ds_read_b64_tr_b16 v[186:187], v192 offset:1664
    buffer_load_dwordx4 v215, s[24:27], s69 offen offset:2048 nt lds
    s_add_u32 s55, s55, 1
    s_waitcnt lgkmcnt(6)
    v_mfma_f32_16x16x32_bf16 v[0:3], v[168:171], v[96:99], v[0:3]
    ds_read_b64_tr_b16 v[188:189], v193 offset:128
    ds_read_b64_tr_b16 v[190:191], v193 offset:1664
    s_add_u32 m0, s45, 122880
    s_nop 0
    buffer_load_dwordx4 v216, s[28:31], s50 offen lds
    v_mfma_f32_16x16x32_bf16 v[4:7], v[172:175], v[96:99], v[4:7]
    ds_read_b64_tr_b16 v[168:169], v194 offset:128
    ds_read_b64_tr_b16 v[170:171], v194 offset:1664
    buffer_load_dwordx4 v217, s[28:31], s50 offen offset:1024 lds
    s_waitcnt lgkmcnt(6)
    v_mfma_f32_16x16x32_bf16 v[8:11], v[176:179], v[96:99], v[8:11]
    ds_read_b64_tr_b16 v[172:173], v195 offset:128
    ds_read_b64_tr_b16 v[174:175], v195 offset:1664
    buffer_load_dwordx4 v218, s[28:31], s50 offen offset:2048 lds
    s_add_u32 s50, s50, 393216
    v_mfma_f32_16x16x32_bf16 v[12:15], v[180:183], v[96:99], v[12:15]
    s_waitcnt lgkmcnt(6)
    v_mfma_f32_16x16x32_bf16 v[16:19], v[184:187], v[96:99], v[16:19]
    s_waitcnt vmcnt(11) lgkmcnt(0)
    s_barrier
    ds_read_b64_tr_b16 v[176:177], v192 offset:256
    ds_read_b64_tr_b16 v[178:179], v192 offset:1792
    ds_read_b64_tr_b16 v[180:181], v193 offset:256
    ds_read_b64_tr_b16 v[182:183], v193 offset:1792
    v_mfma_f32_16x16x32_bf16 v[20:23], v[188:191], v[96:99], v[20:23]
    ds_read_b64_tr_b16 v[184:185], v194 offset:256
    ds_read_b64_tr_b16 v[186:187], v194 offset:1792
    s_add_u32 s69, s63, s54
    s_and_b32 s69, s69, 15
    s_and_b32 s68, s54, 16
    s_or_b32 s69, s69, s68
    s_xor_b32 s69, s69, s73
    s_add_u32 m0, s45, s53
    s_mul_i32 s69, s69, 12288
    buffer_load_dwordx4 v210, s[20:23], s69 offen nt lds
    v_mfma_f32_16x16x32_bf16 v[24:27], v[168:171], v[96:99], v[24:27]
    ds_read_b64_tr_b16 v[188:189], v195 offset:256
    ds_read_b64_tr_b16 v[190:191], v195 offset:1792
    s_add_u32 s53, s53, 12288
    s_cmp_ge_u32 s53, 86016
    s_cselect_b32 s53, 0, s53
    buffer_load_dwordx4 v211, s[20:23], s69 offen offset:1024 nt lds
    v_mfma_f32_16x16x32_bf16 v[28:31], v[172:175], v[96:99], v[28:31]
    ds_read_b64_tr_b16 v[168:169], v192 offset:12288
    ds_read_b64_tr_b16 v[170:171], v192 offset:13824
    buffer_load_dwordx4 v212, s[20:23], s69 offen offset:2048 nt lds
    s_add_u32 s54, s54, 1
    s_waitcnt lgkmcnt(6)
    v_mfma_f32_16x16x32_bf16 v[32:35], v[176:179], v[96:99], v[32:35]
    ds_read_b64_tr_b16 v[172:173], v193 offset:12288
    ds_read_b64_tr_b16 v[174:175], v193 offset:13824
    s_add_u32 m0, s46, 0
    s_add_u32 s67, s51, s48
    buffer_load_dwordx4 v219, s[16:19], s51 offen lds
    v_mfma_f32_16x16x32_bf16 v[36:39], v[180:183], v[96:99], v[36:39]
    ds_read_b64_tr_b16 v[176:177], v194 offset:12288
    ds_read_b64_tr_b16 v[178:179], v194 offset:13824
    buffer_load_dwordx4 v220, s[16:19], s51 offen offset:1024 lds
    s_waitcnt lgkmcnt(6)
    v_mfma_f32_16x16x32_bf16 v[40:43], v[184:187], v[96:99], v[40:43]
    ds_read_b64_tr_b16 v[180:181], v195 offset:12288
    ds_read_b64_tr_b16 v[182:183], v195 offset:13824
    s_add_u32 s51, s51, 128
    v_mfma_f32_16x16x32_bf16 v[44:47], v[188:191], v[96:99], v[44:47]
    s_cmp_ge_u32 s51, 1280
    s_cselect_b32 s51, 0x40000000, s51
    s_waitcnt lgkmcnt(6)
    v_mfma_f32_16x16x32_bf16 v[0:3], v[168:171], v[104:107], v[0:3]
    s_waitcnt vmcnt(11) lgkmcnt(0)
    s_barrier
    ds_read_b64_tr_b16 v[184:185], v192 offset:12416
    ds_read_b64_tr_b16 v[186:187], v192 offset:13952
    ds_read_b64_tr_b16 v[188:189], v193 offset:12416
    ds_read_b64_tr_b16 v[190:191], v193 offset:13952
    v_mfma_f32_16x16x32_bf16 v[4:7], v[172:175], v[104:107], v[4:7]
    ds_read_b64_tr_b16 v[168:169], v194 offset:12416
    ds_read_b64_tr_b16 v[170:171], v194 offset:13952
    s_add_u32 s69, s63, s55
    s_and_b32 s69, s69, 15
    s_and_b32 s68, s55, 16
    s_or_b32 s69, s69, s68
    s_xor_b32 s69, s69, s73
    s_add_u32 m0, s45, s53
    s_mul_i32 s69, s69, 12288
    buffer_load_dwordx4 v213, s[24:27], s69 offen nt lds
    v_mfma_f32_16x16x32_bf16 v[8:11], v[176:179], v[104:107], v[8:11]
    ds_read_b64_tr_b16 v[172:173], v195 offset:12416
    ds_read_b64_tr_b16 v[174:175], v195 offset:13952
    s_add_u32 s53, s53, 12288
    s_cmp_ge_u32 s53, 86016
    s_cselect_b32 s53, 0, s53
    buffer_load_dwordx4 v214, s[24:27], s69 offen offset:1024 nt lds
    v_mfma_f32_16x16x32_bf16 v[12:15], v[180:183], v[104:107], v[12:15]
    ds_read_b64_tr_b16 v[176:177], v192 offset:12544
    ds_read_b64_tr_b16 v[178:179], v192 offset:14080
    buffer_load_dwordx4 v215, s[24:27], s69 offen offset:2048 nt lds
    s_add_u32 s55, s55, 1
    s_waitcnt lgkmcnt(6)
    v_mfma_f32_16x16x32_bf16 v[16:19], v[184:187], v[104:107], v[16:19]
    ds_read_b64_tr_b16 v[180:181], v193 offset:12544
    ds_read_b64_tr_b16 v[182:183], v193 offset:14080
    s_add_u32 m0, s45, 86016
    s_nop 0
    buffer_load_dwordx4 v216, s[28:31], s50 offen lds
    ds_read_b128 v[112:115], v196 offset:14336
    v_mfma_f32_16x16x32_bf16 v[20:23], v[188:191], v[104:107], v[20:23]
    ds_read_b64_tr_b16 v[184:185], v194 offset:12544
    ds_read_b64_tr_b16 v[186:187], v194 offset:14080
    buffer_load_dwordx4 v217, s[28:31], s50 offen offset:1024 lds
    ds_read_b128 v[120:123], v197 offset:14336
    s_waitcnt lgkmcnt(8)
    v_mfma_f32_16x16x32_bf16 v[24:27], v[168:171], v[104:107], v[24:27]
    ds_read_b64_tr_b16 v[188:189], v195 offset:12544
    ds_read_b64_tr_b16 v[190:191], v195 offset:14080
    buffer_load_dwordx4 v218, s[28:31], s50 offen offset:2048 lds
    s_add_u32 s50, s50, 393216
    v_mfma_f32_16x16x32_bf16 v[28:31], v[172:175], v[104:107], v[28:31]
    s_waitcnt lgkmcnt(8)
    v_mfma_f32_16x16x32_bf16 v[32:35], v[176:179], v[104:107], v[32:35]
    s_waitcnt vmcnt(11) lgkmcnt(0)
    s_barrier
    ds_read_b64_tr_b16 v[168:169], v192 offset:24576
    ds_read_b64_tr_b16 v[170:171], v192 offset:26112
    ds_read_b64_tr_b16 v[172:173], v193 offset:24576
    ds_read_b64_tr_b16 v[174:175], v193 offset:26112
    v_mfma_f32_16x16x32_bf16 v[36:39], v[180:183], v[104:107], v[36:39]
    ds_read_b64_tr_b16 v[176:177], v194 offset:24576
    ds_read_b64_tr_b16 v[178:179], v194 offset:26112
    s_add_u32 s69, s63, s54
    s_and_b32 s69, s69, 15
    s_and_b32 s68, s54, 16
    s_or_b32 s69, s69, s68
    s_xor_b32 s69, s69, s73
    s_add_u32 m0, s45, s53
    s_mul_i32 s69, s69, 12288
    buffer_load_dwordx4 v210, s[20:23], s69 offen nt lds
    v_mfma_f32_16x16x32_bf16 v[40:43], v[184:187], v[104:107], v[40:43]
    ds_read_b64_tr_b16 v[180:181], v195 offset:24576
    ds_read_b64_tr_b16 v[182:183], v195 offset:26112
    s_add_u32 s53, s53, 12288
    s_cmp_ge_u32 s53, 86016
    s_cselect_b32 s53, 0, s53
    buffer_load_dwordx4 v211, s[20:23], s69 offen offset:1024 nt lds
    v_mfma_f32_16x16x32_bf16 v[44:47], v[188:191], v[104:107], v[44:47]
    ds_read_b64_tr_b16 v[184:185], v192 offset:24704
    ds_read_b64_tr_b16 v[186:187], v192 offset:26240
    buffer_load_dwordx4 v212, s[20:23], s69 offen offset:2048 nt lds
    s_add_u32 s54, s54, 1
    s_waitcnt lgkmcnt(6)
    v_mfma_f32_16x16x32_bf16 v[0:3], v[168:171], v[112:115], v[0:3]
    ds_read_b64_tr_b16 v[188:189], v193 offset:24704
    ds_read_b64_tr_b16 v[190:191], v193 offset:26240
    s_add_u32 m0, s45, 98304
    s_nop 0
    buffer_load_dwordx4 v216, s[28:31], s50 offen lds
    v_mfma_f32_16x16x32_bf16 v[4:7], v[172:175], v[112:115], v[4:7]
    ds_read_b64_tr_b16 v[168:169], v194 offset:24704
    ds_read_b64_tr_b16 v[170:171], v194 offset:26240
    buffer_load_dwordx4 v217, s[28:31], s50 offen offset:1024 lds
    s_waitcnt lgkmcnt(6)
    v_mfma_f32_16x16x32_bf16 v[8:11], v[176:179], v[112:115], v[8:11]
    ds_read_b64_tr_b16 v[172:173], v195 offset:24704
    ds_read_b64_tr_b16 v[174:175], v195 offset:26240
    buffer_load_dwordx4 v218, s[28:31], s50 offen offset:2048 lds
    s_add_u32 s50, s50, 393216
    v_mfma_f32_16x16x32_bf16 v[12:15], v[180:183], v[112:115], v[12:15]
    s_waitcnt lgkmcnt(6)
    v_mfma_f32_16x16x32_bf16 v[16:19], v[184:187], v[112:115], v[16:19]
    s_waitcnt vmcnt(11) lgkmcnt(0)
    s_barrier
    ds_read_b64_tr_b16 v[176:177], v192 offset:24832
    ds_read_b64_tr_b16 v[178:179], v192 offset:26368
    ds_read_b64_tr_b16 v[180:181], v193 offset:24832
    ds_read_b64_tr_b16 v[182:183], v193 offset:26368
    v_mfma_f32_16x16x32_bf16 v[20:23], v[188:191], v[112:115], v[20:23]
    ds_read_b64_tr_b16 v[184:185], v194 offset:24832
    ds_read_b64_tr_b16 v[186:187], v194 offset:26368
    s_add_u32 s69, s63, s55
    s_and_b32 s69, s69, 15
    s_and_b32 s68, s55, 16
    s_or_b32 s69, s69, s68
    s_xor_b32 s69, s69, s73
    s_add_u32 m0, s45, s53
    s_mul_i32 s69, s69, 12288
    buffer_load_dwordx4 v213, s[24:27], s69 offen nt lds
    v_mfma_f32_16x16x32_bf16 v[24:27], v[168:171], v[112:115], v[24:27]
    ds_read_b64_tr_b16 v[188:189], v195 offset:24832
    ds_read_b64_tr_b16 v[190:191], v195 offset:26368
    s_add_u32 s53, s53, 12288
    s_cmp_ge_u32 s53, 86016
    s_cselect_b32 s53, 0, s53
    buffer_load_dwordx4 v214, s[24:27], s69 offen offset:1024 nt lds
    v_mfma_f32_16x16x32_bf16 v[28:31], v[172:175], v[112:115], v[28:31]
    ds_read_b64_tr_b16 v[168:169], v192 offset:36864
    ds_read_b64_tr_b16 v[170:171], v192 offset:38400
    buffer_load_dwordx4 v215, s[24:27], s69 offen offset:2048 nt lds
    s_add_u32 s55, s55, 1
    s_waitcnt lgkmcnt(6)
    v_mfma_f32_16x16x32_bf16 v[32:35], v[176:179], v[112:115], v[32:35]
    ds_read_b64_tr_b16 v[172:173], v193 offset:36864
    ds_read_b64_tr_b16 v[174:175], v193 offset:38400
    s_add_u32 m0, s46, 14336
    s_add_u32 s67, s51, s48
    buffer_load_dwordx4 v219, s[16:19], s51 offen lds
    v_mfma_f32_16x16x32_bf16 v[36:39], v[180:183], v[112:115], v[36:39]
    ds_read_b64_tr_b16 v[176:177], v194 offset:36864
    ds_read_b64_tr_b16 v[178:179], v194 offset:38400
    buffer_load_dwordx4 v220, s[16:19], s51 offen offset:1024 lds
    s_waitcnt lgkmcnt(6)
    v_mfma_f32_16x16x32_bf16 v[40:43], v[184:187], v[112:115], v[40:43]
    ds_read_b64_tr_b16 v[180:181], v195 offset:36864
    ds_read_b64_tr_b16 v[182:183], v195 offset:38400
    s_add_u32 s51, s51, 128
    v_mfma_f32_16x16x32_bf16 v[44:47], v[188:191], v[112:115], v[44:47]
    s_cmp_ge_u32 s51, 1280
    s_cselect_b32 s51, 0x40000000, s51
    s_waitcnt lgkmcnt(6)
    v_mfma_f32_16x16x32_bf16 v[0:3], v[168:171], v[120:123], v[0:3]
    s_waitcnt vmcnt(11) lgkmcnt(0)
    s_barrier
    ds_read_b64_tr_b16 v[184:185], v192 offset:36992
    ds_read_b64_tr_b16 v[186:187], v192 offset:38528
    ds_read_b64_tr_b16 v[188:189], v193 offset:36992
    ds_read_b64_tr_b16 v[190:191], v193 offset:38528
    v_mfma_f32_16x16x32_bf16 v[4:7], v[172:175], v[120:123], v[4:7]
    ds_read_b64_tr_b16 v[168:169], v194 offset:36992
    ds_read_b64_tr_b16 v[170:171], v194 offset:38528
    s_add_u32 s69, s63, s54
    s_and_b32 s69, s69, 15
    s_and_b32 s68, s54, 16
    s_or_b32 s69, s69, s68
    s_xor_b32 s69, s69, s73
    s_add_u32 m0, s45, s53
    s_mul_i32 s69, s69, 12288
    buffer_load_dwordx4 v210, s[20:23], s69 offen nt lds
    v_mfma_f32_16x16x32_bf16 v[8:11], v[176:179], v[120:123], v[8:11]
    ds_read_b64_tr_b16 v[172:173], v195 offset:36992
    ds_read_b64_tr_b16 v[174:175], v195 offset:38528
    s_add_u32 s53, s53, 12288
    s_cmp_ge_u32 s53, 86016
    s_cselect_b32 s53, 0, s53
    buffer_load_dwordx4 v211, s[20:23], s69 offen offset:1024 nt lds
    v_mfma_f32_16x16x32_bf16 v[12:15], v[180:183], v[120:123], v[12:15]
    ds_read_b64_tr_b16 v[176:177], v192 offset:37120
    ds_read_b64_tr_b16 v[178:179], v192 offset:38656
    buffer_load_dwordx4 v212, s[20:23], s69 offen offset:2048 nt lds
    s_add_u32 s54, s54, 1
    s_waitcnt lgkmcnt(6)
    v_mfma_f32_16x16x32_bf16 v[16:19], v[184:187], v[120:123], v[16:19]
    ds_read_b64_tr_b16 v[180:181], v193 offset:37120
    ds_read_b64_tr_b16 v[182:183], v193 offset:38656
    s_add_u32 m0, s45, 110592
    s_nop 0
    buffer_load_dwordx4 v216, s[28:31], s50 offen lds
    ds_read_b128 v[96:99], v196
    v_mfma_f32_16x16x32_bf16 v[20:23], v[188:191], v[120:123], v[20:23]
    ds_read_b64_tr_b16 v[184:185], v194 offset:37120
    ds_read_b64_tr_b16 v[186:187], v194 offset:38656
    buffer_load_dwordx4 v217, s[28:31], s50 offen offset:1024 lds
    ds_read_b128 v[104:107], v197
    s_waitcnt lgkmcnt(8)
    v_mfma_f32_16x16x32_bf16 v[24:27], v[168:171], v[120:123], v[24:27]
    ds_read_b64_tr_b16 v[188:189], v195 offset:37120
    ds_read_b64_tr_b16 v[190:191], v195 offset:38656
    buffer_load_dwordx4 v218, s[28:31], s50 offen offset:2048 lds
    s_add_u32 s50, s50, 393216
    v_mfma_f32_16x16x32_bf16 v[28:31], v[172:175], v[120:123], v[28:31]
    s_waitcnt lgkmcnt(8)
    v_mfma_f32_16x16x32_bf16 v[32:35], v[176:179], v[120:123], v[32:35]
    s_add_u32 s49, s49, 1
    s_cmp_lt_u32 s49, 5
    s_cbranch_scc1 L_q2loop_L
    s_waitcnt vmcnt(17) lgkmcnt(0)
    s_barrier
    s_add_u32 s69, s63, s55
    s_and_b32 s69, s69, 15
    s_and_b32 s68, s55, 16
    s_or_b32 s69, s69, s68
    s_xor_b32 s69, s69, s73
    s_add_u32 m0, s45, s53
    s_mul_i32 s69, s69, 12288
    buffer_load_dwordx4 v213, s[24:27], s69 offen nt lds
    s_add_u32 s53, s53, 12288
    s_cmp_ge_u32 s53, 86016
    s_cselect_b32 s53, 0, s53
    buffer_load_dwordx4 v214, s[24:27], s69 offen offset:1024 nt lds
    buffer_load_dwordx4 v215, s[24:27], s69 offen offset:2048 nt lds
    s_add_u32 s55, s55, 1
L_qend_L:
    v_mfma_f32_16x16x32_bf16 v[36:39], v[180:183], v[120:123], v[36:39]
    v_add_u32 v205, s52, v204
    v_xor_b32 v206, 64, v205
    v_mfma_f32_16x16x32_bf16 v[40:43], v[184:187], v[120:123], v[40:43]
    v_mov_b32 v160, 0
    v_mov_b32 v161, 0
    v_mfma_f32_16x16x32_bf16 v[44:47], v[188:191], v[120:123], v[44:47]
    v_mov_b32 v162, 0
    v_mov_b32 v163, 0
    v_mul_f32 v0, s56, v0
    v_mul_f32 v1, s56, v1
    v_mul_f32 v2, s56, v2
    v_mul_f32 v3, s56, v3
    v_mul_f32 v4, s56, v4
    v_mul_f32 v5, s56, v5
    v_mul_f32 v6, s56, v6
    v_mul_f32 v7, s56, v7
    v_cvt_pk_bf16_f32 v96, v0, v1
    v_cvt_pk_bf16_f32 v97, v2, v3
    v_cvt_pk_bf16_f32 v98, v4, v5
    v_cvt_pk_bf16_f32 v99, v6, v7
    s_nop 1
    v_permlane32_swap_b32 v96, v98
    v_permlane32_swap_b32 v97, v99
    s_nop 1
    v_permlane16_swap_b32 v96, v98
    v_permlane16_swap_b32 v97, v99
    v_mul_f32 v8, s56, v8
    v_mul_f32 v9, s56, v9
    v_mul_f32 v10, s56, v10
    v_mul_f32 v11, s56, v11
    v_mul_f32 v12, s56, v12
    v_mul_f32 v13, s56, v13
    v_mul_f32 v14, s56, v14
    v_mul_f32 v15, s56, v15
    v_cvt_pk_bf16_f32 v100, v8, v9
    v_cvt_pk_bf16_f32 v101, v10, v11
    v_cvt_pk_bf16_f32 v102, v12, v13
    v_cvt_pk_bf16_f32 v103, v14, v15
    s_nop 1
    v_permlane32_swap_b32 v100, v102
    v_permlane32_swap_b32 v101, v103
    s_nop 1
    v_permlane16_swap_b32 v100, v102
    v_permlane16_swap_b32 v101, v103
    v_mul_f32 v16, s56, v16
    v_mul_f32 v17, s56, v17
    v_mul_f32 v18, s56, v18
    v_mul_f32 v19, s56, v19
    v_mul_f32 v20, s56, v20
    v_mul_f32 v21, s56, v21
    v_mul_f32 v22, s56, v22
    v_mul_f32 v23, s56, v23
    v_cvt_pk_bf16_f32 v104, v16, v17
    v_cvt_pk_bf16_f32 v105, v18, v19
    v_cvt_pk_bf16_f32 v106, v20, v21
    v_cvt_pk_bf16_f32 v107, v22, v23
    s_nop 1
    v_permlane32_swap_b32 v104, v106
    v_permlane32_swap_b32 v105, v107
    s_nop 1
    v_permlane16_swap_b32 v104, v106
    v_permlane16_swap_b32 v105, v107
    s_setprio 1
    s_waitcnt vmcnt(13)
    s_barrier
    ds_read_b128 v[168:171], v205
    ds_read_b128 v[172:175], v205 offset:1536
    ds_read_b128 v[176:179], v206
    ds_read_b128 v[180:183], v206 offset:1536
    ds_read_b128 v[184:187], v205 offset:128
    s_waitcnt lgkmcnt(3)
    v_mfma_f32_16x16x32_bf16 v[144:147], v[168:171], v[96:99], 0
    ds_read_b128 v[188:191], v205 offset:1664
    v_mul_f32 v24, s56, v24
    v_mul_f32 v25, s56, v25
    v_mul_f32 v26, s56, v26
    v_mul_f32 v27, s56, v27
    v_mul_f32 v28, s56, v28
    v_mul_f32 v29, s56, v29
    s_add_u32 s52, s52, 12288
    s_cmp_ge_u32 s52, 86016
    s_cselect_b32 s52, 0, s52
    v_mfma_f32_16x16x32_bf16 v[148:151], v[172:175], v[96:99], 0
    ds_read_b128 v[168:171], v206 offset:128
    v_mul_f32 v30, s56, v30
    v_mul_f32 v31, s56, v31
    v_cvt_pk_bf16_f32 v108, v24, v25
    v_cvt_pk_bf16_f32 v109, v26, v27
    v_cvt_pk_bf16_f32 v110, v28, v29
    v_cvt_pk_bf16_f32 v111, v30, v31
    s_waitcnt lgkmcnt(3)
    v_mfma_f32_16x16x32_bf16 v[144:147], v[176:179], v[100:103], v[144:147]
    ds_read_b128 v[172:175], v206 offset:1664
    s_nop 1
    v_permlane32_swap_b32 v108, v110
    v_permlane32_swap_b32 v109, v111
    s_nop 1
    v_permlane16_swap_b32 v108, v110
    v_permlane16_swap_b32 v109, v111
    v_mfma_f32_16x16x32_bf16 v[148:151], v[180:183], v[100:103], v[148:151]
    ds_read_b128 v[176:179], v205 offset:256
    v_mul_f32 v32, s56, v32
    v_mul_f32 v33, s56, v33
    v_mul_f32 v34, s56, v34
    v_mul_f32 v35, s56, v35
    v_mul_f32 v36, s56, v36
    v_mul_f32 v37, s56, v37
    s_waitcnt lgkmcnt(3)
    v_mfma_f32_16x16x32_bf16 v[144:147], v[184:187], v[104:107], v[144:147]
    ds_read_b128 v[180:183], v205 offset:1792
    v_mul_f32 v38, s56, v38
    v_mul_f32 v39, s56, v39
    v_cvt_pk_bf16_f32 v112, v32, v33
    v_cvt_pk_bf16_f32 v113, v34, v35
    v_cvt_pk_bf16_f32 v114, v36, v37
    v_cvt_pk_bf16_f32 v115, v38, v39
    v_mfma_f32_16x16x32_bf16 v[148:151], v[188:191], v[104:107], v[148:151]
    ds_read_b128 v[184:187], v206 offset:256
    s_nop 1
    v_permlane32_swap_b32 v112, v114
    v_permlane32_swap_b32 v113, v115
    s_nop 1
    v_permlane16_swap_b32 v112, v114
    v_permlane16_swap_b32 v113, v115
    s_waitcnt lgkmcnt(3)
    v_mfma_f32_16x16x32_bf16 v[144:147], v[168:171], v[108:111], v[144:147]
    ds_read_b128 v[188:191], v206 offset:1792
    v_mul_f32 v40, s56, v40
    v_mul_f32 v41, s56, v41
    v_mul_f32 v42, s56, v42
    v_mul_f32 v43, s56, v43
    v_mul_f32 v44, s56, v44
    v_mul_f32 v45, s56, v45
    v_mfma_f32_16x16x32_bf16 v[148:151], v[172:175], v[108:111], v[148:151]
    v_mul_f32 v46, s56, v46
    v_mul_f32 v47, s56, v47
    v_cvt_pk_bf16_f32 v116, v40, v41
    v_cvt_pk_bf16_f32 v117, v42, v43
    v_cvt_pk_bf16_f32 v118, v44, v45
    v_cvt_pk_bf16_f32 v119, v46, v47
    s_waitcnt lgkmcnt(3)
    v_mfma_f32_16x16x32_bf16 v[144:147], v[176:179], v[112:115], v[144:147]
    s_nop 1
    v_permlane32_swap_b32 v116, v118
    v_permlane32_swap_b32 v117, v119
    s_nop 1
    v_permlane16_swap_b32 v116, v118
    v_permlane16_swap_b32 v117, v119
    s_waitcnt vmcnt(10) lgkmcnt(0)
    s_barrier
    v_mfma_f32_16x16x32_bf16 v[148:151], v[180:183], v[112:115], v[148:151]
    v_mfma_f32_16x16x32_bf16 v[144:147], v[184:187], v[116:119], v[144:147]
    v_mfma_f32_16x16x32_bf16 v[148:151], v[188:191], v[116:119], v[148:151]
    v_mfma_f32_16x16x32_bf16 v[0:3], v[200:203], v[160:163], 0
    v_mfma_f32_16x16x32_bf16 v[4:7], v[200:203], v[160:163], 0
    v_mfma_f32_16x16x32_bf16 v[8:11], v[200:203], v[160:163], 0
    s_add_u32 s52, s52, 12288
    s_cmp_ge_u32 s52, 86016
    s_cselect_b32 s52, 0, s52
    v_add_u32 v205, s52, v204
    v_xor_b32 v206, 64, v205
    v_mfma_f32_16x16x32_bf16 v[12:15], v[200:203], v[160:163], 0
    v_max3_f32 v207, v144, v145, v146
    v_max3_f32 v207, v207, v147, v148
    v_max3_f32 v207, v207, v149, v150
    v_mfma_f32_16x16x32_bf16 v[16:19], v[200:203], v[160:163], 0
    v_max_f32 v207, v207, v151
    v_mov_b32 v209, v207
    s_nop 1
    v_mfma_f32_16x16x32_bf16 v[20:23], v[200:203], v[160:163], 0
    v_permlane32_swap_b32 v207, v209
    v_max_f32 v207, v207, v209
    v_mov_b32 v209, v207
    v_mfma_f32_16x16x32_bf16 v[24:27], v[200:203], v[160:163], 0
    s_nop 1
    v_permlane16_swap_b32 v207, v209
    v_max_f32 v207, v207, v209
    v_mfma_f32_16x16x32_bf16 v[28:31], v[200:203], v[160:163], 0
    v_sub_f32 v144, v144, v207
    v_sub_f32 v145, v145, v207
    v_sub_f32 v146, v146, v207
    v_mfma_f32_16x16x32_bf16 v[32:35], v[200:203], v[160:163], 0
    v_sub_f32 v147, v147, v207
    v_sub_f32 v148, v148, v207
    v_sub_f32 v149, v149, v207
    v_mfma_f32_16x16x32_bf16 v[36:39], v[200:203], v[160:163], 0
    v_sub_f32 v150, v150, v207
    v_sub_f32 v151, v151, v207
    v_sub_f32 v192, 0, v207
    v_mfma_f32_16x16x32_bf16 v[40:43], v[200:203], v[160:163], 0
    v_sub_f32 v193, 0, v207
    v_sub_f32 v194, 0, v207
    v_sub_f32 v195, 0, v207
    v_mfma_f32_16x16x32_bf16 v[44:47], v[200:203], v[160:163], 0
    v_exp_f32 v144, v144
    v_exp_f32 v145, v145
    v_exp_f32 v146, v146
    v_mfma_f32_16x16x32_bf16 v[216:219], v[200:203], v[160:163], 0
    s_mov_b32 s58, 0
    s_mov_b32 s49, 0
    s_waitcnt vmcnt(0)
L_aloop_L:
    s_waitcnt lgkmcnt(0)
    s_barrier
    ds_read_b128 v[168:171], v205
    ds_read_b128 v[172:175], v205 offset:1536
    v_mfma_f32_16x16x32_bf16 v[36:39], v[180:183], v[160:163], v[36:39]
    ds_read_b128 v[176:179], v206
    v_mfma_f32_16x16x32_bf16 v[40:43], v[184:187], v[160:163], v[40:43]
    ds_read_b128 v[180:183], v206 offset:1536
    v_exp_f32 v147, v147
    v_mfma_f32_16x16x32_bf16 v[44:47], v[188:191], v[160:163], v[44:47]
    ds_read_b128 v[184:187], v205 offset:128
    v_exp_f32 v148, v148
    s_cmp_lg_u32 s58, 0
    s_cbranch_scc1 L_resc_l0_L
L_rret_l0_L:
    s_waitcnt lgkmcnt(3)
    v_mfma_f32_16x16x32_bf16 v[232:235], v[168:171], v[96:99], v[192:195]
    ds_read_b128 v[188:191], v205 offset:1664
    v_mfma_f32_16x16x32_bf16 v[236:239], v[172:175], v[96:99], v[192:195]
    ds_read_b128 v[168:171], v206 offset:128
    v_exp_f32 v149, v149
    s_waitcnt lgkmcnt(3)
    v_mfma_f32_16x16x32_bf16 v[232:235], v[176:179], v[100:103], v[232:235]
    ds_read_b128 v[172:175], v206 offset:1664
    v_exp_f32 v150, v150
    v_mfma_f32_16x16x32_bf16 v[236:239], v[180:183], v[100:103], v[236:239]
    ds_read_b128 v[176:179], v205 offset:256
    s_waitcnt lgkmcnt(3)
    v_mfma_f32_16x16x32_bf16 v[232:235], v[184:187], v[104:107], v[232:235]
    ds_read_b128 v[180:183], v205 offset:1792
    v_exp_f32 v151, v151
    v_mfma_f32_16x16x32_bf16 v[236:239], v[188:191], v[104:107], v[236:239]
    ds_read_b128 v[184:187], v206 offset:256
    v_cvt_pk_bf16_f32 v160, v144, v145
    s_waitcnt lgkmcnt(3)
    v_mfma_f32_16x16x32_bf16 v[232:235], v[168:171], v[108:111], v[232:235]
    ds_read_b128 v[188:191], v206 offset:1792
    v_cvt_pk_bf16_f32 v161, v146, v147
    v_cvt_pk_bf16_f32 v162, v148, v149
    v_mfma_f32_16x16x32_bf16 v[236:239], v[172:175], v[108:111], v[236:239]
    v_cvt_pk_bf16_f32 v163, v150, v151
    s_add_u32 s52, s52, 12288
    s_cmp_ge_u32 s52, 86016
    s_cselect_b32 s52, 0, s52
    s_waitcnt lgkmcnt(3)
    v_mfma_f32_16x16x32_bf16 v[232:235], v[176:179], v[112:115], v[232:235]
    v_add_u32 v225, s52, v224
    v_xor_b32 v226, 32, v225
    v_xor_b32 v227, 64, v225
    v_xor_b32 v228, 96, v225
    s_waitcnt lgkmcnt(0)
    s_barrier
    ds_read_b64_tr_b16 v[168:169], v225
    ds_read_b64_tr_b16 v[170:171], v225 offset:1536
    ds_read_b64_tr_b16 v[172:173], v226
    ds_read_b64_tr_b16 v[174:175], v226 offset:1536
    v_mfma_f32_16x16x32_bf16 v[236:239], v[180:183], v[112:115], v[236:239]
    ds_read_b64_tr_b16 v[176:177], v227
    ds_read_b64_tr_b16 v[178:179], v227 offset:1536
    s_add_u32 s52, s52, 12288
    s_cmp_ge_u32 s52, 86016
    s_cselect_b32 s52, 0, s52
    v_mfma_f32_16x16x32_bf16 v[232:235], v[184:187], v[116:119], v[232:235]
    ds_read_b64_tr_b16 v[180:181], v228
    ds_read_b64_tr_b16 v[182:183], v228 offset:1536
    v_mfma_f32_16x16x32_bf16 v[236:239], v[188:191], v[116:119], v[236:239]
    ds_read_b64_tr_b16 v[184:185], v225 offset:128
    ds_read_b64_tr_b16 v[186:187], v225 offset:1664
    v_add_u32 v205, s52, v204
    v_xor_b32 v206, 64, v205
    v_mfma_f32_16x16x32_bf16 v[216:219], v[200:203], v[160:163], v[216:219]
    s_waitcnt lgkmcnt(6)
    v_mfma_f32_16x16x32_bf16 v[0:3], v[168:171], v[160:163], v[0:3]
    ds_read_b64_tr_b16 v[188:189], v226 offset:128
    ds_read_b64_tr_b16 v[190:191], v226 offset:1664
    v_mfma_f32_16x16x32_bf16 v[4:7], v[172:175], v[160:163], v[4:7]
    ds_read_b64_tr_b16 v[168:169], v227 offset:128
    ds_read_b64_tr_b16 v[170:171], v227 offset:1664
    v_max3_f32 v207, v232, v233, v234
    v_max3_f32 v207, v207, v235, v236
    s_waitcnt lgkmcnt(6)
    v_mfma_f32_16x16x32_bf16 v[8:11], v[176:179], v[160:163], v[8:11]
    ds_read_b64_tr_b16 v[172:173], v228 offset:128
    ds_read_b64_tr_b16 v[174:175], v228 offset:1664
    v_max3_f32 v207, v207, v237, v238
    v_max_f32 v207, v207, v239
    v_cmp_lt_f32 vcc, s57, v207
    s_cbranch_vccnz L_rare_l0_L
L_ret_l0_L:
    v_mfma_f32_16x16x32_bf16 v[12:15], v[180:183], v[160:163], v[12:15]
    ds_read_b64_tr_b16 v[176:177], v225 offset:256
    ds_read_b64_tr_b16 v[178:179], v225 offset:1792
    s_waitcnt lgkmcnt(6)
    v_mfma_f32_16x16x32_bf16 v[16:19], v[184:187], v[160:163], v[16:19]
    ds_read_b64_tr_b16 v[180:181], v226 offset:256
    ds_read_b64_tr_b16 v[182:183], v226 offset:1792
    v_exp_f32 v232, v232
    v_mfma_f32_16x16x32_bf16 v[20:23], v[188:191], v[160:163], v[20:23]
    ds_read_b64_tr_b16 v[184:185], v227 offset:256
    ds_read_b64_tr_b16 v[186:187], v227 offset:1792
    s_waitcnt lgkmcnt(6)
    v_mfma_f32_16x16x32_bf16 v[24:27], v[168:171], v[160:163], v[24:27]
    ds_read_b64_tr_b16 v[188:189], v228 offset:256
    ds_read_b64_tr_b16 v[190:191], v228 offset:1792
    v_exp_f32 v233, v233
    v_mfma_f32_16x16x32_bf16 v[28:31], v[172:175], v[160:163], v[28:31]
    s_waitcnt lgkmcnt(6)
    v_mfma_f32_16x16x32_bf16 v[32:35], v[176:179], v[160:163], v[32:35]
    v_exp_f32 v234, v234
    s_add_u32 s49, s49, 1
    s_cmp_eq_u32 s49, 8
    s_cbranch_scc1 L_aexit_L
    s_waitcnt lgkmcnt(0)
    s_barrier
    ds_read_b128 v[168:171], v205
    ds_read_b128 v[172:175], v205 offset:1536
    v_mfma_f32_16x16x32_bf16 v[36:39], v[180:183], v[160:163], v[36:39]
    ds_read_b128 v[176:179], v206
    v_mfma_f32_16x16x32_bf16 v[40:43], v[184:187], v[160:163], v[40:43]
    ds_read_b128 v[180:183], v206 offset:1536
    v_exp_f32 v235, v235
    v_mfma_f32_16x16x32_bf16 v[44:47], v[188:191], v[160:163], v[44:47]
    ds_read_b128 v[184:187], v205 offset:128
    v_exp_f32 v236, v236
    s_cmp_lg_u32 s58, 0
    s_cbranch_scc1 L_resc_l1_L
L_rret_l1_L:
    s_waitcnt lgkmcnt(3)
    v_mfma_f32_16x16x32_bf16 v[144:147], v[168:171], v[96:99], v[192:195]
    ds_read_b128 v[188:191], v205 offset:1664
    v_mfma_f32_16x16x32_bf16 v[148:151], v[172:175], v[96:99], v[192:195]
    ds_read_b128 v[168:171], v206 offset:128
    v_exp_f32 v237, v237
    s_waitcnt lgkmcnt(3)
    v_mfma_f32_16x16x32_bf16 v[144:147], v[176:179], v[100:103], v[144:147]
    ds_read_b128 v[172:175], v206 offset:1664
    v_exp_f32 v238, v238
    v_mfma_f32_16x16x32_bf16 v[148:151], v[180:183], v[100:103], v[148:151]
    ds_read_b128 v[176:179], v205 offset:256
    s_waitcnt lgkmcnt(3)
    v_mfma_f32_16x16x32_bf16 v[144:147], v[184:187], v[104:107], v[144:147]
    ds_read_b128 v[180:183], v205 offset:1792
    v_exp_f32 v239, v239
    v_mfma_f32_16x16x32_bf16 v[148:151], v[188:191], v[104:107], v[148:151]
    ds_read_b128 v[184:187], v206 offset:256
    v_cvt_pk_bf16_f32 v160, v232, v233
    s_waitcnt lgkmcnt(3)
    v_mfma_f32_16x16x32_bf16 v[144:147], v[168:171], v[108:111], v[144:147]
    ds_read_b128 v[188:191], v206 offset:1792
    v_cvt_pk_bf16_f32 v161, v234, v235
    v_cvt_pk_bf16_f32 v162, v236, v237
    v_mfma_f32_16x16x32_bf16 v[148:151], v[172:175], v[108:111], v[148:151]
    v_cvt_pk_bf16_f32 v163, v238, v239
    s_add_u32 s52, s52, 12288
    s_cmp_ge_u32 s52, 86016
    s_cselect_b32 s52, 0, s52
    s_waitcnt lgkmcnt(3)
    v_mfma_f32_16x16x32_bf16 v[144:147], v[176:179], v[112:115], v[144:147]
    v_add_u32 v225, s52, v224
    v_xor_b32 v226, 32, v225
    v_xor_b32 v227, 64, v225
    v_xor_b32 v228, 96, v225
    s_waitcnt lgkmcnt(0)
    s_barrier
    ds_read_b64_tr_b16 v[168:169], v225
    ds_read_b64_tr_b16 v[170:171], v225 offset:1536
    ds_read_b64_tr_b16 v[172:173], v226
    ds_read_b64_tr_b16 v[174:175], v226 offset:1536
    v_mfma_f32_16x16x32_bf16 v[148:151], v[180:183], v[112:115], v[148:151]
    ds_read_b64_tr_b16 v[176:177], v227
    ds_read_b64_tr_b16 v[178:179], v227 offset:1536
    s_add_u32 s52, s52, 12288
    s_cmp_ge_u32 s52, 86016
    s_cselect_b32 s52, 0, s52
    v_mfma_f32_16x16x32_bf16 v[144:147], v[184:187], v[116:119], v[144:147]
    ds_read_b64_tr_b16 v[180:181], v228
    ds_read_b64_tr_b16 v[182:183], v228 offset:1536
    v_mfma_f32_16x16x32_bf16 v[148:151], v[188:191], v[116:119], v[148:151]
    ds_read_b64_tr_b16 v[184:185], v225 offset:128
    ds_read_b64_tr_b16 v[186:187], v225 offset:1664
    v_add_u32 v205, s52, v204
    v_xor_b32 v206, 64, v205
    v_mfma_f32_16x16x32_bf16 v[216:219], v[200:203], v[160:163], v[216:219]
    s_waitcnt lgkmcnt(6)
    v_mfma_f32_16x16x32_bf16 v[0:3], v[168:171], v[160:163], v[0:3]
    ds_read_b64_tr_b16 v[188:189], v226 offset:128
    ds_read_b64_tr_b16 v[190:191], v226 offset:1664
    v_mfma_f32_16x16x32_bf16 v[4:7], v[172:175], v[160:163], v[4:7]
    ds_read_b64_tr_b16 v[168:169], v227 offset:128
    ds_read_b64_tr_b16 v[170:171], v227 offset:1664
    v_max3_f32 v207, v144, v145, v146
    v_max3_f32 v207, v207, v147, v148
    s_waitcnt lgkmcnt(6)
    v_mfma_f32_16x16x32_bf16 v[8:11], v[176:179], v[160:163], v[8:11]
    ds_read_b64_tr_b16 v[172:173], v228 offset:128
    ds_read_b64_tr_b16 v[174:175], v228 offset:1664
    v_max3_f32 v207, v207, v149, v150
    v_max_f32 v207, v207, v151
    v_cmp_lt_f32 vcc, s57, v207
    s_cbranch_vccnz L_rare_l1_L
L_ret_l1_L:
    v_mfma_f32_16x16x32_bf16 v[12:15], v[180:183], v[160:163], v[12:15]
    ds_read_b64_tr_b16 v[176:177], v225 offset:256
    ds_read_b64_tr_b16 v[178:179], v225 offset:1792
    s_waitcnt lgkmcnt(6)
    v_mfma_f32_16x16x32_bf16 v[16:19], v[184:187], v[160:163], v[16:19]
    ds_read_b64_tr_b16 v[180:181], v226 offset:256
    ds_read_b64_tr_b16 v[182:183], v226 offset:1792
    v_exp_f32 v144, v144
    v_mfma_f32_16x16x32_bf16 v[20:23], v[188:191], v[160:163], v[20:23]
    ds_read_b64_tr_b16 v[184:185], v227 offset:256
    ds_read_b64_tr_b16 v[186:187], v227 offset:1792
    s_waitcnt lgkmcnt(6)
    v_mfma_f32_16x16x32_bf16 v[24:27], v[168:171], v[160:163], v[24:27]
    ds_read_b64_tr_b16 v[188:189], v228 offset:256
    ds_read_b64_tr_b16 v[190:191], v228 offset:1792
    v_exp_f32 v145, v145
    v_mfma_f32_16x16x32_bf16 v[28:31], v[172:175], v[160:163], v[28:31]
    s_waitcnt lgkmcnt(6)
    v_mfma_f32_16x16x32_bf16 v[32:35], v[176:179], v[160:163], v[32:35]
    v_exp_f32 v146, v146
    s_branch L_aloop_L
L_aexit_L:
    s_cmp_lg_u32 s41, 0
    s_cbranch_scc1 L_g2tail_L
    s_waitcnt lgkmcnt(0)
    s_barrier
    v_mfma_f32_16x16x32_bf16 v[36:39], v[180:183], v[160:163], v[36:39]
    v_exp_f32 v235, v235
    v_exp_f32 v236, v236
    v_mfma_f32_16x16x32_bf16 v[40:43], v[184:187], v[160:163], v[40:43]
    v_exp_f32 v237, v237
    v_exp_f32 v238, v238
    v_mfma_f32_16x16x32_bf16 v[44:47], v[188:191], v[160:163], v[44:47]
    s_add_u32 s69, s63, 2
    s_and_b32 s69, s69, 15
    s_or_b32 s69, s69, s74
    s_add_u32 m0, s45, 12288
    s_mul_i32 s69, s69, 12288
    buffer_load_dwordx4 v210, s[20:23], s69 offen nt lds
    buffer_load_dwordx4 v211, s[20:23], s69 offen offset:1024 nt lds
    buffer_load_dwordx4 v212, s[20:23], s69 offen offset:2048 nt lds
    v_exp_f32 v239, v239
    v_cvt_pk_bf16_f32 v160, v232, v233
    v_cvt_pk_bf16_f32 v161, v234, v235
    v_cvt_pk_bf16_f32 v162, v236, v237
    v_cvt_pk_bf16_f32 v163, v238, v239
    s_cmp_lg_u32 s58, 0
    s_cbranch_scc1 L_resc_e0_L
L_rret_e0_L:
    s_add_u32 s52, s52, 12288
    s_cmp_ge_u32 s52, 86016
    s_cselect_b32 s52, 0, s52
    v_mfma_f32_16x16x32_bf16 v[216:219], v[200:203], v[160:163], v[216:219]
    v_add_u32 v225, s52, v224
    v_xor_b32 v226, 32, v225
    v_xor_b32 v227, 64, v225
    v_xor_b32 v228, 96, v225
    s_add_u32 s68, s65, 1
    s_sub_u32 s64, s68, 10
    s_cselect_b32 s68, s68, s64
    s_lshl_b32 s68, s68, 7
    s_add_u32 s68, s68, s60
    s_add_u32 m0, s59, 86016
    s_add_u32 s66, s68, 0
    buffer_load_dwordx4 v248, s[32:35], s66 offen lds
    s_add_u32 s67, s68, 9216
    buffer_load_dwordx4 v248, s[32:35], s67 offen offset:1024 lds
    s_add_u32 s68, s68, 18432
    buffer_load_dwordx4 v248, s[32:35], s68 offen offset:2048 lds
    v_rcp_f32 v230, v216
    s_barrier
    ds_read_b64_tr_b16 v[168:169], v225
    ds_read_b64_tr_b16 v[170:171], v225 offset:1536
    ds_read_b64_tr_b16 v[172:173], v226
    ds_read_b64_tr_b16 v[174:175], v226 offset:1536
    ds_read_b64_tr_b16 v[176:177], v227
    ds_read_b64_tr_b16 v[178:179], v227 offset:1536
    ds_read_b64_tr_b16 v[180:181], v228
    ds_read_b64_tr_b16 v[182:183], v228 offset:1536
    ds_read_b64_tr_b16 v[184:185], v225 offset:128
    ds_read_b64_tr_b16 v[186:187], v225 offset:1664
    s_waitcnt lgkmcnt(6)
    v_mfma_f32_16x16x32_bf16 v[0:3], v[168:171], v[160:163], v[0:3]
    ds_read_b64_tr_b16 v[188:189], v226 offset:128
    ds_read_b64_tr_b16 v[190:191], v226 offset:1664
    s_add_u32 s69, s63, 1
    s_and_b32 s69, s69, 15
    s_or_b32 s69, s69, s74
    s_add_u32 m0, s45, 24576
    s_mul_i32 s69, s69, 12288
    buffer_load_dwordx4 v213, s[24:27], s69 offen nt lds
    v_mfma_f32_16x16x32_bf16 v[4:7], v[172:175], v[160:163], v[4:7]
    ds_read_b64_tr_b16 v[168:169], v227 offset:128
    ds_read_b64_tr_b16 v[170:171], v227 offset:1664
    buffer_load_dwordx4 v214, s[24:27], s69 offen offset:1024 nt lds
    s_waitcnt lgkmcnt(6)
    v_mfma_f32_16x16x32_bf16 v[8:11], v[176:179], v[160:163], v[8:11]
    ds_read_b64_tr_b16 v[172:173], v228 offset:128
    ds_read_b64_tr_b16 v[174:175], v228 offset:1664
    buffer_load_dwordx4 v215, s[24:27], s69 offen offset:2048 nt lds
    v_mfma_f32_16x16x32_bf16 v[12:15], v[180:183], v[160:163], v[12:15]
    ds_read_b64_tr_b16 v[176:177], v225 offset:256
    ds_read_b64_tr_b16 v[178:179], v225 offset:1792
    s_add_u32 s68, s65, 1
    s_sub_u32 s64, s68, 10
    s_cselect_b32 s68, s68, s64
    s_lshl_b32 s68, s68, 7
    s_add_u32 s68, s68, s60
    s_add_u32 m0, s59, 89088
    s_add_u32 s66, s68, 30720
    buffer_load_dwordx4 v248, s[32:35], s66 offen lds
    s_waitcnt lgkmcnt(6)
    v_mfma_f32_16x16x32_bf16 v[16:19], v[184:187], v[160:163], v[16:19]
    ds_read_b64_tr_b16 v[180:181], v226 offset:256
    ds_read_b64_tr_b16 v[182:183], v226 offset:1792
    s_add_u32 s67, s68, 39936
    buffer_load_dwordx4 v248, s[32:35], s67 offen offset:1024 lds
    v_mfma_f32_16x16x32_bf16 v[20:23], v[188:191], v[160:163], v[20:23]
    ds_read_b64_tr_b16 v[184:185], v227 offset:256
    ds_read_b64_tr_b16 v[186:187], v227 offset:1792
    s_add_u32 s68, s68, 49152
    buffer_load_dwordx4 v248, s[32:35], s68 offen offset:2048 lds
    s_waitcnt lgkmcnt(6)
    v_mfma_f32_16x16x32_bf16 v[24:27], v[168:171], v[160:163], v[24:27]
    ds_read_b64_tr_b16 v[188:189], v228 offset:256
    ds_read_b64_tr_b16 v[190:191], v228 offset:1792
    v_mfma_f32_16x16x32_bf16 v[28:31], v[172:175], v[160:163], v[28:31]
    s_waitcnt lgkmcnt(6)
    v_mfma_f32_16x16x32_bf16 v[32:35], v[176:179], v[160:163], v[32:35]
    s_setprio 0
    s_waitcnt lgkmcnt(0)
    s_barrier
    v_mfma_f32_16x16x32_bf16 v[36:39], v[180:183], v[160:163], v[36:39]
    v_mfma_f32_16x16x32_bf16 v[40:43], v[184:187], v[160:163], v[40:43]
    v_mfma_f32_16x16x32_bf16 v[44:47], v[188:191], v[160:163], v[44:47]
    s_add_u32 s69, s63, 3
    s_and_b32 s69, s69, 15
    s_or_b32 s69, s69, s74
    s_add_u32 m0, s45, 36864
    s_mul_i32 s69, s69, 12288
    buffer_load_dwordx4 v210, s[20:23], s69 offen nt lds
    v_mul_f32 v0, v0, v230
    v_mul_f32 v1, v1, v230
    v_mul_f32 v2, v2, v230
    v_mul_f32 v3, v3, v230
    v_mul_f32 v4, v4, v230
    v_mul_f32 v5, v5, v230
    v_mul_f32 v6, v6, v230
    v_mul_f32 v7, v7, v230
    buffer_load_dwordx4 v211, s[20:23], s69 offen offset:1024 nt lds
    v_cvt_pk_bf16_f32 v96, v0, v1
    v_cvt_pk_bf16_f32 v97, v2, v3
    v_cvt_pk_bf16_f32 v98, v4, v5
    v_cvt_pk_bf16_f32 v99, v6, v7
    buffer_load_dwordx4 v212, s[20:23], s69 offen offset:2048 nt lds
    v_mul_f32 v8, v8, v230
    v_mul_f32 v9, v9, v230
    v_mul_f32 v10, v10, v230
    v_mul_f32 v11, v11, v230
    v_mul_f32 v12, v12, v230
    v_mul_f32 v13, v13, v230
    v_mul_f32 v14, v14, v230
    v_mul_f32 v15, v15, v230
    s_add_u32 s68, s65, 2
    s_sub_u32 s64, s68, 10
    s_cselect_b32 s68, s68, s64
    s_lshl_b32 s68, s68, 7
    s_add_u32 s68, s68, s60
    s_add_u32 m0, s59, 110592
    s_add_u32 s66, s68, 0
    buffer_load_dwordx4 v248, s[32:35], s66 offen lds
    v_cvt_pk_bf16_f32 v100, v8, v9
    v_cvt_pk_bf16_f32 v101, v10, v11
    v_cvt_pk_bf16_f32 v102, v12, v13
    v_cvt_pk_bf16_f32 v103, v14, v15
    s_add_u32 s67, s68, 9216
    buffer_load_dwordx4 v248, s[32:35], s67 offen offset:1024 lds
    v_mul_f32 v16, v16, v230
    v_mul_f32 v17, v17, v230
    v_mul_f32 v18, v18, v230
    v_mul_f32 v19, v19, v230
    v_mul_f32 v20, v20, v230
    v_mul_f32 v21, v21, v230
    v_mul_f32 v22, v22, v230
    v_mul_f32 v23, v23, v230
    s_add_u32 s68, s68, 18432
    buffer_load_dwordx4 v248, s[32:35], s68 offen offset:2048 lds
    v_cvt_pk_bf16_f32 v104, v16, v17
    v_cvt_pk_bf16_f32 v105, v18, v19
    v_cvt_pk_bf16_f32 v106, v20, v21
    v_cvt_pk_bf16_f32 v107, v22, v23
    v_mov_b32 v160, 0
    v_mov_b32 v161, 0
    v_mov_b32 v162, 0
    v_mov_b32 v163, 0
    v_mov_b32 v164, 159744
    ds_write_b128 v164, v[160:163]
    s_waitcnt lgkmcnt(0)
    s_waitcnt vmcnt(7)
    s_barrier
    s_add_u32 s69, s63, 2
    s_and_b32 s69, s69, 15
    s_or_b32 s69, s69, s74
    s_add_u32 m0, s45, 49152
    s_mul_i32 s69, s69, 12288
    buffer_load_dwordx4 v213, s[24:27], s69 offen nt lds
    v_mul_f32 v24, v24, v230
    v_mul_f32 v25, v25, v230
    v_mul_f32 v26, v26, v230
    v_mul_f32 v27, v27, v230
    v_mul_f32 v28, v28, v230
    v_mul_f32 v29, v29, v230
    v_mul_f32 v30, v30, v230
    v_mul_f32 v31, v31, v230
    buffer_load_dwordx4 v214, s[24:27], s69 offen offset:1024 nt lds
    v_cvt_pk_bf16_f32 v108, v24, v25
    v_cvt_pk_bf16_f32 v109, v26, v27
    v_cvt_pk_bf16_f32 v110, v28, v29
    v_cvt_pk_bf16_f32 v111, v30, v31
    buffer_load_dwordx4 v215, s[24:27], s69 offen offset:2048 nt lds
    v_mul_f32 v32, v32, v230
    v_mul_f32 v33, v33, v230
    v_mul_f32 v34, v34, v230
    v_mul_f32 v35, v35, v230
    v_mul_f32 v36, v36, v230
    v_mul_f32 v37, v37, v230
    v_mul_f32 v38, v38, v230
    v_mul_f32 v39, v39, v230
    s_add_u32 s68, s65, 2
    s_sub_u32 s64, s68, 10
    s_cselect_b32 s68, s68, s64
    s_lshl_b32 s68, s68, 7
    s_add_u32 s68, s68, s60
    s_add_u32 m0, s59, 113664
    s_add_u32 s66, s68, 30720
    buffer_load_dwordx4 v248, s[32:35], s66 offen lds
    v_cvt_pk_bf16_f32 v112, v32, v33
    v_cvt_pk_bf16_f32 v113, v34, v35
    v_cvt_pk_bf16_f32 v114, v36, v37
    v_cvt_pk_bf16_f32 v115, v38, v39
    s_add_u32 s67, s68, 39936
    buffer_load_dwordx4 v248, s[32:35], s67 offen offset:1024 lds
    v_mul_f32 v40, v40, v230
    v_mul_f32 v41, v41, v230
    v_mul_f32 v42, v42, v230
    v_mul_f32 v43, v43, v230
    v_mul_f32 v44, v44, v230
    v_mul_f32 v45, v45, v230
    v_mul_f32 v46, v46, v230
    v_mul_f32 v47, v47, v230
    s_add_u32 s68, s68, 49152
    buffer_load_dwordx4 v248, s[32:35], s68 offen offset:2048 lds
    v_cvt_pk_bf16_f32 v116, v40, v41
    v_cvt_pk_bf16_f32 v117, v42, v43
    v_cvt_pk_bf16_f32 v118, v44, v45
    v_cvt_pk_bf16_f32 v119, v46, v47
    s_waitcnt vmcnt(6)
    s_barrier
    v_add_u32 v250, 86016, v249
    ds_read_b64_tr_b16 v[168:169], v250
    ds_read_b64_tr_b16 v[170:171], v250 offset:2048
    ds_read_b64_tr_b16 v[172:173], v250 offset:4096
    ds_read_b64_tr_b16 v[174:175], v250 offset:6144
    ds_read_b64_tr_b16 v[176:177], v250 offset:8192
    ds_read_b64_tr_b16 v[178:179], v250 offset:10240
    ds_read_b64_tr_b16 v[180:181], v250 offset:12288
    ds_read_b64_tr_b16 v[182:183], v250 offset:14336
    ds_read_b64_tr_b16 v[184:185], v250 offset:16384
    ds_read_b64_tr_b16 v[186:187], v250 offset:18432
    s_waitcnt lgkmcnt(6)
    v_mfma_f32_16x16x32_bf16 v[216:219], v[168:171], v[96:99], 0
    ds_read_b64_tr_b16 v[188:189], v250 offset:20480
    ds_read_b64_tr_b16 v[190:191], v250 offset:22528
    s_add_u32 s69, s63, 4
    s_and_b32 s69, s69, 15
    s_or_b32 s69, s69, s74
    s_add_u32 m0, s45, 61440
    s_mul_i32 s69, s69, 12288
    buffer_load_dwordx4 v210, s[20:23], s69 offen nt lds
    v_mfma_f32_16x16x32_bf16 v[216:219], v[172:175], v[100:103], v[216:219]
    v_xor_b32 v250, 32, v250
    ds_read_b64_tr_b16 v[168:169], v250
    ds_read_b64_tr_b16 v[170:171], v250 offset:2048
    buffer_load_dwordx4 v211, s[20:23], s69 offen offset:1024 nt lds
    s_waitcnt lgkmcnt(6)
    v_mfma_f32_16x16x32_bf16 v[216:219], v[176:179], v[104:107], v[216:219]
    buffer_load_dwordx4 v212, s[20:23], s69 offen offset:2048 nt lds
    v_mfma_f32_16x16x32_bf16 v[216:219], v[180:183], v[108:111], v[216:219]
    s_add_u32 s68, s65, 3
    s_sub_u32 s64, s68, 10
    s_cselect_b32 s68, s68, s64
    s_lshl_b32 s68, s68, 7
    s_add_u32 s68, s68, s60
    s_add_u32 m0, s59, 135168
    s_add_u32 s66, s68, 0
    buffer_load_dwordx4 v248, s[32:35], s66 offen lds
    s_add_u32 s67, s68, 9216
    buffer_load_dwordx4 v248, s[32:35], s67 offen offset:1024 lds
    s_add_u32 s68, s68, 18432
    buffer_load_dwordx4 v248, s[32:35], s68 offen offset:2048 lds
    s_waitcnt vmcnt(6) lgkmcnt(0)
    s_barrier
    ds_read_b64_tr_b16 v[172:173], v250 offset:4096
    ds_read_b64_tr_b16 v[174:175], v250 offset:6144
    ds_read_b64_tr_b16 v[176:177], v250 offset:8192
    ds_read_b64_tr_b16 v[178:179], v250 offset:10240
    v_mfma_f32_16x16x32_bf16 v[216:219], v[184:187], v[112:115], v[216:219]
    ds_read_b64_tr_b16 v[180:181], v250 offset:12288
    ds_read_b64_tr_b16 v[182:183], v250 offset:14336
    s_add_u32 s69, s63, 3
    s_and_b32 s69, s69, 15
    s_or_b32 s69, s69, s74
    s_add_u32 m0, s45, 73728
    s_mul_i32 s69, s69, 12288
    buffer_load_dwordx4 v213, s[24:27], s69 offen nt lds
    v_mfma_f32_16x16x32_bf16 v[216:219], v[188:191], v[116:119], v[216:219]
    ds_read_b64_tr_b16 v[184:185], v250 offset:16384
    ds_read_b64_tr_b16 v[186:187], v250 offset:18432
    buffer_load_dwordx4 v214, s[24:27], s69 offen offset:1024 nt lds
    v_mfma_f32_16x16x32_bf16 v[220:223], v[168:171], v[96:99], 0
    ds_read_b64_tr_b16 v[188:189], v250 offset:20480
    ds_read_b64_tr_b16 v[190:191], v250 offset:22528
    buffer_load_dwordx4 v215, s[24:27], s69 offen offset:2048 nt lds
    s_waitcnt lgkmcnt(6)
    v_mfma_f32_16x16x32_bf16 v[220:223], v[172:175], v[100:103], v[220:223]
    v_xor_b32 v250, 96, v250
    ds_read_b64_tr_b16 v[168:169], v250
    ds_read_b64_tr_b16 v[170:171], v250 offset:2048
    s_add_u32 s68, s65, 3
    s_sub_u32 s64, s68, 10
    s_cselect_b32 s68, s68, s64
    s_lshl_b32 s68, s68, 7
    s_add_u32 s68, s68, s60
    s_add_u32 m0, s59, 138240
    s_add_u32 s66, s68, 30720
    buffer_load_dwordx4 v248, s[32:35], s66 offen lds
    v_mfma_f32_16x16x32_bf16 v[220:223], v[176:179], v[104:107], v[220:223]
    ds_read_b64_tr_b16 v[172:173], v250 offset:4096
    ds_read_b64_tr_b16 v[174:175], v250 offset:6144
    s_add_u32 s67, s68, 39936
    buffer_load_dwordx4 v248, s[32:35], s67 offen offset:1024 lds
    s_waitcnt lgkmcnt(6)
    v_mfma_f32_16x16x32_bf16 v[220:223], v[180:183], v[108:111], v[220:223]
    ds_read_b64_tr_b16 v[176:177], v250 offset:8192
    ds_read_b64_tr_b16 v[178:179], v250 offset:10240
    s_add_u32 s68, s68, 49152
    buffer_load_dwordx4 v248, s[32:35], s68 offen offset:2048 lds
    v_mfma_f32_16x16x32_bf16 v[220:223], v[184:187], v[112:115], v[220:223]
    s_waitcnt lgkmcnt(6)
    v_mfma_f32_16x16x32_bf16 v[220:223], v[188:191], v[116:119], v[220:223]
    s_waitcnt vmcnt(6) lgkmcnt(0)
    s_barrier
    ds_read_b64_tr_b16 v[180:181], v250 offset:12288
    ds_read_b64_tr_b16 v[182:183], v250 offset:14336
    ds_read_b64_tr_b16 v[184:185], v250 offset:16384
    ds_read_b64_tr_b16 v[186:187], v250 offset:18432
    v_mfma_f32_16x16x32_bf16 v[232:235], v[168:171], v[96:99], 0
    ds_read_b64_tr_b16 v[188:189], v250 offset:20480
    ds_read_b64_tr_b16 v[190:191], v250 offset:22528
    s_add_u32 s69, s63, 5
    s_and_b32 s69, s69, 15
    s_or_b32 s69, s69, s74
    s_add_u32 m0, s45, 0
    s_mul_i32 s69, s69, 12288
    buffer_load_dwordx4 v210, s[20:23], s69 offen nt lds
    v_mfma_f32_16x16x32_bf16 v[232:235], v[172:175], v[100:103], v[232:235]
    v_xor_b32 v250, 32, v250
    ds_read_b64_tr_b16 v[168:169], v250
    ds_read_b64_tr_b16 v[170:171], v250 offset:2048
    buffer_load_dwordx4 v211, s[20:23], s69 offen offset:1024 nt lds
    v_mfma_f32_16x16x32_bf16 v[232:235], v[176:179], v[104:107], v[232:235]
    ds_read_b64_tr_b16 v[172:173], v250 offset:4096
    ds_read_b64_tr_b16 v[174:175], v250 offset:6144
    buffer_load_dwordx4 v212, s[20:23], s69 offen offset:2048 nt lds
    s_waitcnt lgkmcnt(6)
    v_mfma_f32_16x16x32_bf16 v[232:235], v[180:183], v[108:111], v[232:235]
    ds_read_b64_tr_b16 v[176:177], v250 offset:8192
    ds_read_b64_tr_b16 v[178:179], v250 offset:10240
    v_cvt_pk_bf16_f32 v0, v216, v217
    v_cvt_pk_bf16_f32 v1, v218, v219
    v_cvt_pk_bf16_f32 v2, v220, v221
    v_cvt_pk_bf16_f32 v3, v222, v223
    v_mfma_f32_16x16x32_bf16 v[232:235], v[184:187], v[112:115], v[232:235]
    ds_read_b64_tr_b16 v[180:181], v250 offset:12288
    ds_read_b64_tr_b16 v[182:183], v250 offset:14336
    s_waitcnt lgkmcnt(6)
    v_mfma_f32_16x16x32_bf16 v[232:235], v[188:191], v[116:119], v[232:235]
    v_mfma_f32_16x16x32_bf16 v[236:239], v[168:171], v[96:99], 0
    s_waitcnt vmcnt(6) lgkmcnt(0)
    s_barrier
    ds_read_b64_tr_b16 v[184:185], v250 offset:16384
    ds_read_b64_tr_b16 v[186:187], v250 offset:18432
    ds_read_b64_tr_b16 v[188:189], v250 offset:20480
    ds_read_b64_tr_b16 v[190:191], v250 offset:22528
    v_mfma_f32_16x16x32_bf16 v[236:239], v[172:175], v[100:103], v[236:239]
    v_add_u32 v250, 110592, v249
    ds_read_b64_tr_b16 v[168:169], v250
    ds_read_b64_tr_b16 v[170:171], v250 offset:2048
    s_add_u32 s69, s63, 4
    s_and_b32 s69, s69, 15
    s_or_b32 s69, s69, s74
    s_add_u32 m0, s45, 12288
    s_mul_i32 s69, s69, 12288
    buffer_load_dwordx4 v213, s[24:27], s69 offen nt lds
    v_mfma_f32_16x16x32_bf16 v[236:239], v[176:179], v[104:107], v[236:239]
    ds_read_b64_tr_b16 v[172:173], v250 offset:4096
    ds_read_b64_tr_b16 v[174:175], v250 offset:6144
    buffer_load_dwordx4 v214, s[24:27], s69 offen offset:1024 nt lds
    v_mfma_f32_16x16x32_bf16 v[236:239], v[180:183], v[108:111], v[236:239]
    ds_read_b64_tr_b16 v[176:177], v250 offset:8192
    ds_read_b64_tr_b16 v[178:179], v250 offset:10240
    buffer_load_dwordx4 v215, s[24:27], s69 offen offset:2048 nt lds
    s_waitcnt lgkmcnt(6)
    v_mfma_f32_16x16x32_bf16 v[236:239], v[184:187], v[112:115], v[236:239]
    ds_read_b64_tr_b16 v[180:181], v250 offset:12288
    ds_read_b64_tr_b16 v[182:183], v250 offset:14336
    v_mfma_f32_16x16x32_bf16 v[236:239], v[188:191], v[116:119], v[236:239]
    ds_read_b64_tr_b16 v[184:185], v250 offset:16384
    ds_read_b64_tr_b16 v[186:187], v250 offset:18432
    s_waitcnt lgkmcnt(6)
    v_mfma_f32_16x16x32_bf16 v[216:219], v[168:171], v[96:99], 0
    ds_read_b64_tr_b16 v[188:189], v250 offset:20480
    ds_read_b64_tr_b16 v[190:191], v250 offset:22528
    v_mfma_f32_16x16x32_bf16 v[216:219], v[172:175], v[100:103], v[216:219]
    s_waitcnt lgkmcnt(6)
    v_mfma_f32_16x16x32_bf16 v[216:219], v[176:179], v[104:107], v[216:219]
    s_waitcnt vmcnt(6) lgkmcnt(0)
    s_barrier
    v_xor_b32 v250, 32, v250
    ds_read_b64_tr_b16 v[168:169], v250
    ds_read_b64_tr_b16 v[170:171], v250 offset:2048
    ds_read_b64_tr_b16 v[172:173], v250 offset:4096
    ds_read_b64_tr_b16 v[174:175], v250 offset:6144
    v_mfma_f32_16x16x32_bf16 v[216:219], v[180:183], v[108:111], v[216:219]
    ds_read_b64_tr_b16 v[176:177], v250 offset:8192
    ds_read_b64_tr_b16 v[178:179], v250 offset:10240
    s_add_u32 s69, s63, 6
    s_and_b32 s69, s69, 15
    s_or_b32 s69, s69, s74
    s_add_u32 m0, s45, 24576
    s_mul_i32 s69, s69, 12288
    buffer_load_dwordx4 v210, s[20:23], s69 offen nt lds
    v_cvt_pk_bf16_f32 v8, v232, v233
    v_cvt_pk_bf16_f32 v9, v234, v235
    v_cvt_pk_bf16_f32 v10, v236, v237
    v_cvt_pk_bf16_f32 v11, v238, v239
    v_mfma_f32_16x16x32_bf16 v[216:219], v[184:187], v[112:115], v[216:219]
    ds_read_b64_tr_b16 v[180:181], v250 offset:12288
    ds_read_b64_tr_b16 v[182:183], v250 offset:14336
    buffer_load_dwordx4 v211, s[20:23], s69 offen offset:1024 nt lds
    v_mfma_f32_16x16x32_bf16 v[216:219], v[188:191], v[116:119], v[216:219]
    ds_read_b64_tr_b16 v[184:185], v250 offset:16384
    ds_read_b64_tr_b16 v[186:187], v250 offset:18432
    buffer_load_dwordx4 v212, s[20:23], s69 offen offset:2048 nt lds
    s_waitcnt lgkmcnt(6)
    v_mfma_f32_16x16x32_bf16 v[220:223], v[168:171], v[96:99], 0
    ds_read_b64_tr_b16 v[188:189], v250 offset:20480
    ds_read_b64_tr_b16 v[190:191], v250 offset:22528
    s_add_u32 s68, s65, 4
    s_sub_u32 s64, s68, 10
    s_cselect_b32 s68, s68, s64
    s_lshl_b32 s68, s68, 7
    s_add_u32 s68, s68, s60
    s_add_u32 m0, s59, 86016
    s_add_u32 s66, s68, 0
    buffer_load_dwordx4 v248, s[32:35], s66 offen lds
    v_mfma_f32_16x16x32_bf16 v[220:223], v[172:175], v[100:103], v[220:223]
    v_xor_b32 v250, 96, v250
    ds_read_b64_tr_b16 v[168:169], v250
    ds_read_b64_tr_b16 v[170:171], v250 offset:2048
    s_add_u32 s67, s68, 9216
    buffer_load_dwordx4 v248, s[32:35], s67 offen offset:1024 lds
    s_waitcnt lgkmcnt(6)
    v_mfma_f32_16x16x32_bf16 v[220:223], v[176:179], v[104:107], v[220:223]
    ds_read_b64_tr_b16 v[172:173], v250 offset:4096
    ds_read_b64_tr_b16 v[174:175], v250 offset:6144
    s_add_u32 s68, s68, 18432
    buffer_load_dwordx4 v248, s[32:35], s68 offen offset:2048 lds
    v_mfma_f32_16x16x32_bf16 v[220:223], v[180:183], v[108:111], v[220:223]
    s_waitcnt lgkmcnt(6)
    v_mfma_f32_16x16x32_bf16 v[220:223], v[184:187], v[112:115], v[220:223]
    s_waitcnt vmcnt(6) lgkmcnt(0)
    s_barrier
    ds_read_b64_tr_b16 v[176:177], v250 offset:8192
    ds_read_b64_tr_b16 v[178:179], v250 offset:10240
    ds_read_b64_tr_b16 v[180:181], v250 offset:12288
    ds_read_b64_tr_b16 v[182:183], v250 offset:14336
    v_mfma_f32_16x16x32_bf16 v[220:223], v[188:191], v[116:119], v[220:223]
    ds_read_b64_tr_b16 v[184:185], v250 offset:16384
    ds_read_b64_tr_b16 v[186:187], v250 offset:18432
    s_add_u32 s69, s63, 5
    s_and_b32 s69, s69, 15
    s_or_b32 s69, s69, s74
    s_add_u32 m0, s45, 36864
    s_mul_i32 s69, s69, 12288
    buffer_load_dwordx4 v213, s[24:27], s69 offen nt lds
    v_mfma_f32_16x16x32_bf16 v[232:235], v[168:171], v[96:99], 0
    ds_read_b64_tr_b16 v[188:189], v250 offset:20480
    ds_read_b64_tr_b16 v[190:191], v250 offset:22528
    buffer_load_dwordx4 v214, s[24:27], s69 offen offset:1024 nt lds
    v_mfma_f32_16x16x32_bf16 v[232:235], v[172:175], v[100:103], v[232:235]
    v_xor_b32 v250, 32, v250
    ds_read_b64_tr_b16 v[168:169], v250
    ds_read_b64_tr_b16 v[170:171], v250 offset:2048
    buffer_load_dwordx4 v215, s[24:27], s69 offen offset:2048 nt lds
    s_waitcnt lgkmcnt(6)
    v_mfma_f32_16x16x32_bf16 v[232:235], v[176:179], v[104:107], v[232:235]
    ds_read_b64_tr_b16 v[172:173], v250 offset:4096
    ds_read_b64_tr_b16 v[174:175], v250 offset:6144
    s_add_u32 s68, s65, 4
    s_sub_u32 s64, s68, 10
    s_cselect_b32 s68, s68, s64
    s_lshl_b32 s68, s68, 7
    s_add_u32 s68, s68, s60
    s_add_u32 m0, s59, 89088
    s_add_u32 s66, s68, 30720
    buffer_load_dwordx4 v248, s[32:35], s66 offen lds
    v_mfma_f32_16x16x32_bf16 v[232:235], v[180:183], v[108:111], v[232:235]
    ds_read_b64_tr_b16 v[176:177], v250 offset:8192
    ds_read_b64_tr_b16 v[178:179], v250 offset:10240
    s_add_u32 s67, s68, 39936
    buffer_load_dwordx4 v248, s[32:35], s67 offen offset:1024 lds
    v_cvt_pk_bf16_f32 v16, v216, v217
    v_cvt_pk_bf16_f32 v17, v218, v219
    v_cvt_pk_bf16_f32 v18, v220, v221
    v_cvt_pk_bf16_f32 v19, v222, v223
    s_waitcnt lgkmcnt(6)
    v_mfma_f32_16x16x32_bf16 v[232:235], v[184:187], v[112:115], v[232:235]
    s_add_u32 s68, s68, 49152
    buffer_load_dwordx4 v248, s[32:35], s68 offen offset:2048 lds
    v_mfma_f32_16x16x32_bf16 v[232:235], v[188:191], v[116:119], v[232:235]
    s_waitcnt vmcnt(6) lgkmcnt(0)
    s_barrier
    ds_read_b64_tr_b16 v[180:181], v250 offset:12288
    ds_read_b64_tr_b16 v[182:183], v250 offset:14336
    ds_read_b64_tr_b16 v[184:185], v250 offset:16384
    ds_read_b64_tr_b16 v[186:187], v250 offset:18432
    v_mfma_f32_16x16x32_bf16 v[236:239], v[168:171], v[96:99], 0
    ds_read_b64_tr_b16 v[188:189], v250 offset:20480
    ds_read_b64_tr_b16 v[190:191], v250 offset:22528
    s_add_u32 s69, s63, 7
    s_and_b32 s69, s69, 15
    s_or_b32 s69, s69, s74
    s_add_u32 m0, s45, 49152
    s_mul_i32 s69, s69, 12288
    buffer_load_dwordx4 v210, s[20:23], s69 offen nt lds
    v_mfma_f32_16x16x32_bf16 v[236:239], v[172:175], v[100:103], v[236:239]
    v_add_u32 v250, 135168, v249
    ds_read_b64_tr_b16 v[168:169], v250
    ds_read_b64_tr_b16 v[170:171], v250 offset:2048
    buffer_load_dwordx4 v211, s[20:23], s69 offen offset:1024 nt lds
    v_mfma_f32_16x16x32_bf16 v[236:239], v[176:179], v[104:107], v[236:239]
    ds_read_b64_tr_b16 v[172:173], v250 offset:4096
    ds_read_b64_tr_b16 v[174:175], v250 offset:6144
    buffer_load_dwordx4 v212, s[20:23], s69 offen offset:2048 nt lds
    s_waitcnt lgkmcnt(6)
    v_mfma_f32_16x16x32_bf16 v[236:239], v[180:183], v[108:111], v[236:239]
    ds_read_b64_tr_b16 v[176:177], v250 offset:8192
    ds_read_b64_tr_b16 v[178:179], v250 offset:10240
    v_mfma_f32_16x16x32_bf16 v[236:239], v[184:187], v[112:115], v[236:239]
    ds_read_b64_tr_b16 v[180:181], v250 offset:12288
    ds_read_b64_tr_b16 v[182:183], v250 offset:14336
    s_waitcnt lgkmcnt(6)
    v_mfma_f32_16x16x32_bf16 v[236:239], v[188:191], v[116:119], v[236:239]
    ds_read_b64_tr_b16 v[184:185], v250 offset:16384
    ds_read_b64_tr_b16 v[186:187], v250 offset:18432
    v_mfma_f32_16x16x32_bf16 v[216:219], v[168:171], v[96:99], 0
    s_waitcnt lgkmcnt(6)
    v_mfma_f32_16x16x32_bf16 v[216:219], v[172:175], v[100:103], v[216:219]
    s_waitcnt vmcnt(6) lgkmcnt(0)
    s_barrier
    ds_read_b64_tr_b16 v[188:189], v250 offset:20480
    ds_read_b64_tr_b16 v[190:191], v250 offset:22528
    v_xor_b32 v250, 32, v250
    ds_read_b64_tr_b16 v[168:169], v250
    ds_read_b64_tr_b16 v[170:171], v250 offset:2048
    v_mfma_f32_16x16x32_bf16 v[216:219], v[176:179], v[104:107], v[216:219]
    ds_read_b64_tr_b16 v[172:173], v250 offset:4096
    ds_read_b64_tr_b16 v[174:175], v250 offset:6144
    s_add_u32 s69, s63, 6
    s_and_b32 s69, s69, 15
    s_or_b32 s69, s69, s74
    s_add_u32 m0, s45, 61440
    s_mul_i32 s69, s69, 12288
    buffer_load_dwordx4 v213, s[24:27], s69 offen nt lds
    v_mfma_f32_16x16x32_bf16 v[216:219], v[180:183], v[108:111], v[216:219]
    ds_read_b64_tr_b16 v[176:177], v250 offset:8192
    ds_read_b64_tr_b16 v[178:179], v250 offset:10240
    buffer_load_dwordx4 v214, s[24:27], s69 offen offset:1024 nt lds
    v_cvt_pk_bf16_f32 v24, v232, v233
    v_cvt_pk_bf16_f32 v25, v234, v235
    v_cvt_pk_bf16_f32 v26, v236, v237
    v_cvt_pk_bf16_f32 v27, v238, v239
    v_mfma_f32_16x16x32_bf16 v[216:219], v[184:187], v[112:115], v[216:219]
    ds_read_b64_tr_b16 v[180:181], v250 offset:12288
    ds_read_b64_tr_b16 v[182:183], v250 offset:14336
    buffer_load_dwordx4 v215, s[24:27], s69 offen offset:2048 nt lds
    s_waitcnt lgkmcnt(6)
    v_mfma_f32_16x16x32_bf16 v[216:219], v[188:191], v[116:119], v[216:219]
    ds_read_b64_tr_b16 v[184:185], v250 offset:16384
    ds_read_b64_tr_b16 v[186:187], v250 offset:18432
    s_add_u32 s68, s65, 5
    s_sub_u32 s64, s68, 10
    s_cselect_b32 s68, s68, s64
    s_lshl_b32 s68, s68, 7
    s_add_u32 s68, s68, s60
    s_add_u32 m0, s59, 110592
    s_add_u32 s66, s68, 0
    buffer_load_dwordx4 v248, s[32:35], s66 offen lds
    v_mfma_f32_16x16x32_bf16 v[220:223], v[168:171], v[96:99], 0
    ds_read_b64_tr_b16 v[188:189], v250 offset:20480
    ds_read_b64_tr_b16 v[190:191], v250 offset:22528
    s_add_u32 s67, s68, 9216
    buffer_load_dwordx4 v248, s[32:35], s67 offen offset:1024 lds
    s_waitcnt lgkmcnt(6)
    v_mfma_f32_16x16x32_bf16 v[220:223], v[172:175], v[100:103], v[220:223]
    v_xor_b32 v250, 96, v250
    ds_read_b64_tr_b16 v[168:169], v250
    ds_read_b64_tr_b16 v[170:171], v250 offset:2048
    s_add_u32 s68, s68, 18432
    buffer_load_dwordx4 v248, s[32:35], s68 offen offset:2048 lds
    v_mfma_f32_16x16x32_bf16 v[220:223], v[176:179], v[104:107], v[220:223]
    s_waitcnt lgkmcnt(6)
    v_mfma_f32_16x16x32_bf16 v[220:223], v[180:183], v[108:111], v[220:223]
    s_waitcnt vmcnt(6) lgkmcnt(0)
    s_barrier
    ds_read_b64_tr_b16 v[172:173], v250 offset:4096
    ds_read_b64_tr_b16 v[174:175], v250 offset:6144
    ds_read_b64_tr_b16 v[176:177], v250 offset:8192
    ds_read_b64_tr_b16 v[178:179], v250 offset:10240
    v_mfma_f32_16x16x32_bf16 v[220:223], v[184:187], v[112:115], v[220:223]
    ds_read_b64_tr_b16 v[180:181], v250 offset:12288
    ds_read_b64_tr_b16 v[182:183], v250 offset:14336
    s_add_u32 s69, s63, 8
    s_and_b32 s69, s69, 15
    s_or_b32 s69, s69, s74
    s_add_u32 m0, s45, 73728
    s_mul_i32 s69, s69, 12288
    buffer_load_dwordx4 v210, s[20:23], s69 offen nt lds
    v_mfma_f32_16x16x32_bf16 v[220:223], v[188:191], v[116:119], v[220:223]
    ds_read_b64_tr_b16 v[184:185], v250 offset:16384
    ds_read_b64_tr_b16 v[186:187], v250 offset:18432
    buffer_load_dwordx4 v211, s[20:23], s69 offen offset:1024 nt lds
    v_mfma_f32_16x16x32_bf16 v[232:235], v[168:171], v[96:99], 0
    ds_read_b64_tr_b16 v[188:189], v250 offset:20480
    ds_read_b64_tr_b16 v[190:191], v250 offset:22528
    buffer_load_dwordx4 v212, s[20:23], s69 offen offset:2048 nt lds
    s_waitcnt lgkmcnt(6)
    v_mfma_f32_16x16x32_bf16 v[232:235], v[172:175], v[100:103], v[232:235]
    v_xor_b32 v250, 32, v250
    ds_read_b64_tr_b16 v[168:169], v250
    ds_read_b64_tr_b16 v[170:171], v250 offset:2048
    s_add_u32 s68, s65, 5
    s_sub_u32 s64, s68, 10
    s_cselect_b32 s68, s68, s64
    s_lshl_b32 s68, s68, 7
    s_add_u32 s68, s68, s60
    s_add_u32 m0, s59, 113664
    s_add_u32 s66, s68, 30720
    buffer_load_dwordx4 v248, s[32:35], s66 offen lds
    v_mfma_f32_16x16x32_bf16 v[232:235], v[176:179], v[104:107], v[232:235]
    ds_read_b64_tr_b16 v[172:173], v250 offset:4096
    ds_read_b64_tr_b16 v[174:175], v250 offset:6144
    s_add_u32 s67, s68, 39936
    buffer_load_dwordx4 v248, s[32:35], s67 offen offset:1024 lds
    s_waitcnt lgkmcnt(6)
    v_mfma_f32_16x16x32_bf16 v[232:235], v[180:183], v[108:111], v[232:235]
    s_add_u32 s68, s68, 49152
    buffer_load_dwordx4 v248, s[32:35], s68 offen offset:2048 lds
    v_cvt_pk_bf16_f32 v32, v216, v217
    v_cvt_pk_bf16_f32 v33, v218, v219
    v_cvt_pk_bf16_f32 v34, v220, v221
    v_cvt_pk_bf16_f32 v35, v222, v223
    v_mfma_f32_16x16x32_bf16 v[232:235], v[184:187], v[112:115], v[232:235]
    s_waitcnt vmcnt(6) lgkmcnt(0)
    s_barrier
    ds_read_b64_tr_b16 v[176:177], v250 offset:8192
    ds_read_b64_tr_b16 v[178:179], v250 offset:10240
    ds_read_b64_tr_b16 v[180:181], v250 offset:12288
    ds_read_b64_tr_b16 v[182:183], v250 offset:14336
    v_mfma_f32_16x16x32_bf16 v[232:235], v[188:191], v[116:119], v[232:235]
    ds_read_b64_tr_b16 v[184:185], v250 offset:16384
    ds_read_b64_tr_b16 v[186:187], v250 offset:18432
    s_add_u32 s69, s63, 7
    s_and_b32 s69, s69, 15
    s_or_b32 s69, s69, s74
    s_add_u32 m0, s45, 0
    s_mul_i32 s69, s69, 12288
    buffer_load_dwordx4 v213, s[24:27], s69 offen nt lds
    v_mfma_f32_16x16x32_bf16 v[236:239], v[168:171], v[96:99], 0
    ds_read_b64_tr_b16 v[188:189], v250 offset:20480
    ds_read_b64_tr_b16 v[190:191], v250 offset:22528
    buffer_load_dwordx4 v214, s[24:27], s69 offen offset:1024 nt lds
    v_mfma_f32_16x16x32_bf16 v[236:239], v[172:175], v[100:103], v[236:239]
    v_add_u32 v250, 86016, v249
    ds_read_b64_tr_b16 v[168:169], v250
    ds_read_b64_tr_b16 v[170:171], v250 offset:2048
    buffer_load_dwordx4 v215, s[24:27], s69 offen offset:2048 nt lds
    s_waitcnt lgkmcnt(6)
    v_mfma_f32_16x16x32_bf16 v[236:239], v[176:179], v[104:107], v[236:239]
    ds_read_b64_tr_b16 v[172:173], v250 offset:4096
    ds_read_b64_tr_b16 v[174:175], v250 offset:6144
    v_mfma_f32_16x16x32_bf16 v[236:239], v[180:183], v[108:111], v[236:239]
    ds_read_b64_tr_b16 v[176:177], v250 offset:8192
    ds_read_b64_tr_b16 v[178:179], v250 offset:10240
    s_waitcnt lgkmcnt(6)
    v_mfma_f32_16x16x32_bf16 v[236:239], v[184:187], v[112:115], v[236:239]
    ds_read_b64_tr_b16 v[180:181], v250 offset:12288
    ds_read_b64_tr_b16 v[182:183], v250 offset:14336
    v_mfma_f32_16x16x32_bf16 v[236:239], v[188:191], v[116:119], v[236:239]
    s_waitcnt lgkmcnt(6)
    v_mfma_f32_16x16x32_bf16 v[216:219], v[168:171], v[96:99], 0
    s_waitcnt vmcnt(6) lgkmcnt(0)
    s_barrier
    ds_read_b64_tr_b16 v[184:185], v250 offset:16384
    ds_read_b64_tr_b16 v[186:187], v250 offset:18432
    ds_read_b64_tr_b16 v[188:189], v250 offset:20480
    ds_read_b64_tr_b16 v[190:191], v250 offset:22528
    v_mfma_f32_16x16x32_bf16 v[216:219], v[172:175], v[100:103], v[216:219]
    v_xor_b32 v250, 32, v250
    ds_read_b64_tr_b16 v[168:169], v250
    ds_read_b64_tr_b16 v[170:171], v250 offset:2048
    s_add_u32 s69, s63, 9
    s_and_b32 s69, s69, 15
    s_or_b32 s69, s69, s74
    s_add_u32 m0, s45, 12288
    s_mul_i32 s69, s69, 12288
    buffer_load_dwordx4 v210, s[20:23], s69 offen nt lds
    v_mfma_f32_16x16x32_bf16 v[216:219], v[176:179], v[104:107], v[216:219]
    ds_read_b64_tr_b16 v[172:173], v250 offset:4096
    ds_read_b64_tr_b16 v[174:175], v250 offset:6144
    buffer_load_dwordx4 v211, s[20:23], s69 offen offset:1024 nt lds
    v_mfma_f32_16x16x32_bf16 v[216:219], v[180:183], v[108:111], v[216:219]
    ds_read_b64_tr_b16 v[176:177], v250 offset:8192
    ds_read_b64_tr_b16 v[178:179], v250 offset:10240
    buffer_load_dwordx4 v212, s[20:23], s69 offen offset:2048 nt lds
    v_cvt_pk_bf16_f32 v40, v232, v233
    v_cvt_pk_bf16_f32 v41, v234, v235
    v_cvt_pk_bf16_f32 v42, v236, v237
    v_cvt_pk_bf16_f32 v43, v238, v239
    s_waitcnt lgkmcnt(6)
    v_mfma_f32_16x16x32_bf16 v[216:219], v[184:187], v[112:115], v[216:219]
    ds_read_b64_tr_b16 v[180:181], v250 offset:12288
    ds_read_b64_tr_b16 v[182:183], v250 offset:14336
    s_add_u32 s68, s65, 6
    s_sub_u32 s64, s68, 10
    s_cselect_b32 s68, s68, s64
    s_lshl_b32 s68, s68, 7
    s_add_u32 s68, s68, s60
    s_add_u32 m0, s59, 135168
    s_add_u32 s66, s68, 0
    buffer_load_dwordx4 v248, s[32:35], s66 offen lds
    v_mfma_f32_16x16x32_bf16 v[216:219], v[188:191], v[116:119], v[216:219]
    ds_read_b64_tr_b16 v[184:185], v250 offset:16384
    ds_read_b64_tr_b16 v[186:187], v250 offset:18432
    s_add_u32 s67, s68, 9216
    buffer_load_dwordx4 v248, s[32:35], s67 offen offset:1024 lds
    s_waitcnt lgkmcnt(6)
    v_mfma_f32_16x16x32_bf16 v[220:223], v[168:171], v[96:99], 0
    ds_read_b64_tr_b16 v[188:189], v250 offset:20480
    ds_read_b64_tr_b16 v[190:191], v250 offset:22528
    s_add_u32 s68, s68, 18432
    buffer_load_dwordx4 v248, s[32:35], s68 offen offset:2048 lds
    v_mfma_f32_16x16x32_bf16 v[220:223], v[172:175], v[100:103], v[220:223]
    s_waitcnt lgkmcnt(6)
    v_mfma_f32_16x16x32_bf16 v[220:223], v[176:179], v[104:107], v[220:223]
    s_waitcnt vmcnt(6) lgkmcnt(0)
    s_barrier
    v_xor_b32 v250, 96, v250
    ds_read_b64_tr_b16 v[168:169], v250
    ds_read_b64_tr_b16 v[170:171], v250 offset:2048
    ds_read_b64_tr_b16 v[172:173], v250 offset:4096
    ds_read_b64_tr_b16 v[174:175], v250 offset:6144
    v_mfma_f32_16x16x32_bf16 v[220:223], v[180:183], v[108:111], v[220:223]
    ds_read_b64_tr_b16 v[176:177], v250 offset:8192
    ds_read_b64_tr_b16 v[178:179], v250 offset:10240
    s_add_u32 s69, s63, 8
    s_and_b32 s69, s69, 15
    s_or_b32 s69, s69, s74
    s_add_u32 m0, s45, 24576
    s_mul_i32 s69, s69, 12288
    buffer_load_dwordx4 v213, s[24:27], s69 offen nt lds
    v_mfma_f32_16x16x32_bf16 v[220:223], v[184:187], v[112:115], v[220:223]
    ds_read_b64_tr_b16 v[180:181], v250 offset:12288
    ds_read_b64_tr_b16 v[182:183], v250 offset:14336
    buffer_load_dwordx4 v214, s[24:27], s69 offen offset:1024 nt lds
    v_mfma_f32_16x16x32_bf16 v[220:223], v[188:191], v[116:119], v[220:223]
    ds_read_b64_tr_b16 v[184:185], v250 offset:16384
    ds_read_b64_tr_b16 v[186:187], v250 offset:18432
    buffer_load_dwordx4 v215, s[24:27], s69 offen offset:2048 nt lds
    s_waitcnt lgkmcnt(6)
    v_mfma_f32_16x16x32_bf16 v[232:235], v[168:171], v[96:99], 0
    ds_read_b64_tr_b16 v[188:189], v250 offset:20480
    ds_read_b64_tr_b16 v[190:191], v250 offset:22528
    s_add_u32 s68, s65, 6
    s_sub_u32 s64, s68, 10
    s_cselect_b32 s68, s68, s64
    s_lshl_b32 s68, s68, 7
    s_add_u32 s68, s68, s60
    s_add_u32 m0, s59, 138240
    s_add_u32 s66, s68, 30720
    buffer_load_dwordx4 v248, s[32:35], s66 offen lds
    v_mfma_f32_16x16x32_bf16 v[232:235], v[172:175], v[100:103], v[232:235]
    v_xor_b32 v250, 32, v250
    ds_read_b64_tr_b16 v[168:169], v250
    ds_read_b64_tr_b16 v[170:171], v250 offset:2048
    s_add_u32 s67, s68, 39936
    buffer_load_dwordx4 v248, s[32:35], s67 offen offset:1024 lds
    s_waitcnt lgkmcnt(6)
    v_mfma_f32_16x16x32_bf16 v[232:235], v[176:179], v[104:107], v[232:235]
    s_add_u32 s68, s68, 49152
    buffer_load_dwordx4 v248, s[32:35], s68 offen offset:2048 lds
    v_mfma_f32_16x16x32_bf16 v[232:235], v[180:183], v[108:111], v[232:235]
    v_cvt_pk_bf16_f32 v48, v216, v217
    v_cvt_pk_bf16_f32 v49, v218, v219
    v_cvt_pk_bf16_f32 v50, v220, v221
    v_cvt_pk_bf16_f32 v51, v222, v223
    s_waitcnt vmcnt(6) lgkmcnt(0)
    s_barrier
    ds_read_b64_tr_b16 v[172:173], v250 offset:4096
    ds_read_b64_tr_b16 v[174:175], v250 offset:6144
    ds_read_b64_tr_b16 v[176:177], v250 offset:8192
    ds_read_b64_tr_b16 v[178:179], v250 offset:10240
    v_mfma_f32_16x16x32_bf16 v[232:235], v[184:187], v[112:115], v[232:235]
    ds_read_b64_tr_b16 v[180:181], v250 offset:12288
    ds_read_b64_tr_b16 v[182:183], v250 offset:14336
    s_add_u32 s69, s63, 10
    s_and_b32 s69, s69, 15
    s_or_b32 s69, s69, s74
    s_add_u32 m0, s45, 36864
    s_mul_i32 s69, s69, 12288
    buffer_load_dwordx4 v210, s[20:23], s69 offen nt lds
    v_mfma_f32_16x16x32_bf16 v[232:235], v[188:191], v[116:119], v[232:235]
    ds_read_b64_tr_b16 v[184:185], v250 offset:16384
    ds_read_b64_tr_b16 v[186:187], v250 offset:18432
    buffer_load_dwordx4 v211, s[20:23], s69 offen offset:1024 nt lds
    v_mfma_f32_16x16x32_bf16 v[236:239], v[168:171], v[96:99], 0
    ds_read_b64_tr_b16 v[188:189], v250 offset:20480
    ds_read_b64_tr_b16 v[190:191], v250 offset:22528
    buffer_load_dwordx4 v212, s[20:23], s69 offen offset:2048 nt lds
    s_waitcnt lgkmcnt(6)
    v_mfma_f32_16x16x32_bf16 v[236:239], v[172:175], v[100:103], v[236:239]
    v_add_u32 v250, 110592, v249
    ds_read_b64_tr_b16 v[168:169], v250
    ds_read_b64_tr_b16 v[170:171], v250 offset:2048
    v_mfma_f32_16x16x32_bf16 v[236:239], v[176:179], v[104:107], v[236:239]
    ds_read_b64_tr_b16 v[172:173], v250 offset:4096
    ds_read_b64_tr_b16 v[174:175], v250 offset:6144
    s_waitcnt lgkmcnt(6)
    v_mfma_f32_16x16x32_bf16 v[236:239], v[180:183], v[108:111], v[236:239]
    ds_read_b64_tr_b16 v[176:177], v250 offset:8192
    ds_read_b64_tr_b16 v[178:179], v250 offset:10240
    v_mfma_f32_16x16x32_bf16 v[236:239], v[184:187], v[112:115], v[236:239]
    s_waitcnt lgkmcnt(6)
    v_mfma_f32_16x16x32_bf16 v[236:239], v[188:191], v[116:119], v[236:239]
    s_waitcnt vmcnt(6) lgkmcnt(0)
    s_barrier
    ds_read_b64_tr_b16 v[180:181], v250 offset:12288
    ds_read_b64_tr_b16 v[182:183], v250 offset:14336
    ds_read_b64_tr_b16 v[184:185], v250 offset:16384
    ds_read_b64_tr_b16 v[186:187], v250 offset:18432
    v_mfma_f32_16x16x32_bf16 v[216:219], v[168:171], v[96:99], 0
    ds_read_b64_tr_b16 v[188:189], v250 offset:20480
    ds_read_b64_tr_b16 v[190:191], v250 offset:22528
    s_add_u32 s69, s63, 9
    s_and_b32 s69, s69, 15
    s_or_b32 s69, s69, s74
    s_add_u32 m0, s45, 49152
    s_mul_i32 s69, s69, 12288
    buffer_load_dwordx4 v213, s[24:27], s69 offen nt lds
    v_mfma_f32_16x16x32_bf16 v[216:219], v[172:175], v[100:103], v[216:219]
    v_xor_b32 v250, 32, v250
    ds_read_b64_tr_b16 v[168:169], v250
    ds_read_b64_tr_b16 v[170:171], v250 offset:2048
    buffer_load_dwordx4 v214, s[24:27], s69 offen offset:1024 nt lds
    v_mfma_f32_16x16x32_bf16 v[216:219], v[176:179], v[104:107], v[216:219]
    ds_read_b64_tr_b16 v[172:173], v250 offset:4096
    ds_read_b64_tr_b16 v[174:175], v250 offset:6144
    buffer_load_dwordx4 v215, s[24:27], s69 offen offset:2048 nt lds
    s_waitcnt lgkmcnt(6)
    v_mfma_f32_16x16x32_bf16 v[216:219], v[180:183], v[108:111], v[216:219]
    ds_read_b64_tr_b16 v[176:177], v250 offset:8192
    ds_read_b64_tr_b16 v[178:179], v250 offset:10240
    s_add_u32 s68, s65, 7
    s_sub_u32 s64, s68, 10
    s_cselect_b32 s68, s68, s64
    s_lshl_b32 s68, s68, 7
    s_add_u32 s68, s68, s60
    s_add_u32 m0, s59, 86016
    s_add_u32 s66, s68, 0
    buffer_load_dwordx4 v248, s[32:35], s66 offen lds
    v_cvt_pk_bf16_f32 v56, v232, v233
    v_cvt_pk_bf16_f32 v57, v234, v235
    v_cvt_pk_bf16_f32 v58, v236, v237
    v_cvt_pk_bf16_f32 v59, v238, v239
    v_mfma_f32_16x16x32_bf16 v[216:219], v[184:187], v[112:115], v[216:219]
    ds_read_b64_tr_b16 v[180:181], v250 offset:12288
    ds_read_b64_tr_b16 v[182:183], v250 offset:14336
    s_add_u32 s67, s68, 9216
    buffer_load_dwordx4 v248, s[32:35], s67 offen offset:1024 lds
    s_waitcnt lgkmcnt(6)
    v_mfma_f32_16x16x32_bf16 v[216:219], v[188:191], v[116:119], v[216:219]
    ds_read_b64_tr_b16 v[184:185], v250 offset:16384
    ds_read_b64_tr_b16 v[186:187], v250 offset:18432
    s_add_u32 s68, s68, 18432
    buffer_load_dwordx4 v248, s[32:35], s68 offen offset:2048 lds
    v_mfma_f32_16x16x32_bf16 v[220:223], v[168:171], v[96:99], 0
    s_waitcnt lgkmcnt(6)
    v_mfma_f32_16x16x32_bf16 v[220:223], v[172:175], v[100:103], v[220:223]
    s_waitcnt vmcnt(6) lgkmcnt(0)
    s_barrier
    ds_read_b64_tr_b16 v[188:189], v250 offset:20480
    ds_read_b64_tr_b16 v[190:191], v250 offset:22528
    v_xor_b32 v250, 96, v250
    ds_read_b64_tr_b16 v[168:169], v250
    ds_read_b64_tr_b16 v[170:171], v250 offset:2048
    v_mfma_f32_16x16x32_bf16 v[220:223], v[176:179], v[104:107], v[220:223]
    ds_read_b64_tr_b16 v[172:173], v250 offset:4096
    ds_read_b64_tr_b16 v[174:175], v250 offset:6144
    s_add_u32 s69, s63, 11
    s_and_b32 s69, s69, 15
    s_or_b32 s69, s69, s74
    s_add_u32 m0, s45, 61440
    s_mul_i32 s69, s69, 12288
    buffer_load_dwordx4 v210, s[20:23], s69 offen nt lds
    v_mfma_f32_16x16x32_bf16 v[220:223], v[180:183], v[108:111], v[220:223]
    ds_read_b64_tr_b16 v[176:177], v250 offset:8192
    ds_read_b64_tr_b16 v[178:179], v250 offset:10240
    buffer_load_dwordx4 v211, s[20:23], s69 offen offset:1024 nt lds
    v_mfma_f32_16x16x32_bf16 v[220:223], v[184:187], v[112:115], v[220:223]
    ds_read_b64_tr_b16 v[180:181], v250 offset:12288
    ds_read_b64_tr_b16 v[182:183], v250 offset:14336
    buffer_load_dwordx4 v212, s[20:23], s69 offen offset:2048 nt lds
    s_waitcnt lgkmcnt(6)
    v_mfma_f32_16x16x32_bf16 v[220:223], v[188:191], v[116:119], v[220:223]
    ds_read_b64_tr_b16 v[184:185], v250 offset:16384
    ds_read_b64_tr_b16 v[186:187], v250 offset:18432
    s_add_u32 s68, s65, 7
    s_sub_u32 s64, s68, 10
    s_cselect_b32 s68, s68, s64
    s_lshl_b32 s68, s68, 7
    s_add_u32 s68, s68, s60
    s_add_u32 m0, s59, 89088
    s_add_u32 s66, s68, 30720
    buffer_load_dwordx4 v248, s[32:35], s66 offen lds
    v_mfma_f32_16x16x32_bf16 v[232:235], v[168:171], v[96:99], 0
    ds_read_b64_tr_b16 v[188:189], v250 offset:20480
    ds_read_b64_tr_b16 v[190:191], v250 offset:22528
    s_add_u32 s67, s68, 39936
    buffer_load_dwordx4 v248, s[32:35], s67 offen offset:1024 lds
    s_waitcnt lgkmcnt(6)
    v_mfma_f32_16x16x32_bf16 v[232:235], v[172:175], v[100:103], v[232:235]
    s_add_u32 s68, s68, 49152
    buffer_load_dwordx4 v248, s[32:35], s68 offen offset:2048 lds
    v_mfma_f32_16x16x32_bf16 v[232:235], v[176:179], v[104:107], v[232:235]
    s_waitcnt vmcnt(6) lgkmcnt(0)
    s_barrier
    v_xor_b32 v250, 32, v250
    ds_read_b64_tr_b16 v[168:169], v250
    ds_read_b64_tr_b16 v[170:171], v250 offset:2048
    ds_read_b64_tr_b16 v[172:173], v250 offset:4096
    ds_read_b64_tr_b16 v[174:175], v250 offset:6144
    v_mfma_f32_16x16x32_bf16 v[232:235], v[180:183], v[108:111], v[232:235]
    ds_read_b64_tr_b16 v[176:177], v250 offset:8192
    ds_read_b64_tr_b16 v[178:179], v250 offset:10240
    s_add_u32 s69, s63, 10
    s_and_b32 s69, s69, 15
    s_or_b32 s69, s69, s74
    s_add_u32 m0, s45, 73728
    s_mul_i32 s69, s69, 12288
    buffer_load_dwordx4 v213, s[24:27], s69 offen nt lds
    v_cvt_pk_bf16_f32 v64, v216, v217
    v_cvt_pk_bf16_f32 v65, v218, v219
    v_cvt_pk_bf16_f32 v66, v220, v221
    v_cvt_pk_bf16_f32 v67, v222, v223
    v_mfma_f32_16x16x32_bf16 v[232:235], v[184:187], v[112:115], v[232:235]
    ds_read_b64_tr_b16 v[180:181], v250 offset:12288
    ds_read_b64_tr_b16 v[182:183], v250 offset:14336
    buffer_load_dwordx4 v214, s[24:27], s69 offen offset:1024 nt lds
    v_mfma_f32_16x16x32_bf16 v[232:235], v[188:191], v[116:119], v[232:235]
    ds_read_b64_tr_b16 v[184:185], v250 offset:16384
    ds_read_b64_tr_b16 v[186:187], v250 offset:18432
    buffer_load_dwordx4 v215, s[24:27], s69 offen offset:2048 nt lds
    s_waitcnt lgkmcnt(6)
    v_mfma_f32_16x16x32_bf16 v[236:239], v[168:171], v[96:99], 0
    ds_read_b64_tr_b16 v[188:189], v250 offset:20480
    ds_read_b64_tr_b16 v[190:191], v250 offset:22528
    v_mfma_f32_16x16x32_bf16 v[236:239], v[172:175], v[100:103], v[236:239]
    v_add_u32 v250, 135168, v249
    ds_read_b64_tr_b16 v[168:169], v250
    ds_read_b64_tr_b16 v[170:171], v250 offset:2048
    s_waitcnt lgkmcnt(6)
    v_mfma_f32_16x16x32_bf16 v[236:239], v[176:179], v[104:107], v[236:239]
    ds_read_b64_tr_b16 v[172:173], v250 offset:4096
    ds_read_b64_tr_b16 v[174:175], v250 offset:6144
    v_mfma_f32_16x16x32_bf16 v[236:239], v[180:183], v[108:111], v[236:239]
    s_waitcnt lgkmcnt(6)
    v_mfma_f32_16x16x32_bf16 v[236:239], v[184:187], v[112:115], v[236:239]
    s_waitcnt vmcnt(6) lgkmcnt(0)
    s_barrier
    ds_read_b64_tr_b16 v[176:177], v250 offset:8192
    ds_read_b64_tr_b16 v[178:179], v250 offset:10240
    ds_read_b64_tr_b16 v[180:181], v250 offset:12288
    ds_read_b64_tr_b16 v[182:183], v250 offset:14336
    v_mfma_f32_16x16x32_bf16 v[236:239], v[188:191], v[116:119], v[236:239]
    ds_read_b64_tr_b16 v[184:185], v250 offset:16384
    ds_read_b64_tr_b16 v[186:187], v250 offset:18432
    s_add_u32 s69, s63, 12
    s_and_b32 s69, s69, 15
    s_or_b32 s69, s69, s74
    s_add_u32 m0, s45, 0
    s_mul_i32 s69, s69, 12288
    buffer_load_dwordx4 v210, s[20:23], s69 offen nt lds
    v_mfma_f32_16x16x32_bf16 v[216:219], v[168:171], v[96:99], 0
    ds_read_b64_tr_b16 v[188:189], v250 offset:20480
    ds_read_b64_tr_b16 v[190:191], v250 offset:22528
    buffer_load_dwordx4 v211, s[20:23], s69 offen offset:1024 nt lds
    v_mfma_f32_16x16x32_bf16 v[216:219], v[172:175], v[100:103], v[216:219]
    v_xor_b32 v250, 32, v250
    ds_read_b64_tr_b16 v[168:169], v250
    ds_read_b64_tr_b16 v[170:171], v250 offset:2048
    buffer_load_dwordx4 v212, s[20:23], s69 offen offset:2048 nt lds
    s_waitcnt lgkmcnt(6)
    v_mfma_f32_16x16x32_bf16 v[216:219], v[176:179], v[104:107], v[216:219]
    ds_read_b64_tr_b16 v[172:173], v250 offset:4096
    ds_read_b64_tr_b16 v[174:175], v250 offset:6144
    s_add_u32 s68, s65, 8
    s_sub_u32 s64, s68, 10
    s_cselect_b32 s68, s68, s64
    s_lshl_b32 s68, s68, 7
    s_add_u32 s68, s68, s60
    s_add_u32 m0, s59, 110592
    s_add_u32 s66, s68, 0
    buffer_load_dwordx4 v248, s[32:35], s66 offen lds
    v_mfma_f32_16x16x32_bf16 v[216:219], v[180:183], v[108:111], v[216:219]
    ds_read_b64_tr_b16 v[176:177], v250 offset:8192
    ds_read_b64_tr_b16 v[178:179], v250 offset:10240
    s_add_u32 s67, s68, 9216
    buffer_load_dwordx4 v248, s[32:35], s67 offen offset:1024 lds
    v_cvt_pk_bf16_f32 v72, v232, v233
    v_cvt_pk_bf16_f32 v73, v234, v235
    v_cvt_pk_bf16_f32 v74, v236, v237
    v_cvt_pk_bf16_f32 v75, v238, v239
    s_waitcnt lgkmcnt(6)
    v_mfma_f32_16x16x32_bf16 v[216:219], v[184:187], v[112:115], v[216:219]
    ds_read_b64_tr_b16 v[180:181], v250 offset:12288
    ds_read_b64_tr_b16 v[182:183], v250 offset:14336
    s_add_u32 s68, s68, 18432
    buffer_load_dwordx4 v248, s[32:35], s68 offen offset:2048 lds
    v_mfma_f32_16x16x32_bf16 v[216:219], v[188:191], v[116:119], v[216:219]
    s_waitcnt lgkmcnt(6)
    v_mfma_f32_16x16x32_bf16 v[220:223], v[168:171], v[96:99], 0
    s_waitcnt vmcnt(6) lgkmcnt(0)
    s_barrier
    ds_read_b64_tr_b16 v[184:185], v250 offset:16384
    ds_read_b64_tr_b16 v[186:187], v250 offset:18432
    ds_read_b64_tr_b16 v[188:189], v250 offset:20480
    ds_read_b64_tr_b16 v[190:191], v250 offset:22528
    v_mfma_f32_16x16x32_bf16 v[220:223], v[172:175], v[100:103], v[220:223]
    v_xor_b32 v250, 96, v250
    ds_read_b64_tr_b16 v[168:169], v250
    ds_read_b64_tr_b16 v[170:171], v250 offset:2048
    s_add_u32 s69, s63, 11
    s_and_b32 s69, s69, 15
    s_or_b32 s69, s69, s74
    s_add_u32 m0, s45, 12288
    s_mul_i32 s69, s69, 12288
    buffer_load_dwordx4 v213, s[24:27], s69 offen nt lds
    v_mfma_f32_16x16x32_bf16 v[220:223], v[176:179], v[104:107], v[220:223]
    ds_read_b64_tr_b16 v[172:173], v250 offset:4096
    ds_read_b64_tr_b16 v[174:175], v250 offset:6144
    buffer_load_dwordx4 v214, s[24:27], s69 offen offset:1024 nt lds
    v_mfma_f32_16x16x32_bf16 v[220:223], v[180:183], v[108:111], v[220:223]
    ds_read_b64_tr_b16 v[176:177], v250 offset:8192
    ds_read_b64_tr_b16 v[178:179], v250 offset:10240
    buffer_load_dwordx4 v215, s[24:27], s69 offen offset:2048 nt lds
    s_waitcnt lgkmcnt(6)
    v_mfma_f32_16x16x32_bf16 v[220:223], v[184:187], v[112:115], v[220:223]
    ds_read_b64_tr_b16 v[180:181], v250 offset:12288
    ds_read_b64_tr_b16 v[182:183], v250 offset:14336
    s_add_u32 s68, s65, 8
    s_sub_u32 s64, s68, 10
    s_cselect_b32 s68, s68, s64
    s_lshl_b32 s68, s68, 7
    s_add_u32 s68, s68, s60
    s_add_u32 m0, s59, 113664
    s_add_u32 s66, s68, 30720
    buffer_load_dwordx4 v248, s[32:35], s66 offen lds
    v_mfma_f32_16x16x32_bf16 v[220:223], v[188:191], v[116:119], v[220:223]
    ds_read_b64_tr_b16 v[184:185], v250 offset:16384
    ds_read_b64_tr_b16 v[186:187], v250 offset:18432
    s_add_u32 s67, s68, 39936
    buffer_load_dwordx4 v248, s[32:35], s67 offen offset:1024 lds
    s_waitcnt lgkmcnt(6)
    v_mfma_f32_16x16x32_bf16 v[232:235], v[168:171], v[96:99], 0
    s_add_u32 s68, s68, 49152
    buffer_load_dwordx4 v248, s[32:35], s68 offen offset:2048 lds
    v_mfma_f32_16x16x32_bf16 v[232:235], v[172:175], v[100:103], v[232:235]
    s_waitcnt vmcnt(6) lgkmcnt(0)
    s_barrier
    ds_read_b64_tr_b16 v[188:189], v250 offset:20480
    ds_read_b64_tr_b16 v[190:191], v250 offset:22528
    v_xor_b32 v250, 32, v250
    ds_read_b64_tr_b16 v[168:169], v250
    ds_read_b64_tr_b16 v[170:171], v250 offset:2048
    v_mfma_f32_16x16x32_bf16 v[232:235], v[176:179], v[104:107], v[232:235]
    ds_read_b64_tr_b16 v[172:173], v250 offset:4096
    ds_read_b64_tr_b16 v[174:175], v250 offset:6144
    s_add_u32 s69, s63, 13
    s_and_b32 s69, s69, 15
    s_or_b32 s69, s69, s74
    s_add_u32 m0, s45, 24576
    s_mul_i32 s69, s69, 12288
    buffer_load_dwordx4 v210, s[20:23], s69 offen nt lds
    v_mfma_f32_16x16x32_bf16 v[232:235], v[180:183], v[108:111], v[232:235]
    ds_read_b64_tr_b16 v[176:177], v250 offset:8192
    ds_read_b64_tr_b16 v[178:179], v250 offset:10240
    buffer_load_dwordx4 v211, s[20:23], s69 offen offset:1024 nt lds
    v_cvt_pk_bf16_f32 v80, v216, v217
    v_cvt_pk_bf16_f32 v81, v218, v219
    v_cvt_pk_bf16_f32 v82, v220, v221
    v_cvt_pk_bf16_f32 v83, v222, v223
    v_mfma_f32_16x16x32_bf16 v[232:235], v[184:187], v[112:115], v[232:235]
    ds_read_b64_tr_b16 v[180:181], v250 offset:12288
    ds_read_b64_tr_b16 v[182:183], v250 offset:14336
    buffer_load_dwordx4 v212, s[20:23], s69 offen offset:2048 nt lds
    s_waitcnt lgkmcnt(6)
    v_mfma_f32_16x16x32_bf16 v[232:235], v[188:191], v[116:119], v[232:235]
    ds_read_b64_tr_b16 v[184:185], v250 offset:16384
    ds_read_b64_tr_b16 v[186:187], v250 offset:18432
    v_mfma_f32_16x16x32_bf16 v[236:239], v[168:171], v[96:99], 0
    ds_read_b64_tr_b16 v[188:189], v250 offset:20480
    ds_read_b64_tr_b16 v[190:191], v250 offset:22528
    s_waitcnt lgkmcnt(6)
    v_mfma_f32_16x16x32_bf16 v[236:239], v[172:175], v[100:103], v[236:239]
    v_add_u32 v250, 86016, v249
    ds_read_b64_tr_b16 v[168:169], v250
    ds_read_b64_tr_b16 v[170:171], v250 offset:2048
    v_mfma_f32_16x16x32_bf16 v[236:239], v[176:179], v[104:107], v[236:239]
    s_waitcnt lgkmcnt(6)
    v_mfma_f32_16x16x32_bf16 v[236:239], v[180:183], v[108:111], v[236:239]
    s_waitcnt vmcnt(6) lgkmcnt(0)
    s_barrier
    ds_read_b64_tr_b16 v[172:173], v250 offset:4096
    ds_read_b64_tr_b16 v[174:175], v250 offset:6144
    ds_read_b64_tr_b16 v[176:177], v250 offset:8192
    ds_read_b64_tr_b16 v[178:179], v250 offset:10240
    v_mfma_f32_16x16x32_bf16 v[236:239], v[184:187], v[112:115], v[236:239]
    ds_read_b64_tr_b16 v[180:181], v250 offset:12288
    ds_read_b64_tr_b16 v[182:183], v250 offset:14336
    s_add_u32 s69, s63, 12
    s_and_b32 s69, s69, 15
    s_or_b32 s69, s69, s74
    s_add_u32 m0, s45, 36864
    s_mul_i32 s69, s69, 12288
    buffer_load_dwordx4 v213, s[24:27], s69 offen nt lds
    v_mfma_f32_16x16x32_bf16 v[236:239], v[188:191], v[116:119], v[236:239]
    ds_read_b64_tr_b16 v[184:185], v250 offset:16384
    ds_read_b64_tr_b16 v[186:187], v250 offset:18432
    buffer_load_dwordx4 v214, s[24:27], s69 offen offset:1024 nt lds
    v_mfma_f32_16x16x32_bf16 v[216:219], v[168:171], v[96:99], 0
    ds_read_b64_tr_b16 v[188:189], v250 offset:20480
    ds_read_b64_tr_b16 v[190:191], v250 offset:22528
    buffer_load_dwordx4 v215, s[24:27], s69 offen offset:2048 nt lds
    s_waitcnt lgkmcnt(6)
    v_mfma_f32_16x16x32_bf16 v[216:219], v[172:175], v[100:103], v[216:219]
    v_xor_b32 v250, 32, v250
    ds_read_b64_tr_b16 v[168:169], v250
    ds_read_b64_tr_b16 v[170:171], v250 offset:2048
    s_add_u32 s68, s65, 9
    s_sub_u32 s64, s68, 10
    s_cselect_b32 s68, s68, s64
    s_lshl_b32 s68, s68, 7
    s_add_u32 s68, s68, s60
    s_add_u32 m0, s59, 135168
    s_add_u32 s66, s68, 0
    buffer_load_dwordx4 v248, s[32:35], s66 offen lds
    v_mfma_f32_16x16x32_bf16 v[216:219], v[176:179], v[104:107], v[216:219]
    ds_read_b64_tr_b16 v[172:173], v250 offset:4096
    ds_read_b64_tr_b16 v[174:175], v250 offset:6144
    s_add_u32 s67, s68, 9216
    buffer_load_dwordx4 v248, s[32:35], s67 offen offset:1024 lds
    s_waitcnt lgkmcnt(6)
    v_mfma_f32_16x16x32_bf16 v[216:219], v[180:183], v[108:111], v[216:219]
    ds_read_b64_tr_b16 v[176:177], v250 offset:8192
    ds_read_b64_tr_b16 v[178:179], v250 offset:10240
    s_add_u32 s68, s68, 18432
    buffer_load_dwordx4 v248, s[32:35], s68 offen offset:2048 lds
    v_cvt_pk_bf16_f32 v88, v232, v233
    v_cvt_pk_bf16_f32 v89, v234, v235
    v_cvt_pk_bf16_f32 v90, v236, v237
    v_cvt_pk_bf16_f32 v91, v238, v239
    v_mfma_f32_16x16x32_bf16 v[216:219], v[184:187], v[112:115], v[216:219]
    s_waitcnt lgkmcnt(6)
    v_mfma_f32_16x16x32_bf16 v[216:219], v[188:191], v[116:119], v[216:219]
    s_waitcnt vmcnt(6) lgkmcnt(0)
    s_barrier
    ds_read_b64_tr_b16 v[180:181], v250 offset:12288
    ds_read_b64_tr_b16 v[182:183], v250 offset:14336
    ds_read_b64_tr_b16 v[184:185], v250 offset:16384
    ds_read_b64_tr_b16 v[186:187], v250 offset:18432
    v_mfma_f32_16x16x32_bf16 v[220:223], v[168:171], v[96:99], 0
    ds_read_b64_tr_b16 v[188:189], v250 offset:20480
    ds_read_b64_tr_b16 v[190:191], v250 offset:22528
    s_add_u32 s69, s63, 14
    s_and_b32 s69, s69, 15
    s_or_b32 s69, s69, s74
    s_add_u32 m0, s45, 49152
    s_mul_i32 s69, s69, 12288
    buffer_load_dwordx4 v210, s[20:23], s69 offen nt lds
    v_mfma_f32_16x16x32_bf16 v[220:223], v[172:175], v[100:103], v[220:223]
    v_xor_b32 v250, 96, v250
    ds_read_b64_tr_b16 v[168:169], v250
    ds_read_b64_tr_b16 v[170:171], v250 offset:2048
    buffer_load_dwordx4 v211, s[20:23], s69 offen offset:1024 nt lds
    v_mfma_f32_16x16x32_bf16 v[220:223], v[176:179], v[104:107], v[220:223]
    ds_read_b64_tr_b16 v[172:173], v250 offset:4096
    ds_read_b64_tr_b16 v[174:175], v250 offset:6144
    buffer_load_dwordx4 v212, s[20:23], s69 offen offset:2048 nt lds
    s_waitcnt lgkmcnt(6)
    v_mfma_f32_16x16x32_bf16 v[220:223], v[180:183], v[108:111], v[220:223]
    ds_read_b64_tr_b16 v[176:177], v250 offset:8192
    ds_read_b64_tr_b16 v[178:179], v250 offset:10240
    s_add_u32 s68, s65, 9
    s_sub_u32 s64, s68, 10
    s_cselect_b32 s68, s68, s64
    s_lshl_b32 s68, s68, 7
    s_add_u32 s68, s68, s60
    s_add_u32 m0, s59, 138240
    s_add_u32 s66, s68, 30720
    buffer_load_dwordx4 v248, s[32:35], s66 offen lds
    v_mfma_f32_16x16x32_bf16 v[220:223], v[184:187], v[112:115], v[220:223]
    ds_read_b64_tr_b16 v[180:181], v250 offset:12288
    ds_read_b64_tr_b16 v[182:183], v250 offset:14336
    s_add_u32 s67, s68, 39936
    buffer_load_dwordx4 v248, s[32:35], s67 offen offset:1024 lds
    s_waitcnt lgkmcnt(6)
    v_mfma_f32_16x16x32_bf16 v[220:223], v[188:191], v[116:119], v[220:223]
    s_add_u32 s68, s68, 49152
    buffer_load_dwordx4 v248, s[32:35], s68 offen offset:2048 lds
    v_mfma_f32_16x16x32_bf16 v[232:235], v[168:171], v[96:99], 0
    s_waitcnt vmcnt(6) lgkmcnt(0)
    s_barrier
    ds_read_b64_tr_b16 v[184:185], v250 offset:16384
    ds_read_b64_tr_b16 v[186:187], v250 offset:18432
    ds_read_b64_tr_b16 v[188:189], v250 offset:20480
    ds_read_b64_tr_b16 v[190:191], v250 offset:22528
    v_mfma_f32_16x16x32_bf16 v[232:235], v[172:175], v[100:103], v[232:235]
    v_xor_b32 v250, 32, v250
    ds_read_b64_tr_b16 v[168:169], v250
    ds_read_b64_tr_b16 v[170:171], v250 offset:2048
    s_add_u32 s69, s63, 13
    s_and_b32 s69, s69, 15
    s_or_b32 s69, s69, s74
    s_add_u32 m0, s45, 61440
    s_mul_i32 s69, s69, 12288
    buffer_load_dwordx4 v213, s[24:27], s69 offen nt lds
    v_mfma_f32_16x16x32_bf16 v[232:235], v[176:179], v[104:107], v[232:235]
    ds_read_b64_tr_b16 v[172:173], v250 offset:4096
    ds_read_b64_tr_b16 v[174:175], v250 offset:6144
    buffer_load_dwordx4 v214, s[24:27], s69 offen offset:1024 nt lds
    v_mfma_f32_16x16x32_bf16 v[232:235], v[180:183], v[108:111], v[232:235]
    ds_read_b64_tr_b16 v[176:177], v250 offset:8192
    ds_read_b64_tr_b16 v[178:179], v250 offset:10240
    buffer_load_dwordx4 v215, s[24:27], s69 offen offset:2048 nt lds
    v_cvt_pk_bf16_f32 v144, v216, v217
    v_cvt_pk_bf16_f32 v145, v218, v219
    v_cvt_pk_bf16_f32 v146, v220, v221
    v_cvt_pk_bf16_f32 v147, v222, v223
    s_waitcnt lgkmcnt(6)
    v_mfma_f32_16x16x32_bf16 v[232:235], v[184:187], v[112:115], v[232:235]
    ds_read_b64_tr_b16 v[180:181], v250 offset:12288
    ds_read_b64_tr_b16 v[182:183], v250 offset:14336
    v_mfma_f32_16x16x32_bf16 v[232:235], v[188:191], v[116:119], v[232:235]
    ds_read_b64_tr_b16 v[184:185], v250 offset:16384
    ds_read_b64_tr_b16 v[186:187], v250 offset:18432
    s_waitcnt lgkmcnt(6)
    v_mfma_f32_16x16x32_bf16 v[236:239], v[168:171], v[96:99], 0
    ds_read_b64_tr_b16 v[188:189], v250 offset:20480
    ds_read_b64_tr_b16 v[190:191], v250 offset:22528
    v_mfma_f32_16x16x32_bf16 v[236:239], v[172:175], v[100:103], v[236:239]
    s_waitcnt lgkmcnt(6)
    v_mfma_f32_16x16x32_bf16 v[236:239], v[176:179], v[104:107], v[236:239]
    s_waitcnt vmcnt(6) lgkmcnt(0)
    s_barrier
    v_add_u32 v250, 110592, v249
    ds_read_b64_tr_b16 v[168:169], v250
    ds_read_b64_tr_b16 v[170:171], v250 offset:2048
    ds_read_b64_tr_b16 v[172:173], v250 offset:4096
    ds_read_b64_tr_b16 v[174:175], v250 offset:6144
    v_mfma_f32_16x16x32_bf16 v[236:239], v[180:183], v[108:111], v[236:239]
    ds_read_b64_tr_b16 v[176:177], v250 offset:8192
    ds_read_b64_tr_b16 v[178:179], v250 offset:10240
    s_add_u32 s69, s63, 15
    s_and_b32 s69, s69, 15
    s_or_b32 s69, s69, s74
    s_add_u32 m0, s45, 73728
    s_mul_i32 s69, s69, 12288
    buffer_load_dwordx4 v210, s[20:23], s69 offen nt lds
    v_mfma_f32_16x16x32_bf16 v[236:239], v[184:187], v[112:115], v[236:239]
    ds_read_b64_tr_b16 v[180:181], v250 offset:12288
    ds_read_b64_tr_b16 v[182:183], v250 offset:14336
    buffer_load_dwordx4 v211, s[20:23], s69 offen offset:1024 nt lds
    v_mfma_f32_16x16x32_bf16 v[236:239], v[188:191], v[116:119], v[236:239]
    ds_read_b64_tr_b16 v[184:185], v250 offset:16384
    ds_read_b64_tr_b16 v[186:187], v250 offset:18432
    buffer_load_dwordx4 v212, s[20:23], s69 offen offset:2048 nt lds
    s_waitcnt lgkmcnt(6)
    v_mfma_f32_16x16x32_bf16 v[216:219], v[168:171], v[96:99], 0
    ds_read_b64_tr_b16 v[188:189], v250 offset:20480
    ds_read_b64_tr_b16 v[190:191], v250 offset:22528
    s_add_u32 s68, s65, 0
    s_sub_u32 s64, s68, 10
    s_cselect_b32 s68, s68, s64
    s_lshl_b32 s68, s68, 7
    s_add_u32 s68, s68, s60
    s_add_u32 m0, s59, 86016
    s_add_u32 s66, s68, 0
    buffer_load_dwordx4 v248, s[32:35], s66 offen lds
    v_mfma_f32_16x16x32_bf16 v[216:219], v[172:175], v[100:103], v[216:219]
    v_xor_b32 v250, 32, v250
    ds_read_b64_tr_b16 v[168:169], v250
    ds_read_b64_tr_b16 v[170:171], v250 offset:2048
    s_add_u32 s67, s68, 9216
    buffer_load_dwordx4 v248, s[32:35], s67 offen offset:1024 lds
    s_waitcnt lgkmcnt(6)
    v_mfma_f32_16x16x32_bf16 v[216:219], v[176:179], v[104:107], v[216:219]
    ds_read_b64_tr_b16 v[172:173], v250 offset:4096
    ds_read_b64_tr_b16 v[174:175], v250 offset:6144
    s_add_u32 s68, s68, 18432
    buffer_load_dwordx4 v248, s[32:35], s68 offen offset:2048 lds
    v_mfma_f32_16x16x32_bf16 v[216:219], v[180:183], v[108:111], v[216:219]
    v_cvt_pk_bf16_f32 v152, v232, v233
    v_cvt_pk_bf16_f32 v153, v234, v235
    v_cvt_pk_bf16_f32 v154, v236, v237
    v_cvt_pk_bf16_f32 v155, v238, v239
    s_waitcnt lgkmcnt(6)
    v_mfma_f32_16x16x32_bf16 v[216:219], v[184:187], v[112:115], v[216:219]
    s_waitcnt vmcnt(6) lgkmcnt(0)
    s_barrier
    ds_read_b64_tr_b16 v[176:177], v250 offset:8192
    ds_read_b64_tr_b16 v[178:179], v250 offset:10240
    ds_read_b64_tr_b16 v[180:181], v250 offset:12288
    ds_read_b64_tr_b16 v[182:183], v250 offset:14336
    v_mfma_f32_16x16x32_bf16 v[216:219], v[188:191], v[116:119], v[216:219]
    ds_read_b64_tr_b16 v[184:185], v250 offset:16384
    ds_read_b64_tr_b16 v[186:187], v250 offset:18432
    s_add_u32 s69, s63, 14
    s_and_b32 s69, s69, 15
    s_or_b32 s69, s69, s74
    s_add_u32 m0, s45, 0
    s_mul_i32 s69, s69, 12288
    buffer_load_dwordx4 v213, s[24:27], s69 offen nt lds
    v_mfma_f32_16x16x32_bf16 v[220:223], v[168:171], v[96:99], 0
    ds_read_b64_tr_b16 v[188:189], v250 offset:20480
    ds_read_b64_tr_b16 v[190:191], v250 offset:22528
    buffer_load_dwordx4 v214, s[24:27], s69 offen offset:1024 nt lds
    v_mfma_f32_16x16x32_bf16 v[220:223], v[172:175], v[100:103], v[220:223]
    v_xor_b32 v250, 96, v250
    ds_read_b64_tr_b16 v[168:169], v250
    ds_read_b64_tr_b16 v[170:171], v250 offset:2048
    buffer_load_dwordx4 v215, s[24:27], s69 offen offset:2048 nt lds
    s_waitcnt lgkmcnt(6)
    v_mfma_f32_16x16x32_bf16 v[220:223], v[176:179], v[104:107], v[220:223]
    ds_read_b64_tr_b16 v[172:173], v250 offset:4096
    ds_read_b64_tr_b16 v[174:175], v250 offset:6144
    s_add_u32 s68, s65, 0
    s_sub_u32 s64, s68, 10
    s_cselect_b32 s68, s68, s64
    s_lshl_b32 s68, s68, 7
    s_add_u32 s68, s68, s60
    s_add_u32 m0, s59, 89088
    s_add_u32 s66, s68, 30720
    buffer_load_dwordx4 v248, s[32:35], s66 offen lds
    v_mfma_f32_16x16x32_bf16 v[220:223], v[180:183], v[108:111], v[220:223]
    ds_read_b64_tr_b16 v[176:177], v250 offset:8192
    ds_read_b64_tr_b16 v[178:179], v250 offset:10240
    s_add_u32 s67, s68, 39936
    buffer_load_dwordx4 v248, s[32:35], s67 offen offset:1024 lds
    s_waitcnt lgkmcnt(6)
    v_mfma_f32_16x16x32_bf16 v[220:223], v[184:187], v[112:115], v[220:223]
    ds_read_b64_tr_b16 v[180:181], v250 offset:12288
    ds_read_b64_tr_b16 v[182:183], v250 offset:14336
    s_add_u32 s68, s68, 49152
    buffer_load_dwordx4 v248, s[32:35], s68 offen offset:2048 lds
    v_mfma_f32_16x16x32_bf16 v[220:223], v[188:191], v[116:119], v[220:223]
    s_waitcnt lgkmcnt(6)
    v_mfma_f32_16x16x32_bf16 v[232:235], v[168:171], v[96:99], 0
    s_waitcnt vmcnt(6) lgkmcnt(0)
    s_barrier
    ds_read_b64_tr_b16 v[184:185], v250 offset:16384
    ds_read_b64_tr_b16 v[186:187], v250 offset:18432
    ds_read_b64_tr_b16 v[188:189], v250 offset:20480
    ds_read_b64_tr_b16 v[190:191], v250 offset:22528
    v_mfma_f32_16x16x32_bf16 v[232:235], v[172:175], v[100:103], v[232:235]
    v_xor_b32 v250, 32, v250
    ds_read_b64_tr_b16 v[168:169], v250
    ds_read_b64_tr_b16 v[170:171], v250 offset:2048
    s_add_u32 s69, s63, 15
    s_and_b32 s69, s69, 15
    s_or_b32 s69, s69, s74
    s_add_u32 m0, s45, 12288
    s_mul_i32 s69, s69, 12288
    buffer_load_dwordx4 v213, s[24:27], s69 offen nt lds
    v_mfma_f32_16x16x32_bf16 v[232:235], v[176:179], v[104:107], v[232:235]
    ds_read_b64_tr_b16 v[172:173], v250 offset:4096
    ds_read_b64_tr_b16 v[174:175], v250 offset:6144
    buffer_load_dwordx4 v214, s[24:27], s69 offen offset:1024 nt lds
    v_mfma_f32_16x16x32_bf16 v[232:235], v[180:183], v[108:111], v[232:235]
    ds_read_b64_tr_b16 v[176:177], v250 offset:8192
    ds_read_b64_tr_b16 v[178:179], v250 offset:10240
    buffer_load_dwordx4 v215, s[24:27], s69 offen offset:2048 nt lds
    v_cvt_pk_bf16_f32 v160, v216, v217
    v_cvt_pk_bf16_f32 v161, v218, v219
    v_cvt_pk_bf16_f32 v162, v220, v221
    v_cvt_pk_bf16_f32 v163, v222, v223
    s_waitcnt lgkmcnt(6)
    v_mfma_f32_16x16x32_bf16 v[232:235], v[184:187], v[112:115], v[232:235]
    ds_read_b64_tr_b16 v[180:181], v250 offset:12288
    ds_read_b64_tr_b16 v[182:183], v250 offset:14336
    v_mfma_f32_16x16x32_bf16 v[232:235], v[188:191], v[116:119], v[232:235]
    ds_read_b64_tr_b16 v[184:185], v250 offset:16384
    ds_read_b64_tr_b16 v[186:187], v250 offset:18432
    s_waitcnt lgkmcnt(6)
    v_mfma_f32_16x16x32_bf16 v[236:239], v[168:171], v[96:99], 0
    ds_read_b64_tr_b16 v[188:189], v250 offset:20480
    ds_read_b64_tr_b16 v[190:191], v250 offset:22528
    v_mfma_f32_16x16x32_bf16 v[236:239], v[172:175], v[100:103], v[236:239]
    s_waitcnt lgkmcnt(6)
    v_mfma_f32_16x16x32_bf16 v[236:239], v[176:179], v[104:107], v[236:239]
    s_waitcnt vmcnt(6) lgkmcnt(0)
    s_barrier
    v_add_u32 v250, 135168, v249
    ds_read_b64_tr_b16 v[168:169], v250
    ds_read_b64_tr_b16 v[170:171], v250 offset:2048
    ds_read_b64_tr_b16 v[172:173], v250 offset:4096
    ds_read_b64_tr_b16 v[174:175], v250 offset:6144
    v_mfma_f32_16x16x32_bf16 v[236:239], v[180:183], v[108:111], v[236:239]
    ds_read_b64_tr_b16 v[176:177], v250 offset:8192
    ds_read_b64_tr_b16 v[178:179], v250 offset:10240
    s_add_u32 s68, s65, 0
    s_sub_u32 s64, s68, 10
    s_cselect_b32 s68, s68, s64
    s_lshl_b32 s68, s68, 7
    s_add_u32 s68, s68, s70
    s_add_u32 m0, s59, 110592
    s_add_u32 s66, s68, 0
    buffer_load_dwordx4 v248, s[32:35], s66 offen lds
    v_mfma_f32_16x16x32_bf16 v[236:239], v[184:187], v[112:115], v[236:239]
    ds_read_b64_tr_b16 v[180:181], v250 offset:12288
    ds_read_b64_tr_b16 v[182:183], v250 offset:14336
    s_add_u32 s67, s68, 9216
    buffer_load_dwordx4 v248, s[32:35], s67 offen offset:1024 lds
    v_mfma_f32_16x16x32_bf16 v[236:239], v[188:191], v[116:119], v[236:239]
    ds_read_b64_tr_b16 v[184:185], v250 offset:16384
    ds_read_b64_tr_b16 v[186:187], v250 offset:18432
    s_add_u32 s68, s68, 18432
    buffer_load_dwordx4 v248, s[32:35], s68 offen offset:2048 lds
    s_waitcnt lgkmcnt(6)
    v_mfma_f32_16x16x32_bf16 v[216:219], v[168:171], v[96:99], 0
    ds_read_b64_tr_b16 v[188:189], v250 offset:20480
    ds_read_b64_tr_b16 v[190:191], v250 offset:22528
    s_add_u32 s68, s65, 0
    s_sub_u32 s64, s68, 10
    s_cselect_b32 s68, s68, s64
    s_lshl_b32 s68, s68, 7
    s_add_u32 s68, s68, s70
    s_add_u32 m0, s59, 113664
    s_add_u32 s66, s68, 30720
    buffer_load_dwordx4 v248, s[32:35], s66 offen lds
    v_mfma_f32_16x16x32_bf16 v[216:219], v[172:175], v[100:103], v[216:219]
    v_xor_b32 v250, 32, v250
    ds_read_b64_tr_b16 v[168:169], v250
    ds_read_b64_tr_b16 v[170:171], v250 offset:2048
    s_add_u32 s67, s68, 39936
    buffer_load_dwordx4 v248, s[32:35], s67 offen offset:1024 lds
    s_waitcnt lgkmcnt(6)
    v_mfma_f32_16x16x32_bf16 v[216:219], v[176:179], v[104:107], v[216:219]
    ds_read_b64_tr_b16 v[172:173], v250 offset:4096
    ds_read_b64_tr_b16 v[174:175], v250 offset:6144
    s_add_u32 s68, s68, 49152
    buffer_load_dwordx4 v248, s[32:35], s68 offen offset:2048 lds
    v_mfma_f32_16x16x32_bf16 v[216:219], v[180:183], v[108:111], v[216:219]
    v_cvt_pk_bf16_f32 v192, v232, v233
    v_cvt_pk_bf16_f32 v193, v234, v235
    v_cvt_pk_bf16_f32 v194, v236, v237
    v_cvt_pk_bf16_f32 v195, v238, v239
    s_waitcnt lgkmcnt(6)
    v_mfma_f32_16x16x32_bf16 v[216:219], v[184:187], v[112:115], v[216:219]
    s_waitcnt vmcnt(18) lgkmcnt(0)
    s_barrier
    ds_read_b64_tr_b16 v[176:177], v250 offset:8192
    ds_read_b64_tr_b16 v[178:179], v250 offset:10240
    ds_read_b64_tr_b16 v[180:181], v250 offset:12288
    ds_read_b64_tr_b16 v[182:183], v250 offset:14336
    v_mfma_f32_16x16x32_bf16 v[216:219], v[188:191], v[116:119], v[216:219]
    ds_read_b64_tr_b16 v[184:185], v250 offset:16384
    ds_read_b64_tr_b16 v[186:187], v250 offset:18432
    s_add_u32 s68, s65, 1
    s_sub_u32 s64, s68, 10
    s_cselect_b32 s68, s68, s64
    s_lshl_b32 s68, s68, 7
    s_add_u32 s68, s68, s70
    s_add_u32 m0, s59, 49152
    s_add_u32 s66, s68, 0
    buffer_load_dwordx4 v248, s[32:35], s66 offen lds
    v_mfma_f32_16x16x32_bf16 v[220:223], v[168:171], v[96:99], 0
    ds_read_b64_tr_b16 v[188:189], v250 offset:20480
    ds_read_b64_tr_b16 v[190:191], v250 offset:22528
    s_add_u32 s67, s68, 9216
    buffer_load_dwordx4 v248, s[32:35], s67 offen offset:1024 lds
    v_mfma_f32_16x16x32_bf16 v[220:223], v[172:175], v[100:103], v[220:223]
    v_xor_b32 v250, 96, v250
    ds_read_b64_tr_b16 v[168:169], v250
    ds_read_b64_tr_b16 v[170:171], v250 offset:2048
    s_add_u32 s68, s68, 18432
    buffer_load_dwordx4 v248, s[32:35], s68 offen offset:2048 lds
    s_waitcnt lgkmcnt(6)
    v_mfma_f32_16x16x32_bf16 v[220:223], v[176:179], v[104:107], v[220:223]
    ds_read_b64_tr_b16 v[172:173], v250 offset:4096
    ds_read_b64_tr_b16 v[174:175], v250 offset:6144
    s_add_u32 s68, s65, 1
    s_sub_u32 s64, s68, 10
    s_cselect_b32 s68, s68, s64
    s_lshl_b32 s68, s68, 7
    s_add_u32 s68, s68, s70
    s_add_u32 m0, s59, 52224
    s_add_u32 s66, s68, 30720
    buffer_load_dwordx4 v248, s[32:35], s66 offen lds
    v_mfma_f32_16x16x32_bf16 v[220:223], v[180:183], v[108:111], v[220:223]
    ds_read_b64_tr_b16 v[176:177], v250 offset:8192
    ds_read_b64_tr_b16 v[178:179], v250 offset:10240
    s_add_u32 s67, s68, 39936
    buffer_load_dwordx4 v248, s[32:35], s67 offen offset:1024 lds
    s_waitcnt lgkmcnt(6)
    v_mfma_f32_16x16x32_bf16 v[220:223], v[184:187], v[112:115], v[220:223]
    ds_read_b64_tr_b16 v[180:181], v250 offset:12288
    ds_read_b64_tr_b16 v[182:183], v250 offset:14336
    s_add_u32 s68, s68, 49152
    buffer_load_dwordx4 v248, s[32:35], s68 offen offset:2048 lds
    v_mfma_f32_16x16x32_bf16 v[220:223], v[188:191], v[116:119], v[220:223]
    s_waitcnt lgkmcnt(6)
    v_mfma_f32_16x16x32_bf16 v[232:235], v[168:171], v[96:99], 0
    s_waitcnt vmcnt(18) lgkmcnt(0)
    s_barrier
    ds_read_b64_tr_b16 v[184:185], v250 offset:16384
    ds_read_b64_tr_b16 v[186:187], v250 offset:18432
    ds_read_b64_tr_b16 v[188:189], v250 offset:20480
    ds_read_b64_tr_b16 v[190:191], v250 offset:22528
    v_mfma_f32_16x16x32_bf16 v[232:235], v[172:175], v[100:103], v[232:235]
    v_xor_b32 v250, 32, v250
    ds_read_b64_tr_b16 v[168:169], v250
    ds_read_b64_tr_b16 v[170:171], v250 offset:2048
    v_mfma_f32_16x16x32_bf16 v[232:235], v[176:179], v[104:107], v[232:235]
    ds_read_b64_tr_b16 v[172:173], v250 offset:4096
    ds_read_b64_tr_b16 v[174:175], v250 offset:6144
    v_mfma_f32_16x16x32_bf16 v[232:235], v[180:183], v[108:111], v[232:235]
    ds_read_b64_tr_b16 v[176:177], v250 offset:8192
    ds_read_b64_tr_b16 v[178:179], v250 offset:10240
    v_cvt_pk_bf16_f32 v200, v216, v217
    v_cvt_pk_bf16_f32 v201, v218, v219
    v_cvt_pk_bf16_f32 v202, v220, v221
    v_cvt_pk_bf16_f32 v203, v222, v223
    s_waitcnt lgkmcnt(6)
    v_mfma_f32_16x16x32_bf16 v[232:235], v[184:187], v[112:115], v[232:235]
    ds_read_b64_tr_b16 v[180:181], v250 offset:12288
    ds_read_b64_tr_b16 v[182:183], v250 offset:14336
    v_mfma_f32_16x16x32_bf16 v[232:235], v[188:191], v[116:119], v[232:235]
    ds_read_b64_tr_b16 v[184:185], v250 offset:16384
    ds_read_b64_tr_b16 v[186:187], v250 offset:18432
    s_waitcnt lgkmcnt(6)
    v_mfma_f32_16x16x32_bf16 v[236:239], v[168:171], v[96:99], 0
    ds_read_b64_tr_b16 v[188:189], v250 offset:20480
    ds_read_b64_tr_b16 v[190:191], v250 offset:22528
    v_mfma_f32_16x16x32_bf16 v[236:239], v[172:175], v[100:103], v[236:239]
    s_waitcnt lgkmcnt(6)
    v_mfma_f32_16x16x32_bf16 v[236:239], v[176:179], v[104:107], v[236:239]
    s_waitcnt vmcnt(12) lgkmcnt(0)
    s_barrier
    v_add_u32 v250, 86016, v249
    ds_read_b64_tr_b16 v[168:169], v250
    ds_read_b64_tr_b16 v[170:171], v250 offset:2048
    ds_read_b64_tr_b16 v[172:173], v250 offset:4096
    ds_read_b64_tr_b16 v[174:175], v250 offset:6144
    v_mfma_f32_16x16x32_bf16 v[236:239], v[180:183], v[108:111], v[236:239]
    ds_read_b64_tr_b16 v[176:177], v250 offset:8192
    ds_read_b64_tr_b16 v[178:179], v250 offset:10240
    s_add_u32 s68, s65, 2
    s_sub_u32 s64, s68, 10
    s_cselect_b32 s68, s68, s64
    s_lshl_b32 s68, s68, 7
    s_add_u32 s68, s68, s70
    s_add_u32 m0, s59, 135168
    s_add_u32 s66, s68, 0
    buffer_load_dwordx4 v248, s[32:35], s66 offen lds
    v_mfma_f32_16x16x32_bf16 v[236:239], v[184:187], v[112:115], v[236:239]
    ds_read_b64_tr_b16 v[180:181], v250 offset:12288
    ds_read_b64_tr_b16 v[182:183], v250 offset:14336
    s_add_u32 s67, s68, 9216
    buffer_load_dwordx4 v248, s[32:35], s67 offen offset:1024 lds
    v_mfma_f32_16x16x32_bf16 v[236:239], v[188:191], v[116:119], v[236:239]
    ds_read_b64_tr_b16 v[184:185], v250 offset:16384
    ds_read_b64_tr_b16 v[186:187], v250 offset:18432
    s_add_u32 s68, s68, 18432
    buffer_load_dwordx4 v248, s[32:35], s68 offen offset:2048 lds
    s_waitcnt lgkmcnt(6)
    v_mfma_f32_16x16x32_bf16 v[216:219], v[168:171], v[96:99], 0
    ds_read_b64_tr_b16 v[188:189], v250 offset:20480
    ds_read_b64_tr_b16 v[190:191], v250 offset:22528
    s_add_u32 s68, s65, 2
    s_sub_u32 s64, s68, 10
    s_cselect_b32 s68, s68, s64
    s_lshl_b32 s68, s68, 7
    s_add_u32 s68, s68, s70
    s_add_u32 m0, s59, 138240
    s_add_u32 s66, s68, 30720
    buffer_load_dwordx4 v248, s[32:35], s66 offen lds
    v_mfma_f32_16x16x32_bf16 v[216:219], v[172:175], v[100:103], v[216:219]
    v_xor_b32 v250, 32, v250
    ds_read_b64_tr_b16 v[168:169], v250
    ds_read_b64_tr_b16 v[170:171], v250 offset:2048
    s_add_u32 s67, s68, 39936
    buffer_load_dwordx4 v248, s[32:35], s67 offen offset:1024 lds
    s_waitcnt lgkmcnt(6)
    v_mfma_f32_16x16x32_bf16 v[216:219], v[176:179], v[104:107], v[216:219]
    ds_read_b64_tr_b16 v[172:173], v250 offset:4096
    ds_read_b64_tr_b16 v[174:175], v250 offset:6144
    s_add_u32 s68, s68, 49152
    buffer_load_dwordx4 v248, s[32:35], s68 offen offset:2048 lds
    v_mfma_f32_16x16x32_bf16 v[216:219], v[180:183], v[108:111], v[216:219]
    ds_read_b64_tr_b16 v[176:177], v250 offset:8192
    ds_read_b64_tr_b16 v[178:179], v250 offset:10240
    v_cvt_pk_bf16_f32 v208, v232, v233
    v_cvt_pk_bf16_f32 v209, v234, v235
    v_cvt_pk_bf16_f32 v210, v236, v237
    v_cvt_pk_bf16_f32 v211, v238, v239
    s_waitcnt lgkmcnt(6)
    v_mfma_f32_16x16x32_bf16 v[216:219], v[184:187], v[112:115], v[216:219]
    ds_read_b64_tr_b16 v[180:181], v250 offset:12288
    ds_read_b64_tr_b16 v[182:183], v250 offset:14336
    v_mfma_f32_16x16x32_bf16 v[216:219], v[188:191], v[116:119], v[216:219]
    ds_read_b64_tr_b16 v[184:185], v250 offset:16384
    ds_read_b64_tr_b16 v[186:187], v250 offset:18432
    s_waitcnt lgkmcnt(6)
    v_mfma_f32_16x16x32_bf16 v[220:223], v[168:171], v[96:99], 0
    ds_read_b64_tr_b16 v[188:189], v250 offset:20480
    ds_read_b64_tr_b16 v[190:191], v250 offset:22528
    v_mfma_f32_16x16x32_bf16 v[220:223], v[172:175], v[100:103], v[220:223]
    v_xor_b32 v250, 96, v250
    ds_read_b64_tr_b16 v[168:169], v250
    ds_read_b64_tr_b16 v[170:171], v250 offset:2048
    s_waitcnt lgkmcnt(6)
    v_mfma_f32_16x16x32_bf16 v[220:223], v[176:179], v[104:107], v[220:223]
    ds_read_b64_tr_b16 v[172:173], v250 offset:4096
    ds_read_b64_tr_b16 v[174:175], v250 offset:6144
    v_mfma_f32_16x16x32_bf16 v[220:223], v[180:183], v[108:111], v[220:223]
    ds_read_b64_tr_b16 v[176:177], v250 offset:8192
    ds_read_b64_tr_b16 v[178:179], v250 offset:10240
    s_waitcnt lgkmcnt(6)
    v_mfma_f32_16x16x32_bf16 v[220:223], v[184:187], v[112:115], v[220:223]
    ds_read_b64_tr_b16 v[180:181], v250 offset:12288
    ds_read_b64_tr_b16 v[182:183], v250 offset:14336
    v_mfma_f32_16x16x32_bf16 v[220:223], v[188:191], v[116:119], v[220:223]
    ds_read_b64_tr_b16 v[184:185], v250 offset:16384
    ds_read_b64_tr_b16 v[186:187], v250 offset:18432
    s_waitcnt lgkmcnt(6)
    v_mfma_f32_16x16x32_bf16 v[232:235], v[168:171], v[96:99], 0
    ds_read_b64_tr_b16 v[188:189], v250 offset:20480
    ds_read_b64_tr_b16 v[190:191], v250 offset:22528
    v_mfma_f32_16x16x32_bf16 v[232:235], v[172:175], v[100:103], v[232:235]
    v_xor_b32 v250, 32, v250
    ds_read_b64_tr_b16 v[168:169], v250
    ds_read_b64_tr_b16 v[170:171], v250 offset:2048
    s_waitcnt lgkmcnt(6)
    v_mfma_f32_16x16x32_bf16 v[232:235], v[176:179], v[104:107], v[232:235]
    ds_read_b64_tr_b16 v[172:173], v250 offset:4096
    ds_read_b64_tr_b16 v[174:175], v250 offset:6144
    v_mfma_f32_16x16x32_bf16 v[232:235], v[180:183], v[108:111], v[232:235]
    ds_read_b64_tr_b16 v[176:177], v250 offset:8192
    ds_read_b64_tr_b16 v[178:179], v250 offset:10240
    s_waitcnt lgkmcnt(6)
    v_mfma_f32_16x16x32_bf16 v[232:235], v[184:187], v[112:115], v[232:235]
    ds_read_b64_tr_b16 v[180:181], v250 offset:12288
    ds_read_b64_tr_b16 v[182:183], v250 offset:14336
    v_mfma_f32_16x16x32_bf16 v[232:235], v[188:191], v[116:119], v[232:235]
    ds_read_b64_tr_b16 v[184:185], v250 offset:16384
    ds_read_b64_tr_b16 v[186:187], v250 offset:18432
    s_waitcnt lgkmcnt(6)
    v_mfma_f32_16x16x32_bf16 v[236:239], v[168:171], v[96:99], 0
    ds_read_b64_tr_b16 v[188:189], v250 offset:20480
    ds_read_b64_tr_b16 v[190:191], v250 offset:22528
    v_mfma_f32_16x16x32_bf16 v[236:239], v[172:175], v[100:103], v[236:239]
    s_waitcnt lgkmcnt(4)
    v_mfma_f32_16x16x32_bf16 v[236:239], v[176:179], v[104:107], v[236:239]
    v_mfma_f32_16x16x32_bf16 v[236:239], v[180:183], v[108:111], v[236:239]
    s_waitcnt lgkmcnt(0)
    v_mfma_f32_16x16x32_bf16 v[236:239], v[184:187], v[112:115], v[236:239]
    v_mfma_f32_16x16x32_bf16 v[236:239], v[188:191], v[116:119], v[236:239]
    v_add_u32 v248, s62, v251
    s_waitcnt vmcnt(12) lgkmcnt(0)
    s_barrier
    v_add_u32 v250, 110592, v249
    ds_read_b128 v[96:99], v248
    ds_read_b64_tr_b16 v[168:169], v250
    ds_read_b64_tr_b16 v[170:171], v250 offset:2048
    ds_read_b128 v[100:103], v248 offset:1024
    ds_read_b64_tr_b16 v[172:173], v250 offset:4096
    ds_read_b64_tr_b16 v[174:175], v250 offset:6144
    ds_read_b128 v[104:107], v248 offset:2048
    ds_read_b64_tr_b16 v[176:177], v250 offset:8192
    ds_read_b64_tr_b16 v[178:179], v250 offset:10240
    ds_read_b128 v[108:111], v248 offset:3072
    ds_read_b64_tr_b16 v[180:181], v250 offset:12288
    ds_read_b64_tr_b16 v[182:183], v250 offset:14336
    ds_read_b128 v[112:115], v248 offset:4096
    ds_read_b64_tr_b16 v[184:185], v250 offset:16384
    ds_read_b64_tr_b16 v[186:187], v250 offset:18432
    s_waitcnt lgkmcnt(6)
    v_mfma_f32_16x16x32_bf16 v[216:219], v[168:171], v[96:99], v[216:219]
    ds_read_b128 v[116:119], v248 offset:5120
    ds_read_b64_tr_b16 v[188:189], v250 offset:20480
    ds_read_b64_tr_b16 v[190:191], v250 offset:22528
    v_mfma_f32_16x16x32_bf16 v[216:219], v[172:175], v[100:103], v[216:219]
    v_xor_b32 v250, 32, v250
    ds_read_b64_tr_b16 v[168:169], v250
    ds_read_b64_tr_b16 v[170:171], v250 offset:2048
    v_mfma_f32_16x16x32_bf16 v[216:219], v[176:179], v[104:107], v[216:219]
    ds_read_b64_tr_b16 v[172:173], v250 offset:4096
    ds_read_b64_tr_b16 v[174:175], v250 offset:6144
    s_waitcnt lgkmcnt(4)
    v_mfma_f32_16x16x32_bf16 v[216:219], v[180:183], v[108:111], v[216:219]
    ds_read_b64_tr_b16 v[176:177], v250 offset:8192
    ds_read_b64_tr_b16 v[178:179], v250 offset:10240
    v_mfma_f32_16x16x32_bf16 v[216:219], v[184:187], v[112:115], v[216:219]
    ds_read_b64_tr_b16 v[180:181], v250 offset:12288
    ds_read_b64_tr_b16 v[182:183], v250 offset:14336
    v_mfma_f32_16x16x32_bf16 v[216:219], v[188:191], v[116:119], v[216:219]
    ds_read_b64_tr_b16 v[184:185], v250 offset:16384
    ds_read_b64_tr_b16 v[186:187], v250 offset:18432
    s_waitcnt lgkmcnt(4)
    v_mfma_f32_16x16x32_bf16 v[220:223], v[168:171], v[96:99], v[220:223]
    ds_read_b64_tr_b16 v[188:189], v250 offset:20480
    ds_read_b64_tr_b16 v[190:191], v250 offset:22528
    v_mfma_f32_16x16x32_bf16 v[220:223], v[172:175], v[100:103], v[220:223]
    v_xor_b32 v250, 96, v250
    ds_read_b64_tr_b16 v[168:169], v250
    ds_read_b64_tr_b16 v[170:171], v250 offset:2048
    v_mfma_f32_16x16x32_bf16 v[220:223], v[176:179], v[104:107], v[220:223]
    ds_read_b64_tr_b16 v[172:173], v250 offset:4096
    ds_read_b64_tr_b16 v[174:175], v250 offset:6144
    s_waitcnt lgkmcnt(4)
    v_mfma_f32_16x16x32_bf16 v[220:223], v[180:183], v[108:111], v[220:223]
    ds_read_b64_tr_b16 v[176:177], v250 offset:8192
    ds_read_b64_tr_b16 v[178:179], v250 offset:10240
    v_mfma_f32_16x16x32_bf16 v[220:223], v[184:187], v[112:115], v[220:223]
    ds_read_b64_tr_b16 v[180:181], v250 offset:12288
    ds_read_b64_tr_b16 v[182:183], v250 offset:14336
    v_cvt_pk_bf16_f32 v216, v216, v217
    v_mfma_f32_16x16x32_bf16 v[220:223], v[188:191], v[116:119], v[220:223]
    ds_read_b64_tr_b16 v[184:185], v250 offset:16384
    ds_read_b64_tr_b16 v[186:187], v250 offset:18432
    v_cvt_pk_bf16_f32 v217, v218, v219
    s_waitcnt lgkmcnt(4)
    v_mfma_f32_16x16x32_bf16 v[232:235], v[168:171], v[96:99], v[232:235]
    ds_read_b64_tr_b16 v[188:189], v250 offset:20480
    ds_read_b64_tr_b16 v[190:191], v250 offset:22528
    v_mfma_f32_16x16x32_bf16 v[232:235], v[172:175], v[100:103], v[232:235]
    v_xor_b32 v250, 32, v250
    ds_read_b64_tr_b16 v[168:169], v250
    ds_read_b64_tr_b16 v[170:171], v250 offset:2048
    v_mfma_f32_16x16x32_bf16 v[232:235], v[176:179], v[104:107], v[232:235]
    ds_read_b64_tr_b16 v[172:173], v250 offset:4096
    ds_read_b64_tr_b16 v[174:175], v250 offset:6144
    s_waitcnt lgkmcnt(4)
    v_mfma_f32_16x16x32_bf16 v[232:235], v[180:183], v[108:111], v[232:235]
    ds_read_b64_tr_b16 v[176:177], v250 offset:8192
    ds_read_b64_tr_b16 v[178:179], v250 offset:10240
    v_mfma_f32_16x16x32_bf16 v[232:235], v[184:187], v[112:115], v[232:235]
    ds_read_b64_tr_b16 v[180:181], v250 offset:12288
    ds_read_b64_tr_b16 v[182:183], v250 offset:14336
    v_cvt_pk_bf16_f32 v218, v220, v221
    v_mfma_f32_16x16x32_bf16 v[232:235], v[188:191], v[116:119], v[232:235]
    ds_read_b64_tr_b16 v[184:185], v250 offset:16384
    ds_read_b64_tr_b16 v[186:187], v250 offset:18432
    v_cvt_pk_bf16_f32 v219, v222, v223
    s_waitcnt lgkmcnt(8)
    v_mfma_f32_16x16x32_bf16 v[236:239], v[168:171], v[96:99], v[236:239]
    ds_read_b64_tr_b16 v[188:189], v250 offset:20480
    ds_read_b64_tr_b16 v[190:191], v250 offset:22528
    s_add_u32 s66, s61, 0
    buffer_store_dwordx4 v[216:219], v251, s[36:39], s66 offen sc1
    v_lshlrev_b32 v220, 16, v2
    s_waitcnt vmcnt(7)
    s_barrier
    s_waitcnt lgkmcnt(4)
    v_mfma_f32_16x16x32_bf16 v[236:239], v[172:175], v[100:103], v[236:239]
    v_add_u32 v250, 49152, v249
    ds_read_b64_tr_b16 v[168:169], v250
    ds_read_b64_tr_b16 v[170:171], v250 offset:2048
    v_and_b32 v221, 0xffff0000, v2
    v_lshlrev_b32 v216, 16, v0
    v_mfma_f32_16x16x32_bf16 v[236:239], v[176:179], v[104:107], v[236:239]
    ds_read_b64_tr_b16 v[172:173], v250 offset:4096
    ds_read_b64_tr_b16 v[174:175], v250 offset:6144
    v_lshlrev_b32 v222, 16, v3
    v_and_b32 v217, 0xffff0000, v0
    v_mfma_f32_16x16x32_bf16 v[236:239], v[180:183], v[108:111], v[236:239]
    ds_read_b64_tr_b16 v[176:177], v250 offset:8192
    ds_read_b64_tr_b16 v[178:179], v250 offset:10240
    v_and_b32 v223, 0xffff0000, v3
    v_lshlrev_b32 v218, 16, v1
    s_waitcnt lgkmcnt(4)
    v_mfma_f32_16x16x32_bf16 v[236:239], v[184:187], v[112:115], v[236:239]
    ds_read_b64_tr_b16 v[180:181], v250 offset:12288
    ds_read_b64_tr_b16 v[182:183], v250 offset:14336
    v_cvt_pk_bf16_f32 v0, v232, v233
    v_and_b32 v219, 0xffff0000, v1
    v_mfma_f32_16x16x32_bf16 v[236:239], v[188:191], v[116:119], v[236:239]
    ds_read_b64_tr_b16 v[184:185], v250 offset:16384
    ds_read_b64_tr_b16 v[186:187], v250 offset:18432
    v_cvt_pk_bf16_f32 v1, v234, v235
    v_mfma_f32_16x16x32_bf16 v[216:219], v[168:171], v[96:99], v[216:219]
    ds_read_b64_tr_b16 v[188:189], v250 offset:20480
    ds_read_b64_tr_b16 v[190:191], v250 offset:22528
    v_lshlrev_b32 v232, 16, v8
    s_waitcnt lgkmcnt(4)
    v_mfma_f32_16x16x32_bf16 v[216:219], v[172:175], v[100:103], v[216:219]
    v_xor_b32 v250, 32, v250
    ds_read_b64_tr_b16 v[168:169], v250
    ds_read_b64_tr_b16 v[170:171], v250 offset:2048
    v_and_b32 v233, 0xffff0000, v8
    v_mfma_f32_16x16x32_bf16 v[216:219], v[176:179], v[104:107], v[216:219]
    ds_read_b64_tr_b16 v[172:173], v250 offset:4096
    ds_read_b64_tr_b16 v[174:175], v250 offset:6144
    v_lshlrev_b32 v234, 16, v9
    v_mfma_f32_16x16x32_bf16 v[216:219], v[180:183], v[108:111], v[216:219]
    ds_read_b64_tr_b16 v[176:177], v250 offset:8192
    ds_read_b64_tr_b16 v[178:179], v250 offset:10240
    v_and_b32 v235, 0xffff0000, v9
    s_waitcnt lgkmcnt(4)
    v_mfma_f32_16x16x32_bf16 v[216:219], v[184:187], v[112:115], v[216:219]
    ds_read_b64_tr_b16 v[180:181], v250 offset:12288
    ds_read_b64_tr_b16 v[182:183], v250 offset:14336
    v_cvt_pk_bf16_f32 v2, v236, v237
    v_mfma_f32_16x16x32_bf16 v[216:219], v[188:191], v[116:119], v[216:219]
    ds_read_b64_tr_b16 v[184:185], v250 offset:16384
    ds_read_b64_tr_b16 v[186:187], v250 offset:18432
    v_cvt_pk_bf16_f32 v3, v238, v239
    v_mfma_f32_16x16x32_bf16 v[220:223], v[168:171], v[96:99], v[220:223]
    ds_read_b64_tr_b16 v[188:189], v250 offset:20480
    ds_read_b64_tr_b16 v[190:191], v250 offset:22528
    v_lshlrev_b32 v236, 16, v10
    s_waitcnt lgkmcnt(4)
    v_mfma_f32_16x16x32_bf16 v[220:223], v[172:175], v[100:103], v[220:223]
    v_xor_b32 v250, 96, v250
    ds_read_b64_tr_b16 v[168:169], v250
    ds_read_b64_tr_b16 v[170:171], v250 offset:2048
    v_and_b32 v237, 0xffff0000, v10
    s_add_u32 s66, s61, 8192
    buffer_store_dwordx4 v[0:3], v251, s[36:39], s66 offen sc1
    v_mfma_f32_16x16x32_bf16 v[220:223], v[176:179], v[104:107], v[220:223]
    ds_read_b64_tr_b16 v[172:173], v250 offset:4096
    ds_read_b64_tr_b16 v[174:175], v250 offset:6144
    v_lshlrev_b32 v238, 16, v11
    v_mfma_f32_16x16x32_bf16 v[220:223], v[180:183], v[108:111], v[220:223]
    ds_read_b64_tr_b16 v[176:177], v250 offset:8192
    ds_read_b64_tr_b16 v[178:179], v250 offset:10240
    v_and_b32 v239, 0xffff0000, v11
    s_waitcnt lgkmcnt(4)
    v_mfma_f32_16x16x32_bf16 v[220:223], v[184:187], v[112:115], v[220:223]
    ds_read_b64_tr_b16 v[180:181], v250 offset:12288
    ds_read_b64_tr_b16 v[182:183], v250 offset:14336
    v_cvt_pk_bf16_f32 v8, v216, v217
    v_mfma_f32_16x16x32_bf16 v[220:223], v[188:191], v[116:119], v[220:223]
    ds_read_b64_tr_b16 v[184:185], v250 offset:16384
    ds_read_b64_tr_b16 v[186:187], v250 offset:18432
    v_cvt_pk_bf16_f32 v9, v218, v219
    v_mfma_f32_16x16x32_bf16 v[232:235], v[168:171], v[96:99], v[232:235]
    ds_read_b64_tr_b16 v[188:189], v250 offset:20480
    ds_read_b64_tr_b16 v[190:191], v250 offset:22528
    v_lshlrev_b32 v216, 16, v16
    s_waitcnt lgkmcnt(4)
    v_mfma_f32_16x16x32_bf16 v[232:235], v[172:175], v[100:103], v[232:235]
    v_xor_b32 v250, 32, v250
    ds_read_b64_tr_b16 v[168:169], v250
    ds_read_b64_tr_b16 v[170:171], v250 offset:2048
    v_and_b32 v217, 0xffff0000, v16
    v_mfma_f32_16x16x32_bf16 v[232:235], v[176:179], v[104:107], v[232:235]
    ds_read_b64_tr_b16 v[172:173], v250 offset:4096
    ds_read_b64_tr_b16 v[174:175], v250 offset:6144
    v_lshlrev_b32 v218, 16, v17
    v_mfma_f32_16x16x32_bf16 v[232:235], v[180:183], v[108:111], v[232:235]
    ds_read_b64_tr_b16 v[176:177], v250 offset:8192
    ds_read_b64_tr_b16 v[178:179], v250 offset:10240
    v_and_b32 v219, 0xffff0000, v17
    s_waitcnt lgkmcnt(4)
    v_mfma_f32_16x16x32_bf16 v[232:235], v[184:187], v[112:115], v[232:235]
    ds_read_b64_tr_b16 v[180:181], v250 offset:12288
    ds_read_b64_tr_b16 v[182:183], v250 offset:14336
    v_cvt_pk_bf16_f32 v10, v220, v221
    v_mfma_f32_16x16x32_bf16 v[232:235], v[188:191], v[116:119], v[232:235]
    ds_read_b64_tr_b16 v[184:185], v250 offset:16384
    ds_read_b64_tr_b16 v[186:187], v250 offset:18432
    v_cvt_pk_bf16_f32 v11, v222, v223
    v_mfma_f32_16x16x32_bf16 v[236:239], v[168:171], v[96:99], v[236:239]
    ds_read_b64_tr_b16 v[188:189], v250 offset:20480
    ds_read_b64_tr_b16 v[190:191], v250 offset:22528
    v_lshlrev_b32 v220, 16, v18
    s_waitcnt vmcnt(2)
    s_barrier
    s_waitcnt lgkmcnt(4)
    v_mfma_f32_16x16x32_bf16 v[236:239], v[172:175], v[100:103], v[236:239]
    v_add_u32 v250, 135168, v249
    ds_read_b64_tr_b16 v[168:169], v250
    ds_read_b64_tr_b16 v[170:171], v250 offset:2048
    v_and_b32 v221, 0xffff0000, v18
    s_add_u32 s66, s61, 16384
    buffer_store_dwordx4 v[8:11], v251, s[36:39], s66 offen sc1
    v_mfma_f32_16x16x32_bf16 v[236:239], v[176:179], v[104:107], v[236:239]
    ds_read_b64_tr_b16 v[172:173], v250 offset:4096
    ds_read_b64_tr_b16 v[174:175], v250 offset:6144
    v_lshlrev_b32 v222, 16, v19
    v_mfma_f32_16x16x32_bf16 v[236:239], v[180:183], v[108:111], v[236:239]
    ds_read_b64_tr_b16 v[176:177], v250 offset:8192
    ds_read_b64_tr_b16 v[178:179], v250 offset:10240
    v_and_b32 v223, 0xffff0000, v19
    s_waitcnt lgkmcnt(4)
    v_mfma_f32_16x16x32_bf16 v[236:239], v[184:187], v[112:115], v[236:239]
    ds_read_b64_tr_b16 v[180:181], v250 offset:12288
    ds_read_b64_tr_b16 v[182:183], v250 offset:14336
    v_cvt_pk_bf16_f32 v16, v232, v233
    v_mfma_f32_16x16x32_bf16 v[236:239], v[188:191], v[116:119], v[236:239]
    ds_read_b64_tr_b16 v[184:185], v250 offset:16384
    ds_read_b64_tr_b16 v[186:187], v250 offset:18432
    v_cvt_pk_bf16_f32 v17, v234, v235
    v_mfma_f32_16x16x32_bf16 v[216:219], v[168:171], v[96:99], v[216:219]
    ds_read_b64_tr_b16 v[188:189], v250 offset:20480
    ds_read_b64_tr_b16 v[190:191], v250 offset:22528
    v_lshlrev_b32 v232, 16, v24
    s_waitcnt lgkmcnt(4)
    v_mfma_f32_16x16x32_bf16 v[216:219], v[172:175], v[100:103], v[216:219]
    v_xor_b32 v250, 32, v250
    ds_read_b64_tr_b16 v[168:169], v250
    ds_read_b64_tr_b16 v[170:171], v250 offset:2048
    v_and_b32 v233, 0xffff0000, v24
    v_mfma_f32_16x16x32_bf16 v[216:219], v[176:179], v[104:107], v[216:219]
    ds_read_b64_tr_b16 v[172:173], v250 offset:4096
    ds_read_b64_tr_b16 v[174:175], v250 offset:6144
    v_lshlrev_b32 v234, 16, v25
    v_mfma_f32_16x16x32_bf16 v[216:219], v[180:183], v[108:111], v[216:219]
    ds_read_b64_tr_b16 v[176:177], v250 offset:8192
    ds_read_b64_tr_b16 v[178:179], v250 offset:10240
    v_and_b32 v235, 0xffff0000, v25
    s_waitcnt lgkmcnt(4)
    v_mfma_f32_16x16x32_bf16 v[216:219], v[184:187], v[112:115], v[216:219]
    ds_read_b64_tr_b16 v[180:181], v250 offset:12288
    ds_read_b64_tr_b16 v[182:183], v250 offset:14336
    v_cvt_pk_bf16_f32 v18, v236, v237
    v_mfma_f32_16x16x32_bf16 v[216:219], v[188:191], v[116:119], v[216:219]
    ds_read_b64_tr_b16 v[184:185], v250 offset:16384
    ds_read_b64_tr_b16 v[186:187], v250 offset:18432
    v_cvt_pk_bf16_f32 v19, v238, v239
    v_mfma_f32_16x16x32_bf16 v[220:223], v[168:171], v[96:99], v[220:223]
    ds_read_b64_tr_b16 v[188:189], v250 offset:20480
    ds_read_b64_tr_b16 v[190:191], v250 offset:22528
    v_lshlrev_b32 v236, 16, v26
    s_waitcnt lgkmcnt(4)
    v_mfma_f32_16x16x32_bf16 v[220:223], v[172:175], v[100:103], v[220:223]
    v_xor_b32 v250, 96, v250
    ds_read_b64_tr_b16 v[168:169], v250
    ds_read_b64_tr_b16 v[170:171], v250 offset:2048
    v_and_b32 v237, 0xffff0000, v26
    s_add_u32 s66, s61, 24576
    buffer_store_dwordx4 v[16:19], v251, s[36:39], s66 offen sc1
    v_mfma_f32_16x16x32_bf16 v[220:223], v[176:179], v[104:107], v[220:223]
    ds_read_b64_tr_b16 v[172:173], v250 offset:4096
    ds_read_b64_tr_b16 v[174:175], v250 offset:6144
    v_lshlrev_b32 v238, 16, v27
    v_mfma_f32_16x16x32_bf16 v[220:223], v[180:183], v[108:111], v[220:223]
    ds_read_b64_tr_b16 v[176:177], v250 offset:8192
    ds_read_b64_tr_b16 v[178:179], v250 offset:10240
    v_and_b32 v239, 0xffff0000, v27
    s_waitcnt lgkmcnt(4)
    v_mfma_f32_16x16x32_bf16 v[220:223], v[184:187], v[112:115], v[220:223]
    ds_read_b64_tr_b16 v[180:181], v250 offset:12288
    ds_read_b64_tr_b16 v[182:183], v250 offset:14336
    v_cvt_pk_bf16_f32 v24, v216, v217
    v_mfma_f32_16x16x32_bf16 v[220:223], v[188:191], v[116:119], v[220:223]
    ds_read_b64_tr_b16 v[184:185], v250 offset:16384
    ds_read_b64_tr_b16 v[186:187], v250 offset:18432
    v_cvt_pk_bf16_f32 v25, v218, v219
    v_mfma_f32_16x16x32_bf16 v[232:235], v[168:171], v[96:99], v[232:235]
    ds_read_b64_tr_b16 v[188:189], v250 offset:20480
    ds_read_b64_tr_b16 v[190:191], v250 offset:22528
    v_lshlrev_b32 v216, 16, v32
    s_waitcnt lgkmcnt(4)
    v_mfma_f32_16x16x32_bf16 v[232:235], v[172:175], v[100:103], v[232:235]
    v_xor_b32 v250, 32, v250
    ds_read_b64_tr_b16 v[168:169], v250
    ds_read_b64_tr_b16 v[170:171], v250 offset:2048
    v_and_b32 v217, 0xffff0000, v32
    v_mfma_f32_16x16x32_bf16 v[232:235], v[176:179], v[104:107], v[232:235]
    ds_read_b64_tr_b16 v[172:173], v250 offset:4096
    ds_read_b64_tr_b16 v[174:175], v250 offset:6144
    v_lshlrev_b32 v218, 16, v33
    v_mfma_f32_16x16x32_bf16 v[232:235], v[180:183], v[108:111], v[232:235]
    ds_read_b64_tr_b16 v[176:177], v250 offset:8192
    ds_read_b64_tr_b16 v[178:179], v250 offset:10240
    v_and_b32 v219, 0xffff0000, v33
    s_waitcnt lgkmcnt(4)
    v_mfma_f32_16x16x32_bf16 v[232:235], v[184:187], v[112:115], v[232:235]
    ds_read_b64_tr_b16 v[180:181], v250 offset:12288
    ds_read_b64_tr_b16 v[182:183], v250 offset:14336
    v_cvt_pk_bf16_f32 v26, v220, v221
    v_mfma_f32_16x16x32_bf16 v[232:235], v[188:191], v[116:119], v[232:235]
    ds_read_b64_tr_b16 v[184:185], v250 offset:16384
    ds_read_b64_tr_b16 v[186:187], v250 offset:18432
    v_cvt_pk_bf16_f32 v27, v222, v223
    v_mfma_f32_16x16x32_bf16 v[236:239], v[168:171], v[96:99], v[236:239]
    ds_read_b64_tr_b16 v[188:189], v250 offset:20480
    ds_read_b64_tr_b16 v[190:191], v250 offset:22528
    v_lshlrev_b32 v220, 16, v34
    s_barrier
    s_waitcnt lgkmcnt(4)
    v_mfma_f32_16x16x32_bf16 v[236:239], v[172:175], v[100:103], v[236:239]
    v_add_u32 v250, 86016, v249
    ds_read_b64_tr_b16 v[168:169], v250
    ds_read_b64_tr_b16 v[170:171], v250 offset:2048
    v_and_b32 v221, 0xffff0000, v34
    s_add_u32 s66, s61, 32768
    buffer_store_dwordx4 v[24:27], v251, s[36:39], s66 offen sc1
    v_mfma_f32_16x16x32_bf16 v[236:239], v[176:179], v[104:107], v[236:239]
    ds_read_b64_tr_b16 v[172:173], v250 offset:4096
    ds_read_b64_tr_b16 v[174:175], v250 offset:6144
    v_lshlrev_b32 v222, 16, v35
    v_mfma_f32_16x16x32_bf16 v[236:239], v[180:183], v[108:111], v[236:239]
    ds_read_b64_tr_b16 v[176:177], v250 offset:8192
    ds_read_b64_tr_b16 v[178:179], v250 offset:10240
    v_and_b32 v223, 0xffff0000, v35
    s_waitcnt lgkmcnt(4)
    v_mfma_f32_16x16x32_bf16 v[236:239], v[184:187], v[112:115], v[236:239]
    ds_read_b64_tr_b16 v[180:181], v250 offset:12288
    ds_read_b64_tr_b16 v[182:183], v250 offset:14336
    v_cvt_pk_bf16_f32 v32, v232, v233
    v_mfma_f32_16x16x32_bf16 v[236:239], v[188:191], v[116:119], v[236:239]
    ds_read_b64_tr_b16 v[184:185], v250 offset:16384
    ds_read_b64_tr_b16 v[186:187], v250 offset:18432
    v_cvt_pk_bf16_f32 v33, v234, v235
    v_mfma_f32_16x16x32_bf16 v[216:219], v[168:171], v[96:99], v[216:219]
    ds_read_b64_tr_b16 v[188:189], v250 offset:20480
    ds_read_b64_tr_b16 v[190:191], v250 offset:22528
    v_lshlrev_b32 v232, 16, v40
    s_waitcnt lgkmcnt(4)
    v_mfma_f32_16x16x32_bf16 v[216:219], v[172:175], v[100:103], v[216:219]
    v_xor_b32 v250, 32, v250
    ds_read_b64_tr_b16 v[168:169], v250
    ds_read_b64_tr_b16 v[170:171], v250 offset:2048
    v_and_b32 v233, 0xffff0000, v40
    v_mfma_f32_16x16x32_bf16 v[216:219], v[176:179], v[104:107], v[216:219]
    ds_read_b64_tr_b16 v[172:173], v250 offset:4096
    ds_read_b64_tr_b16 v[174:175], v250 offset:6144
    v_lshlrev_b32 v234, 16, v41
    v_mfma_f32_16x16x32_bf16 v[216:219], v[180:183], v[108:111], v[216:219]
    ds_read_b64_tr_b16 v[176:177], v250 offset:8192
    ds_read_b64_tr_b16 v[178:179], v250 offset:10240
    v_and_b32 v235, 0xffff0000, v41
    s_waitcnt lgkmcnt(4)
    v_mfma_f32_16x16x32_bf16 v[216:219], v[184:187], v[112:115], v[216:219]
    ds_read_b64_tr_b16 v[180:181], v250 offset:12288
    ds_read_b64_tr_b16 v[182:183], v250 offset:14336
    v_cvt_pk_bf16_f32 v34, v236, v237
    v_mfma_f32_16x16x32_bf16 v[216:219], v[188:191], v[116:119], v[216:219]
    ds_read_b64_tr_b16 v[184:185], v250 offset:16384
    ds_read_b64_tr_b16 v[186:187], v250 offset:18432
    v_cvt_pk_bf16_f32 v35, v238, v239
    v_mfma_f32_16x16x32_bf16 v[220:223], v[168:171], v[96:99], v[220:223]
    ds_read_b64_tr_b16 v[188:189], v250 offset:20480
    ds_read_b64_tr_b16 v[190:191], v250 offset:22528
    v_lshlrev_b32 v236, 16, v42
    s_waitcnt lgkmcnt(4)
    v_mfma_f32_16x16x32_bf16 v[220:223], v[172:175], v[100:103], v[220:223]
    v_xor_b32 v250, 96, v250
    ds_read_b64_tr_b16 v[168:169], v250
    ds_read_b64_tr_b16 v[170:171], v250 offset:2048
    v_and_b32 v237, 0xffff0000, v42
    s_add_u32 s66, s61, 40960
    buffer_store_dwordx4 v[32:35], v251, s[36:39], s66 offen sc1
    v_mfma_f32_16x16x32_bf16 v[220:223], v[176:179], v[104:107], v[220:223]
    ds_read_b64_tr_b16 v[172:173], v250 offset:4096
    ds_read_b64_tr_b16 v[174:175], v250 offset:6144
    v_lshlrev_b32 v238, 16, v43
    v_mfma_f32_16x16x32_bf16 v[220:223], v[180:183], v[108:111], v[220:223]
    ds_read_b64_tr_b16 v[176:177], v250 offset:8192
    ds_read_b64_tr_b16 v[178:179], v250 offset:10240
    v_and_b32 v239, 0xffff0000, v43
    s_waitcnt lgkmcnt(4)
    v_mfma_f32_16x16x32_bf16 v[220:223], v[184:187], v[112:115], v[220:223]
    ds_read_b64_tr_b16 v[180:181], v250 offset:12288
    ds_read_b64_tr_b16 v[182:183], v250 offset:14336
    v_cvt_pk_bf16_f32 v40, v216, v217
    v_mfma_f32_16x16x32_bf16 v[220:223], v[188:191], v[116:119], v[220:223]
    ds_read_b64_tr_b16 v[184:185], v250 offset:16384
    ds_read_b64_tr_b16 v[186:187], v250 offset:18432
    v_cvt_pk_bf16_f32 v41, v218, v219
    v_mfma_f32_16x16x32_bf16 v[232:235], v[168:171], v[96:99], v[232:235]
    ds_read_b64_tr_b16 v[188:189], v250 offset:20480
    ds_read_b64_tr_b16 v[190:191], v250 offset:22528
    v_lshlrev_b32 v216, 16, v48
    s_waitcnt lgkmcnt(4)
    v_mfma_f32_16x16x32_bf16 v[232:235], v[172:175], v[100:103], v[232:235]
    v_xor_b32 v250, 32, v250
    ds_read_b64_tr_b16 v[168:169], v250
    ds_read_b64_tr_b16 v[170:171], v250 offset:2048
    v_and_b32 v217, 0xffff0000, v48
    v_mfma_f32_16x16x32_bf16 v[232:235], v[176:179], v[104:107], v[232:235]
    ds_read_b64_tr_b16 v[172:173], v250 offset:4096
    ds_read_b64_tr_b16 v[174:175], v250 offset:6144
    v_lshlrev_b32 v218, 16, v49
    v_mfma_f32_16x16x32_bf16 v[232:235], v[180:183], v[108:111], v[232:235]
    ds_read_b64_tr_b16 v[176:177], v250 offset:8192
    ds_read_b64_tr_b16 v[178:179], v250 offset:10240
    v_and_b32 v219, 0xffff0000, v49
    s_waitcnt lgkmcnt(4)
    v_mfma_f32_16x16x32_bf16 v[232:235], v[184:187], v[112:115], v[232:235]
    ds_read_b64_tr_b16 v[180:181], v250 offset:12288
    ds_read_b64_tr_b16 v[182:183], v250 offset:14336
    v_cvt_pk_bf16_f32 v42, v220, v221
    v_mfma_f32_16x16x32_bf16 v[232:235], v[188:191], v[116:119], v[232:235]
    ds_read_b64_tr_b16 v[184:185], v250 offset:16384
    ds_read_b64_tr_b16 v[186:187], v250 offset:18432
    v_cvt_pk_bf16_f32 v43, v222, v223
    v_mfma_f32_16x16x32_bf16 v[236:239], v[168:171], v[96:99], v[236:239]
    ds_read_b64_tr_b16 v[188:189], v250 offset:20480
    ds_read_b64_tr_b16 v[190:191], v250 offset:22528
    v_lshlrev_b32 v220, 16, v50
    s_barrier
    s_waitcnt lgkmcnt(4)
    v_mfma_f32_16x16x32_bf16 v[236:239], v[172:175], v[100:103], v[236:239]
    v_add_u32 v250, 0, v249
    ds_read_b64_tr_b16 v[168:169], v250
    ds_read_b64_tr_b16 v[170:171], v250 offset:2048
    v_and_b32 v221, 0xffff0000, v50
    s_add_u32 s66, s61, 49152
    buffer_store_dwordx4 v[40:43], v251, s[36:39], s66 offen sc1
    v_mfma_f32_16x16x32_bf16 v[236:239], v[176:179], v[104:107], v[236:239]
    ds_read_b64_tr_b16 v[172:173], v250 offset:4096
    ds_read_b64_tr_b16 v[174:175], v250 offset:6144
    v_lshlrev_b32 v222, 16, v51
    v_mfma_f32_16x16x32_bf16 v[236:239], v[180:183], v[108:111], v[236:239]
    ds_read_b64_tr_b16 v[176:177], v250 offset:8192
    ds_read_b64_tr_b16 v[178:179], v250 offset:10240
    v_and_b32 v223, 0xffff0000, v51
    s_waitcnt lgkmcnt(4)
    v_mfma_f32_16x16x32_bf16 v[236:239], v[184:187], v[112:115], v[236:239]
    ds_read_b64_tr_b16 v[180:181], v250 offset:12288
    ds_read_b64_tr_b16 v[182:183], v250 offset:14336
    v_cvt_pk_bf16_f32 v48, v232, v233
    v_mfma_f32_16x16x32_bf16 v[236:239], v[188:191], v[116:119], v[236:239]
    ds_read_b64_tr_b16 v[184:185], v250 offset:16384
    ds_read_b64_tr_b16 v[186:187], v250 offset:18432
    v_cvt_pk_bf16_f32 v49, v234, v235
    v_mfma_f32_16x16x32_bf16 v[216:219], v[168:171], v[96:99], v[216:219]
    ds_read_b64_tr_b16 v[188:189], v250 offset:20480
    ds_read_b64_tr_b16 v[190:191], v250 offset:22528
    v_lshlrev_b32 v232, 16, v56
    s_waitcnt lgkmcnt(4)
    v_mfma_f32_16x16x32_bf16 v[216:219], v[172:175], v[100:103], v[216:219]
    v_xor_b32 v250, 32, v250
    ds_read_b64_tr_b16 v[168:169], v250
    ds_read_b64_tr_b16 v[170:171], v250 offset:2048
    v_and_b32 v233, 0xffff0000, v56
    v_mfma_f32_16x16x32_bf16 v[216:219], v[176:179], v[104:107], v[216:219]
    ds_read_b64_tr_b16 v[172:173], v250 offset:4096
    ds_read_b64_tr_b16 v[174:175], v250 offset:6144
    v_lshlrev_b32 v234, 16, v57
    v_mfma_f32_16x16x32_bf16 v[216:219], v[180:183], v[108:111], v[216:219]
    ds_read_b64_tr_b16 v[176:177], v250 offset:8192
    ds_read_b64_tr_b16 v[178:179], v250 offset:10240
    v_and_b32 v235, 0xffff0000, v57
    s_waitcnt lgkmcnt(4)
    v_mfma_f32_16x16x32_bf16 v[216:219], v[184:187], v[112:115], v[216:219]
    ds_read_b64_tr_b16 v[180:181], v250 offset:12288
    ds_read_b64_tr_b16 v[182:183], v250 offset:14336
    v_cvt_pk_bf16_f32 v50, v236, v237
    v_mfma_f32_16x16x32_bf16 v[216:219], v[188:191], v[116:119], v[216:219]
    ds_read_b64_tr_b16 v[184:185], v250 offset:16384
    ds_read_b64_tr_b16 v[186:187], v250 offset:18432
    v_cvt_pk_bf16_f32 v51, v238, v239
    v_mfma_f32_16x16x32_bf16 v[220:223], v[168:171], v[96:99], v[220:223]
    ds_read_b64_tr_b16 v[188:189], v250 offset:20480
    ds_read_b64_tr_b16 v[190:191], v250 offset:22528
    v_lshlrev_b32 v236, 16, v58
    s_waitcnt lgkmcnt(4)
    v_mfma_f32_16x16x32_bf16 v[220:223], v[172:175], v[100:103], v[220:223]
    v_xor_b32 v250, 96, v250
    ds_read_b64_tr_b16 v[168:169], v250
    ds_read_b64_tr_b16 v[170:171], v250 offset:2048
    v_and_b32 v237, 0xffff0000, v58
    s_add_u32 s66, s61, 57344
    buffer_store_dwordx4 v[48:51], v251, s[36:39], s66 offen sc1
    v_mfma_f32_16x16x32_bf16 v[220:223], v[176:179], v[104:107], v[220:223]
    ds_read_b64_tr_b16 v[172:173], v250 offset:4096
    ds_read_b64_tr_b16 v[174:175], v250 offset:6144
    v_lshlrev_b32 v238, 16, v59
    v_mfma_f32_16x16x32_bf16 v[220:223], v[180:183], v[108:111], v[220:223]
    ds_read_b64_tr_b16 v[176:177], v250 offset:8192
    ds_read_b64_tr_b16 v[178:179], v250 offset:10240
    v_and_b32 v239, 0xffff0000, v59
    s_waitcnt lgkmcnt(4)
    v_mfma_f32_16x16x32_bf16 v[220:223], v[184:187], v[112:115], v[220:223]
    ds_read_b64_tr_b16 v[180:181], v250 offset:12288
    ds_read_b64_tr_b16 v[182:183], v250 offset:14336
    v_cvt_pk_bf16_f32 v56, v216, v217
    v_mfma_f32_16x16x32_bf16 v[220:223], v[188:191], v[116:119], v[220:223]
    ds_read_b64_tr_b16 v[184:185], v250 offset:16384
    ds_read_b64_tr_b16 v[186:187], v250 offset:18432
    v_cvt_pk_bf16_f32 v57, v218, v219
    v_mfma_f32_16x16x32_bf16 v[232:235], v[168:171], v[96:99], v[232:235]
    ds_read_b64_tr_b16 v[188:189], v250 offset:20480
    ds_read_b64_tr_b16 v[190:191], v250 offset:22528
    v_lshlrev_b32 v216, 16, v64
    s_waitcnt lgkmcnt(4)
    v_mfma_f32_16x16x32_bf16 v[232:235], v[172:175], v[100:103], v[232:235]
    v_xor_b32 v250, 32, v250
    ds_read_b64_tr_b16 v[168:169], v250
    ds_read_b64_tr_b16 v[170:171], v250 offset:2048
    v_and_b32 v217, 0xffff0000, v64
    v_mfma_f32_16x16x32_bf16 v[232:235], v[176:179], v[104:107], v[232:235]
    ds_read_b64_tr_b16 v[172:173], v250 offset:4096
    ds_read_b64_tr_b16 v[174:175], v250 offset:6144
    v_lshlrev_b32 v218, 16, v65
    v_mfma_f32_16x16x32_bf16 v[232:235], v[180:183], v[108:111], v[232:235]
    ds_read_b64_tr_b16 v[176:177], v250 offset:8192
    ds_read_b64_tr_b16 v[178:179], v250 offset:10240
    v_and_b32 v219, 0xffff0000, v65
    s_waitcnt lgkmcnt(4)
    v_mfma_f32_16x16x32_bf16 v[232:235], v[184:187], v[112:115], v[232:235]
    ds_read_b64_tr_b16 v[180:181], v250 offset:12288
    ds_read_b64_tr_b16 v[182:183], v250 offset:14336
    v_cvt_pk_bf16_f32 v58, v220, v221
    v_mfma_f32_16x16x32_bf16 v[232:235], v[188:191], v[116:119], v[232:235]
    ds_read_b64_tr_b16 v[184:185], v250 offset:16384
    ds_read_b64_tr_b16 v[186:187], v250 offset:18432
    v_cvt_pk_bf16_f32 v59, v222, v223
    v_mfma_f32_16x16x32_bf16 v[236:239], v[168:171], v[96:99], v[236:239]
    ds_read_b64_tr_b16 v[188:189], v250 offset:20480
    ds_read_b64_tr_b16 v[190:191], v250 offset:22528
    v_lshlrev_b32 v220, 16, v66
    s_barrier
    s_waitcnt lgkmcnt(4)
    v_mfma_f32_16x16x32_bf16 v[236:239], v[172:175], v[100:103], v[236:239]
    v_add_u32 v250, 24576, v249
    ds_read_b64_tr_b16 v[168:169], v250
    ds_read_b64_tr_b16 v[170:171], v250 offset:2048
    v_and_b32 v221, 0xffff0000, v66
    s_add_u32 s66, s61, 65536
    buffer_store_dwordx4 v[56:59], v251, s[36:39], s66 offen sc1
    v_mfma_f32_16x16x32_bf16 v[236:239], v[176:179], v[104:107], v[236:239]
    ds_read_b64_tr_b16 v[172:173], v250 offset:4096
    ds_read_b64_tr_b16 v[174:175], v250 offset:6144
    v_lshlrev_b32 v222, 16, v67
    v_mfma_f32_16x16x32_bf16 v[236:239], v[180:183], v[108:111], v[236:239]
    ds_read_b64_tr_b16 v[176:177], v250 offset:8192
    ds_read_b64_tr_b16 v[178:179], v250 offset:10240
    v_and_b32 v223, 0xffff0000, v67
    s_waitcnt lgkmcnt(4)
    v_mfma_f32_16x16x32_bf16 v[236:239], v[184:187], v[112:115], v[236:239]
    ds_read_b64_tr_b16 v[180:181], v250 offset:12288
    ds_read_b64_tr_b16 v[182:183], v250 offset:14336
    v_cvt_pk_bf16_f32 v64, v232, v233
    v_mfma_f32_16x16x32_bf16 v[236:239], v[188:191], v[116:119], v[236:239]
    ds_read_b64_tr_b16 v[184:185], v250 offset:16384
    ds_read_b64_tr_b16 v[186:187], v250 offset:18432
    v_cvt_pk_bf16_f32 v65, v234, v235
    v_mfma_f32_16x16x32_bf16 v[216:219], v[168:171], v[96:99], v[216:219]
    ds_read_b64_tr_b16 v[188:189], v250 offset:20480
    ds_read_b64_tr_b16 v[190:191], v250 offset:22528
    v_lshlrev_b32 v232, 16, v72
    s_waitcnt lgkmcnt(4)
    v_mfma_f32_16x16x32_bf16 v[216:219], v[172:175], v[100:103], v[216:219]
    v_xor_b32 v250, 32, v250
    ds_read_b64_tr_b16 v[168:169], v250
    ds_read_b64_tr_b16 v[170:171], v250 offset:2048
    v_and_b32 v233, 0xffff0000, v72
    v_mfma_f32_16x16x32_bf16 v[216:219], v[176:179], v[104:107], v[216:219]
    ds_read_b64_tr_b16 v[172:173], v250 offset:4096
    ds_read_b64_tr_b16 v[174:175], v250 offset:6144
    v_lshlrev_b32 v234, 16, v73
    v_mfma_f32_16x16x32_bf16 v[216:219], v[180:183], v[108:111], v[216:219]
    ds_read_b64_tr_b16 v[176:177], v250 offset:8192
    ds_read_b64_tr_b16 v[178:179], v250 offset:10240
    v_and_b32 v235, 0xffff0000, v73
    s_waitcnt lgkmcnt(4)
    v_mfma_f32_16x16x32_bf16 v[216:219], v[184:187], v[112:115], v[216:219]
    ds_read_b64_tr_b16 v[180:181], v250 offset:12288
    ds_read_b64_tr_b16 v[182:183], v250 offset:14336
    v_cvt_pk_bf16_f32 v66, v236, v237
    v_mfma_f32_16x16x32_bf16 v[216:219], v[188:191], v[116:119], v[216:219]
    ds_read_b64_tr_b16 v[184:185], v250 offset:16384
    ds_read_b64_tr_b16 v[186:187], v250 offset:18432
    v_cvt_pk_bf16_f32 v67, v238, v239
    v_mfma_f32_16x16x32_bf16 v[220:223], v[168:171], v[96:99], v[220:223]
    ds_read_b64_tr_b16 v[188:189], v250 offset:20480
    ds_read_b64_tr_b16 v[190:191], v250 offset:22528
    v_lshlrev_b32 v236, 16, v74
    s_waitcnt lgkmcnt(4)
    v_mfma_f32_16x16x32_bf16 v[220:223], v[172:175], v[100:103], v[220:223]
    v_xor_b32 v250, 96, v250
    ds_read_b64_tr_b16 v[168:169], v250
    ds_read_b64_tr_b16 v[170:171], v250 offset:2048
    v_and_b32 v237, 0xffff0000, v74
    s_add_u32 s66, s61, 73728
    buffer_store_dwordx4 v[64:67], v251, s[36:39], s66 offen sc1
    v_mfma_f32_16x16x32_bf16 v[220:223], v[176:179], v[104:107], v[220:223]
    ds_read_b64_tr_b16 v[172:173], v250 offset:4096
    ds_read_b64_tr_b16 v[174:175], v250 offset:6144
    v_lshlrev_b32 v238, 16, v75
    v_mfma_f32_16x16x32_bf16 v[220:223], v[180:183], v[108:111], v[220:223]
    ds_read_b64_tr_b16 v[176:177], v250 offset:8192
    ds_read_b64_tr_b16 v[178:179], v250 offset:10240
    v_and_b32 v239, 0xffff0000, v75
    s_waitcnt lgkmcnt(4)
    v_mfma_f32_16x16x32_bf16 v[220:223], v[184:187], v[112:115], v[220:223]
    ds_read_b64_tr_b16 v[180:181], v250 offset:12288
    ds_read_b64_tr_b16 v[182:183], v250 offset:14336
    v_cvt_pk_bf16_f32 v72, v216, v217
    v_mfma_f32_16x16x32_bf16 v[220:223], v[188:191], v[116:119], v[220:223]
    ds_read_b64_tr_b16 v[184:185], v250 offset:16384
    ds_read_b64_tr_b16 v[186:187], v250 offset:18432
    v_cvt_pk_bf16_f32 v73, v218, v219
    v_mfma_f32_16x16x32_bf16 v[232:235], v[168:171], v[96:99], v[232:235]
    ds_read_b64_tr_b16 v[188:189], v250 offset:20480
    ds_read_b64_tr_b16 v[190:191], v250 offset:22528
    v_lshlrev_b32 v216, 16, v80
    s_waitcnt lgkmcnt(4)
    v_mfma_f32_16x16x32_bf16 v[232:235], v[172:175], v[100:103], v[232:235]
    v_xor_b32 v250, 32, v250
    ds_read_b64_tr_b16 v[168:169], v250
    ds_read_b64_tr_b16 v[170:171], v250 offset:2048
    v_and_b32 v217, 0xffff0000, v80
    v_mfma_f32_16x16x32_bf16 v[232:235], v[176:179], v[104:107], v[232:235]
    ds_read_b64_tr_b16 v[172:173], v250 offset:4096
    ds_read_b64_tr_b16 v[174:175], v250 offset:6144
    v_lshlrev_b32 v218, 16, v81
    v_mfma_f32_16x16x32_bf16 v[232:235], v[180:183], v[108:111], v[232:235]
    ds_read_b64_tr_b16 v[176:177], v250 offset:8192
    ds_read_b64_tr_b16 v[178:179], v250 offset:10240
    v_and_b32 v219, 0xffff0000, v81
    s_waitcnt lgkmcnt(4)
    v_mfma_f32_16x16x32_bf16 v[232:235], v[184:187], v[112:115], v[232:235]
    ds_read_b64_tr_b16 v[180:181], v250 offset:12288
    ds_read_b64_tr_b16 v[182:183], v250 offset:14336
    v_cvt_pk_bf16_f32 v74, v220, v221
    v_mfma_f32_16x16x32_bf16 v[232:235], v[188:191], v[116:119], v[232:235]
    ds_read_b64_tr_b16 v[184:185], v250 offset:16384
    ds_read_b64_tr_b16 v[186:187], v250 offset:18432
    v_cvt_pk_bf16_f32 v75, v222, v223
    v_mfma_f32_16x16x32_bf16 v[236:239], v[168:171], v[96:99], v[236:239]
    ds_read_b64_tr_b16 v[188:189], v250 offset:20480
    ds_read_b64_tr_b16 v[190:191], v250 offset:22528
    v_lshlrev_b32 v220, 16, v82
    s_barrier
    s_waitcnt lgkmcnt(4)
    v_mfma_f32_16x16x32_bf16 v[236:239], v[172:175], v[100:103], v[236:239]
    v_add_u32 v250, 110592, v249
    ds_read_b64_tr_b16 v[168:169], v250
    ds_read_b64_tr_b16 v[170:171], v250 offset:2048
    v_and_b32 v221, 0xffff0000, v82
    s_add_u32 s66, s61, 81920
    buffer_store_dwordx4 v[72:75], v251, s[36:39], s66 offen sc1
    v_mfma_f32_16x16x32_bf16 v[236:239], v[176:179], v[104:107], v[236:239]
    ds_read_b64_tr_b16 v[172:173], v250 offset:4096
    ds_read_b64_tr_b16 v[174:175], v250 offset:6144
    v_lshlrev_b32 v222, 16, v83
    v_mfma_f32_16x16x32_bf16 v[236:239], v[180:183], v[108:111], v[236:239]
    ds_read_b64_tr_b16 v[176:177], v250 offset:8192
    ds_read_b64_tr_b16 v[178:179], v250 offset:10240
    v_and_b32 v223, 0xffff0000, v83
    s_waitcnt lgkmcnt(4)
    v_mfma_f32_16x16x32_bf16 v[236:239], v[184:187], v[112:115], v[236:239]
    ds_read_b64_tr_b16 v[180:181], v250 offset:12288
    ds_read_b64_tr_b16 v[182:183], v250 offset:14336
    v_cvt_pk_bf16_f32 v80, v232, v233
    v_mfma_f32_16x16x32_bf16 v[236:239], v[188:191], v[116:119], v[236:239]
    ds_read_b64_tr_b16 v[184:185], v250 offset:16384
    ds_read_b64_tr_b16 v[186:187], v250 offset:18432
    v_cvt_pk_bf16_f32 v81, v234, v235
    v_mfma_f32_16x16x32_bf16 v[216:219], v[168:171], v[96:99], v[216:219]
    ds_read_b64_tr_b16 v[188:189], v250 offset:20480
    ds_read_b64_tr_b16 v[190:191], v250 offset:22528
    v_lshlrev_b32 v232, 16, v88
    s_waitcnt lgkmcnt(4)
    v_mfma_f32_16x16x32_bf16 v[216:219], v[172:175], v[100:103], v[216:219]
    v_xor_b32 v250, 32, v250
    ds_read_b64_tr_b16 v[168:169], v250
    ds_read_b64_tr_b16 v[170:171], v250 offset:2048
    v_and_b32 v233, 0xffff0000, v88
    v_mfma_f32_16x16x32_bf16 v[216:219], v[176:179], v[104:107], v[216:219]
    ds_read_b64_tr_b16 v[172:173], v250 offset:4096
    ds_read_b64_tr_b16 v[174:175], v250 offset:6144
    v_lshlrev_b32 v234, 16, v89
    v_mfma_f32_16x16x32_bf16 v[216:219], v[180:183], v[108:111], v[216:219]
    ds_read_b64_tr_b16 v[176:177], v250 offset:8192
    ds_read_b64_tr_b16 v[178:179], v250 offset:10240
    v_and_b32 v235, 0xffff0000, v89
    s_waitcnt lgkmcnt(4)
    v_mfma_f32_16x16x32_bf16 v[216:219], v[184:187], v[112:115], v[216:219]
    ds_read_b64_tr_b16 v[180:181], v250 offset:12288
    ds_read_b64_tr_b16 v[182:183], v250 offset:14336
    v_cvt_pk_bf16_f32 v82, v236, v237
    v_mfma_f32_16x16x32_bf16 v[216:219], v[188:191], v[116:119], v[216:219]
    ds_read_b64_tr_b16 v[184:185], v250 offset:16384
    ds_read_b64_tr_b16 v[186:187], v250 offset:18432
    v_cvt_pk_bf16_f32 v83, v238, v239
    v_mfma_f32_16x16x32_bf16 v[220:223], v[168:171], v[96:99], v[220:223]
    ds_read_b64_tr_b16 v[188:189], v250 offset:20480
    ds_read_b64_tr_b16 v[190:191], v250 offset:22528
    v_lshlrev_b32 v236, 16, v90
    s_waitcnt lgkmcnt(4)
    v_mfma_f32_16x16x32_bf16 v[220:223], v[172:175], v[100:103], v[220:223]
    v_xor_b32 v250, 96, v250
    ds_read_b64_tr_b16 v[168:169], v250
    ds_read_b64_tr_b16 v[170:171], v250 offset:2048
    v_and_b32 v237, 0xffff0000, v90
    s_add_u32 s66, s61, 90112
    buffer_store_dwordx4 v[80:83], v251, s[36:39], s66 offen sc1
    v_mfma_f32_16x16x32_bf16 v[220:223], v[176:179], v[104:107], v[220:223]
    ds_read_b64_tr_b16 v[172:173], v250 offset:4096
    ds_read_b64_tr_b16 v[174:175], v250 offset:6144
    v_lshlrev_b32 v238, 16, v91
    v_mfma_f32_16x16x32_bf16 v[220:223], v[180:183], v[108:111], v[220:223]
    ds_read_b64_tr_b16 v[176:177], v250 offset:8192
    ds_read_b64_tr_b16 v[178:179], v250 offset:10240
    v_and_b32 v239, 0xffff0000, v91
    s_waitcnt lgkmcnt(4)
    v_mfma_f32_16x16x32_bf16 v[220:223], v[184:187], v[112:115], v[220:223]
    ds_read_b64_tr_b16 v[180:181], v250 offset:12288
    ds_read_b64_tr_b16 v[182:183], v250 offset:14336
    v_cvt_pk_bf16_f32 v88, v216, v217
    v_mfma_f32_16x16x32_bf16 v[220:223], v[188:191], v[116:119], v[220:223]
    ds_read_b64_tr_b16 v[184:185], v250 offset:16384
    ds_read_b64_tr_b16 v[186:187], v250 offset:18432
    v_cvt_pk_bf16_f32 v89, v218, v219
    v_mfma_f32_16x16x32_bf16 v[232:235], v[168:171], v[96:99], v[232:235]
    ds_read_b64_tr_b16 v[188:189], v250 offset:20480
    ds_read_b64_tr_b16 v[190:191], v250 offset:22528
    v_lshlrev_b32 v216, 16, v144
    s_waitcnt lgkmcnt(4)
    v_mfma_f32_16x16x32_bf16 v[232:235], v[172:175], v[100:103], v[232:235]
    v_xor_b32 v250, 32, v250
    ds_read_b64_tr_b16 v[168:169], v250
    ds_read_b64_tr_b16 v[170:171], v250 offset:2048
    v_and_b32 v217, 0xffff0000, v144
    v_mfma_f32_16x16x32_bf16 v[232:235], v[176:179], v[104:107], v[232:235]
    ds_read_b64_tr_b16 v[172:173], v250 offset:4096
    ds_read_b64_tr_b16 v[174:175], v250 offset:6144
    v_lshlrev_b32 v218, 16, v145
    v_mfma_f32_16x16x32_bf16 v[232:235], v[180:183], v[108:111], v[232:235]
    ds_read_b64_tr_b16 v[176:177], v250 offset:8192
    ds_read_b64_tr_b16 v[178:179], v250 offset:10240
    v_and_b32 v219, 0xffff0000, v145
    s_waitcnt lgkmcnt(4)
    v_mfma_f32_16x16x32_bf16 v[232:235], v[184:187], v[112:115], v[232:235]
    ds_read_b64_tr_b16 v[180:181], v250 offset:12288
    ds_read_b64_tr_b16 v[182:183], v250 offset:14336
    v_cvt_pk_bf16_f32 v90, v220, v221
    v_mfma_f32_16x16x32_bf16 v[232:235], v[188:191], v[116:119], v[232:235]
    ds_read_b64_tr_b16 v[184:185], v250 offset:16384
    ds_read_b64_tr_b16 v[186:187], v250 offset:18432
    v_cvt_pk_bf16_f32 v91, v222, v223
    v_mfma_f32_16x16x32_bf16 v[236:239], v[168:171], v[96:99], v[236:239]
    ds_read_b64_tr_b16 v[188:189], v250 offset:20480
    ds_read_b64_tr_b16 v[190:191], v250 offset:22528
    v_lshlrev_b32 v220, 16, v146
    s_barrier
    s_waitcnt lgkmcnt(4)
    v_mfma_f32_16x16x32_bf16 v[236:239], v[172:175], v[100:103], v[236:239]
    v_add_u32 v250, 49152, v249
    ds_read_b64_tr_b16 v[168:169], v250
    ds_read_b64_tr_b16 v[170:171], v250 offset:2048
    v_and_b32 v221, 0xffff0000, v146
    s_add_u32 s66, s61, 98304
    buffer_store_dwordx4 v[88:91], v251, s[36:39], s66 offen sc1
    v_mfma_f32_16x16x32_bf16 v[236:239], v[176:179], v[104:107], v[236:239]
    ds_read_b64_tr_b16 v[172:173], v250 offset:4096
    ds_read_b64_tr_b16 v[174:175], v250 offset:6144
    v_lshlrev_b32 v222, 16, v147
    v_mfma_f32_16x16x32_bf16 v[236:239], v[180:183], v[108:111], v[236:239]
    ds_read_b64_tr_b16 v[176:177], v250 offset:8192
    ds_read_b64_tr_b16 v[178:179], v250 offset:10240
    v_and_b32 v223, 0xffff0000, v147
    s_waitcnt lgkmcnt(4)
    v_mfma_f32_16x16x32_bf16 v[236:239], v[184:187], v[112:115], v[236:239]
    ds_read_b64_tr_b16 v[180:181], v250 offset:12288
    ds_read_b64_tr_b16 v[182:183], v250 offset:14336
    v_cvt_pk_bf16_f32 v144, v232, v233
    v_mfma_f32_16x16x32_bf16 v[236:239], v[188:191], v[116:119], v[236:239]
    ds_read_b64_tr_b16 v[184:185], v250 offset:16384
    ds_read_b64_tr_b16 v[186:187], v250 offset:18432
    v_cvt_pk_bf16_f32 v145, v234, v235
    v_mfma_f32_16x16x32_bf16 v[216:219], v[168:171], v[96:99], v[216:219]
    ds_read_b64_tr_b16 v[188:189], v250 offset:20480
    ds_read_b64_tr_b16 v[190:191], v250 offset:22528
    v_lshlrev_b32 v232, 16, v152
    s_waitcnt lgkmcnt(4)
    v_mfma_f32_16x16x32_bf16 v[216:219], v[172:175], v[100:103], v[216:219]
    v_xor_b32 v250, 32, v250
    ds_read_b64_tr_b16 v[168:169], v250
    ds_read_b64_tr_b16 v[170:171], v250 offset:2048
    v_and_b32 v233, 0xffff0000, v152
    v_mfma_f32_16x16x32_bf16 v[216:219], v[176:179], v[104:107], v[216:219]
    ds_read_b64_tr_b16 v[172:173], v250 offset:4096
    ds_read_b64_tr_b16 v[174:175], v250 offset:6144
    v_lshlrev_b32 v234, 16, v153
    v_mfma_f32_16x16x32_bf16 v[216:219], v[180:183], v[108:111], v[216:219]
    ds_read_b64_tr_b16 v[176:177], v250 offset:8192
    ds_read_b64_tr_b16 v[178:179], v250 offset:10240
    v_and_b32 v235, 0xffff0000, v153
    s_waitcnt lgkmcnt(4)
    v_mfma_f32_16x16x32_bf16 v[216:219], v[184:187], v[112:115], v[216:219]
    ds_read_b64_tr_b16 v[180:181], v250 offset:12288
    ds_read_b64_tr_b16 v[182:183], v250 offset:14336
    v_cvt_pk_bf16_f32 v146, v236, v237
    v_mfma_f32_16x16x32_bf16 v[216:219], v[188:191], v[116:119], v[216:219]
    ds_read_b64_tr_b16 v[184:185], v250 offset:16384
    ds_read_b64_tr_b16 v[186:187], v250 offset:18432
    v_cvt_pk_bf16_f32 v147, v238, v239
    v_mfma_f32_16x16x32_bf16 v[220:223], v[168:171], v[96:99], v[220:223]
    ds_read_b64_tr_b16 v[188:189], v250 offset:20480
    ds_read_b64_tr_b16 v[190:191], v250 offset:22528
    v_lshlrev_b32 v236, 16, v154
    s_waitcnt lgkmcnt(4)
    v_mfma_f32_16x16x32_bf16 v[220:223], v[172:175], v[100:103], v[220:223]
    v_xor_b32 v250, 96, v250
    ds_read_b64_tr_b16 v[168:169], v250
    ds_read_b64_tr_b16 v[170:171], v250 offset:2048
    v_and_b32 v237, 0xffff0000, v154
    s_add_u32 s66, s61, 106496
    buffer_store_dwordx4 v[144:147], v251, s[36:39], s66 offen sc1
    v_mfma_f32_16x16x32_bf16 v[220:223], v[176:179], v[104:107], v[220:223]
    ds_read_b64_tr_b16 v[172:173], v250 offset:4096
    ds_read_b64_tr_b16 v[174:175], v250 offset:6144
    v_lshlrev_b32 v238, 16, v155
    v_mfma_f32_16x16x32_bf16 v[220:223], v[180:183], v[108:111], v[220:223]
    ds_read_b64_tr_b16 v[176:177], v250 offset:8192
    ds_read_b64_tr_b16 v[178:179], v250 offset:10240
    v_and_b32 v239, 0xffff0000, v155
    s_waitcnt lgkmcnt(4)
    v_mfma_f32_16x16x32_bf16 v[220:223], v[184:187], v[112:115], v[220:223]
    ds_read_b64_tr_b16 v[180:181], v250 offset:12288
    ds_read_b64_tr_b16 v[182:183], v250 offset:14336
    v_cvt_pk_bf16_f32 v152, v216, v217
    v_mfma_f32_16x16x32_bf16 v[220:223], v[188:191], v[116:119], v[220:223]
    ds_read_b64_tr_b16 v[184:185], v250 offset:16384
    ds_read_b64_tr_b16 v[186:187], v250 offset:18432
    v_cvt_pk_bf16_f32 v153, v218, v219
    v_mfma_f32_16x16x32_bf16 v[232:235], v[168:171], v[96:99], v[232:235]
    ds_read_b64_tr_b16 v[188:189], v250 offset:20480
    ds_read_b64_tr_b16 v[190:191], v250 offset:22528
    v_lshlrev_b32 v216, 16, v160
    s_waitcnt lgkmcnt(4)
    v_mfma_f32_16x16x32_bf16 v[232:235], v[172:175], v[100:103], v[232:235]
    v_xor_b32 v250, 32, v250
    ds_read_b64_tr_b16 v[168:169], v250
    ds_read_b64_tr_b16 v[170:171], v250 offset:2048
    v_and_b32 v217, 0xffff0000, v160
    v_mfma_f32_16x16x32_bf16 v[232:235], v[176:179], v[104:107], v[232:235]
    ds_read_b64_tr_b16 v[172:173], v250 offset:4096
    ds_read_b64_tr_b16 v[174:175], v250 offset:6144
    v_lshlrev_b32 v218, 16, v161
    v_mfma_f32_16x16x32_bf16 v[232:235], v[180:183], v[108:111], v[232:235]
    ds_read_b64_tr_b16 v[176:177], v250 offset:8192
    ds_read_b64_tr_b16 v[178:179], v250 offset:10240
    v_and_b32 v219, 0xffff0000, v161
    s_waitcnt lgkmcnt(4)
    v_mfma_f32_16x16x32_bf16 v[232:235], v[184:187], v[112:115], v[232:235]
    ds_read_b64_tr_b16 v[180:181], v250 offset:12288
    ds_read_b64_tr_b16 v[182:183], v250 offset:14336
    v_cvt_pk_bf16_f32 v154, v220, v221
    v_mfma_f32_16x16x32_bf16 v[232:235], v[188:191], v[116:119], v[232:235]
    ds_read_b64_tr_b16 v[184:185], v250 offset:16384
    ds_read_b64_tr_b16 v[186:187], v250 offset:18432
    v_cvt_pk_bf16_f32 v155, v222, v223
    v_mfma_f32_16x16x32_bf16 v[236:239], v[168:171], v[96:99], v[236:239]
    ds_read_b64_tr_b16 v[188:189], v250 offset:20480
    ds_read_b64_tr_b16 v[190:191], v250 offset:22528
    v_lshlrev_b32 v220, 16, v162
    s_waitcnt vmcnt(2)
    s_barrier
    s_waitcnt lgkmcnt(4)
    v_mfma_f32_16x16x32_bf16 v[236:239], v[172:175], v[100:103], v[236:239]
    v_add_u32 v250, 135168, v249
    ds_read_b64_tr_b16 v[168:169], v250
    ds_read_b64_tr_b16 v[170:171], v250 offset:2048
    v_and_b32 v221, 0xffff0000, v162
    s_add_u32 s66, s61, 114688
    buffer_store_dwordx4 v[152:155], v251, s[36:39], s66 offen sc1
    v_mfma_f32_16x16x32_bf16 v[236:239], v[176:179], v[104:107], v[236:239]
    ds_read_b64_tr_b16 v[172:173], v250 offset:4096
    ds_read_b64_tr_b16 v[174:175], v250 offset:6144
    v_lshlrev_b32 v222, 16, v163
    v_mfma_f32_16x16x32_bf16 v[236:239], v[180:183], v[108:111], v[236:239]
    ds_read_b64_tr_b16 v[176:177], v250 offset:8192
    ds_read_b64_tr_b16 v[178:179], v250 offset:10240
    v_and_b32 v223, 0xffff0000, v163
    s_waitcnt lgkmcnt(4)
    v_mfma_f32_16x16x32_bf16 v[236:239], v[184:187], v[112:115], v[236:239]
    ds_read_b64_tr_b16 v[180:181], v250 offset:12288
    ds_read_b64_tr_b16 v[182:183], v250 offset:14336
    v_cvt_pk_bf16_f32 v160, v232, v233
    v_mfma_f32_16x16x32_bf16 v[236:239], v[188:191], v[116:119], v[236:239]
    ds_read_b64_tr_b16 v[184:185], v250 offset:16384
    ds_read_b64_tr_b16 v[186:187], v250 offset:18432
    v_cvt_pk_bf16_f32 v161, v234, v235
    v_mfma_f32_16x16x32_bf16 v[216:219], v[168:171], v[96:99], v[216:219]
    ds_read_b64_tr_b16 v[188:189], v250 offset:20480
    ds_read_b64_tr_b16 v[190:191], v250 offset:22528
    v_lshlrev_b32 v232, 16, v192
    s_waitcnt lgkmcnt(4)
    v_mfma_f32_16x16x32_bf16 v[216:219], v[172:175], v[100:103], v[216:219]
    v_xor_b32 v250, 32, v250
    ds_read_b64_tr_b16 v[168:169], v250
    ds_read_b64_tr_b16 v[170:171], v250 offset:2048
    v_and_b32 v233, 0xffff0000, v192
    v_mfma_f32_16x16x32_bf16 v[216:219], v[176:179], v[104:107], v[216:219]
    ds_read_b64_tr_b16 v[172:173], v250 offset:4096
    ds_read_b64_tr_b16 v[174:175], v250 offset:6144
    v_lshlrev_b32 v234, 16, v193
    v_mfma_f32_16x16x32_bf16 v[216:219], v[180:183], v[108:111], v[216:219]
    ds_read_b64_tr_b16 v[176:177], v250 offset:8192
    ds_read_b64_tr_b16 v[178:179], v250 offset:10240
    v_and_b32 v235, 0xffff0000, v193
    s_waitcnt lgkmcnt(4)
    v_mfma_f32_16x16x32_bf16 v[216:219], v[184:187], v[112:115], v[216:219]
    ds_read_b64_tr_b16 v[180:181], v250 offset:12288
    ds_read_b64_tr_b16 v[182:183], v250 offset:14336
    v_cvt_pk_bf16_f32 v162, v236, v237
    v_mfma_f32_16x16x32_bf16 v[216:219], v[188:191], v[116:119], v[216:219]
    ds_read_b64_tr_b16 v[184:185], v250 offset:16384
    ds_read_b64_tr_b16 v[186:187], v250 offset:18432
    v_cvt_pk_bf16_f32 v163, v238, v239
    v_mfma_f32_16x16x32_bf16 v[220:223], v[168:171], v[96:99], v[220:223]
    ds_read_b64_tr_b16 v[188:189], v250 offset:20480
    ds_read_b64_tr_b16 v[190:191], v250 offset:22528
    v_lshlrev_b32 v236, 16, v194
    s_waitcnt lgkmcnt(4)
    v_mfma_f32_16x16x32_bf16 v[220:223], v[172:175], v[100:103], v[220:223]
    v_xor_b32 v250, 96, v250
    ds_read_b64_tr_b16 v[168:169], v250
    ds_read_b64_tr_b16 v[170:171], v250 offset:2048
    v_and_b32 v237, 0xffff0000, v194
    s_add_u32 s66, s61, 122880
    buffer_store_dwordx4 v[160:163], v251, s[36:39], s66 offen sc1
    v_mfma_f32_16x16x32_bf16 v[220:223], v[176:179], v[104:107], v[220:223]
    ds_read_b64_tr_b16 v[172:173], v250 offset:4096
    ds_read_b64_tr_b16 v[174:175], v250 offset:6144
    v_lshlrev_b32 v238, 16, v195
    v_mfma_f32_16x16x32_bf16 v[220:223], v[180:183], v[108:111], v[220:223]
    ds_read_b64_tr_b16 v[176:177], v250 offset:8192
    ds_read_b64_tr_b16 v[178:179], v250 offset:10240
    v_and_b32 v239, 0xffff0000, v195
    s_waitcnt lgkmcnt(4)
    v_mfma_f32_16x16x32_bf16 v[220:223], v[184:187], v[112:115], v[220:223]
    ds_read_b64_tr_b16 v[180:181], v250 offset:12288
    ds_read_b64_tr_b16 v[182:183], v250 offset:14336
    v_cvt_pk_bf16_f32 v192, v216, v217
    v_mfma_f32_16x16x32_bf16 v[220:223], v[188:191], v[116:119], v[220:223]
    ds_read_b64_tr_b16 v[184:185], v250 offset:16384
    ds_read_b64_tr_b16 v[186:187], v250 offset:18432
    v_cvt_pk_bf16_f32 v193, v218, v219
    v_mfma_f32_16x16x32_bf16 v[232:235], v[168:171], v[96:99], v[232:235]
    ds_read_b64_tr_b16 v[188:189], v250 offset:20480
    ds_read_b64_tr_b16 v[190:191], v250 offset:22528
    v_lshlrev_b32 v216, 16, v200
    s_waitcnt lgkmcnt(4)
    v_mfma_f32_16x16x32_bf16 v[232:235], v[172:175], v[100:103], v[232:235]
    v_xor_b32 v250, 32, v250
    ds_read_b64_tr_b16 v[168:169], v250
    ds_read_b64_tr_b16 v[170:171], v250 offset:2048
    v_and_b32 v217, 0xffff0000, v200
    v_mfma_f32_16x16x32_bf16 v[232:235], v[176:179], v[104:107], v[232:235]
    ds_read_b64_tr_b16 v[172:173], v250 offset:4096
    ds_read_b64_tr_b16 v[174:175], v250 offset:6144
    v_lshlrev_b32 v218, 16, v201
    v_mfma_f32_16x16x32_bf16 v[232:235], v[180:183], v[108:111], v[232:235]
    ds_read_b64_tr_b16 v[176:177], v250 offset:8192
    ds_read_b64_tr_b16 v[178:179], v250 offset:10240
    v_and_b32 v219, 0xffff0000, v201
    s_waitcnt lgkmcnt(4)
    v_mfma_f32_16x16x32_bf16 v[232:235], v[184:187], v[112:115], v[232:235]
    ds_read_b64_tr_b16 v[180:181], v250 offset:12288
    ds_read_b64_tr_b16 v[182:183], v250 offset:14336
    v_cvt_pk_bf16_f32 v194, v220, v221
    v_mfma_f32_16x16x32_bf16 v[232:235], v[188:191], v[116:119], v[232:235]
    ds_read_b64_tr_b16 v[184:185], v250 offset:16384
    ds_read_b64_tr_b16 v[186:187], v250 offset:18432
    v_cvt_pk_bf16_f32 v195, v222, v223
    v_mfma_f32_16x16x32_bf16 v[236:239], v[168:171], v[96:99], v[236:239]
    ds_read_b64_tr_b16 v[188:189], v250 offset:20480
    ds_read_b64_tr_b16 v[190:191], v250 offset:22528
    v_lshlrev_b32 v220, 16, v202
    s_waitcnt lgkmcnt(4)
    v_mfma_f32_16x16x32_bf16 v[236:239], v[172:175], v[100:103], v[236:239]
    v_add_u32 v250, 86016, v249
    ds_read_b64_tr_b16 v[168:169], v250
    ds_read_b64_tr_b16 v[170:171], v250 offset:2048
    v_and_b32 v221, 0xffff0000, v202
    s_add_u32 s66, s61, 131072
    buffer_store_dwordx4 v[192:195], v251, s[36:39], s66 offen sc1
    v_mfma_f32_16x16x32_bf16 v[236:239], v[176:179], v[104:107], v[236:239]
    ds_read_b64_tr_b16 v[172:173], v250 offset:4096
    ds_read_b64_tr_b16 v[174:175], v250 offset:6144
    v_lshlrev_b32 v222, 16, v203
    v_mfma_f32_16x16x32_bf16 v[236:239], v[180:183], v[108:111], v[236:239]
    ds_read_b64_tr_b16 v[176:177], v250 offset:8192
    ds_read_b64_tr_b16 v[178:179], v250 offset:10240
    v_and_b32 v223, 0xffff0000, v203
    s_waitcnt lgkmcnt(4)
    v_mfma_f32_16x16x32_bf16 v[236:239], v[184:187], v[112:115], v[236:239]
    ds_read_b64_tr_b16 v[180:181], v250 offset:12288
    ds_read_b64_tr_b16 v[182:183], v250 offset:14336
    v_cvt_pk_bf16_f32 v200, v232, v233
    v_mfma_f32_16x16x32_bf16 v[236:239], v[188:191], v[116:119], v[236:239]
    ds_read_b64_tr_b16 v[184:185], v250 offset:16384
    ds_read_b64_tr_b16 v[186:187], v250 offset:18432
    v_cvt_pk_bf16_f32 v201, v234, v235
    v_mfma_f32_16x16x32_bf16 v[216:219], v[168:171], v[96:99], v[216:219]
    ds_read_b64_tr_b16 v[188:189], v250 offset:20480
    ds_read_b64_tr_b16 v[190:191], v250 offset:22528
    v_lshlrev_b32 v232, 16, v208
    s_waitcnt lgkmcnt(4)
    v_mfma_f32_16x16x32_bf16 v[216:219], v[172:175], v[100:103], v[216:219]
    v_xor_b32 v250, 32, v250
    ds_read_b64_tr_b16 v[168:169], v250
    ds_read_b64_tr_b16 v[170:171], v250 offset:2048
    v_and_b32 v233, 0xffff0000, v208
    v_mfma_f32_16x16x32_bf16 v[216:219], v[176:179], v[104:107], v[216:219]
    ds_read_b64_tr_b16 v[172:173], v250 offset:4096
    ds_read_b64_tr_b16 v[174:175], v250 offset:6144
    v_lshlrev_b32 v234, 16, v209
    v_mfma_f32_16x16x32_bf16 v[216:219], v[180:183], v[108:111], v[216:219]
    ds_read_b64_tr_b16 v[176:177], v250 offset:8192
    ds_read_b64_tr_b16 v[178:179], v250 offset:10240
    v_and_b32 v235, 0xffff0000, v209
    s_waitcnt lgkmcnt(4)
    v_mfma_f32_16x16x32_bf16 v[216:219], v[184:187], v[112:115], v[216:219]
    ds_read_b64_tr_b16 v[180:181], v250 offset:12288
    ds_read_b64_tr_b16 v[182:183], v250 offset:14336
    v_cvt_pk_bf16_f32 v202, v236, v237
    v_mfma_f32_16x16x32_bf16 v[216:219], v[188:191], v[116:119], v[216:219]
    ds_read_b64_tr_b16 v[184:185], v250 offset:16384
    ds_read_b64_tr_b16 v[186:187], v250 offset:18432
    v_cvt_pk_bf16_f32 v203, v238, v239
    v_mfma_f32_16x16x32_bf16 v[220:223], v[168:171], v[96:99], v[220:223]
    ds_read_b64_tr_b16 v[188:189], v250 offset:20480
    ds_read_b64_tr_b16 v[190:191], v250 offset:22528
    v_lshlrev_b32 v236, 16, v210
    s_waitcnt lgkmcnt(4)
    v_mfma_f32_16x16x32_bf16 v[220:223], v[172:175], v[100:103], v[220:223]
    v_xor_b32 v250, 96, v250
    ds_read_b64_tr_b16 v[168:169], v250
    ds_read_b64_tr_b16 v[170:171], v250 offset:2048
    v_and_b32 v237, 0xffff0000, v210
    s_add_u32 s66, s61, 139264
    buffer_store_dwordx4 v[200:203], v251, s[36:39], s66 offen sc1
    v_mfma_f32_16x16x32_bf16 v[220:223], v[176:179], v[104:107], v[220:223]
    ds_read_b64_tr_b16 v[172:173], v250 offset:4096
    ds_read_b64_tr_b16 v[174:175], v250 offset:6144
    v_lshlrev_b32 v238, 16, v211
    v_mfma_f32_16x16x32_bf16 v[220:223], v[180:183], v[108:111], v[220:223]
    ds_read_b64_tr_b16 v[176:177], v250 offset:8192
    ds_read_b64_tr_b16 v[178:179], v250 offset:10240
    v_and_b32 v239, 0xffff0000, v211
    s_waitcnt lgkmcnt(4)
    v_mfma_f32_16x16x32_bf16 v[220:223], v[184:187], v[112:115], v[220:223]
    ds_read_b64_tr_b16 v[180:181], v250 offset:12288
    ds_read_b64_tr_b16 v[182:183], v250 offset:14336
    v_cvt_pk_bf16_f32 v208, v216, v217
    v_mfma_f32_16x16x32_bf16 v[220:223], v[188:191], v[116:119], v[220:223]
    ds_read_b64_tr_b16 v[184:185], v250 offset:16384
    ds_read_b64_tr_b16 v[186:187], v250 offset:18432
    v_cvt_pk_bf16_f32 v209, v218, v219
    v_mfma_f32_16x16x32_bf16 v[232:235], v[168:171], v[96:99], v[232:235]
    ds_read_b64_tr_b16 v[188:189], v250 offset:20480
    ds_read_b64_tr_b16 v[190:191], v250 offset:22528
    s_waitcnt lgkmcnt(4)
    v_mfma_f32_16x16x32_bf16 v[232:235], v[172:175], v[100:103], v[232:235]
    v_xor_b32 v250, 32, v250
    ds_read_b64_tr_b16 v[168:169], v250
    ds_read_b64_tr_b16 v[170:171], v250 offset:2048
    v_mfma_f32_16x16x32_bf16 v[232:235], v[176:179], v[104:107], v[232:235]
    ds_read_b64_tr_b16 v[172:173], v250 offset:4096
    ds_read_b64_tr_b16 v[174:175], v250 offset:6144
    v_mfma_f32_16x16x32_bf16 v[232:235], v[180:183], v[108:111], v[232:235]
    ds_read_b64_tr_b16 v[176:177], v250 offset:8192
    ds_read_b64_tr_b16 v[178:179], v250 offset:10240
    s_waitcnt lgkmcnt(4)
    v_mfma_f32_16x16x32_bf16 v[232:235], v[184:187], v[112:115], v[232:235]
    ds_read_b64_tr_b16 v[180:181], v250 offset:12288
    ds_read_b64_tr_b16 v[182:183], v250 offset:14336
    v_cvt_pk_bf16_f32 v210, v220, v221
    v_mfma_f32_16x16x32_bf16 v[232:235], v[188:191], v[116:119], v[232:235]
    ds_read_b64_tr_b16 v[184:185], v250 offset:16384
    ds_read_b64_tr_b16 v[186:187], v250 offset:18432
    v_cvt_pk_bf16_f32 v211, v222, v223
    v_mfma_f32_16x16x32_bf16 v[236:239], v[168:171], v[96:99], v[236:239]
    ds_read_b64_tr_b16 v[188:189], v250 offset:20480
    ds_read_b64_tr_b16 v[190:191], v250 offset:22528
    s_waitcnt lgkmcnt(4)
    v_mfma_f32_16x16x32_bf16 v[236:239], v[172:175], v[100:103], v[236:239]
    s_add_u32 s66, s61, 147456
    buffer_store_dwordx4 v[208:211], v251, s[36:39], s66 offen sc1
    v_mfma_f32_16x16x32_bf16 v[236:239], v[176:179], v[104:107], v[236:239]
    v_mfma_f32_16x16x32_bf16 v[236:239], v[180:183], v[108:111], v[236:239]
    s_waitcnt lgkmcnt(0)
    v_mfma_f32_16x16x32_bf16 v[236:239], v[184:187], v[112:115], v[236:239]
    v_cvt_pk_bf16_f32 v232, v232, v233
    v_mfma_f32_16x16x32_bf16 v[236:239], v[188:191], v[116:119], v[236:239]
    v_cvt_pk_bf16_f32 v233, v234, v235
    s_nop 7
    v_cvt_pk_bf16_f32 v234, v236, v237
    v_cvt_pk_bf16_f32 v235, v238, v239
    s_add_u32 s66, s61, 155648
    buffer_store_dwordx4 v[232:235], v251, s[36:39], s66 offen sc1
    s_branch L_fin
L_g2tail_L:
    v_add_u32 v225, s52, v224
    v_xor_b32 v226, 32, v225
    v_xor_b32 v227, 64, v225
    v_xor_b32 v228, 96, v225
    v_add_u32 v250, s62, v251
    s_waitcnt lgkmcnt(0)
    s_barrier
    ds_read_b64_tr_b16 v[168:169], v225
    ds_read_b64_tr_b16 v[170:171], v225 offset:1536
    ds_read_b64_tr_b16 v[172:173], v226
    ds_read_b64_tr_b16 v[174:175], v226 offset:1536
    v_mfma_f32_16x16x32_bf16 v[36:39], v[180:183], v[160:163], v[36:39]
    ds_read_b64_tr_b16 v[176:177], v227
    ds_read_b64_tr_b16 v[178:179], v227 offset:1536
    v_exp_f32 v235, v235
    v_exp_f32 v236, v236
    v_mfma_f32_16x16x32_bf16 v[40:43], v[184:187], v[160:163], v[40:43]
    ds_read_b64_tr_b16 v[180:181], v228
    ds_read_b64_tr_b16 v[182:183], v228 offset:1536
    v_exp_f32 v237, v237
    v_exp_f32 v238, v238
    v_mfma_f32_16x16x32_bf16 v[44:47], v[188:191], v[160:163], v[44:47]
    ds_read_b64_tr_b16 v[184:185], v225 offset:128
    ds_read_b64_tr_b16 v[186:187], v225 offset:1664
    v_exp_f32 v239, v239
    v_cvt_pk_bf16_f32 v160, v232, v233
    v_cvt_pk_bf16_f32 v161, v234, v235
    v_cvt_pk_bf16_f32 v162, v236, v237
    v_cvt_pk_bf16_f32 v163, v238, v239
    s_cmp_lg_u32 s58, 0
    s_cbranch_scc1 L_resc_e1_L
L_rret_e1_L:
    s_nop 0
    v_mfma_f32_16x16x32_bf16 v[216:219], v[200:203], v[160:163], v[216:219]
    s_waitcnt lgkmcnt(6)
    v_mfma_f32_16x16x32_bf16 v[0:3], v[168:171], v[160:163], v[0:3]
    ds_read_b64_tr_b16 v[188:189], v226 offset:128
    ds_read_b64_tr_b16 v[190:191], v226 offset:1664
    v_mfma_f32_16x16x32_bf16 v[4:7], v[172:175], v[160:163], v[4:7]
    ds_read_b64_tr_b16 v[168:169], v227 offset:128
    ds_read_b64_tr_b16 v[170:171], v227 offset:1664
    s_waitcnt lgkmcnt(6)
    v_mfma_f32_16x16x32_bf16 v[8:11], v[176:179], v[160:163], v[8:11]
    ds_read_b64_tr_b16 v[172:173], v228 offset:128
    ds_read_b64_tr_b16 v[174:175], v228 offset:1664
    v_mfma_f32_16x16x32_bf16 v[12:15], v[180:183], v[160:163], v[12:15]
    ds_read_b64_tr_b16 v[176:177], v225 offset:256
    ds_read_b64_tr_b16 v[178:179], v225 offset:1792
    v_rcp_f32 v230, v216
    s_waitcnt lgkmcnt(6)
    v_mfma_f32_16x16x32_bf16 v[16:19], v[184:187], v[160:163], v[16:19]
    ds_read_b64_tr_b16 v[180:181], v226 offset:256
    ds_read_b64_tr_b16 v[182:183], v226 offset:1792
    v_mul_f32 v0, v0, v230
    v_mul_f32 v1, v1, v230
    v_mul_f32 v2, v2, v230
    v_mul_f32 v3, v3, v230
    v_mul_f32 v4, v4, v230
    v_mul_f32 v5, v5, v230
    v_mul_f32 v6, v6, v230
    v_mul_f32 v7, v7, v230
    v_mfma_f32_16x16x32_bf16 v[20:23], v[188:191], v[160:163], v[20:23]
    ds_read_b64_tr_b16 v[184:185], v227 offset:256
    ds_read_b64_tr_b16 v[186:187], v227 offset:1792
    v_cvt_pk_bf16_f32 v96, v0, v1
    v_cvt_pk_bf16_f32 v97, v2, v3
    v_cvt_pk_bf16_f32 v98, v4, v5
    v_cvt_pk_bf16_f32 v99, v6, v7
    ds_write_b128 v250, v[96:99]
    s_waitcnt lgkmcnt(7)
    v_mfma_f32_16x16x32_bf16 v[24:27], v[168:171], v[160:163], v[24:27]
    ds_read_b64_tr_b16 v[188:189], v228 offset:256
    ds_read_b64_tr_b16 v[190:191], v228 offset:1792
    v_mul_f32 v8, v8, v230
    v_mul_f32 v9, v9, v230
    v_mul_f32 v10, v10, v230
    v_mul_f32 v11, v11, v230
    v_mul_f32 v12, v12, v230
    v_mul_f32 v13, v13, v230
    v_mul_f32 v14, v14, v230
    v_mul_f32 v15, v15, v230
    v_mfma_f32_16x16x32_bf16 v[28:31], v[172:175], v[160:163], v[28:31]
    v_cvt_pk_bf16_f32 v100, v8, v9
    v_cvt_pk_bf16_f32 v101, v10, v11
    v_cvt_pk_bf16_f32 v102, v12, v13
    v_cvt_pk_bf16_f32 v103, v14, v15
    ds_write_b128 v250, v[100:103] offset:1024
    s_waitcnt lgkmcnt(6)
    v_mfma_f32_16x16x32_bf16 v[32:35], v[176:179], v[160:163], v[32:35]
    v_mul_f32 v16, v16, v230
    v_mul_f32 v17, v17, v230
    v_mul_f32 v18, v18, v230
    v_mul_f32 v19, v19, v230
    v_mul_f32 v20, v20, v230
    v_mul_f32 v21, v21, v230
    v_mul_f32 v22, v22, v230
    v_mul_f32 v23, v23, v230
    v_mfma_f32_16x16x32_bf16 v[36:39], v[180:183], v[160:163], v[36:39]
    v_cvt_pk_bf16_f32 v104, v16, v17
    v_cvt_pk_bf16_f32 v105, v18, v19
    v_cvt_pk_bf16_f32 v106, v20, v21
    v_cvt_pk_bf16_f32 v107, v22, v23
    ds_write_b128 v250, v[104:107] offset:2048
    s_waitcnt lgkmcnt(2)
    v_mfma_f32_16x16x32_bf16 v[40:43], v[184:187], v[160:163], v[40:43]
    v_mul_f32 v24, v24, v230
    v_mul_f32 v25, v25, v230
    v_mul_f32 v26, v26, v230
    v_mul_f32 v27, v27, v230
    v_mul_f32 v28, v28, v230
    v_mul_f32 v29, v29, v230
    v_mul_f32 v30, v30, v230
    v_mul_f32 v31, v31, v230
    v_mfma_f32_16x16x32_bf16 v[44:47], v[188:191], v[160:163], v[44:47]
    v_cvt_pk_bf16_f32 v108, v24, v25
    v_cvt_pk_bf16_f32 v109, v26, v27
    v_cvt_pk_bf16_f32 v110, v28, v29
    v_cvt_pk_bf16_f32 v111, v30, v31
    ds_write_b128 v250, v[108:111] offset:3072
    s_nop 3
    v_mul_f32 v32, v32, v230
    v_mul_f32 v33, v33, v230
    v_mul_f32 v34, v34, v230
    v_mul_f32 v35, v35, v230
    v_mul_f32 v36, v36, v230
    v_mul_f32 v37, v37, v230
    v_mul_f32 v38, v38, v230
    v_mul_f32 v39, v39, v230
    v_cvt_pk_bf16_f32 v112, v32, v33
    v_cvt_pk_bf16_f32 v113, v34, v35
    v_cvt_pk_bf16_f32 v114, v36, v37
    v_cvt_pk_bf16_f32 v115, v38, v39
    ds_write_b128 v250, v[112:115] offset:4096
    v_mul_f32 v40, v40, v230
    v_mul_f32 v41, v41, v230
    v_mul_f32 v42, v42, v230
    v_mul_f32 v43, v43, v230
    v_mul_f32 v44, v44, v230
    v_mul_f32 v45, v45, v230
    v_mul_f32 v46, v46, v230
    v_mul_f32 v47, v47, v230
    v_cvt_pk_bf16_f32 v116, v40, v41
    v_cvt_pk_bf16_f32 v117, v42, v43
    v_cvt_pk_bf16_f32 v118, v44, v45
    v_cvt_pk_bf16_f32 v119, v46, v47
    ds_write_b128 v250, v[116:119] offset:5120
    s_setprio 0
    s_waitcnt lgkmcnt(0)
    s_barrier
    s_add_u32 s68, s65, 3
    s_sub_u32 s64, s68, 10
    s_cselect_b32 s68, s68, s64
    s_lshl_b32 s68, s68, 7
    s_add_u32 s68, s68, s70
    s_add_u32 m0, s59, 86016
    s_add_u32 s66, s68, 0
    buffer_load_dwordx4 v248, s[32:35], s66 offen lds
    s_add_u32 s67, s68, 9216
    buffer_load_dwordx4 v248, s[32:35], s67 offen offset:1024 lds
    s_add_u32 s68, s68, 18432
    buffer_load_dwordx4 v248, s[32:35], s68 offen offset:2048 lds
    s_add_u32 s68, s65, 3
    s_sub_u32 s64, s68, 10
    s_cselect_b32 s68, s68, s64
    s_lshl_b32 s68, s68, 7
    s_add_u32 s68, s68, s70
    s_add_u32 m0, s59, 89088
    s_add_u32 s66, s68, 30720
    buffer_load_dwordx4 v248, s[32:35], s66 offen lds
    s_add_u32 s67, s68, 39936
    buffer_load_dwordx4 v248, s[32:35], s67 offen offset:1024 lds
    s_add_u32 s68, s68, 49152
    buffer_load_dwordx4 v248, s[32:35], s68 offen offset:2048 lds
    s_barrier
    s_add_u32 s68, s65, 4
    s_sub_u32 s64, s68, 10
    s_cselect_b32 s68, s68, s64
    s_lshl_b32 s68, s68, 7
    s_add_u32 s68, s68, s70
    s_add_u32 m0, s59, 0
    s_add_u32 s66, s68, 0
    buffer_load_dwordx4 v248, s[32:35], s66 offen lds
    s_add_u32 s67, s68, 9216
    buffer_load_dwordx4 v248, s[32:35], s67 offen offset:1024 lds
    s_add_u32 s68, s68, 18432
    buffer_load_dwordx4 v248, s[32:35], s68 offen offset:2048 lds
    s_add_u32 s68, s65, 4
    s_sub_u32 s64, s68, 10
    s_cselect_b32 s68, s68, s64
    s_lshl_b32 s68, s68, 7
    s_add_u32 s68, s68, s70
    s_add_u32 m0, s59, 3072
    s_add_u32 s66, s68, 30720
    buffer_load_dwordx4 v248, s[32:35], s66 offen lds
    s_add_u32 s67, s68, 39936
    buffer_load_dwordx4 v248, s[32:35], s67 offen offset:1024 lds
    s_add_u32 s68, s68, 49152
    buffer_load_dwordx4 v248, s[32:35], s68 offen offset:2048 lds
    s_barrier
    s_add_u32 s68, s65, 5
    s_sub_u32 s64, s68, 10
    s_cselect_b32 s68, s68, s64
    s_lshl_b32 s68, s68, 7
    s_add_u32 s68, s68, s70
    s_add_u32 m0, s59, 24576
    s_add_u32 s66, s68, 0
    buffer_load_dwordx4 v248, s[32:35], s66 offen lds
    s_add_u32 s67, s68, 9216
    buffer_load_dwordx4 v248, s[32:35], s67 offen offset:1024 lds
    s_add_u32 s68, s68, 18432
    buffer_load_dwordx4 v248, s[32:35], s68 offen offset:2048 lds
    s_add_u32 s68, s65, 5
    s_sub_u32 s64, s68, 10
    s_cselect_b32 s68, s68, s64
    s_lshl_b32 s68, s68, 7
    s_add_u32 s68, s68, s70
    s_add_u32 m0, s59, 27648
    s_add_u32 s66, s68, 30720
    buffer_load_dwordx4 v248, s[32:35], s66 offen lds
    s_add_u32 s67, s68, 39936
    buffer_load_dwordx4 v248, s[32:35], s67 offen offset:1024 lds
    s_add_u32 s68, s68, 49152
    buffer_load_dwordx4 v248, s[32:35], s68 offen offset:2048 lds
    s_waitcnt vmcnt(12)
    s_barrier
    s_add_u32 s68, s65, 6
    s_sub_u32 s64, s68, 10
    s_cselect_b32 s68, s68, s64
    s_lshl_b32 s68, s68, 7
    s_add_u32 s68, s68, s70
    s_add_u32 m0, s59, 110592
    s_add_u32 s66, s68, 0
    buffer_load_dwordx4 v248, s[32:35], s66 offen lds
    s_add_u32 s67, s68, 9216
    buffer_load_dwordx4 v248, s[32:35], s67 offen offset:1024 lds
    s_add_u32 s68, s68, 18432
    buffer_load_dwordx4 v248, s[32:35], s68 offen offset:2048 lds
    s_add_u32 s68, s65, 6
    s_sub_u32 s64, s68, 10
    s_cselect_b32 s68, s68, s64
    s_lshl_b32 s68, s68, 7
    s_add_u32 s68, s68, s70
    s_add_u32 m0, s59, 113664
    s_add_u32 s66, s68, 30720
    buffer_load_dwordx4 v248, s[32:35], s66 offen lds
    s_add_u32 s67, s68, 39936
    buffer_load_dwordx4 v248, s[32:35], s67 offen offset:1024 lds
    s_add_u32 s68, s68, 49152
    buffer_load_dwordx4 v248, s[32:35], s68 offen offset:2048 lds
    s_waitcnt vmcnt(12)
    s_barrier
    s_add_u32 s68, s65, 7
    s_sub_u32 s64, s68, 10
    s_cselect_b32 s68, s68, s64
    s_lshl_b32 s68, s68, 7
    s_add_u32 s68, s68, s70
    s_add_u32 m0, s59, 49152
    s_add_u32 s66, s68, 0
    buffer_load_dwordx4 v248, s[32:35], s66 offen lds
    s_add_u32 s67, s68, 9216
    buffer_load_dwordx4 v248, s[32:35], s67 offen offset:1024 lds
    s_add_u32 s68, s68, 18432
    buffer_load_dwordx4 v248, s[32:35], s68 offen offset:2048 lds
    s_add_u32 s68, s65, 7
    s_sub_u32 s64, s68, 10
    s_cselect_b32 s68, s68, s64
    s_lshl_b32 s68, s68, 7
    s_add_u32 s68, s68, s70
    s_add_u32 m0, s59, 52224
    s_add_u32 s66, s68, 30720
    buffer_load_dwordx4 v248, s[32:35], s66 offen lds
    s_add_u32 s67, s68, 39936
    buffer_load_dwordx4 v248, s[32:35], s67 offen offset:1024 lds
    s_add_u32 s68, s68, 49152
    buffer_load_dwordx4 v248, s[32:35], s68 offen offset:2048 lds
    s_waitcnt vmcnt(12)
    s_barrier
    s_add_u32 s68, s65, 8
    s_sub_u32 s64, s68, 10
    s_cselect_b32 s68, s68, s64
    s_lshl_b32 s68, s68, 7
    s_add_u32 s68, s68, s70
    s_add_u32 m0, s59, 135168
    s_add_u32 s66, s68, 0
    buffer_load_dwordx4 v248, s[32:35], s66 offen lds
    s_add_u32 s67, s68, 9216
    buffer_load_dwordx4 v248, s[32:35], s67 offen offset:1024 lds
    s_add_u32 s68, s68, 18432
    buffer_load_dwordx4 v248, s[32:35], s68 offen offset:2048 lds
    s_add_u32 s68, s65, 8
    s_sub_u32 s64, s68, 10
    s_cselect_b32 s68, s68, s64
    s_lshl_b32 s68, s68, 7
    s_add_u32 s68, s68, s70
    s_add_u32 m0, s59, 138240
    s_add_u32 s66, s68, 30720
    buffer_load_dwordx4 v248, s[32:35], s66 offen lds
    s_add_u32 s67, s68, 39936
    buffer_load_dwordx4 v248, s[32:35], s67 offen offset:1024 lds
    s_add_u32 s68, s68, 49152
    buffer_load_dwordx4 v248, s[32:35], s68 offen offset:2048 lds
    s_waitcnt vmcnt(12)
    s_barrier
    s_add_u32 s68, s65, 9
    s_sub_u32 s64, s68, 10
    s_cselect_b32 s68, s68, s64
    s_lshl_b32 s68, s68, 7
    s_add_u32 s68, s68, s70
    s_add_u32 m0, s59, 86016
    s_add_u32 s66, s68, 0
    buffer_load_dwordx4 v248, s[32:35], s66 offen lds
    s_add_u32 s67, s68, 9216
    buffer_load_dwordx4 v248, s[32:35], s67 offen offset:1024 lds
    s_add_u32 s68, s68, 18432
    buffer_load_dwordx4 v248, s[32:35], s68 offen offset:2048 lds
    s_add_u32 s68, s65, 9
    s_sub_u32 s64, s68, 10
    s_cselect_b32 s68, s68, s64
    s_lshl_b32 s68, s68, 7
    s_add_u32 s68, s68, s70
    s_add_u32 m0, s59, 89088
    s_add_u32 s66, s68, 30720
    buffer_load_dwordx4 v248, s[32:35], s66 offen lds
    s_add_u32 s67, s68, 39936
    buffer_load_dwordx4 v248, s[32:35], s67 offen offset:1024 lds
    s_add_u32 s68, s68, 49152
    buffer_load_dwordx4 v248, s[32:35], s68 offen offset:2048 lds
    s_waitcnt vmcnt(12)
    s_barrier
    s_waitcnt vmcnt(0)
    s_barrier
    s_branch L_fin
L_rare_l0_L:
    v_mov_b32 v209, v207
    s_nop 1
    v_permlane32_swap_b32 v207, v209
    v_max_f32 v207, v207, v209
    v_mov_b32 v209, v207
    s_nop 1
    v_permlane16_swap_b32 v207, v209
    v_max_f32 v207, v207, v209
    v_max_f32 v207, 0, v207
    v_exp_f32 v230, -v207
    v_sub_f32 v192, v192, v207
    v_sub_f32 v193, v193, v207
    v_sub_f32 v194, v194, v207
    v_sub_f32 v195, v195, v207
    v_sub_f32 v232, v232, v207
    v_sub_f32 v233, v233, v207
    v_sub_f32 v234, v234, v207
    v_sub_f32 v235, v235, v207
    v_sub_f32 v236, v236, v207
    v_sub_f32 v237, v237, v207
    v_sub_f32 v238, v238, v207
    v_sub_f32 v239, v239, v207
    s_mov_b32 s58, 1
    s_branch L_ret_l0_L
L_rare_l1_L:
    v_mov_b32 v209, v207
    s_nop 1
    v_permlane32_swap_b32 v207, v209
    v_max_f32 v207, v207, v209
    v_mov_b32 v209, v207
    s_nop 1
    v_permlane16_swap_b32 v207, v209
    v_max_f32 v207, v207, v209
    v_max_f32 v207, 0, v207
    v_exp_f32 v230, -v207
    v_sub_f32 v192, v192, v207
    v_sub_f32 v193, v193, v207
    v_sub_f32 v194, v194, v207
    v_sub_f32 v195, v195, v207
    v_sub_f32 v144, v144, v207
    v_sub_f32 v145, v145, v207
    v_sub_f32 v146, v146, v207
    v_sub_f32 v147, v147, v207
    v_sub_f32 v148, v148, v207
    v_sub_f32 v149, v149, v207
    v_sub_f32 v150, v150, v207
    v_sub_f32 v151, v151, v207
    s_mov_b32 s58, 1
    s_branch L_ret_l1_L
L_resc_l0_L:
    s_nop 15
    v_mul_f32 v0, v0, v230
    v_mul_f32 v1, v1, v230
    v_mul_f32 v2, v2, v230
    v_mul_f32 v3, v3, v230
    v_mul_f32 v4, v4, v230
    v_mul_f32 v5, v5, v230
    v_mul_f32 v6, v6, v230
    v_mul_f32 v7, v7, v230
    v_mul_f32 v8, v8, v230
    v_mul_f32 v9, v9, v230
    v_mul_f32 v10, v10, v230
    v_mul_f32 v11, v11, v230
    v_mul_f32 v12, v12, v230
    v_mul_f32 v13, v13, v230
    v_mul_f32 v14, v14, v230
    v_mul_f32 v15, v15, v230
    v_mul_f32 v16, v16, v230
    v_mul_f32 v17, v17, v230
    v_mul_f32 v18, v18, v230
    v_mul_f32 v19, v19, v230
    v_mul_f32 v20, v20, v230
    v_mul_f32 v21, v21, v230
    v_mul_f32 v22, v22, v230
    v_mul_f32 v23, v23, v230
    v_mul_f32 v24, v24, v230
    v_mul_f32 v25, v25, v230
    v_mul_f32 v26, v26, v230
    v_mul_f32 v27, v27, v230
    v_mul_f32 v28, v28, v230
    v_mul_f32 v29, v29, v230
    v_mul_f32 v30, v30, v230
    v_mul_f32 v31, v31, v230
    v_mul_f32 v32, v32, v230
    v_mul_f32 v33, v33, v230
    v_mul_f32 v34, v34, v230
    v_mul_f32 v35, v35, v230
    v_mul_f32 v36, v36, v230
    v_mul_f32 v37, v37, v230
    v_mul_f32 v38, v38, v230
    v_mul_f32 v39, v39, v230
    v_mul_f32 v40, v40, v230
    v_mul_f32 v41, v41, v230
    v_mul_f32 v42, v42, v230
    v_mul_f32 v43, v43, v230
    v_mul_f32 v44, v44, v230
    v_mul_f32 v45, v45, v230
    v_mul_f32 v46, v46, v230
    v_mul_f32 v47, v47, v230
    v_mul_f32 v216, v216, v230
    v_mul_f32 v217, v217, v230
    v_mul_f32 v218, v218, v230
    v_mul_f32 v219, v219, v230
    s_mov_b32 s58, 0
    s_nop 1
    s_branch L_rret_l0_L
L_resc_l1_L:
    s_nop 15
    v_mul_f32 v0, v0, v230
    v_mul_f32 v1, v1, v230
    v_mul_f32 v2, v2, v230
    v_mul_f32 v3, v3, v230
    v_mul_f32 v4, v4, v230
    v_mul_f32 v5, v5, v230
    v_mul_f32 v6, v6, v230
    v_mul_f32 v7, v7, v230
    v_mul_f32 v8, v8, v230
    v_mul_f32 v9, v9, v230
    v_mul_f32 v10, v10, v230
    v_mul_f32 v11, v11, v230
    v_mul_f32 v12, v12, v230
    v_mul_f32 v13, v13, v230
    v_mul_f32 v14, v14, v230
    v_mul_f32 v15, v15, v230
    v_mul_f32 v16, v16, v230
    v_mul_f32 v17, v17, v230
    v_mul_f32 v18, v18, v230
    v_mul_f32 v19, v19, v230
    v_mul_f32 v20, v20, v230
    v_mul_f32 v21, v21, v230
    v_mul_f32 v22, v22, v230
    v_mul_f32 v23, v23, v230
    v_mul_f32 v24, v24, v230
    v_mul_f32 v25, v25, v230
    v_mul_f32 v26, v26, v230
    v_mul_f32 v27, v27, v230
    v_mul_f32 v28, v28, v230
    v_mul_f32 v29, v29, v230
    v_mul_f32 v30, v30, v230
    v_mul_f32 v31, v31, v230
    v_mul_f32 v32, v32, v230
    v_mul_f32 v33, v33, v230
    v_mul_f32 v34, v34, v230
    v_mul_f32 v35, v35, v230
    v_mul_f32 v36, v36, v230
    v_mul_f32 v37, v37, v230
    v_mul_f32 v38, v38, v230
    v_mul_f32 v39, v39, v230
    v_mul_f32 v40, v40, v230
    v_mul_f32 v41, v41, v230
    v_mul_f32 v42, v42, v230
    v_mul_f32 v43, v43, v230
    v_mul_f32 v44, v44, v230
    v_mul_f32 v45, v45, v230
    v_mul_f32 v46, v46, v230
    v_mul_f32 v47, v47, v230
    v_mul_f32 v216, v216, v230
    v_mul_f32 v217, v217, v230
    v_mul_f32 v218, v218, v230
    v_mul_f32 v219, v219, v230
    s_mov_b32 s58, 0
    s_nop 1
    s_branch L_rret_l1_L
L_resc_e0_L:
    s_nop 15
    v_mul_f32 v0, v0, v230
    v_mul_f32 v1, v1, v230
    v_mul_f32 v2, v2, v230
    v_mul_f32 v3, v3, v230
    v_mul_f32 v4, v4, v230
    v_mul_f32 v5, v5, v230
    v_mul_f32 v6, v6, v230
    v_mul_f32 v7, v7, v230
    v_mul_f32 v8, v8, v230
    v_mul_f32 v9, v9, v230
    v_mul_f32 v10, v10, v230
    v_mul_f32 v11, v11, v230
    v_mul_f32 v12, v12, v230
    v_mul_f32 v13, v13, v230
    v_mul_f32 v14, v14, v230
    v_mul_f32 v15, v15, v230
    v_mul_f32 v16, v16, v230
    v_mul_f32 v17, v17, v230
    v_mul_f32 v18, v18, v230
    v_mul_f32 v19, v19, v230
    v_mul_f32 v20, v20, v230
    v_mul_f32 v21, v21, v230
    v_mul_f32 v22, v22, v230
    v_mul_f32 v23, v23, v230
    v_mul_f32 v24, v24, v230
    v_mul_f32 v25, v25, v230
    v_mul_f32 v26, v26, v230
    v_mul_f32 v27, v27, v230
    v_mul_f32 v28, v28, v230
    v_mul_f32 v29, v29, v230
    v_mul_f32 v30, v30, v230
    v_mul_f32 v31, v31, v230
    v_mul_f32 v32, v32, v230
    v_mul_f32 v33, v33, v230
    v_mul_f32 v34, v34, v230
    v_mul_f32 v35, v35, v230
    v_mul_f32 v36, v36, v230
    v_mul_f32 v37, v37, v230
    v_mul_f32 v38, v38, v230
    v_mul_f32 v39, v39, v230
    v_mul_f32 v40, v40, v230
    v_mul_f32 v41, v41, v230
    v_mul_f32 v42, v42, v230
    v_mul_f32 v43, v43, v230
    v_mul_f32 v44, v44, v230
    v_mul_f32 v45, v45, v230
    v_mul_f32 v46, v46, v230
    v_mul_f32 v47, v47, v230
    v_mul_f32 v216, v216, v230
    v_mul_f32 v217, v217, v230
    v_mul_f32 v218, v218, v230
    v_mul_f32 v219, v219, v230
    s_mov_b32 s58, 0
    s_nop 1
    s_branch L_rret_e0_L
L_resc_e1_L:
    s_nop 15
    v_mul_f32 v0, v0, v230
    v_mul_f32 v1, v1, v230
    v_mul_f32 v2, v2, v230
    v_mul_f32 v3, v3, v230
    v_mul_f32 v4, v4, v230
    v_mul_f32 v5, v5, v230
    v_mul_f32 v6, v6, v230
    v_mul_f32 v7, v7, v230
    v_mul_f32 v8, v8, v230
    v_mul_f32 v9, v9, v230
    v_mul_f32 v10, v10, v230
    v_mul_f32 v11, v11, v230
    v_mul_f32 v12, v12, v230
    v_mul_f32 v13, v13, v230
    v_mul_f32 v14, v14, v230
    v_mul_f32 v15, v15, v230
    v_mul_f32 v16, v16, v230
    v_mul_f32 v17, v17, v230
    v_mul_f32 v18, v18, v230
    v_mul_f32 v19, v19, v230
    v_mul_f32 v20, v20, v230
    v_mul_f32 v21, v21, v230
    v_mul_f32 v22, v22, v230
    v_mul_f32 v23, v23, v230
    v_mul_f32 v24, v24, v230
    v_mul_f32 v25, v25, v230
    v_mul_f32 v26, v26, v230
    v_mul_f32 v27, v27, v230
    v_mul_f32 v28, v28, v230
    v_mul_f32 v29, v29, v230
    v_mul_f32 v30, v30, v230
    v_mul_f32 v31, v31, v230
    v_mul_f32 v32, v32, v230
    v_mul_f32 v33, v33, v230
    v_mul_f32 v34, v34, v230
    v_mul_f32 v35, v35, v230
    v_mul_f32 v36, v36, v230
    v_mul_f32 v37, v37, v230
    v_mul_f32 v38, v38, v230
    v_mul_f32 v39, v39, v230
    v_mul_f32 v40, v40, v230
    v_mul_f32 v41, v41, v230
    v_mul_f32 v42, v42, v230
    v_mul_f32 v43, v43, v230
    v_mul_f32 v44, v44, v230
    v_mul_f32 v45, v45, v230
    v_mul_f32 v46, v46, v230
    v_mul_f32 v47, v47, v230
    v_mul_f32 v216, v216, v230
    v_mul_f32 v217, v217, v230
    v_mul_f32 v218, v218, v230
    v_mul_f32 v219, v219, v230
    s_mov_b32 s58, 0
    s_nop 1
    s_branch L_rret_e1_L
L_fin:
    s_mov_b32 s16, s6
    s_mov_b32 s17, s7
    s_mov_b32 s18, 256
    s_mov_b32 s20, s4
    s_mov_b32 s21, s5
    s_mov_b32 s22, 2293760
    s_mul_i32 s66, s43, 2691072
    s_add_u32 s24, s14, s66
    s_addc_u32 s25, s15, 0
    s_mov_b32 s26, 2691072
    v_lshrrev_b32 v248, 4, v251
    v_and_b32 v249, 15, v248
    v_mul_u32_u24 v249, 1280, v249
    v_and_b32 v248, 48, v248
    v_add_u32 v249, v249, v248
    v_mov_b32 v250, 0
    v_mov_b32 v247, 159744
    s_mov_b32 s68, 10512
    v_mul_lo_u32 v246, v251, s68
    v_mov_b32 v245, 1
    s_lshl_b32 s62, s43, 4
    s_lshl_b32 s69, s41, 7
    s_add_u32 s69, s69, 163840
    s_mov_b32 s61, 0
    s_cmp_eq_u32 s40, 4
    s_cbranch_scc1 L_sig
    s_cmp_lg_u32 s41, 0
    s_cbranch_scc1 L_wait
    s_waitcnt vmcnt(0)
    s_mov_b64 exec, 1
    ds_add_rtn_u32 v0, v247, v245
    s_mov_b64 exec, -1
    s_waitcnt lgkmcnt(0)
    v_readfirstlane_b32 s68, v0
    s_cmp_lg_u32 s68, 3
    s_cbranch_scc1 L_wait
    s_mov_b32 s61, 1
L_sig:
    s_mov_b64 exec, 0xffff
    buffer_atomic_add v245, v246, s[24:27], s69 offen
L_wait:
    s_mov_b64 exec, 1
    s_add_u32 s71, s71, 16
    s_mov_b32 s49, 0
    s_lshl_b32 s58, 1, s44
L_poll:
    buffer_load_dword v0, v250, s[36:39], s69 offen sc1
    s_add_u32 s49, s49, 1
    s_waitcnt vmcnt(0)
    v_readfirstlane_b32 s68, v0
    s_cmp_eq_u32 s68, s71
    s_cbranch_scc1 L_go
    s_cmp_lt_u32 s49, 4000
    s_cbranch_scc1 L_poll
    ds_write_b32 v247, v245 offset:8
    s_mov_b32 s58, 0
L_go:
    s_mov_b64 exec, -1
    s_mov_b32 s53, 0
    s_cmp_eq_u32 s41, 0
    s_cselect_b32 s45, 84, 0
    s_cselect_b32 s59, 56, 0
    s_add_u32 s59, s59, 84
L_next:
    s_cmp_eq_u32 s58, 0
    s_cbranch_scc1 L_done
    s_ff1_i32_b32 s52, s58
    s_bitset0_b32 s58, s52
    s_mul_i32 s66, s41, 15
    s_xor_b32 s52, s52, s66
    s_lshl_b32 s69, s42, 4
    s_add_u32 s69, s69, s52
    s_add_u32 s69, s69, s45
    s_cmp_ge_u32 s69, s59
    s_cbranch_scc1 L_next
    s_mul_i32 s66, s69, 9363
    s_lshr_b32 s66, s66, 16
    s_add_u32 s54, s69, s66
    s_lshl_b32 s54, s54, 10
    s_mul_i32 s67, s66, 7
    s_sub_u32 s67, s69, s67
    s_lshl_b32 s68, s65, 1
    s_add_u32 s66, s66, s68
    s_sub_u32 s68, s66, 20
    s_cselect_b32 s66, s66, s68
    s_mul_i32 s67, s67, 20480
    s_lshl_b32 s66, s66, 6
    s_add_u32 s55, s66, s67
    s_mul_i32 s66, s43, 143360
    s_add_u32 s55, s55, s66
    buffer_load_dwordx4 v[16:19], v251, s[24:27], s54 offen sc1
    s_add_u32 s54, s54, 168192
    buffer_load_dwordx4 v[20:23], v251, s[24:27], s54 offen sc1
    s_add_u32 s54, s54, 168192
    buffer_load_dwordx4 v[24:27], v251, s[24:27], s54 offen sc1
    s_add_u32 s54, s54, 168192
    buffer_load_dwordx4 v[28:31], v251, s[24:27], s54 offen sc1
    s_add_u32 s54, s54, 168192
    buffer_load_dwordx4 v[32:35], v251, s[24:27], s54 offen sc1
    s_add_u32 s54, s54, 168192
    buffer_load_dwordx4 v[36:39], v251, s[24:27], s54 offen sc1
    s_add_u32 s54, s54, 168192
    buffer_load_dwordx4 v[40:43], v251, s[24:27], s54 offen sc1
    s_add_u32 s54, s54, 168192
    buffer_load_dwordx4 v[44:47], v251, s[24:27], s54 offen sc1
    s_add_u32 s54, s54, 168192
    buffer_load_dwordx4 v[48:51], v251, s[24:27], s54 offen sc1
    s_add_u32 s54, s54, 168192
    buffer_load_dwordx4 v[52:55], v251, s[24:27], s54 offen sc1
    s_add_u32 s54, s54, 168192
    buffer_load_dwordx4 v[56:59], v251, s[24:27], s54 offen sc1
    s_add_u32 s54, s54, 168192
    buffer_load_dwordx4 v[60:63], v251, s[24:27], s54 offen sc1
    s_add_u32 s54, s54, 168192
    buffer_load_dwordx4 v[64:67], v251, s[24:27], s54 offen sc1
    s_add_u32 s54, s54, 168192
    buffer_load_dwordx4 v[68:71], v251, s[24:27], s54 offen sc1
    s_add_u32 s54, s54, 168192
    buffer_load_dwordx4 v[72:75], v251, s[24:27], s54 offen sc1
    s_add_u32 s54, s54, 168192
    buffer_load_dwordx4 v[76:79], v251, s[24:27], s54 offen sc1
    s_add_u32 s69, s69, 64
    s_cmp_ge_u32 s69, s59
    s_cbranch_scc1 L_one
    s_mul_i32 s66, s69, 9363
    s_lshr_b32 s66, s66, 16
    s_add_u32 s50, s69, s66
    s_lshl_b32 s50, s50, 10
    s_mul_i32 s67, s66, 7
    s_sub_u32 s67, s69, s67
    s_lshl_b32 s68, s65, 1
    s_add_u32 s66, s66, s68
    s_sub_u32 s68, s66, 20
    s_cselect_b32 s66, s66, s68
    s_mul_i32 s67, s67, 20480
    s_lshl_b32 s66, s66, 6
    s_add_u32 s51, s66, s67
    s_mul_i32 s66, s43, 143360
    s_add_u32 s51, s51, s66
    buffer_load_dwordx4 v[80:83], v251, s[24:27], s50 offen sc1
    s_add_u32 s50, s50, 168192
    buffer_load_dwordx4 v[84:87], v251, s[24:27], s50 offen sc1
    s_add_u32 s50, s50, 168192
    buffer_load_dwordx4 v[88:91], v251, s[24:27], s50 offen sc1
    s_add_u32 s50, s50, 168192
    buffer_load_dwordx4 v[92:95], v251, s[24:27], s50 offen sc1
    s_add_u32 s50, s50, 168192
    buffer_load_dwordx4 v[96:99], v251, s[24:27], s50 offen sc1
    s_add_u32 s50, s50, 168192
    buffer_load_dwordx4 v[100:103], v251, s[24:27], s50 offen sc1
    s_add_u32 s50, s50, 168192
    buffer_load_dwordx4 v[104:107], v251, s[24:27], s50 offen sc1
    s_add_u32 s50, s50, 168192
    buffer_load_dwordx4 v[108:111], v251, s[24:27], s50 offen sc1
    s_add_u32 s50, s50, 168192
    buffer_load_dwordx4 v[112:115], v251, s[24:27], s50 offen sc1
    s_add_u32 s50, s50, 168192
    buffer_load_dwordx4 v[116:119], v251, s[24:27], s50 offen sc1
    s_add_u32 s50, s50, 168192
    buffer_load_dwordx4 v[120:123], v251, s[24:27], s50 offen sc1
    s_add_u32 s50, s50, 168192
    buffer_load_dwordx4 v[124:127], v251, s[24:27], s50 offen sc1
    s_add_u32 s50, s50, 168192
    buffer_load_dwordx4 v[128:131], v251, s[24:27], s50 offen sc1
    s_add_u32 s50, s50, 168192
    buffer_load_dwordx4 v[132:135], v251, s[24:27], s50 offen sc1
    s_add_u32 s50, s50, 168192
    buffer_load_dwordx4 v[136:139], v251, s[24:27], s50 offen sc1
    s_add_u32 s50, s50, 168192
    buffer_load_dwordx4 v[140:143], v251, s[24:27], s50 offen sc1
    s_waitcnt vmcnt(31)
    v_lshlrev_b32 v0, 16, v16
    v_and_b32 v1, 0xffff0000, v16
    v_lshlrev_b32 v2, 16, v17
    v_and_b32 v3, 0xffff0000, v17
    v_lshlrev_b32 v4, 16, v18
    v_and_b32 v5, 0xffff0000, v18
    v_lshlrev_b32 v6, 16, v19
    v_and_b32 v7, 0xffff0000, v19
    s_waitcnt vmcnt(30)
    v_lshlrev_b32 v8, 16, v20
    v_and_b32 v9, 0xffff0000, v20
    v_add_f32 v0, v0, v8
    v_add_f32 v1, v1, v9
    v_lshlrev_b32 v8, 16, v21
    v_and_b32 v9, 0xffff0000, v21
    v_add_f32 v2, v2, v8
    v_add_f32 v3, v3, v9
    v_lshlrev_b32 v8, 16, v22
    v_and_b32 v9, 0xffff0000, v22
    v_add_f32 v4, v4, v8
    v_add_f32 v5, v5, v9
    v_lshlrev_b32 v8, 16, v23
    v_and_b32 v9, 0xffff0000, v23
    v_add_f32 v6, v6, v8
    v_add_f32 v7, v7, v9
    s_waitcnt vmcnt(29)
    v_lshlrev_b32 v8, 16, v24
    v_and_b32 v9, 0xffff0000, v24
    v_add_f32 v0, v0, v8
    v_add_f32 v1, v1, v9
    v_lshlrev_b32 v8, 16, v25
    v_and_b32 v9, 0xffff0000, v25
    v_add_f32 v2, v2, v8
    v_add_f32 v3, v3, v9
    v_lshlrev_b32 v8, 16, v26
    v_and_b32 v9, 0xffff0000, v26
    v_add_f32 v4, v4, v8
    v_add_f32 v5, v5, v9
    v_lshlrev_b32 v8, 16, v27
    v_and_b32 v9, 0xffff0000, v27
    v_add_f32 v6, v6, v8
    v_add_f32 v7, v7, v9
    s_waitcnt vmcnt(28)
    v_lshlrev_b32 v8, 16, v28
    v_and_b32 v9, 0xffff0000, v28
    v_add_f32 v0, v0, v8
    v_add_f32 v1, v1, v9
    v_lshlrev_b32 v8, 16, v29
    v_and_b32 v9, 0xffff0000, v29
    v_add_f32 v2, v2, v8
    v_add_f32 v3, v3, v9
    v_lshlrev_b32 v8, 16, v30
    v_and_b32 v9, 0xffff0000, v30
    v_add_f32 v4, v4, v8
    v_add_f32 v5, v5, v9
    v_lshlrev_b32 v8, 16, v31
    v_and_b32 v9, 0xffff0000, v31
    v_add_f32 v6, v6, v8
    v_add_f32 v7, v7, v9
    s_waitcnt vmcnt(27)
    v_lshlrev_b32 v8, 16, v32
    v_and_b32 v9, 0xffff0000, v32
    v_add_f32 v0, v0, v8
    v_add_f32 v1, v1, v9
    v_lshlrev_b32 v8, 16, v33
    v_and_b32 v9, 0xffff0000, v33
    v_add_f32 v2, v2, v8
    v_add_f32 v3, v3, v9
    v_lshlrev_b32 v8, 16, v34
    v_and_b32 v9, 0xffff0000, v34
    v_add_f32 v4, v4, v8
    v_add_f32 v5, v5, v9
    v_lshlrev_b32 v8, 16, v35
    v_and_b32 v9, 0xffff0000, v35
    v_add_f32 v6, v6, v8
    v_add_f32 v7, v7, v9
    s_waitcnt vmcnt(26)
    v_lshlrev_b32 v8, 16, v36
    v_and_b32 v9, 0xffff0000, v36
    v_add_f32 v0, v0, v8
    v_add_f32 v1, v1, v9
    v_lshlrev_b32 v8, 16, v37
    v_and_b32 v9, 0xffff0000, v37
    v_add_f32 v2, v2, v8
    v_add_f32 v3, v3, v9
    v_lshlrev_b32 v8, 16, v38
    v_and_b32 v9, 0xffff0000, v38
    v_add_f32 v4, v4, v8
    v_add_f32 v5, v5, v9
    v_lshlrev_b32 v8, 16, v39
    v_and_b32 v9, 0xffff0000, v39
    v_add_f32 v6, v6, v8
    v_add_f32 v7, v7, v9
    s_waitcnt vmcnt(25)
    v_lshlrev_b32 v8, 16, v40
    v_and_b32 v9, 0xffff0000, v40
    v_add_f32 v0, v0, v8
    v_add_f32 v1, v1, v9
    v_lshlrev_b32 v8, 16, v41
    v_and_b32 v9, 0xffff0000, v41
    v_add_f32 v2, v2, v8
    v_add_f32 v3, v3, v9
    v_lshlrev_b32 v8, 16, v42
    v_and_b32 v9, 0xffff0000, v42
    v_add_f32 v4, v4, v8
    v_add_f32 v5, v5, v9
    v_lshlrev_b32 v8, 16, v43
    v_and_b32 v9, 0xffff0000, v43
    v_add_f32 v6, v6, v8
    v_add_f32 v7, v7, v9
    s_waitcnt vmcnt(24)
    v_lshlrev_b32 v8, 16, v44
    v_and_b32 v9, 0xffff0000, v44
    v_add_f32 v0, v0, v8
    v_add_f32 v1, v1, v9
    v_lshlrev_b32 v8, 16, v45
    v_and_b32 v9, 0xffff0000, v45
    v_add_f32 v2, v2, v8
    v_add_f32 v3, v3, v9
    v_lshlrev_b32 v8, 16, v46
    v_and_b32 v9, 0xffff0000, v46
    v_add_f32 v4, v4, v8
    v_add_f32 v5, v5, v9
    v_lshlrev_b32 v8, 16, v47
    v_and_b32 v9, 0xffff0000, v47
    v_add_f32 v6, v6, v8
    v_add_f32 v7, v7, v9
    s_waitcnt vmcnt(23)
    v_lshlrev_b32 v8, 16, v48
    v_and_b32 v9, 0xffff0000, v48
    v_add_f32 v0, v0, v8
    v_add_f32 v1, v1, v9
    v_lshlrev_b32 v8, 16, v49
    v_and_b32 v9, 0xffff0000, v49
    v_add_f32 v2, v2, v8
    v_add_f32 v3, v3, v9
    v_lshlrev_b32 v8, 16, v50
    v_and_b32 v9, 0xffff0000, v50
    v_add_f32 v4, v4, v8
    v_add_f32 v5, v5, v9
    v_lshlrev_b32 v8, 16, v51
    v_and_b32 v9, 0xffff0000, v51
    v_add_f32 v6, v6, v8
    v_add_f32 v7, v7, v9
    s_waitcnt vmcnt(22)
    v_lshlrev_b32 v8, 16, v52
    v_and_b32 v9, 0xffff0000, v52
    v_add_f32 v0, v0, v8
    v_add_f32 v1, v1, v9
    v_lshlrev_b32 v8, 16, v53
    v_and_b32 v9, 0xffff0000, v53
    v_add_f32 v2, v2, v8
    v_add_f32 v3, v3, v9
    v_lshlrev_b32 v8, 16, v54
    v_and_b32 v9, 0xffff0000, v54
    v_add_f32 v4, v4, v8
    v_add_f32 v5, v5, v9
    v_lshlrev_b32 v8, 16, v55
    v_and_b32 v9, 0xffff0000, v55
    v_add_f32 v6, v6, v8
    v_add_f32 v7, v7, v9
    s_waitcnt vmcnt(21)
    v_lshlrev_b32 v8, 16, v56
    v_and_b32 v9, 0xffff0000, v56
    v_add_f32 v0, v0, v8
    v_add_f32 v1, v1, v9
    v_lshlrev_b32 v8, 16, v57
    v_and_b32 v9, 0xffff0000, v57
    v_add_f32 v2, v2, v8
    v_add_f32 v3, v3, v9
    v_lshlrev_b32 v8, 16, v58
    v_and_b32 v9, 0xffff0000, v58
    v_add_f32 v4, v4, v8
    v_add_f32 v5, v5, v9
    v_lshlrev_b32 v8, 16, v59
    v_and_b32 v9, 0xffff0000, v59
    v_add_f32 v6, v6, v8
    v_add_f32 v7, v7, v9
    s_waitcnt vmcnt(20)
    v_lshlrev_b32 v8, 16, v60
    v_and_b32 v9, 0xffff0000, v60
    v_add_f32 v0, v0, v8
    v_add_f32 v1, v1, v9
    v_lshlrev_b32 v8, 16, v61
    v_and_b32 v9, 0xffff0000, v61
    v_add_f32 v2, v2, v8
    v_add_f32 v3, v3, v9
    v_lshlrev_b32 v8, 16, v62
    v_and_b32 v9, 0xffff0000, v62
    v_add_f32 v4, v4, v8
    v_add_f32 v5, v5, v9
    v_lshlrev_b32 v8, 16, v63
    v_and_b32 v9, 0xffff0000, v63
    v_add_f32 v6, v6, v8
    v_add_f32 v7, v7, v9
    s_waitcnt vmcnt(19)
    v_lshlrev_b32 v8, 16, v64
    v_and_b32 v9, 0xffff0000, v64
    v_add_f32 v0, v0, v8
    v_add_f32 v1, v1, v9
    v_lshlrev_b32 v8, 16, v65
    v_and_b32 v9, 0xffff0000, v65
    v_add_f32 v2, v2, v8
    v_add_f32 v3, v3, v9
    v_lshlrev_b32 v8, 16, v66
    v_and_b32 v9, 0xffff0000, v66
    v_add_f32 v4, v4, v8
    v_add_f32 v5, v5, v9
    v_lshlrev_b32 v8, 16, v67
    v_and_b32 v9, 0xffff0000, v67
    v_add_f32 v6, v6, v8
    v_add_f32 v7, v7, v9
    s_waitcnt vmcnt(18)
    v_lshlrev_b32 v8, 16, v68
    v_and_b32 v9, 0xffff0000, v68
    v_add_f32 v0, v0, v8
    v_add_f32 v1, v1, v9
    v_lshlrev_b32 v8, 16, v69
    v_and_b32 v9, 0xffff0000, v69
    v_add_f32 v2, v2, v8
    v_add_f32 v3, v3, v9
    v_lshlrev_b32 v8, 16, v70
    v_and_b32 v9, 0xffff0000, v70
    v_add_f32 v4, v4, v8
    v_add_f32 v5, v5, v9
    v_lshlrev_b32 v8, 16, v71
    v_and_b32 v9, 0xffff0000, v71
    v_add_f32 v6, v6, v8
    v_add_f32 v7, v7, v9
    s_waitcnt vmcnt(17)
    v_lshlrev_b32 v8, 16, v72
    v_and_b32 v9, 0xffff0000, v72
    v_add_f32 v0, v0, v8
    v_add_f32 v1, v1, v9
    v_lshlrev_b32 v8, 16, v73
    v_and_b32 v9, 0xffff0000, v73
    v_add_f32 v2, v2, v8
    v_add_f32 v3, v3, v9
    v_lshlrev_b32 v8, 16, v74
    v_and_b32 v9, 0xffff0000, v74
    v_add_f32 v4, v4, v8
    v_add_f32 v5, v5, v9
    v_lshlrev_b32 v8, 16, v75
    v_and_b32 v9, 0xffff0000, v75
    v_add_f32 v6, v6, v8
    v_add_f32 v7, v7, v9
    s_waitcnt vmcnt(16)
    v_lshlrev_b32 v8, 16, v76
    v_and_b32 v9, 0xffff0000, v76
    v_add_f32 v0, v0, v8
    v_add_f32 v1, v1, v9
    v_lshlrev_b32 v8, 16, v77
    v_and_b32 v9, 0xffff0000, v77
    v_add_f32 v2, v2, v8
    v_add_f32 v3, v3, v9
    v_lshlrev_b32 v8, 16, v78
    v_and_b32 v9, 0xffff0000, v78
    v_add_f32 v4, v4, v8
    v_add_f32 v5, v5, v9
    v_lshlrev_b32 v8, 16, v79
    v_and_b32 v9, 0xffff0000, v79
    v_add_f32 v6, v6, v8
    v_add_f32 v7, v7, v9
    v_cvt_pk_bf16_f32 v12, v0, v1
    v_cvt_pk_bf16_f32 v13, v2, v3
    v_cvt_pk_bf16_f32 v14, v4, v5
    v_cvt_pk_bf16_f32 v15, v6, v7
    s_nop 1
    v_permlane32_swap_b32 v12, v14
    v_permlane32_swap_b32 v13, v15
    s_nop 1
    v_permlane16_swap_b32 v12, v14
    v_permlane16_swap_b32 v13, v15
    buffer_store_dwordx4 v[12:15], v249, s[20:23], s55 offen sc1
    s_waitcnt vmcnt(13)
    v_mov_b32 v16, v80
    v_mov_b32 v17, v81
    v_mov_b32 v18, v82
    v_mov_b32 v19, v83
    v_mov_b32 v20, v84
    v_mov_b32 v21, v85
    v_mov_b32 v22, v86
    v_mov_b32 v23, v87
    v_mov_b32 v24, v88
    v_mov_b32 v25, v89
    v_mov_b32 v26, v90
    v_mov_b32 v27, v91
    v_mov_b32 v28, v92
    v_mov_b32 v29, v93
    v_mov_b32 v30, v94
    v_mov_b32 v31, v95
    s_waitcnt vmcnt(9)
    v_mov_b32 v32, v96
    v_mov_b32 v33, v97
    v_mov_b32 v34, v98
    v_mov_b32 v35, v99
    v_mov_b32 v36, v100
    v_mov_b32 v37, v101
    v_mov_b32 v38, v102
    v_mov_b32 v39, v103
    v_mov_b32 v40, v104
    v_mov_b32 v41, v105
    v_mov_b32 v42, v106
    v_mov_b32 v43, v107
    v_mov_b32 v44, v108
    v_mov_b32 v45, v109
    v_mov_b32 v46, v110
    v_mov_b32 v47, v111
    s_waitcnt vmcnt(5)
    v_mov_b32 v48, v112
    v_mov_b32 v49, v113
    v_mov_b32 v50, v114
    v_mov_b32 v51, v115
    v_mov_b32 v52, v116
    v_mov_b32 v53, v117
    v_mov_b32 v54, v118
    v_mov_b32 v55, v119
    v_mov_b32 v56, v120
    v_mov_b32 v57, v121
    v_mov_b32 v58, v122
    v_mov_b32 v59, v123
    v_mov_b32 v60, v124
    v_mov_b32 v61, v125
    v_mov_b32 v62, v126
    v_mov_b32 v63, v127
    s_waitcnt vmcnt(1)
    v_mov_b32 v64, v128
    v_mov_b32 v65, v129
    v_mov_b32 v66, v130
    v_mov_b32 v67, v131
    v_mov_b32 v68, v132
    v_mov_b32 v69, v133
    v_mov_b32 v70, v134
    v_mov_b32 v71, v135
    v_mov_b32 v72, v136
    v_mov_b32 v73, v137
    v_mov_b32 v74, v138
    v_mov_b32 v75, v139
    v_mov_b32 v76, v140
    v_mov_b32 v77, v141
    v_mov_b32 v78, v142
    v_mov_b32 v79, v143
    s_mov_b32 s55, s51
L_one:
    s_waitcnt vmcnt(15)
    v_lshlrev_b32 v0, 16, v16
    v_and_b32 v1, 0xffff0000, v16
    v_lshlrev_b32 v2, 16, v17
    v_and_b32 v3, 0xffff0000, v17
    v_lshlrev_b32 v4, 16, v18
    v_and_b32 v5, 0xffff0000, v18
    v_lshlrev_b32 v6, 16, v19
    v_and_b32 v7, 0xffff0000, v19
    s_waitcnt vmcnt(14)
    v_lshlrev_b32 v8, 16, v20
    v_and_b32 v9, 0xffff0000, v20
    v_add_f32 v0, v0, v8
    v_add_f32 v1, v1, v9
    v_lshlrev_b32 v8, 16, v21
    v_and_b32 v9, 0xffff0000, v21
    v_add_f32 v2, v2, v8
    v_add_f32 v3, v3, v9
    v_lshlrev_b32 v8, 16, v22
    v_and_b32 v9, 0xffff0000, v22
    v_add_f32 v4, v4, v8
    v_add_f32 v5, v5, v9
    v_lshlrev_b32 v8, 16, v23
    v_and_b32 v9, 0xffff0000, v23
    v_add_f32 v6, v6, v8
    v_add_f32 v7, v7, v9
    s_waitcnt vmcnt(13)
    v_lshlrev_b32 v8, 16, v24
    v_and_b32 v9, 0xffff0000, v24
    v_add_f32 v0, v0, v8
    v_add_f32 v1, v1, v9
    v_lshlrev_b32 v8, 16, v25
    v_and_b32 v9, 0xffff0000, v25
    v_add_f32 v2, v2, v8
    v_add_f32 v3, v3, v9
    v_lshlrev_b32 v8, 16, v26
    v_and_b32 v9, 0xffff0000, v26
    v_add_f32 v4, v4, v8
    v_add_f32 v5, v5, v9
    v_lshlrev_b32 v8, 16, v27
    v_and_b32 v9, 0xffff0000, v27
    v_add_f32 v6, v6, v8
    v_add_f32 v7, v7, v9
    s_waitcnt vmcnt(12)
    v_lshlrev_b32 v8, 16, v28
    v_and_b32 v9, 0xffff0000, v28
    v_add_f32 v0, v0, v8
    v_add_f32 v1, v1, v9
    v_lshlrev_b32 v8, 16, v29
    v_and_b32 v9, 0xffff0000, v29
    v_add_f32 v2, v2, v8
    v_add_f32 v3, v3, v9
    v_lshlrev_b32 v8, 16, v30
    v_and_b32 v9, 0xffff0000, v30
    v_add_f32 v4, v4, v8
    v_add_f32 v5, v5, v9
    v_lshlrev_b32 v8, 16, v31
    v_and_b32 v9, 0xffff0000, v31
    v_add_f32 v6, v6, v8
    v_add_f32 v7, v7, v9
    s_waitcnt vmcnt(11)
    v_lshlrev_b32 v8, 16, v32
    v_and_b32 v9, 0xffff0000, v32
    v_add_f32 v0, v0, v8
    v_add_f32 v1, v1, v9
    v_lshlrev_b32 v8, 16, v33
    v_and_b32 v9, 0xffff0000, v33
    v_add_f32 v2, v2, v8
    v_add_f32 v3, v3, v9
    v_lshlrev_b32 v8, 16, v34
    v_and_b32 v9, 0xffff0000, v34
    v_add_f32 v4, v4, v8
    v_add_f32 v5, v5, v9
    v_lshlrev_b32 v8, 16, v35
    v_and_b32 v9, 0xffff0000, v35
    v_add_f32 v6, v6, v8
    v_add_f32 v7, v7, v9
    s_waitcnt vmcnt(10)
    v_lshlrev_b32 v8, 16, v36
    v_and_b32 v9, 0xffff0000, v36
    v_add_f32 v0, v0, v8
    v_add_f32 v1, v1, v9
    v_lshlrev_b32 v8, 16, v37
    v_and_b32 v9, 0xffff0000, v37
    v_add_f32 v2, v2, v8
    v_add_f32 v3, v3, v9
    v_lshlrev_b32 v8, 16, v38
    v_and_b32 v9, 0xffff0000, v38
    v_add_f32 v4, v4, v8
    v_add_f32 v5, v5, v9
    v_lshlrev_b32 v8, 16, v39
    v_and_b32 v9, 0xffff0000, v39
    v_add_f32 v6, v6, v8
    v_add_f32 v7, v7, v9
    s_waitcnt vmcnt(9)
    v_lshlrev_b32 v8, 16, v40
    v_and_b32 v9, 0xffff0000, v40
    v_add_f32 v0, v0, v8
    v_add_f32 v1, v1, v9
    v_lshlrev_b32 v8, 16, v41
    v_and_b32 v9, 0xffff0000, v41
    v_add_f32 v2, v2, v8
    v_add_f32 v3, v3, v9
    v_lshlrev_b32 v8, 16, v42
    v_and_b32 v9, 0xffff0000, v42
    v_add_f32 v4, v4, v8
    v_add_f32 v5, v5, v9
    v_lshlrev_b32 v8, 16, v43
    v_and_b32 v9, 0xffff0000, v43
    v_add_f32 v6, v6, v8
    v_add_f32 v7, v7, v9
    s_waitcnt vmcnt(8)
    v_lshlrev_b32 v8, 16, v44
    v_and_b32 v9, 0xffff0000, v44
    v_add_f32 v0, v0, v8
    v_add_f32 v1, v1, v9
    v_lshlrev_b32 v8, 16, v45
    v_and_b32 v9, 0xffff0000, v45
    v_add_f32 v2, v2, v8
    v_add_f32 v3, v3, v9
    v_lshlrev_b32 v8, 16, v46
    v_and_b32 v9, 0xffff0000, v46
    v_add_f32 v4, v4, v8
    v_add_f32 v5, v5, v9
    v_lshlrev_b32 v8, 16, v47
    v_and_b32 v9, 0xffff0000, v47
    v_add_f32 v6, v6, v8
    v_add_f32 v7, v7, v9
    s_waitcnt vmcnt(7)
    v_lshlrev_b32 v8, 16, v48
    v_and_b32 v9, 0xffff0000, v48
    v_add_f32 v0, v0, v8
    v_add_f32 v1, v1, v9
    v_lshlrev_b32 v8, 16, v49
    v_and_b32 v9, 0xffff0000, v49
    v_add_f32 v2, v2, v8
    v_add_f32 v3, v3, v9
    v_lshlrev_b32 v8, 16, v50
    v_and_b32 v9, 0xffff0000, v50
    v_add_f32 v4, v4, v8
    v_add_f32 v5, v5, v9
    v_lshlrev_b32 v8, 16, v51
    v_and_b32 v9, 0xffff0000, v51
    v_add_f32 v6, v6, v8
    v_add_f32 v7, v7, v9
    s_waitcnt vmcnt(6)
    v_lshlrev_b32 v8, 16, v52
    v_and_b32 v9, 0xffff0000, v52
    v_add_f32 v0, v0, v8
    v_add_f32 v1, v1, v9
    v_lshlrev_b32 v8, 16, v53
    v_and_b32 v9, 0xffff0000, v53
    v_add_f32 v2, v2, v8
    v_add_f32 v3, v3, v9
    v_lshlrev_b32 v8, 16, v54
    v_and_b32 v9, 0xffff0000, v54
    v_add_f32 v4, v4, v8
    v_add_f32 v5, v5, v9
    v_lshlrev_b32 v8, 16, v55
    v_and_b32 v9, 0xffff0000, v55
    v_add_f32 v6, v6, v8
    v_add_f32 v7, v7, v9
    s_waitcnt vmcnt(5)
    v_lshlrev_b32 v8, 16, v56
    v_and_b32 v9, 0xffff0000, v56
    v_add_f32 v0, v0, v8
    v_add_f32 v1, v1, v9
    v_lshlrev_b32 v8, 16, v57
    v_and_b32 v9, 0xffff0000, v57
    v_add_f32 v2, v2, v8
    v_add_f32 v3, v3, v9
    v_lshlrev_b32 v8, 16, v58
    v_and_b32 v9, 0xffff0000, v58
    v_add_f32 v4, v4, v8
    v_add_f32 v5, v5, v9
    v_lshlrev_b32 v8, 16, v59
    v_and_b32 v9, 0xffff0000, v59
    v_add_f32 v6, v6, v8
    v_add_f32 v7, v7, v9
    s_waitcnt vmcnt(4)
    v_lshlrev_b32 v8, 16, v60
    v_and_b32 v9, 0xffff0000, v60
    v_add_f32 v0, v0, v8
    v_add_f32 v1, v1, v9
    v_lshlrev_b32 v8, 16, v61
    v_and_b32 v9, 0xffff0000, v61
    v_add_f32 v2, v2, v8
    v_add_f32 v3, v3, v9
    v_lshlrev_b32 v8, 16, v62
    v_and_b32 v9, 0xffff0000, v62
    v_add_f32 v4, v4, v8
    v_add_f32 v5, v5, v9
    v_lshlrev_b32 v8, 16, v63
    v_and_b32 v9, 0xffff0000, v63
    v_add_f32 v6, v6, v8
    v_add_f32 v7, v7, v9
    s_waitcnt vmcnt(3)
    v_lshlrev_b32 v8, 16, v64
    v_and_b32 v9, 0xffff0000, v64
    v_add_f32 v0, v0, v8
    v_add_f32 v1, v1, v9
    v_lshlrev_b32 v8, 16, v65
    v_and_b32 v9, 0xffff0000, v65
    v_add_f32 v2, v2, v8
    v_add_f32 v3, v3, v9
    v_lshlrev_b32 v8, 16, v66
    v_and_b32 v9, 0xffff0000, v66
    v_add_f32 v4, v4, v8
    v_add_f32 v5, v5, v9
    v_lshlrev_b32 v8, 16, v67
    v_and_b32 v9, 0xffff0000, v67
    v_add_f32 v6, v6, v8
    v_add_f32 v7, v7, v9
    s_waitcnt vmcnt(2)
    v_lshlrev_b32 v8, 16, v68
    v_and_b32 v9, 0xffff0000, v68
    v_add_f32 v0, v0, v8
    v_add_f32 v1, v1, v9
    v_lshlrev_b32 v8, 16, v69
    v_and_b32 v9, 0xffff0000, v69
    v_add_f32 v2, v2, v8
    v_add_f32 v3, v3, v9
    v_lshlrev_b32 v8, 16, v70
    v_and_b32 v9, 0xffff0000, v70
    v_add_f32 v4, v4, v8
    v_add_f32 v5, v5, v9
    v_lshlrev_b32 v8, 16, v71
    v_and_b32 v9, 0xffff0000, v71
    v_add_f32 v6, v6, v8
    v_add_f32 v7, v7, v9
    s_waitcnt vmcnt(1)
    v_lshlrev_b32 v8, 16, v72
    v_and_b32 v9, 0xffff0000, v72
    v_add_f32 v0, v0, v8
    v_add_f32 v1, v1, v9
    v_lshlrev_b32 v8, 16, v73
    v_and_b32 v9, 0xffff0000, v73
    v_add_f32 v2, v2, v8
    v_add_f32 v3, v3, v9
    v_lshlrev_b32 v8, 16, v74
    v_and_b32 v9, 0xffff0000, v74
    v_add_f32 v4, v4, v8
    v_add_f32 v5, v5, v9
    v_lshlrev_b32 v8, 16, v75
    v_and_b32 v9, 0xffff0000, v75
    v_add_f32 v6, v6, v8
    v_add_f32 v7, v7, v9
    s_waitcnt vmcnt(0)
    v_lshlrev_b32 v8, 16, v76
    v_and_b32 v9, 0xffff0000, v76
    v_add_f32 v0, v0, v8
    v_add_f32 v1, v1, v9
    v_lshlrev_b32 v8, 16, v77
    v_and_b32 v9, 0xffff0000, v77
    v_add_f32 v2, v2, v8
    v_add_f32 v3, v3, v9
    v_lshlrev_b32 v8, 16, v78
    v_and_b32 v9, 0xffff0000, v78
    v_add_f32 v4, v4, v8
    v_add_f32 v5, v5, v9
    v_lshlrev_b32 v8, 16, v79
    v_and_b32 v9, 0xffff0000, v79
    v_add_f32 v6, v6, v8
    v_add_f32 v7, v7, v9
    v_cvt_pk_bf16_f32 v12, v0, v1
    v_cvt_pk_bf16_f32 v13, v2, v3
    v_cvt_pk_bf16_f32 v14, v4, v5
    v_cvt_pk_bf16_f32 v15, v6, v7
    s_nop 1
    v_permlane32_swap_b32 v12, v14
    v_permlane32_swap_b32 v13, v15
    s_nop 1
    v_permlane16_swap_b32 v12, v14
    v_permlane16_swap_b32 v13, v15
    buffer_store_dwordx4 v[12:15], v249, s[20:23], s55 offen sc1
    s_branch L_next
L_done:
    s_cmp_lg_u32 s53, 0
    s_cbranch_scc1 L_out
    s_mov_b32 s53, 1
    s_cmp_lg_u32 s40, 7
    s_cbranch_scc1 L_f3
L_bk:
    ds_read_b32 v0, v247
    s_waitcnt lgkmcnt(0)
    v_readfirstlane_b32 s68, v0
    s_cmp_lt_u32 s68, 4
    s_cbranch_scc1 L_bk
    v_mov_b32 v10, 1
    s_mov_b64 exec, 1
    buffer_atomic_add v10, v250, s[16:19], s62 offen sc0
    s_mov_b64 exec, -1
    s_waitcnt vmcnt(0)
    v_readfirstlane_b32 s68, v10
    s_and_b32 s69, s68, 0xffff
    s_lshr_b32 s68, s68, 16
    s_cmp_eq_u32 s69, 15
    s_cselect_b32 s68, s68, 0
    v_mov_b32 v0, s68
    ds_write_b32 v247, v0 offset:4
L_f3:
    s_waitcnt lgkmcnt(0)
    s_barrier
    ds_read2_b32 v[0:1], v247 offset0:1 offset1:2
    s_waitcnt lgkmcnt(0)
    v_readfirstlane_b32 s58, v0
    v_readfirstlane_b32 s68, v1
    s_cmp_eq_u32 s68, 0
    s_cbranch_scc1 L_next
    s_cmp_lg_u32 s40, 0
    s_cbranch_scc1 L_f4
    s_lshl_b32 s67, 0x10000, s44
    s_mov_b64 exec, 1
    v_mov_b32 v0, s67
    buffer_atomic_or v0, v250, s[16:19], s62 offen sc0
    s_waitcnt vmcnt(0)
    ds_write_b32 v247, v0 offset:12
    s_mov_b64 exec, -1
    s_waitcnt lgkmcnt(0)
L_f4:
    s_barrier
    ds_read_b32 v0, v247 offset:12
    s_waitcnt lgkmcnt(0)
    v_readfirstlane_b32 s68, v0
    s_and_b32 s68, s68, 0xffff
    s_lshl_b32 s67, 1, s44
    s_cmp_eq_u32 s68, 16
    s_cselect_b32 s67, s67, 0
    s_or_b32 s58, s58, s67
    s_branch L_next
L_out:
L_end:
    s_endpgm
.set CODE_LAST, L_end-L_pc
.set CODE_SHARE, ((L_end-L_pc)/32/128+1)*128
.section .rodata,"a"
.p2align 6
.amdhsa_kernel standalone__mha_block_cached__near_ridge_kernel
  .amdhsa_next_free_vgpr 256
  .amdhsa_next_free_sgpr 80
  .amdhsa_accum_offset 256
  .amdhsa_group_segment_fixed_size 0
  .amdhsa_kernarg_size 64
  .amdhsa_user_sgpr_count 2
  .amdhsa_user_sgpr_kernarg_segment_ptr 1
  .amdhsa_system_sgpr_workgroup_id_x 1
.end_amdhsa_kernel
```
